```python
import torch

def _softmax(x, axis=-1):
    return torch.softmax(x, dim=axis)
def _gelu(x):
    return torch.nn.functional.gelu(x, approximate="tanh")
def _silu(x):
    return torch.nn.functional.silu(x)
def _sigmoid(x):
    return torch.sigmoid(x)
def _layernorm(x, axis=-1, eps=1e-5):
    m = x.mean(dim=axis, keepdim=True)
    v = x.var(dim=axis, keepdim=True, unbiased=False)
    return (x - m) / torch.sqrt(v + eps)
def _scatter_add(tgt, idx, src, axis=0):
    return tgt.clone().index_add_(axis, idx, src)
def _segment_sum(src, seg, n):
    out = torch.zeros((n,) + src.shape[1:], dtype=src.dtype)
    return out.index_add_(0, seg, src)
def _pad(x, pw):
    flat = tuple(v for pair in reversed(pw) for v in pair)
    return torch.nn.functional.pad(x, flat)

kernel_name = 'standalone__mha_softmax__near_ridge'

def setup_inputs():

    _w = (lambda a: (lambda t: t.to(torch.bfloat16) if t.is_floating_point() else t)(torch.as_tensor(a)))
    B, H, Sq, Sk, D = 8, 32, 608, 1024, 128
    return {
        "q": _w((lambda *s: torch.randn(*s, dtype=torch.bfloat16) * 0.8)(B, H, Sq, D)),
        "k": _w((lambda *s: torch.randn(*s, dtype=torch.bfloat16) * 0.8)(B, H, Sk, D)),
        "v": _w((lambda *s: torch.randn(*s, dtype=torch.bfloat16) * 0.05)(B, H, Sk, D)),
    }

def reference(q, k, v):
    scale = q.shape[-1] ** -0.5
    scores = torch.einsum("bhqd,bhkd->bhqk", q, k) * scale
    p = _softmax(scores, axis=-1)
    return torch.einsum("bhqk,bhkd->bhqd", p, v)
```

```asm
; @launch grid=(256,1,1) block=(256,1,1) lds=163840
.amdgcn_target "amdgcn-amd-amdhsa--gfx950"
.macro qa d,a,b,c
v_mfma_f32_16x16x32_bf16 v[\d:\d+3], a[\a:\a+3], v[\b:\b+3], v[\c:\c+3]
.endm
.macro qb d,a,b,c
v_mfma_f32_16x16x32_bf16 v[\d:\d+3], a[\a:\a+3], a[\b:\b+3], v[\c:\c+3]
.endm
.macro pv d,a,b
v_mfma_f32_16x16x32_bf16 a[\d:\d+3], a[\a:\a+3], v[\b:\b+3], a[\d:\d+3]
.endm
.macro pw d,a,b
v_mfma_f32_16x16x32_bf16 v[\d:\d+3], a[\a:\a+3], v[\b:\b+3], v[\d:\d+3]
.endm
.macro pa d,a,b
v_mfma_f32_16x16x32_bf16 a[\d:\d+3], v[\a:\a+3], a[\b:\b+3], a[\d:\d+3]
.endm
.macro pb d,a,b
v_mfma_f32_16x16x32_bf16 v[\d:\d+3], v[\a:\a+3], a[\b:\b+3], v[\d:\d+3]
.endm
.macro ex r
v_exp_f32 v\r, v\r
.endm
.macro cv d,a,b
v_cvt_pk_bf16_f32 v\d, v\a, v\b
.endm
.macro lk d,a,o
ds_read_b128 a[\d:\d+3], v\a offset:\o
.endm
.macro lv d,a,o
ds_read_b64_tr_b16 a[\d:\d+1], v\a offset:\o
.endm
.text
.globl standalone__mha_softmax__near_ridge_kernel
.p2align 8
.type standalone__mha_softmax__near_ridge_kernel,@function
standalone__mha_softmax__near_ridge_kernel:
    s_cmp_lt_u32 s2, 256
s_cbranch_scc1 Lgo
s_endpgm
Lgo:
s_load_dwordx4 s[8:11], s[0:1], 0
s_load_dwordx4 s[12:15], s[0:1], 16
v_lshrrev_b32 v1, 6, v0
v_and_b32 v16, 63, v0
v_and_b32 v17, 15, v0
v_readfirstlane_b32 s3, v1
v_lshrrev_b32 v18, 4, v16
s_getpc_b64 s[36:37]
Lpf:
s_lshr_b32 s34, s2, 4
s_lshl_b32 s34, s34, 13
s_bitcmp1_b32 s2, 3
s_cselect_b32 s35, LroleY-Lpf, 0
s_add_u32 s34, s34, s35
v_lshl_add_u32 v19, v0, 5, s34
v_min_u32 v19, Lcodeend-Lpf, v19
v_mov_b32 v25, s37
v_add_co_u32 v24, vcc, s36, v19
s_nop 1
v_addc_co_u32 v25, vcc, 0, v25, vcc
global_load_dword v253, v[24:25], off
v_xor_b32 v19, v18, v17
v_lshlrev_b32 v19, 4, v19
v_lshl_add_u32 v12, v18, 8, v19
v_xor_b32 v13, 128, v12
v_and_b32 v19, 31, v16
v_lshlrev_b32 v19, 4, v19
v_lshrrev_b32 v20, 5, v16
v_lshl_add_u32 v22, v20, 18, v19
s_lshl_b32 s21, s3, 12
s_mov_b32 s20, s21
s_mov_b32 s43, s21
s_mul_i32 s28, s3, 20480
s_add_u32 s29, s28, 16384
s_lshl_b32 s30, s3, 14
s_add_u32 s30, s30, 81920
s_and_b32 s31, s21, 0x2000
s_lshr_b32 s31, s31, 1
s_add_u32 s31, s31, 147456
s_bitcmp1_b32 s2, 3
s_cselect_b64 s[24:25], s[30:31], s[28:29]
s_cselect_b64 s[26:27], s[28:29], s[30:31]
s_and_b32 s34, s2, 7
s_lshr_b32 s35, s2, 4
s_lshl_b32 s34, s34, 4
s_add_u32 s34, s34, s35
s_mul_i32 s35, s34, 311296
s_lshl_b32 s34, s34, 19
s_mov_b32 s6, 311296
s_mov_b32 s7, 0x00020000
s_waitcnt lgkmcnt(0)
s_add_u32 s4, s8, s35
s_addc_u32 s5, s9, 0
s_add_u32 s8, s10, s34
s_addc_u32 s9, s11, 0
s_mov_b32 s10, 524288
s_mov_b32 s11, 0x00020000
s_add_u32 s16, s14, s35
s_addc_u32 s17, s15, 0
s_mov_b32 s18, 311296
s_mov_b32 s19, 0x00020000
s_add_u32 s12, s12, s34
s_addc_u32 s13, s13, 0
s_mov_b32 s14, 524288
s_mov_b32 s15, 0x00020000
buffer_load_dwordx4 v[24:27], v22, s[12:15], 0 offen offset:0 nt
buffer_load_dwordx4 v[28:31], v22, s[12:15], 0 offen offset:512 nt
s_add_u32 m0, s21, 32768
s_nop 0
buffer_load_dwordx4 v12, s[8:11], s20 offen offset:0 nt lds
buffer_load_dwordx4 v13, s[8:11], s20 offen offset:1024 nt lds
buffer_load_dwordx4 v12, s[8:11], s20 offen offset:2048 nt lds
buffer_load_dwordx4 v13, s[8:11], s20 offen offset:3072 nt lds
s_add_u32 s20, s20, 16384
s_add_u32 m0, s21, 49152
s_nop 0
buffer_load_dwordx4 v12, s[8:11], s20 offen offset:0 nt lds
buffer_load_dwordx4 v13, s[8:11], s20 offen offset:1024 nt lds
buffer_load_dwordx4 v12, s[8:11], s20 offen offset:2048 nt lds
buffer_load_dwordx4 v13, s[8:11], s20 offen offset:3072 nt lds
s_add_u32 s37, s24, 0
s_add_u32 m0, s21, 65536
s_nop 0
buffer_load_dwordx4 v12, s[4:7], s37 offen offset:0 nt lds
buffer_load_dwordx4 v13, s[4:7], s37 offen offset:1024 nt lds
buffer_load_dwordx4 v12, s[4:7], s37 offen offset:2048 nt lds
buffer_load_dwordx4 v13, s[4:7], s37 offen offset:3072 nt lds
s_mov_b64 s[96:97], s[8:9]
s_mov_b64 s[98:99], s[12:13]
v_mov_b32 v122, 0
s_add_u32 s26, s26, 155648
s_add_u32 s27, s27, 155648
s_add_u32 s33, s21, 16384
v_and_b32 v19, 1, v18
v_lshlrev_b32 v19, 6, v19
v_lshrrev_b32 v20, 1, v18
v_lshl_add_u32 v19, v20, 4, v19
v_lshl_add_u32 v15, v17, 8, v19
v_and_b32 v19, 3, v17
v_and_b32 v20, 4, v17
v_lshl_add_u32 v19, v20, 1, v19
v_lshlrev_b32 v19, 4, v19
v_xor_b32 v19, v19, v15
v_xor_b32 v20, 0, v19
v_add_u32 v0, 32768, v20
v_add_u32 v236, s33, v20
v_add_u32 v240, 65536, v236
v_xor_b32 v20, 32, v19
v_add_u32 v1, 32768, v20
v_add_u32 v237, s33, v20
v_add_u32 v241, 65536, v237
v_xor_b32 v20, 128, v19
v_add_u32 v2, 32768, v20
v_add_u32 v238, s33, v20
v_add_u32 v242, 65536, v238
v_xor_b32 v20, 160, v19
v_add_u32 v3, 32768, v20
v_add_u32 v239, s33, v20
v_add_u32 v243, 65536, v239
v_lshrrev_b32 v19, 2, v16
v_and_b32 v20, 3, v19
v_and_b32 v21, 4, v19
v_lshl_add_u32 v20, v21, 1, v20
v_and_b32 v21, 2, v16
v_lshl_add_u32 v20, v21, 1, v20
v_lshlrev_b32 v20, 4, v20
v_and_b32 v21, 1, v16
v_lshl_add_u32 v20, v21, 3, v20
v_lshl_add_u32 v20, v19, 8, v20
v_add_u32 v4, 98304, v20
v_xor_b32 v5, 16, v4
v_xor_b32 v6, 32, v4
v_xor_b32 v7, 48, v4
v_xor_b32 v8, 128, v4
v_xor_b32 v9, 144, v4
v_xor_b32 v10, 160, v4
v_xor_b32 v11, 176, v4
s_lshl_b32 s34, s3, 8
s_add_u32 s34, s34, 1024
v_lshl_add_u32 v254, v16, 2, s34
v_mov_b32 v255, 0
ds_write_b32 v254, v255 offset:0
v_accvgpr_write_b32 a160, 0
v_accvgpr_write_b32 a161, 0
v_accvgpr_write_b32 a162, 0
v_accvgpr_write_b32 a163, 0
v_accvgpr_write_b32 a164, 0
v_accvgpr_write_b32 a165, 0
v_accvgpr_write_b32 a166, 0
v_accvgpr_write_b32 a167, 0
v_accvgpr_write_b32 a168, 0
v_accvgpr_write_b32 a169, 0
v_accvgpr_write_b32 a170, 0
v_accvgpr_write_b32 a171, 0
v_mov_b32 v19, 13107
v_bfe_i32 v19, v19, v17, 1
v_mov_b32 v20, 52428
v_bfe_i32 v20, v20, v17, 1
v_mov_b32 v21, 43690
v_bfe_i32 v21, v21, v17, 1
v_and_b32 v19, 0x3f803f80, v19
v_and_b32 v20, 0x3f803f80, v20
v_and_b32 v21, 0xaaaaaaaa, v21
v_or_b32 v14, 0x44444444, v21
v_accvgpr_write_b32 a172, v19
v_accvgpr_write_b32 a173, v19
v_accvgpr_write_b32 a174, v19
v_accvgpr_write_b32 a175, v19
v_accvgpr_write_b32 a176, v20
v_accvgpr_write_b32 a177, v20
v_accvgpr_write_b32 a178, v20
v_accvgpr_write_b32 a179, v20
s_mov_b32 s22, 0x3e0293ee
s_mov_b32 s23, 0x3e0293ee
s_mov_b32 s28, 0xffff0000
s_mov_b32 s29, 0x53800000
s_mov_b64 s[30:31], 0
s_mov_b64 s[32:33], 0
s_and_b32 s3, s3, 1
s_lshl_b32 s34, s3, 13
s_lshl_b32 s3, s3, 7
s_or_b32 s35, s34, s3
s_waitcnt vmcnt(12)
v_max_f32_e64 v32, |v24|, |v28|
v_max_f32_e64 v33, |v25|, |v29|
v_max_f32_e64 v34, |v26|, |v30|
v_max_f32_e64 v35, |v27|, |v31|
v_lshlrev_b32 v24, 16, v24
v_lshlrev_b32 v25, 16, v25
v_lshlrev_b32 v26, 16, v26
v_lshlrev_b32 v27, 16, v27
v_lshlrev_b32 v28, 16, v28
v_lshlrev_b32 v29, 16, v29
v_lshlrev_b32 v30, 16, v30
v_lshlrev_b32 v31, 16, v31
v_max_f32_e64 v36, |v24|, |v28|
v_max_f32_e64 v37, |v25|, |v29|
v_max_f32_e64 v38, |v26|, |v30|
v_max_f32_e64 v39, |v27|, |v31|
v_permlane16_swap_b32 v32, v36
v_permlane16_swap_b32 v33, v37
v_permlane16_swap_b32 v34, v38
v_permlane16_swap_b32 v35, v39
v_max_f32 v32, v32, v36
v_max_f32 v33, v33, v37
v_max_f32 v34, v34, v38
v_max_f32 v35, v35, v39
v_min3_f32 v32, v32, v33, v34
v_min_f32 v32, v32, v35
s_nop 1
v_min_f32_dpp v32, v32, v32 row_ror:8 row_mask:0xf bank_mask:0xf
s_nop 1
v_min_f32_dpp v32, v32, v32 row_ror:4 row_mask:0xf bank_mask:0xf
s_nop 1
v_min_f32_dpp v32, v32, v32 row_ror:2 row_mask:0xf bank_mask:0xf
s_nop 1
v_min_f32_dpp v32, v32, v32 row_ror:1 row_mask:0xf bank_mask:0xf
v_and_b32 v32, 0x7f800000, v32
v_min_f32 v32, 0x71800000, v32
v_mul_f32 v32, 0x3e400000, v32
s_nop 0
v_readlane_b32 s40, v32, 0
v_readlane_b32 s36, v32, 16
v_readlane_b32 s41, v32, 32
v_readlane_b32 s37, v32, 48
s_nop 1
s_min_u32 s40, s40, s36
s_min_u32 s41, s41, s37
s_add_u32 s38, s24, 4096
s_add_u32 m0, s21, 114688
s_nop 0
buffer_load_dwordx4 v12, s[4:7], s38 offen offset:0 nt lds
buffer_load_dwordx4 v13, s[4:7], s38 offen offset:1024 nt lds
buffer_load_dwordx4 v12, s[4:7], s38 offen offset:2048 nt lds
buffer_load_dwordx4 v13, s[4:7], s38 offen offset:3072 nt lds
s_bitcmp1_b32 s2, 3
s_cbranch_scc1 LroleY
s_branch LroleX
.p2align 12
LroleX:
s_mov_b64 vcc, -1
s_cmp_eq_u32 s21, 0
s_cbranch_scc1 LwX0_0
s_cmp_eq_u32 s21, 4096
s_cbranch_scc1 LwX0_1
s_cmp_eq_u32 s21, 8192
s_cbranch_scc1 LwX0_2
s_branch LwX0_3
LwrX0:
s_mov_b64 vcc, 0
s_xor_b32 s2, s3, 128
s_waitcnt vmcnt(8) lgkmcnt(0)
s_add_u32 s39, s24, 8192
s_add_u32 m0, s21, 131072
s_add_u32 s36, s24, 12288
buffer_load_dwordx4 v12, s[4:7], s39 offen offset:0 nt lds
buffer_load_dwordx4 v13, s[4:7], s39 offen offset:1024 nt lds
buffer_load_dwordx4 v12, s[4:7], s39 offen offset:2048 nt lds
buffer_load_dwordx4 v13, s[4:7], s39 offen offset:3072 nt lds
s_barrier
lk 96,0,0
lk 100,1,0
lk 104,2,0
lk 108,3,0
lk 112,0,4096
lk 116,1,4096
lk 120,2,4096
lk 124,3,4096
lk 128,0,8192
lk 132,1,8192
lk 136,2,8192
lk 140,3,8192
lk 144,0,12288
lk 148,1,12288
lk 152,2,12288
s_waitcnt lgkmcnt(14)
lk 156,3,12288
s_add_u32 m0, s21, 81920
s_mov_b32 s37, s25
s_add_u32 s20, s20, 16384
s_waitcnt lgkmcnt(12)
lk 212,0,16384
lk 216,1,16384
lk 220,2,16384
s_waitcnt lgkmcnt(13)
lk 224,3,16384
lk 228,0,20480
s_waitcnt lgkmcnt(13)
lk 232,1,20480
lk 236,2,20480
s_waitcnt lgkmcnt(13)
lk 240,3,20480
lk 244,0,24576
s_waitcnt lgkmcnt(13)
lk 248,1,24576
lk 252,2,24576
s_waitcnt lgkmcnt(13)
ds_read_b128 v[216:219], v3 offset:24576
s_waitcnt vmcnt(8)
ds_read_b128 v[56:59], v236 offset:49152
s_waitcnt lgkmcnt(13)
ds_read_b128 v[60:63], v237 offset:49152
ds_read_b128 v[64:67], v238 offset:49152
s_waitcnt lgkmcnt(14)
ds_read_b128 v[68:71], v239 offset:49152
buffer_load_dwordx4 v12, s[4:7], s36 offen offset:0 nt lds
buffer_load_dwordx4 v13, s[4:7], s36 offen offset:1024 nt lds
buffer_load_dwordx4 v12, s[4:7], s36 offen offset:2048 nt lds
buffer_load_dwordx4 v13, s[4:7], s36 offen offset:3072 nt lds
s_add_u32 m0, s21, 16384
s_waitcnt lgkmcnt(9)
ds_read_b128 v[220:223], v0 offset:28672
ds_read_b128 v[224:227], v1 offset:28672
ds_read_b128 v[228:231], v2 offset:28672
ds_read_b128 v[232:235], v3 offset:28672
v_mov_b32 v255, 1
s_add_u32 s38, s26, 0
s_add_u32 s39, s26, 0
s_add_u32 s36, s26, 0
s_waitcnt lgkmcnt(7)
v_lshlrev_b32 v244, 16, v56
v_and_b32 v245, s28, v56
v_lshlrev_b32 v246, 16, v57
v_and_b32 v247, s28, v57
v_lshlrev_b32 v248, 16, v58
v_and_b32 v249, s28, v58
v_lshlrev_b32 v250, 16, v59
v_and_b32 v251, s28, v59
v_pk_mul_f32 v[244:245], v[244:245], s[22:23]
v_pk_mul_f32 v[246:247], v[246:247], s[22:23]
v_pk_mul_f32 v[248:249], v[248:249], s[22:23]
v_pk_mul_f32 v[250:251], v[250:251], s[22:23]
cv 56,244,245
cv 57,246,247
cv 58,248,249
cv 59,250,251
s_waitcnt lgkmcnt(4)
v_lshlrev_b32 v244, 16, v60
v_and_b32 v245, s28, v60
v_lshlrev_b32 v246, 16, v61
v_and_b32 v247, s28, v61
v_lshlrev_b32 v248, 16, v62
v_and_b32 v249, s28, v62
v_lshlrev_b32 v250, 16, v63
v_and_b32 v251, s28, v63
v_pk_mul_f32 v[244:245], v[244:245], s[22:23]
v_pk_mul_f32 v[246:247], v[246:247], s[22:23]
v_pk_mul_f32 v[248:249], v[248:249], s[22:23]
v_pk_mul_f32 v[250:251], v[250:251], s[22:23]
cv 60,244,245
cv 61,246,247
cv 62,248,249
cv 63,250,251
v_lshlrev_b32 v244, 16, v64
v_and_b32 v245, s28, v64
v_lshlrev_b32 v246, 16, v65
v_and_b32 v247, s28, v65
v_lshlrev_b32 v248, 16, v66
v_and_b32 v249, s28, v66
v_lshlrev_b32 v250, 16, v67
v_and_b32 v251, s28, v67
v_mfma_f32_16x16x32_bf16 v[16:19], a[96:99], v[56:59], 0
v_mul_f32 v244, s22, v244
v_mul_f32 v245, s22, v245
cv 64,244,245
v_lshlrev_b32 v244, 16, v68
v_and_b32 v245, s28, v68
v_pk_mul_f32 v[246:247], v[246:247], s[22:23]
v_pk_mul_f32 v[248:249], v[248:249], s[22:23]
v_pk_mul_f32 v[250:251], v[250:251], s[22:23]
cv 65,246,247
cv 66,248,249
cv 67,250,251
pw 16,100,60
v_lshlrev_b32 v246, 16, v69
v_and_b32 v247, s28, v69
v_lshlrev_b32 v248, 16, v70
v_and_b32 v249, s28, v70
v_lshlrev_b32 v250, 16, v71
v_and_b32 v251, s28, v71
v_pk_mul_f32 v[244:245], v[244:245], s[22:23]
v_pk_mul_f32 v[246:247], v[246:247], s[22:23]
v_pk_mul_f32 v[248:249], v[248:249], s[22:23]
v_pk_mul_f32 v[250:251], v[250:251], s[22:23]
cv 68,244,245
cv 69,246,247
pw 16,104,64
cv 70,248,249
cv 71,250,251
s_nop 1
pw 16,108,68
s_nop 7
v_max3_f32 v252, v16, v17, v18
v_max_f32 v252, v252, v19
v_add_f32 v252, 0x41200000, v252
v_mov_b32 v253, v252
s_nop 1
v_permlane16_swap_b32 v252, v253
v_max_f32 v252, v252, v253
v_mov_b32 v253, v252
s_nop 1
v_permlane32_swap_b32 v252, v253
v_min_f32 v36, -v252, -v253
v_min_f32 v37, -v252, -v253
v_min_f32 v38, -v252, -v253
v_min_f32 v39, -v252, -v253
v_add_f32 v16, v16, v36
v_add_f32 v17, v17, v36
qa 20,112,56,36
v_add_f32 v18, v18, v36
v_add_f32 v19, v19, v36
pw 20,116,60
ex 16
pw 20,120,64
ex 17
pw 20,124,68
ex 18
qa 24,128,56,36
ex 19
pw 24,132,60
cv 136,16,17
cv 137,18,19
pw 24,136,64
pw 24,140,68
ex 20
qa 28,144,56,36
ex 21
pw 28,148,60
ex 22
pw 28,152,64
ex 23
pw 28,156,68
cv 138,20,21
cv 139,22,23
qa 32,212,56,36
ex 24
pw 32,216,60
ex 25
pw 32,220,64
ex 26
pw 32,224,68
ex 27
qa 16,228,56,36
cv 140,24,25
cv 141,26,27
pw 16,232,60
ex 28
pw 16,236,64
ex 29
pw 16,240,68
ex 30
qa 20,244,56,36
ex 31
pw 20,248,60
cv 142,28,29
cv 143,30,31
pw 20,252,64
ex 32
v_mfma_f32_16x16x32_bf16 v[20:23], v[216:219], v[68:71], v[20:23]
s_waitcnt lgkmcnt(0)
ex 33
v_mfma_f32_16x16x32_bf16 v[24:27], v[220:223], v[56:59], v[36:39]
ex 34
v_mfma_f32_16x16x32_bf16 v[24:27], v[224:227], v[60:63], v[24:27]
ex 35
v_mfma_f32_16x16x32_bf16 v[24:27], v[228:231], v[64:67], v[24:27]
cv 176,32,33
cv 177,34,35
v_mfma_f32_16x16x32_bf16 v[24:27], v[232:235], v[68:71], v[24:27]
ex 16
ex 17
ex 18
ex 19
s_waitcnt vmcnt(8)
ds_read_b128 v[72:75], v240 offset:32768
ds_read_b128 v[76:79], v241 offset:32768
ds_read_b128 v[80:83], v242 offset:32768
ds_read_b128 v[84:87], v243 offset:32768
buffer_load_dwordx4 v12, s[4:7], s37 offen offset:0 nt lds
buffer_load_dwordx4 v13, s[4:7], s37 offen offset:1024 nt lds
buffer_load_dwordx4 v12, s[4:7], s37 offen offset:2048 nt lds
buffer_load_dwordx4 v13, s[4:7], s37 offen offset:3072 nt lds
s_add_u32 m0, s21, 98304
cv 178,16,17
cv 179,18,19
ex 20
ex 21
ex 22
ex 23
s_waitcnt lgkmcnt(3)
v_lshlrev_b32 v244, 16, v72
v_and_b32 v245, s28, v72
v_lshlrev_b32 v246, 16, v73
v_and_b32 v247, s28, v73
v_lshlrev_b32 v248, 16, v74
v_and_b32 v249, s28, v74
v_lshlrev_b32 v250, 16, v75
v_and_b32 v251, s28, v75
v_pk_mul_f32 v[244:245], v[244:245], s[22:23]
v_pk_mul_f32 v[246:247], v[246:247], s[22:23]
v_pk_mul_f32 v[248:249], v[248:249], s[22:23]
v_pk_mul_f32 v[250:251], v[250:251], s[22:23]
cv 72,244,245
cv 73,246,247
cv 74,248,249
cv 75,250,251
s_waitcnt lgkmcnt(0)
v_lshlrev_b32 v244, 16, v76
v_and_b32 v245, s28, v76
v_lshlrev_b32 v246, 16, v77
v_and_b32 v247, s28, v77
v_lshlrev_b32 v248, 16, v78
v_and_b32 v249, s28, v78
v_lshlrev_b32 v250, 16, v79
v_and_b32 v251, s28, v79
v_pk_mul_f32 v[244:245], v[244:245], s[22:23]
v_pk_mul_f32 v[246:247], v[246:247], s[22:23]
v_pk_mul_f32 v[248:249], v[248:249], s[22:23]
v_pk_mul_f32 v[250:251], v[250:251], s[22:23]
cv 76,244,245
cv 77,246,247
cv 78,248,249
cv 79,250,251
v_lshlrev_b32 v244, 16, v80
v_and_b32 v245, s28, v80
v_lshlrev_b32 v246, 16, v81
v_and_b32 v247, s28, v81
v_lshlrev_b32 v248, 16, v82
v_and_b32 v249, s28, v82
v_lshlrev_b32 v250, 16, v83
v_and_b32 v251, s28, v83
v_pk_mul_f32 v[244:245], v[244:245], s[22:23]
v_pk_mul_f32 v[246:247], v[246:247], s[22:23]
v_pk_mul_f32 v[248:249], v[248:249], s[22:23]
v_pk_mul_f32 v[250:251], v[250:251], s[22:23]
cv 80,244,245
cv 81,246,247
cv 82,248,249
cv 83,250,251
v_lshlrev_b32 v244, 16, v84
v_and_b32 v245, s28, v84
v_lshlrev_b32 v246, 16, v85
v_and_b32 v247, s28, v85
v_lshlrev_b32 v248, 16, v86
v_and_b32 v249, s28, v86
v_lshlrev_b32 v250, 16, v87
v_and_b32 v251, s28, v87
v_pk_mul_f32 v[244:245], v[244:245], s[22:23]
v_pk_mul_f32 v[246:247], v[246:247], s[22:23]
v_pk_mul_f32 v[248:249], v[248:249], s[22:23]
v_pk_mul_f32 v[250:251], v[250:251], s[22:23]
cv 84,244,245
cv 85,246,247
cv 86,248,249
cv 87,250,251
cv 180,20,21
cv 181,22,23
v_mfma_f32_16x16x32_bf16 v[28:31], a[108:111], v[84:87], 0
s_add_u32 s37, s26, 0
ex 24
pw 28,104,80
ex 25
pw 28,100,76
ex 26
pw 28,96,72
ex 27
cv 182,24,25
cv 183,26,27
s_nop 4
v_max3_f32 v252, v28, v29, v30
v_max_f32 v252, v252, v31
v_add_f32 v252, 0x41200000, v252
v_mov_b32 v253, v252
s_nop 1
v_permlane16_swap_b32 v252, v253
v_max_f32 v252, v252, v253
v_mov_b32 v253, v252
s_nop 1
v_permlane32_swap_b32 v252, v253
v_min_f32 v40, -v252, -v253
v_min_f32 v41, -v252, -v253
v_min_f32 v42, -v252, -v253
v_min_f32 v43, -v252, -v253
v_add_f32 v28, v28, v40
v_add_f32 v29, v29, v40
qa 32,124,84,40
v_add_f32 v30, v30, v40
v_add_f32 v31, v31, v40
pw 32,120,80
ex 28
pw 32,116,76
ex 29
pw 32,112,72
ex 30
qa 16,140,84,40
ex 31
pw 16,136,80
cv 144,28,29
cv 145,30,31
pw 16,132,76
pw 16,128,72
ex 32
qa 20,156,84,40
ex 33
pw 20,152,80
ex 34
pw 20,148,76
ex 35
pw 20,144,72
cv 146,32,33
cv 147,34,35
qa 24,224,84,40
ex 16
pw 24,220,80
ex 17
pw 24,216,76
ex 18
pw 24,212,72
ex 19
qa 28,240,84,40
cv 148,16,17
cv 149,18,19
pw 28,236,80
ex 20
pw 28,232,76
ex 21
pw 28,228,72
ex 22
v_mfma_f32_16x16x32_bf16 v[32:35], v[216:219], v[84:87], v[40:43]
ex 23
pw 32,252,80
cv 150,20,21
cv 151,22,23
pw 32,248,76
ex 24
pw 32,244,72
ex 25
v_mfma_f32_16x16x32_bf16 v[16:19], v[232:235], v[84:87], v[40:43]
ex 26
v_mfma_f32_16x16x32_bf16 v[16:19], v[228:231], v[80:83], v[16:19]
ex 27
v_mfma_f32_16x16x32_bf16 v[16:19], v[224:227], v[76:79], v[16:19]
cv 184,24,25
cv 185,26,27
v_mfma_f32_16x16x32_bf16 v[16:19], v[220:223], v[72:75], v[16:19]
ex 28
ex 29
ex 30
ex 31
s_waitcnt vmcnt(8)
ds_read_b128 v[88:91], v240 offset:49152
ds_read_b128 v[92:95], v241 offset:49152
ds_read_b128 v[96:99], v242 offset:49152
ds_read_b128 v[100:103], v243 offset:49152
buffer_load_dwordx4 v12, s[12:15], s43 offen offset:0 nt lds
buffer_load_dwordx4 v13, s[12:15], s43 offen offset:1024 nt lds
buffer_load_dwordx4 v12, s[12:15], s43 offen offset:2048 nt lds
buffer_load_dwordx4 v13, s[12:15], s43 offen offset:3072 nt lds
s_add_u32 m0, s21, 65536
s_add_u32 s43, s43, 16384
cv 186,28,29
cv 187,30,31
ex 32
ex 33
ex 34
ex 35
s_waitcnt lgkmcnt(3)
v_lshlrev_b32 v244, 16, v88
v_and_b32 v245, s28, v88
v_lshlrev_b32 v246, 16, v89
v_and_b32 v247, s28, v89
v_lshlrev_b32 v248, 16, v90
v_and_b32 v249, s28, v90
v_lshlrev_b32 v250, 16, v91
v_and_b32 v251, s28, v91
v_pk_mul_f32 v[244:245], v[244:245], s[22:23]
v_pk_mul_f32 v[246:247], v[246:247], s[22:23]
v_pk_mul_f32 v[248:249], v[248:249], s[22:23]
v_pk_mul_f32 v[250:251], v[250:251], s[22:23]
cv 88,244,245
cv 89,246,247
cv 90,248,249
cv 91,250,251
s_waitcnt lgkmcnt(0)
v_lshlrev_b32 v244, 16, v92
v_and_b32 v245, s28, v92
v_lshlrev_b32 v246, 16, v93
v_and_b32 v247, s28, v93
v_lshlrev_b32 v248, 16, v94
v_and_b32 v249, s28, v94
v_lshlrev_b32 v250, 16, v95
v_and_b32 v251, s28, v95
v_pk_mul_f32 v[244:245], v[244:245], s[22:23]
v_pk_mul_f32 v[246:247], v[246:247], s[22:23]
v_pk_mul_f32 v[248:249], v[248:249], s[22:23]
v_pk_mul_f32 v[250:251], v[250:251], s[22:23]
cv 92,244,245
cv 93,246,247
cv 94,248,249
cv 95,250,251
v_lshlrev_b32 v244, 16, v96
v_and_b32 v245, s28, v96
v_lshlrev_b32 v246, 16, v97
v_and_b32 v247, s28, v97
v_lshlrev_b32 v248, 16, v98
v_and_b32 v249, s28, v98
v_lshlrev_b32 v250, 16, v99
v_and_b32 v251, s28, v99
v_mfma_f32_16x16x32_bf16 v[20:23], a[96:99], v[88:91], 0
v_mul_f32 v244, s22, v244
v_mul_f32 v245, s22, v245
cv 96,244,245
v_lshlrev_b32 v244, 16, v100
v_and_b32 v245, s28, v100
v_pk_mul_f32 v[246:247], v[246:247], s[22:23]
v_pk_mul_f32 v[248:249], v[248:249], s[22:23]
v_pk_mul_f32 v[250:251], v[250:251], s[22:23]
cv 97,246,247
cv 98,248,249
cv 99,250,251
pw 20,100,92
v_lshlrev_b32 v246, 16, v101
v_and_b32 v247, s28, v101
v_lshlrev_b32 v248, 16, v102
v_and_b32 v249, s28, v102
v_lshlrev_b32 v250, 16, v103
v_and_b32 v251, s28, v103
v_pk_mul_f32 v[244:245], v[244:245], s[22:23]
v_pk_mul_f32 v[246:247], v[246:247], s[22:23]
v_pk_mul_f32 v[248:249], v[248:249], s[22:23]
v_pk_mul_f32 v[250:251], v[250:251], s[22:23]
cv 100,244,245
cv 101,246,247
pw 20,104,96
cv 102,248,249
cv 103,250,251
cv 188,32,33
cv 189,34,35
pw 20,108,100
ex 16
ex 17
ex 18
ex 19
cv 190,16,17
cv 191,18,19
s_nop 1
v_max3_f32 v252, v20, v21, v22
v_max_f32 v252, v252, v23
v_add_f32 v252, 0x41200000, v252
v_mov_b32 v253, v252
s_nop 1
v_permlane16_swap_b32 v252, v253
v_max_f32 v252, v252, v253
v_mov_b32 v253, v252
s_nop 1
v_permlane32_swap_b32 v252, v253
v_min_f32 v44, -v252, -v253
v_min_f32 v45, -v252, -v253
v_min_f32 v46, -v252, -v253
v_min_f32 v47, -v252, -v253
v_add_f32 v20, v20, v44
v_add_f32 v21, v21, v44
qa 24,112,88,44
v_add_f32 v22, v22, v44
v_add_f32 v23, v23, v44
pw 24,116,92
ex 20
pw 24,120,96
ex 21
pw 24,124,100
ex 22
qa 28,128,88,44
ex 23
pw 28,132,92
cv 152,20,21
cv 153,22,23
pw 28,136,96
pw 28,140,100
ex 24
qa 32,144,88,44
ex 25
pw 32,148,92
ex 26
pw 32,152,96
ex 27
pw 32,156,100
cv 154,24,25
cv 155,26,27
qa 16,212,88,44
ex 28
pw 16,216,92
ex 29
pw 16,220,96
ex 30
pw 16,224,100
ex 31
qa 20,228,88,44
cv 156,28,29
cv 157,30,31
pw 20,232,92
ex 32
pw 20,236,96
ex 33
pw 20,240,100
ex 34
qa 24,244,88,44
ex 35
pw 24,248,92
cv 158,32,33
cv 159,34,35
pw 24,252,96
ex 16
v_mfma_f32_16x16x32_bf16 v[24:27], v[216:219], v[100:103], v[24:27]
ex 17
v_mfma_f32_16x16x32_bf16 v[28:31], v[220:223], v[88:91], v[44:47]
ex 18
v_mfma_f32_16x16x32_bf16 v[28:31], v[224:227], v[92:95], v[28:31]
ex 19
v_mfma_f32_16x16x32_bf16 v[28:31], v[228:231], v[96:99], v[28:31]
cv 192,16,17
cv 193,18,19
v_mfma_f32_16x16x32_bf16 v[28:31], v[232:235], v[100:103], v[28:31]
ex 20
ex 21
ex 22
ex 23
s_waitcnt vmcnt(8)
ds_read_b128 v[104:107], v240 offset:0
ds_read_b128 v[108:111], v241 offset:0
ds_read_b128 v[112:115], v242 offset:0
ds_read_b128 v[116:119], v243 offset:0
buffer_load_dwordx4 v12, s[8:11], s20 offen offset:0 nt lds
buffer_load_dwordx4 v13, s[8:11], s20 offen offset:1024 nt lds
buffer_load_dwordx4 v12, s[8:11], s20 offen offset:2048 nt lds
buffer_load_dwordx4 v13, s[8:11], s20 offen offset:3072 nt lds
s_add_u32 m0, s21, 114688
cv 194,20,21
cv 195,22,23
ex 24
ex 25
ex 26
ex 27
s_waitcnt lgkmcnt(3)
v_lshlrev_b32 v244, 16, v104
v_and_b32 v245, s28, v104
v_lshlrev_b32 v246, 16, v105
v_and_b32 v247, s28, v105
v_lshlrev_b32 v248, 16, v106
v_and_b32 v249, s28, v106
v_lshlrev_b32 v250, 16, v107
v_and_b32 v251, s28, v107
v_pk_mul_f32 v[244:245], v[244:245], s[22:23]
v_pk_mul_f32 v[246:247], v[246:247], s[22:23]
v_pk_mul_f32 v[248:249], v[248:249], s[22:23]
v_pk_mul_f32 v[250:251], v[250:251], s[22:23]
cv 104,244,245
cv 105,246,247
cv 106,248,249
cv 107,250,251
s_waitcnt lgkmcnt(0)
v_lshlrev_b32 v244, 16, v108
v_and_b32 v245, s28, v108
v_lshlrev_b32 v246, 16, v109
v_and_b32 v247, s28, v109
v_lshlrev_b32 v248, 16, v110
v_and_b32 v249, s28, v110
v_lshlrev_b32 v250, 16, v111
v_and_b32 v251, s28, v111
v_pk_mul_f32 v[244:245], v[244:245], s[22:23]
v_pk_mul_f32 v[246:247], v[246:247], s[22:23]
v_pk_mul_f32 v[248:249], v[248:249], s[22:23]
v_pk_mul_f32 v[250:251], v[250:251], s[22:23]
cv 108,244,245
cv 109,246,247
cv 110,248,249
cv 111,250,251
v_lshlrev_b32 v244, 16, v112
v_and_b32 v245, s28, v112
v_lshlrev_b32 v246, 16, v113
v_and_b32 v247, s28, v113
v_lshlrev_b32 v248, 16, v114
v_and_b32 v249, s28, v114
v_lshlrev_b32 v250, 16, v115
v_and_b32 v251, s28, v115
v_pk_mul_f32 v[244:245], v[244:245], s[22:23]
v_pk_mul_f32 v[246:247], v[246:247], s[22:23]
v_pk_mul_f32 v[248:249], v[248:249], s[22:23]
v_pk_mul_f32 v[250:251], v[250:251], s[22:23]
cv 112,244,245
cv 113,246,247
cv 114,248,249
cv 115,250,251
v_lshlrev_b32 v244, 16, v116
v_and_b32 v245, s28, v116
v_lshlrev_b32 v246, 16, v117
v_and_b32 v247, s28, v117
v_lshlrev_b32 v248, 16, v118
v_and_b32 v249, s28, v118
v_lshlrev_b32 v250, 16, v119
v_and_b32 v251, s28, v119
v_pk_mul_f32 v[244:245], v[244:245], s[22:23]
v_pk_mul_f32 v[246:247], v[246:247], s[22:23]
v_pk_mul_f32 v[248:249], v[248:249], s[22:23]
v_pk_mul_f32 v[250:251], v[250:251], s[22:23]
cv 116,244,245
cv 117,246,247
cv 118,248,249
cv 119,250,251
cv 196,24,25

LwX0_0:
s_cbranch_vccnz LwX0_4
cv 197,26,27
v_mfma_f32_16x16x32_bf16 v[32:35], a[108:111], v[116:119], 0
s_add_u32 s20, s20, 16384
ex 28
pw 32,104,112
s_add_u32 s96, s8, s20
s_addc_u32 s97, s9, 0
pw 32,100,108
s_add_u32 s96, s96, 16384
s_addc_u32 s97, s97, 0
pw 32,96,104
ex 29
ex 30
ex 31
cv 198,28,29
cv 199,30,31
s_nop 2
v_max3_f32 v252, v32, v33, v34
v_max_f32 v252, v252, v35
v_add_f32 v252, 0x41200000, v252
v_mov_b32 v253, v252
s_nop 1
v_permlane16_swap_b32 v252, v253
v_max_f32 v252, v252, v253
v_mov_b32 v253, v252
s_nop 1
v_permlane32_swap_b32 v252, v253
v_min_f32 v48, -v252, -v253
v_min_f32 v49, -v252, -v253
v_min_f32 v50, -v252, -v253
v_min_f32 v51, -v252, -v253
v_add_f32 v32, v32, v48
v_add_f32 v33, v33, v48
qa 16,124,116,48
v_add_f32 v34, v34, v48
v_add_f32 v35, v35, v48
pw 16,120,112
ex 32
pw 16,116,108
ex 33
pw 16,112,104
ex 34
qa 20,140,116,48
ex 35
pw 20,136,112
cv 160,32,33
cv 161,34,35
pw 20,132,108
pw 20,128,104
ex 16
qa 24,156,116,48
ex 17
pw 24,152,112
ex 18
pw 24,148,108
ex 19
pw 24,144,104
cv 162,16,17
cv 163,18,19
qa 28,224,116,48
ex 20
pw 28,220,112
ex 21
pw 28,216,108
ex 22
pw 28,212,104
ex 23
qa 32,240,116,48
cv 164,20,21
cv 165,22,23
pw 32,236,112
ex 24
pw 32,232,108
ex 25
pw 32,228,104
ex 26
v_mfma_f32_16x16x32_bf16 v[16:19], v[216:219], v[116:119], v[48:51]
ex 27
pw 16,252,112
cv 166,24,25
cv 167,26,27
pw 16,248,108
ex 28
pw 16,244,104
ex 29
v_mfma_f32_16x16x32_bf16 v[20:23], v[232:235], v[116:119], v[48:51]
ex 30
v_mfma_f32_16x16x32_bf16 v[20:23], v[228:231], v[112:115], v[20:23]
ex 31
v_mfma_f32_16x16x32_bf16 v[20:23], v[224:227], v[108:111], v[20:23]
cv 200,28,29
cv 201,30,31
v_mfma_f32_16x16x32_bf16 v[20:23], v[220:223], v[104:107], v[20:23]
ex 32
ex 33
ex 34
ex 35
s_waitcnt vmcnt(8)
ds_read_b128 v[120:123], v236 offset:0
ds_read_b128 v[124:127], v237 offset:0
ds_read_b128 v[128:131], v238 offset:0
ds_read_b128 v[132:135], v239 offset:0
buffer_load_dwordx4 v12, s[12:15], s43 offen offset:0 nt lds
buffer_load_dwordx4 v13, s[12:15], s43 offen offset:1024 nt lds
buffer_load_dwordx4 v12, s[12:15], s43 offen offset:2048 nt lds
buffer_load_dwordx4 v13, s[12:15], s43 offen offset:3072 nt lds
cv 202,32,33
cv 203,34,35
ex 16
ex 17
ex 18
ex 19
cv 204,16,17
s_waitcnt lgkmcnt(3)
v_lshlrev_b32 v244, 16, v120
v_and_b32 v245, s28, v120
v_lshlrev_b32 v246, 16, v121
v_and_b32 v247, s28, v121
v_lshlrev_b32 v248, 16, v122
v_and_b32 v249, s28, v122
v_lshlrev_b32 v250, 16, v123
v_and_b32 v251, s28, v123
v_pk_mul_f32 v[244:245], v[244:245], s[22:23]
v_pk_mul_f32 v[246:247], v[246:247], s[22:23]
v_pk_mul_f32 v[248:249], v[248:249], s[22:23]
v_pk_mul_f32 v[250:251], v[250:251], s[22:23]
cv 120,244,245
cv 121,246,247
cv 122,248,249
cv 123,250,251
s_waitcnt lgkmcnt(0)
v_lshlrev_b32 v244, 16, v124
v_and_b32 v245, s28, v124
v_lshlrev_b32 v246, 16, v125
v_and_b32 v247, s28, v125
v_lshlrev_b32 v248, 16, v126
v_and_b32 v249, s28, v126
v_lshlrev_b32 v250, 16, v127
v_and_b32 v251, s28, v127
v_pk_mul_f32 v[244:245], v[244:245], s[22:23]
v_pk_mul_f32 v[246:247], v[246:247], s[22:23]
v_pk_mul_f32 v[248:249], v[248:249], s[22:23]
v_pk_mul_f32 v[250:251], v[250:251], s[22:23]
cv 124,244,245
cv 125,246,247
cv 126,248,249
cv 127,250,251
v_lshlrev_b32 v244, 16, v128
v_and_b32 v245, s28, v128
v_lshlrev_b32 v246, 16, v129
v_and_b32 v247, s28, v129
v_lshlrev_b32 v248, 16, v130
v_and_b32 v249, s28, v130
v_lshlrev_b32 v250, 16, v131
v_and_b32 v251, s28, v131
v_mfma_f32_16x16x32_bf16 v[24:27], a[96:99], v[120:123], 0
s_add_u32 m0, s21, 81920
v_mul_f32 v244, s22, v244
v_mul_f32 v245, s22, v245
cv 128,244,245
v_lshlrev_b32 v244, 16, v132
v_and_b32 v245, s28, v132
v_pk_mul_f32 v[246:247], v[246:247], s[22:23]
v_pk_mul_f32 v[248:249], v[248:249], s[22:23]
v_pk_mul_f32 v[250:251], v[250:251], s[22:23]
cv 129,246,247
cv 130,248,249
cv 131,250,251
pw 24,100,124
s_add_u32 s43, s43, 16384
v_lshlrev_b32 v246, 16, v133
v_and_b32 v247, s28, v133
v_lshlrev_b32 v248, 16, v134
v_and_b32 v249, s28, v134
v_lshlrev_b32 v250, 16, v135
v_and_b32 v251, s28, v135
v_pk_mul_f32 v[244:245], v[244:245], s[22:23]
v_pk_mul_f32 v[246:247], v[246:247], s[22:23]
v_pk_mul_f32 v[248:249], v[248:249], s[22:23]
v_pk_mul_f32 v[250:251], v[250:251], s[22:23]
cv 132,244,245
cv 133,246,247
pw 24,104,128
cv 134,248,249
cv 135,250,251
cv 205,18,19
ex 20
pw 24,108,132
ex 21
ex 22
ex 23
cv 206,20,21
s_waitcnt vmcnt(8)
cv 207,22,23
s_barrier
lv 196,4,0
v_max3_f32 v252, v24, v25, v26
v_max_f32 v252, v252, v27
v_add_f32 v252, 0x41200000, v252
v_mov_b32 v253, v252
lv 198,4,4096
lv 200,4,8192
v_permlane16_swap_b32 v252, v253
v_max_f32 v252, v252, v253
v_mov_b32 v253, v252
lv 202,4,12288
lv 208,5,8192
v_permlane32_swap_b32 v252, v253
v_min_f32 v52, -v252, -v253
v_min_f32 v53, -v252, -v253
v_min_f32 v54, -v252, -v253
v_min_f32 v55, -v252, -v253
v_add_f32 v24, v24, v52
v_add_f32 v25, v25, v52
qa 28,112,120,52
lv 210,5,12288
v_add_f32 v26, v26, v52
pw 28,116,124
lv 204,5,0
v_add_f32 v27, v27, v52
pw 28,120,128
ex 24
pw 28,124,132
ex 25
qa 32,128,120,52
ex 26
pw 32,132,124
ex 27
pw 32,136,128
lv 206,5,4096
cv 168,24,25
pw 32,140,132
lv 180,6,0
cv 169,26,27
qa 16,144,120,52
ex 28
pw 16,148,124
ex 29
pw 16,152,128
ex 30
pw 16,156,132
ex 31
qa 20,212,120,52
buffer_load_dwordx4 v12, s[8:11], s20 offen offset:0 nt lds
pw 20,216,124
lv 182,6,4096
v_accvgpr_write_b32 a212, s40
pw 20,220,128
lv 184,6,8192
v_accvgpr_write_b32 a213, s40
pw 20,224,132
lv 186,6,12288
v_accvgpr_write_b32 a214, s40
qa 24,228,120,52
lv 192,7,8192
v_accvgpr_write_b32 a215, s40
pw 24,232,124
lv 194,7,12288
cv 170,28,29
pw 24,236,128
lv 188,7,0
cv 171,30,31
pw 24,240,132
s_waitcnt lgkmcnt(6)
ex 32
v_mfma_f32_16x16x32_bf16 a[0:3], v[136:139], a[196:199], a[212:215]
ex 33
pa 0,140,200
ex 34
v_mfma_f32_16x16x32_bf16 a[32:35], v[148:151], a[200:203], a[212:215]
ex 35
pa 32,144,196
ex 16
v_mfma_f32_16x16x32_bf16 a[64:67], v[152:155], a[196:199], a[212:215]
ex 17
pa 64,156,200
ex 18
v_mfma_f32_16x16x32_bf16 a[96:99], v[164:167], a[200:203], a[212:215]
ex 19
pa 96,160,196
cv 172,32,33
cv 173,34,35
v_mfma_f32_16x16x32_bf16 a[128:131], v[168:171], a[196:199], a[212:215]
buffer_load_dwordx4 v13, s[8:11], s20 offen offset:1024 nt lds
cv 174,16,17
cv 175,18,19
lv 190,7,4096
lv 196,8,0
pa 128,172,200
lv 198,8,4096
v_mfma_f32_16x16x32_bf16 a[132:135], v[172:175], a[208:211], a[212:215]
lv 200,8,8192
pa 132,168,204
lv 202,8,12288
v_mfma_f32_16x16x32_bf16 a[100:103], v[160:163], a[204:207], a[212:215]
ex 20
pa 100,164,208
ex 21
v_mfma_f32_16x16x32_bf16 a[68:71], v[156:159], a[208:211], a[212:215]
ex 22
pa 68,152,204
ex 23
v_mfma_f32_16x16x32_bf16 a[36:39], v[144:147], a[204:207], a[212:215]
buffer_load_dwordx4 v12, s[8:11], s20 offen offset:2048 nt lds
pa 36,148,208
cv 208,20,21
cv 209,22,23
v_mfma_f32_16x16x32_bf16 a[4:7], v[140:143], a[208:211], a[212:215]
lv 208,9,8192
pa 4,136,204
lv 210,9,12288
v_smfmac_f32_16x16x64_bf16 a[160:163], a[172:175], v[136:143], v14
lv 204,9,0
qa 28,244,120,52
lv 206,9,4096
pw 28,248,124
ex 24
pw 28,252,128
ex 25
v_mfma_f32_16x16x32_bf16 v[28:31], v[216:219], v[132:135], v[28:31]
s_waitcnt lgkmcnt(4)
ex 26
v_mfma_f32_16x16x32_bf16 a[8:11], v[136:139], a[180:183], a[212:215]
ex 27
pa 8,140,184
cv 210,24,25
cv 211,26,27
v_mfma_f32_16x16x32_bf16 a[40:43], v[148:151], a[184:187], a[212:215]
pa 40,144,180
buffer_load_dwordx4 v13, s[8:11], s20 offen offset:3072 nt lds
v_mfma_f32_16x16x32_bf16 a[72:75], v[152:155], a[180:183], a[212:215]
s_add_u32 m0, s21, 131072
ex 28
pa 72,156,184
ex 29
v_mfma_f32_16x16x32_bf16 a[104:107], v[164:167], a[184:187], a[212:215]
ex 30
pa 104,160,180
ex 31
v_mfma_f32_16x16x32_bf16 a[136:139], v[168:171], a[180:183], a[212:215]
lv 180,10,0
cv 212,28,29
pa 136,172,184
lv 182,10,4096
cv 213,30,31
v_mfma_f32_16x16x32_bf16 a[140:143], v[172:175], a[192:195], a[212:215]
lv 184,10,8192
pa 140,168,188
lv 186,10,12288
v_mfma_f32_16x16x32_bf16 a[108:111], v[160:163], a[188:191], a[212:215]
pa 108,164,192
v_mfma_f32_16x16x32_bf16 a[76:79], v[156:159], a[192:195], a[212:215]
pa 76,152,188
buffer_load_dwordx4 v12, s[12:15], s43 offen offset:0 nt lds
v_mfma_f32_16x16x32_bf16 a[44:47], v[144:147], a[188:191], a[212:215]
pa 44,148,192
v_mfma_f32_16x16x32_bf16 a[12:15], v[140:143], a[192:195], a[212:215]
lv 192,11,8192
pa 12,136,188
lv 194,11,12288
v_smfmac_f32_16x16x64_bf16 a[160:163], a[176:179], v[144:151], v14
lv 188,11,0
v_mfma_f32_16x16x32_bf16 v[32:35], v[220:223], v[120:123], v[52:55]
lv 190,11,4096
v_mfma_f32_16x16x32_bf16 v[32:35], v[224:227], v[124:127], v[32:35]
v_mfma_f32_16x16x32_bf16 v[32:35], v[228:231], v[128:131], v[32:35]
v_mfma_f32_16x16x32_bf16 v[32:35], v[232:235], v[132:135], v[32:35]
v_mfma_f32_16x16x32_bf16 a[16:19], v[136:139], a[196:199], a[212:215]
pa 16,140,200
v_mfma_f32_16x16x32_bf16 a[48:51], v[148:151], a[200:203], a[212:215]
buffer_load_dwordx4 v13, s[12:15], s43 offen offset:1024 nt lds
pa 48,144,196
v_mfma_f32_16x16x32_bf16 a[80:83], v[152:155], a[196:199], a[212:215]
pa 80,156,200
v_mfma_f32_16x16x32_bf16 a[112:115], v[164:167], a[200:203], a[212:215]
ex 32
pa 112,160,196
ex 33
v_mfma_f32_16x16x32_bf16 a[144:147], v[168:171], a[196:199], a[212:215]
ex 34
pa 144,172,200
s_waitcnt lgkmcnt(0)
ex 35
v_mfma_f32_16x16x32_bf16 a[148:151], v[172:175], a[208:211], a[212:215]
cv 214,32,33
cv 215,34,35
pa 148,168,204
v_mfma_f32_16x16x32_bf16 a[116:119], v[160:163], a[204:207], a[212:215]
pa 116,164,208
v_mfma_f32_16x16x32_bf16 a[84:87], v[156:159], a[208:211], a[212:215]
buffer_load_dwordx4 v12, s[12:15], s43 offen offset:2048 nt lds
pa 84,152,204
v_mfma_f32_16x16x32_bf16 a[52:55], v[144:147], a[204:207], a[212:215]
pa 52,148,208
v_mfma_f32_16x16x32_bf16 a[20:23], v[140:143], a[208:211], a[212:215]
pa 20,136,204
v_smfmac_f32_16x16x64_bf16 a[164:167], a[172:175], v[152:159], v14
v_smfmac_f32_16x16x64_bf16 a[164:167], a[176:179], v[160:167], v14
v_mfma_f32_16x16x32_bf16 a[24:27], v[136:139], a[180:183], a[212:215]
s_waitcnt vmcnt(7)
s_barrier
pa 24,140,184
lk 196,0,32768
v_mfma_f32_16x16x32_bf16 a[56:59], v[148:151], a[184:187], a[212:215]
lk 200,1,32768
pa 56,144,180
lk 204,2,32768
v_mfma_f32_16x16x32_bf16 a[88:91], v[152:155], a[180:183], a[212:215]
buffer_load_dwordx4 v13, s[12:15], s43 offen offset:3072 nt lds
pa 88,156,184
s_add_u32 m0, s21, 32768
lk 208,3,32768
s_add_u32 s43, s43, 16384
v_mfma_f32_16x16x32_bf16 a[120:123], v[164:167], a[184:187], a[212:215]
s_add_u32 s98, s12, s43
s_addc_u32 s99, s13, 0
pa 120,160,180
s_add_u32 s98, s98, 16384
s_addc_u32 s99, s99, 0
v_mfma_f32_16x16x32_bf16 a[152:155], v[168:171], a[180:183], a[212:215]
lv 180,4,16384
pa 152,172,184
lv 182,4,20480
v_mfma_f32_16x16x32_bf16 a[156:159], v[172:175], a[192:195], a[212:215]
lv 184,4,24576
pa 156,168,188
lv 186,4,28672
v_mfma_f32_16x16x32_bf16 a[124:127], v[160:163], a[188:191], a[212:215]
pa 124,164,192
v_mfma_f32_16x16x32_bf16 a[92:95], v[156:159], a[192:195], a[212:215]
pa 92,152,188
v_mfma_f32_16x16x32_bf16 a[60:63], v[144:147], a[188:191], a[212:215]
global_load_lds_dwordx4 v12, s[96:97] offset:0 nt
pa 60,148,192
v_mfma_f32_16x16x32_bf16 a[28:31], v[140:143], a[192:195], a[212:215]
lv 192,5,24576
pa 28,136,188
lv 194,5,28672
v_smfmac_f32_16x16x64_bf16 a[168:171], a[172:175], v[168:175], v14
s_waitcnt lgkmcnt(2)
lv 188,5,16384
qa 16,196,56,36
lv 190,5,20480
pw 16,200,60
pw 16,204,64
pw 16,208,68
qa 20,208,84,40
pw 20,204,80
s_nop 2
pw 20,200,76
s_nop 0
pw 20,196,72
global_load_lds_dwordx4 v13, s[96:97] offset:1024 nt
qa 24,196,88,44
ex 16
pw 24,200,92
ex 17
pw 24,204,96
cv 136,16,17
pw 24,208,100
ex 18
qa 28,208,116,48
pw 28,204,112
ex 19
pw 28,200,108
cv 137,18,19
pw 28,196,104
ex 20
qa 32,196,120,52
lk 196,0,36864
pw 32,200,124
lk 200,1,36864
pw 32,204,128
lk 204,2,36864
pw 32,208,132
global_load_lds_dwordx4 v12, s[96:97] offset:2048 nt
lk 208,3,36864
pa 0,176,180
ex 21
pa 0,180,184
ex 22
pa 32,188,184
ex 23
pa 32,184,180
cv 144,20,21
cv 145,22,23
pa 64,192,180
ex 24
pa 64,196,184
ex 25
pa 96,204,184
cv 152,24,25
pa 96,200,180
ex 26
pa 128,208,180
lv 180,6,16384
pa 128,212,184
s_waitcnt lgkmcnt(1)
ex 27
pa 132,212,192
lv 182,6,20480
cv 153,26,27
pa 132,208,188
global_load_lds_dwordx4 v13, s[96:97] offset:3072 nt
s_add_u32 m0, s21, 147456
pa 100,200,188
s_add_u32 s96, s96, 16384
s_addc_u32 s97, s97, 0
lv 184,6,24576
pa 100,204,192
ex 28
pa 68,196,192
ex 29
pa 68,192,188
ex 30
pa 36,184,188
lv 186,6,28672
cv 160,28,29
pa 36,188,192
ex 31
pa 4,180,192
lv 192,7,24576
cv 161,30,31
pa 4,176,188
ex 32
v_smfmac_f32_16x16x64_bf16 a[160:163], a[172:175], v[176:183], v14
lv 194,7,28672
qa 16,196,56,36
ex 33
pw 16,200,60
lv 188,7,16384
cv 168,32,33
pw 16,204,64
buffer_load_dwordx4 v12, s[12:15], s43 offen offset:0 nt lds
pw 16,208,68
ex 34
qa 20,208,84,40
ex 35
pw 20,204,80
lv 190,7,20480
cv 169,34,35
pw 20,200,76
pw 20,196,72
ex 16
qa 24,196,88,44
pw 24,200,92
ex 17
pw 24,204,96
cv 138,16,17
pw 24,208,100
ex 18
qa 28,208,116,48
pw 28,204,112
ex 19
pw 28,200,108
buffer_load_dwordx4 v13, s[12:15], s43 offen offset:1024 nt lds
pw 28,196,104
cv 139,18,19
qa 32,196,120,52
lk 196,0,40960
pw 32,200,124
lk 200,1,40960
pw 32,204,128
lk 204,2,40960
pw 32,208,132
s_waitcnt lgkmcnt(3)
lk 208,3,40960
pa 8,176,180
ex 20
pa 8,180,184
ex 21
pa 40,188,184
ex 22
pa 40,184,180
ex 23
pa 72,192,180
cv 146,20,21
cv 147,22,23
pa 72,196,184
ex 24
pa 104,204,184
buffer_load_dwordx4 v12, s[12:15], s43 offen offset:2048 nt lds
pa 104,200,180
ex 25
pa 136,208,180
ex 26
pa 136,212,184
ex 27
pa 140,212,192
lv 180,8,16384
cv 154,24,25
pa 140,208,188
lv 182,8,20480
cv 155,26,27
pa 108,200,188
ex 28
pa 108,204,192

LwX0_1:
s_cbranch_vccnz LwX0_5
ex 29
pa 76,196,192
lv 184,8,24576
cv 162,28,29
pa 76,192,188
ex 30
pa 44,184,188
lv 186,8,28672
pa 44,188,192
ex 31
pa 12,180,192
buffer_load_dwordx4 v13, s[12:15], s43 offen offset:3072 nt lds
pa 12,176,188
s_add_u32 m0, s21, 49152
lv 192,9,24576
cv 163,30,31
v_smfmac_f32_16x16x64_bf16 a[160:163], a[176:179], v[184:191], v14
s_waitcnt lgkmcnt(3)
lv 194,9,28672
qa 16,196,56,36
ex 32
pw 16,200,60
ex 33
pw 16,204,64
ex 34
pw 16,208,68
lv 188,9,16384
cv 170,32,33
qa 20,208,84,40
ex 35
pw 20,204,80
lv 190,9,20480
cv 171,34,35
pw 20,200,76
pw 20,196,72
ex 16
qa 24,196,88,44
pw 24,200,92
global_load_lds_dwordx4 v12, s[96:97] offset:0 nt
pw 24,204,96
ex 17
pw 24,208,100
ex 18
qa 28,208,116,48
cv 140,16,17
pw 28,204,112
ex 19
pw 28,200,108
cv 141,18,19
pw 28,196,104
ex 20
qa 32,196,120,52
lk 196,0,45056
pw 32,200,124
lk 200,1,45056
pw 32,204,128
lk 204,2,45056
pw 32,208,132
lk 208,3,45056
pa 16,176,180
s_waitcnt lgkmcnt(4)
ex 21
pa 16,180,184
global_load_lds_dwordx4 v13, s[96:97] offset:1024 nt
cv 148,20,21
pa 48,188,184
ex 22
pa 48,184,180
ex 23
pa 80,192,180
cv 149,22,23
pa 80,196,184
ex 24
pa 112,204,184
ex 25
pa 112,200,180
ex 26
pa 144,208,180
lv 180,10,16384
cv 156,24,25
pa 144,212,184
ex 27
pa 148,212,192
lv 182,10,20480
cv 157,26,27
pa 148,208,188
lv 184,10,24576
pa 116,200,188
lv 186,10,28672
pa 116,204,192
global_load_lds_dwordx4 v12, s[96:97] offset:2048 nt
pa 84,196,192
ex 28
pa 84,192,188
ex 29
pa 52,184,188
ex 30
pa 52,188,192
ex 31
pa 20,180,192
lv 192,11,24576
cv 164,28,29
pa 20,176,188
lv 194,11,28672
cv 165,30,31
v_smfmac_f32_16x16x64_bf16 a[164:167], a[172:175], v[192:199], v14
lv 188,11,16384
v_smfmac_f32_16x16x64_bf16 a[164:167], a[176:179], v[200:207], v14
s_waitcnt lgkmcnt(3)
lv 190,11,20480
qa 16,196,56,36
s_waitcnt vmcnt(11)
ds_write_b32 v254, v255 offset:0
pw 16,200,60
ex 32
pw 16,204,64
ex 33
pw 16,208,68
global_load_lds_dwordx4 v13, s[96:97] offset:3072 nt
cv 172,32,33
qa 20,208,84,40
s_add_u32 m0, s21, 98304
ex 34
pw 20,204,80
s_add_u32 s96, s96, 16384
s_addc_u32 s97, s97, 0
pw 20,200,76
ex 35
pw 20,196,72
cv 173,34,35
qa 24,196,88,44
ex 16
pw 24,200,92
ex 17
pw 24,204,96
cv 142,16,17
pw 24,208,100
ex 18
qa 28,208,116,48
pw 28,204,112
ex 19
pw 28,200,108
cv 143,18,19
pw 28,196,104
global_load_lds_dwordx4 v12, s[98:99] offset:0 nt
qa 32,196,120,52
ex 20
pw 32,200,124
ex 21
pw 32,204,128
cv 150,20,21
pw 32,208,132
ex 22
pa 24,176,180
ds_read_b32 v255, v12 offset:1024
pa 24,180,184
ex 23
pa 56,188,184
cv 151,22,23
pa 56,184,180
ex 24
pa 88,192,180
pa 88,196,184
ex 25
pa 120,204,184
cv 158,24,25
pa 120,200,180
s_waitcnt lgkmcnt(0)
global_load_lds_dwordx4 v13, s[98:99] offset:1024 nt
v_cmp_gt_u32 vcc, 1, v255
pa 152,208,180
ex 26
pa 152,212,184
s_cbranch_vccnz LsX1
LrX1:
lk 196,0,49152
v_mov_b32 v255, 2
pa 156,212,192
lk 200,1,49152
pa 156,208,188
lk 204,2,49152
pa 124,200,188
lk 208,3,49152
pa 124,204,192
ex 27
pa 92,196,192
lv 180,4,32768
cv 159,26,27
pa 92,192,188
ex 28
pa 60,184,188
ex 29
pa 60,188,192
ex 30
pa 28,180,192
ex 31
pa 28,176,188
global_load_lds_dwordx4 v12, s[98:99] offset:2048 nt
cv 166,28,29
v_smfmac_f32_16x16x64_bf16 a[168:171], a[172:175], v[208:215], v14
s_waitcnt lgkmcnt(1)
lv 182,4,36864
qa 16,196,56,36
lv 184,4,40960
cv 167,30,31
pw 16,200,60
lv 186,4,45056
pw 16,204,64
ex 32
pw 16,208,68
ex 33
qa 20,208,84,40
ex 34
pw 20,204,80
ex 35
pw 20,200,76
lv 192,5,40960
cv 174,32,33
pw 20,196,72
lv 194,5,45056
cv 175,34,35
qa 24,196,88,44
lv 188,5,32768
pw 24,200,92
lv 190,5,36864
pw 24,204,96
global_load_lds_dwordx4 v13, s[98:99] offset:3072 nt
s_add_u32 m0, s21, 65536
pw 24,208,100
s_add_u32 s98, s98, 16384
s_addc_u32 s99, s99, 0
qa 28,208,116,48
ex 16
pw 28,204,112
ex 17
pw 28,200,108
ex 18
pw 28,196,104
ex 19
qa 32,196,120,52
lk 196,0,53248
cv 176,16,17
pw 32,200,124
lk 200,1,53248
cv 177,18,19
pw 32,204,128
lk 204,2,53248
pw 32,208,132
s_waitcnt lgkmcnt(3)
lk 208,3,53248
pa 0,136,180
ex 20
pa 0,140,184
ex 21
pa 32,148,184
global_load_lds_dwordx4 v12, s[96:97] offset:0 nt
cv 184,20,21
pa 32,144,180
ex 22
pa 64,152,180
ex 23
pa 64,156,184
cv 185,22,23
pa 96,164,184
ex 24
pa 96,160,180
ex 25
pa 128,168,180
ex 26
pa 128,172,184
ex 27
pa 132,172,192
lv 180,6,32768
cv 192,24,25
pa 132,168,188
lv 182,6,36864
cv 193,26,27
pa 100,160,188
ex 28
pa 100,164,192
ex 29
pa 68,156,192
global_load_lds_dwordx4 v13, s[96:97] offset:1024 nt
cv 200,28,29
pa 68,152,188
ex 30
pa 36,144,188
lv 184,6,40960
pa 36,148,192
ex 31
pa 4,140,192
lv 186,6,45056
cv 201,30,31
pa 4,136,188
ex 32
v_smfmac_f32_16x16x64_bf16 a[160:163], a[172:175], v[136:143], v14
s_waitcnt lgkmcnt(2)
lv 192,7,40960
qa 16,196,56,36
ex 33
pw 16,200,60
lv 194,7,45056
cv 208,32,33
pw 16,204,64
ex 34
pw 16,208,68
lv 188,7,32768
qa 20,208,84,40
ex 35
pw 20,204,80
global_load_lds_dwordx4 v12, s[96:97] offset:2048 nt
cv 209,34,35
pw 20,200,76
lv 190,7,36864
pw 20,196,72
ex 16
qa 24,196,88,44
pw 24,200,92
ex 17
pw 24,204,96
cv 178,16,17
pw 24,208,100
ex 18
qa 28,208,116,48
pw 28,204,112
ex 19
pw 28,200,108
cv 179,18,19
pw 28,196,104
ex 20
qa 32,196,120,52
lk 196,0,57344
pw 32,200,124
global_load_lds_dwordx4 v13, s[96:97] offset:3072 nt
lk 200,1,57344
pw 32,204,128
s_add_u32 m0, s21, 114688
lk 204,2,57344
pw 32,208,132
s_add_u32 s96, s96, 16384
s_addc_u32 s97, s97, 0
lk 208,3,57344
pa 8,136,180
s_waitcnt lgkmcnt(4)
ex 21
pa 8,140,184
ex 22
pa 40,148,184
ex 23
pa 40,144,180
cv 186,20,21
cv 187,22,23
pa 72,152,180
ex 24
pa 72,156,184
ex 25
pa 104,164,184
cv 194,24,25
pa 104,160,180
ex 26
pa 136,168,180
lv 180,8,32768
pa 136,172,184
global_load_lds_dwordx4 v12, s[98:99] offset:0 nt
lv 182,8,36864
pa 140,172,192
ex 27
pa 140,168,188
lv 184,8,40960
cv 195,26,27
pa 108,160,188
ex 28
pa 108,164,192
ex 29
pa 76,156,192
lv 186,8,45056
cv 202,28,29
pa 76,152,188
ex 30
pa 44,144,188
pa 44,148,192
ex 31
pa 12,140,192
lv 192,9,40960
cv 203,30,31
pa 12,136,188
ex 32
v_smfmac_f32_16x16x64_bf16 a[160:163], a[176:179], v[144:151], v14
s_waitcnt lgkmcnt(2)
lv 194,9,45056
qa 16,196,56,36
global_load_lds_dwordx4 v13, s[98:99] offset:1024 nt
lv 188,9,32768
pw 16,200,60
ex 33
pw 16,204,64
ex 34
pw 16,208,68
lv 190,9,36864
cv 210,32,33
qa 20,208,84,40
ex 35
pw 20,204,80
cv 211,34,35
s_nop 0
pw 20,200,76
pw 20,196,72
ex 16
qa 24,196,88,44
pw 24,200,92
ex 17
pw 24,204,96
cv 180,16,17
pw 24,208,100
ex 18
qa 28,208,116,48
global_load_lds_dwordx4 v12, s[98:99] offset:2048 nt
pw 28,204,112
ex 19
pw 28,200,108
cv 181,18,19
pw 28,196,104
ex 20
qa 32,196,120,52
lk 196,0,61440
pw 32,200,124
lk 200,1,61440
pw 32,204,128
lk 204,2,61440
pw 32,208,132
lk 208,3,61440
pa 16,136,180
s_waitcnt lgkmcnt(4)
ex 21
pa 16,140,184
ex 22
pa 48,148,184
ex 23
pa 48,144,180
cv 188,20,21
cv 189,22,23
pa 80,152,180
global_load_lds_dwordx4 v13, s[98:99] offset:3072 nt
s_add_u32 m0, s21, 81920
pa 80,156,184
s_add_u32 s98, s98, 16384
s_addc_u32 s99, s99, 0
pa 112,164,184
ex 24
pa 112,160,180
ex 25
pa 144,168,180
ex 26
pa 144,172,184
ex 27
pa 148,172,192
lv 180,10,32768
cv 196,24,25
pa 148,168,188
lv 182,10,36864
cv 197,26,27
pa 116,160,188
lv 184,10,40960
pa 116,164,192
lv 186,10,45056
pa 84,156,192
ex 28
pa 84,152,188
ex 29
pa 52,144,188
ex 30
pa 52,148,192
ex 31
pa 20,140,192
lv 192,11,40960
cv 204,28,29
pa 20,136,188
lv 194,11,45056
cv 205,30,31
v_smfmac_f32_16x16x64_bf16 a[164:167], a[172:175], v[152:159], v14
lv 188,11,32768
v_smfmac_f32_16x16x64_bf16 a[164:167], a[176:179], v[160:167], v14
s_waitcnt lgkmcnt(3)
lv 190,11,36864
qa 16,196,56,36
s_waitcnt vmcnt(16)
ds_write_b32 v254, v255 offset:0
pw 16,200,60
ex 32
pw 16,204,64
ex 33
pw 16,208,68
ex 34
qa 20,208,84,40
ex 35
pw 20,204,80
cv 212,32,33
cv 213,34,35
pw 20,200,76
pw 20,196,72
ex 16
qa 24,196,88,44
pw 24,200,92
ex 17
pw 24,204,96
cv 182,16,17
pw 24,208,100
ex 18
qa 28,208,116,48
pw 28,204,112
ex 19
pw 28,200,108
cv 183,18,19
pw 28,196,104
ex 20
qa 32,196,120,52
pw 32,200,124
ex 21
pw 32,204,128
cv 190,20,21
pw 32,208,132
ex 22
pa 24,136,180
ds_read_b32 v255, v12 offset:1024
pa 24,140,184
ex 23
pa 56,148,184
cv 191,22,23
pa 56,144,180
ex 24
pa 88,152,180
pa 88,156,184
ex 25
pa 120,164,184
cv 198,24,25
pa 120,160,180
s_waitcnt lgkmcnt(0)
v_cmp_gt_u32 vcc, 2, v255
pa 152,168,180
ex 26
pa 152,172,184
s_cbranch_vccnz LsX2
LrX2:
lk 196,0,0
global_load_lds_dwordx4 v12, s[96:97] offset:0 nt
pa 156,172,192
lk 200,1,0
v_mov_b32 v255, 3
pa 156,168,188
lk 204,2,0
pa 124,160,188
lk 208,3,0
pa 124,164,192
ex 27
pa 92,156,192
lv 180,4,49152
cv 199,26,27
pa 92,152,188
ex 28
pa 60,144,188
ex 29
pa 60,148,192
ex 30
pa 28,140,192
ex 31
pa 28,136,188
lv 182,4,53248
cv 206,28,29
v_smfmac_f32_16x16x64_bf16 a[168:171], a[172:175], v[168:175], v14
s_waitcnt lgkmcnt(2)
lv 184,4,57344
qa 16,196,56,36
lv 186,4,61440
cv 207,30,31
pw 16,200,60
global_load_lds_dwordx4 v13, s[96:97] offset:1024 nt
lv 192,5,57344
pw 16,204,64
ex 32
pw 16,208,68
ex 33
qa 20,208,84,40
ex 34
pw 20,204,80
ex 35
pw 20,200,76
lv 194,5,61440
cv 214,32,33
pw 20,196,72
lv 188,5,49152
cv 215,34,35
qa 24,196,88,44

LwX0_2:
s_cbranch_vccnz LwX0_6
lv 190,5,53248
pw 24,200,92
ex 16
pw 24,204,96
ex 17
pw 24,208,100
ex 18
qa 28,208,116,48
cv 136,16,17
pw 28,204,112
ex 19
pw 28,200,108
cv 137,18,19
pw 28,196,104
ex 20
qa 32,196,120,52
global_load_lds_dwordx4 v12, s[96:97] offset:2048 nt
lk 196,0,4096
pw 32,200,124
lk 200,1,4096
pw 32,204,128
lk 204,2,4096
pw 32,208,132
s_waitcnt lgkmcnt(3)
lk 208,3,4096
pa 0,176,180
ex 21
pa 0,180,184
ex 22
pa 32,188,184
ex 23
pa 32,184,180
cv 144,20,21
cv 145,22,23
pa 64,192,180
ex 24
pa 64,196,184
ex 25
pa 96,204,184
cv 152,24,25
pa 96,200,180
ex 26
pa 128,208,180
lv 180,6,49152
pa 128,212,184
ex 27
pa 132,212,192
lv 182,6,53248
cv 153,26,27
pa 132,208,188
global_load_lds_dwordx4 v13, s[96:97] offset:3072 nt
lv 184,6,57344
pa 100,200,188
s_add_u32 m0, s21, 131072
ex 28
pa 100,204,192
s_add_u32 s96, s96, 16384
s_addc_u32 s97, s97, 0
lv 186,6,61440
pa 68,196,192
ex 29
pa 68,192,188
ex 30
pa 36,184,188
cv 160,28,29
pa 36,188,192
ex 31
pa 4,180,192
lv 192,7,57344
cv 161,30,31
pa 4,176,188
ex 32
v_smfmac_f32_16x16x64_bf16 a[160:163], a[172:175], v[176:183], v14
s_waitcnt lgkmcnt(2)
lv 194,7,61440
qa 16,196,56,36
ex 33
pw 16,200,60
lv 188,7,49152
cv 168,32,33
pw 16,204,64
ex 34
pw 16,208,68
lv 190,7,53248
qa 20,208,84,40
ex 35
pw 20,204,80
global_load_lds_dwordx4 v12, s[98:99] offset:0 nt
cv 169,34,35
pw 20,200,76
pw 20,196,72
ex 16
qa 24,196,88,44
pw 24,200,92
ex 17
pw 24,204,96
cv 138,16,17
pw 24,208,100
ex 18
qa 28,208,116,48
pw 28,204,112
ex 19
pw 28,200,108
cv 139,18,19
pw 28,196,104
ex 20
qa 32,196,120,52
lk 196,0,8192
pw 32,200,124
lk 200,1,8192
pw 32,204,128
lk 204,2,8192
pw 32,208,132
lk 208,3,8192
pa 8,176,180
s_waitcnt lgkmcnt(4)
global_load_lds_dwordx4 v13, s[98:99] offset:1024 nt
pa 8,180,184
ex 21
pa 40,188,184
ex 22
pa 40,184,180
ex 23
pa 72,192,180
cv 146,20,21
cv 147,22,23
pa 72,196,184
ex 24
pa 104,204,184
ex 25
pa 104,200,180
ex 26
pa 136,208,180
lv 180,8,49152
cv 154,24,25
pa 136,212,184
ex 27
pa 140,212,192
lv 182,8,53248
cv 155,26,27
pa 140,208,188
ex 28
pa 108,200,188
lv 184,8,57344
pa 108,204,192
ex 29
pa 76,196,192
lv 186,8,61440
cv 162,28,29
pa 76,192,188
global_load_lds_dwordx4 v12, s[98:99] offset:2048 nt
pa 44,184,188
ex 30
pa 44,188,192
ex 31
pa 12,180,192
lv 192,9,57344
cv 163,30,31
pa 12,176,188
ex 32
v_smfmac_f32_16x16x64_bf16 a[160:163], a[176:179], v[184:191], v14
s_waitcnt lgkmcnt(2)
lv 194,9,61440
qa 16,196,56,36
ex 33
pw 16,200,60
lv 188,9,49152
cv 170,32,33
pw 16,204,64
ex 34
pw 16,208,68
lv 190,9,53248
qa 20,208,84,40
ex 35
pw 20,204,80
cv 171,34,35
s_nop 0
pw 20,200,76
pw 20,196,72
ex 16
qa 24,196,88,44
pw 24,200,92
global_load_lds_dwordx4 v13, s[98:99] offset:3072 nt
s_add_u32 m0, s21, 32768
pw 24,204,96
s_add_u32 s98, s98, 16384
s_addc_u32 s99, s99, 0
pw 24,208,100
ex 17
qa 28,208,116,48
ex 18
pw 28,204,112
ex 19
pw 28,200,108
cv 140,16,17
cv 141,18,19
pw 28,196,104
ex 20
qa 32,196,120,52
lk 196,0,12288
pw 32,200,124
lk 200,1,12288
pw 32,204,128
lk 204,2,12288
pw 32,208,132
lk 208,3,12288
pa 16,176,180
s_waitcnt lgkmcnt(4)
ex 21
pa 16,180,184
ex 22
pa 48,188,184
ex 23
pa 48,184,180
cv 148,20,21
cv 149,22,23
pa 80,192,180
ex 24
pa 80,196,184
ex 25
pa 112,204,184
cv 156,24,25
pa 112,200,180
ex 26
pa 144,208,180
lv 180,10,49152
pa 144,212,184
ex 27
pa 148,212,192
lv 182,10,53248
cv 157,26,27
pa 148,208,188
lv 184,10,57344
pa 116,200,188
lv 186,10,61440
pa 116,204,192
ex 28
pa 84,196,192
ex 29
pa 84,192,188
ex 30
pa 52,184,188
cv 164,28,29
pa 52,188,192
ex 31
pa 20,180,192
lv 192,11,57344
cv 165,30,31
pa 20,176,188
lv 194,11,61440
v_smfmac_f32_16x16x64_bf16 a[164:167], a[172:175], v[192:199], v14
lv 188,11,49152
v_smfmac_f32_16x16x64_bf16 a[164:167], a[176:179], v[200:207], v14
s_waitcnt lgkmcnt(3)
lv 190,11,53248
qa 16,196,56,36
s_waitcnt vmcnt(16)
ds_write_b32 v254, v255 offset:0
pw 16,200,60
ex 32
pw 16,204,64
ex 33
pw 16,208,68
ex 34
qa 20,208,84,40
ex 35
pw 20,204,80
cv 172,32,33
cv 173,34,35
pw 20,200,76
pw 20,196,72
ex 16
qa 24,196,88,44
pw 24,200,92
ex 17
pw 24,204,96
cv 142,16,17
pw 24,208,100
ex 18
qa 28,208,116,48
pw 28,204,112
ex 19
pw 28,200,108
cv 143,18,19
pw 28,196,104
ex 20
qa 32,196,120,52
pw 32,200,124
ex 21
pw 32,204,128
cv 150,20,21
pw 32,208,132
ex 22
pa 24,176,180
ds_read_b32 v255, v12 offset:1024
pa 24,180,184
ex 23
pa 56,188,184
cv 151,22,23
pa 56,184,180
ex 24
pa 88,192,180
pa 88,196,184
ex 25
pa 120,204,184
cv 158,24,25
pa 120,200,180
s_waitcnt lgkmcnt(0)
v_cmp_gt_u32 vcc, 3, v255
pa 152,208,180
ex 26
pa 152,212,184
s_cbranch_vccnz LsX3
LrX3:
lk 196,0,16384
global_load_lds_dwordx4 v12, s[96:97] offset:0 nt
pa 156,212,192
lk 200,1,16384
v_mov_b32 v255, 4
pa 156,208,188
lk 204,2,16384
pa 124,200,188
lk 208,3,16384
pa 124,204,192
ex 27
pa 92,196,192
lv 180,4,0
cv 159,26,27
pa 92,192,188
ex 28
pa 60,184,188
ex 29
pa 60,188,192
ex 30
pa 28,180,192
ex 31
pa 28,176,188
lv 182,4,4096
cv 166,28,29
v_smfmac_f32_16x16x64_bf16 a[168:171], a[172:175], v[208:215], v14
s_waitcnt lgkmcnt(2)
lv 184,4,8192
qa 16,196,56,36
lv 186,4,12288
cv 167,30,31
pw 16,200,60
global_load_lds_dwordx4 v13, s[96:97] offset:1024 nt
lv 192,5,8192
pw 16,204,64
ex 32
pw 16,208,68
ex 33
qa 20,208,84,40
ex 34
pw 20,204,80
ex 35
pw 20,200,76
lv 194,5,12288
cv 174,32,33
pw 20,196,72
lv 188,5,0
cv 175,34,35
qa 24,196,88,44
lv 190,5,4096
pw 24,200,92
ex 16
pw 24,204,96
ex 17
pw 24,208,100
ex 18
qa 28,208,116,48
cv 176,16,17
pw 28,204,112
ex 19
pw 28,200,108
cv 177,18,19
pw 28,196,104
ex 20
qa 32,196,120,52
global_load_lds_dwordx4 v12, s[96:97] offset:2048 nt
lk 196,0,20480
pw 32,200,124
lk 200,1,20480
pw 32,204,128
lk 204,2,20480
pw 32,208,132
s_waitcnt lgkmcnt(3)
lk 208,3,20480
pa 0,136,180
ex 21
pa 0,140,184
ex 22
pa 32,148,184
ex 23
pa 32,144,180
cv 184,20,21
cv 185,22,23
pa 64,152,180
ex 24
pa 64,156,184
ex 25
pa 96,164,184
cv 192,24,25
pa 96,160,180
ex 26
pa 128,168,180
lv 180,6,0
pa 128,172,184
ex 27
pa 132,172,192
lv 182,6,4096
cv 193,26,27
pa 132,168,188
global_load_lds_dwordx4 v13, s[96:97] offset:3072 nt
lv 184,6,8192
pa 100,160,188
s_add_u32 m0, s21, 147456
ex 28
pa 100,164,192
s_add_u32 s96, s96, 16384
s_addc_u32 s97, s97, 0
lv 186,6,12288
pa 68,156,192
ex 29
pa 68,152,188
ex 30
pa 36,144,188
cv 200,28,29
pa 36,148,192
ex 31
pa 4,140,192
lv 192,7,8192
cv 201,30,31
pa 4,136,188
ex 32
v_smfmac_f32_16x16x64_bf16 a[160:163], a[172:175], v[136:143], v14
s_waitcnt lgkmcnt(2)
lv 194,7,12288
qa 16,196,56,36
ex 33
pw 16,200,60
lv 188,7,0
cv 208,32,33
pw 16,204,64
ex 34
pw 16,208,68
lv 190,7,4096
qa 20,208,84,40
ex 35
pw 20,204,80
global_load_lds_dwordx4 v12, s[98:99] offset:0 nt
cv 209,34,35
pw 20,200,76
pw 20,196,72
ex 16
qa 24,196,88,44
pw 24,200,92
ex 17
pw 24,204,96
buffer_load_dwordx4 v[220:223], v15, s[4:7], s38 offen offset:0 nt
pw 24,208,100
s_add_u32 s38, s26, 4096
ex 18
qa 28,208,116,48
cv 178,16,17
pw 28,204,112
ex 19
pw 28,200,108
cv 179,18,19
pw 28,196,104
ex 20
qa 32,196,120,52
lk 196,0,24576
pw 32,200,124
lk 200,1,24576
pw 32,204,128
lk 204,2,24576
pw 32,208,132
lk 208,3,24576
pa 8,136,180
s_waitcnt lgkmcnt(4)
ex 21
pa 8,140,184
ex 22
pa 40,148,184
ex 23
pa 40,144,180
cv 186,20,21
cv 187,22,23
pa 72,152,180
ex 24
pa 72,156,184
ex 25
pa 104,164,184
global_load_lds_dwordx4 v13, s[98:99] offset:1024 nt
cv 194,24,25
pa 104,160,180
ex 26
pa 136,168,180
lv 180,8,0
pa 136,172,184
ex 27
pa 140,172,192
lv 182,8,4096
cv 195,26,27
pa 140,168,188
ex 28
pa 108,160,188
lv 184,8,8192
pa 108,164,192
ex 29
pa 76,156,192
lv 186,8,12288
cv 202,28,29
pa 76,152,188
global_load_lds_dwordx4 v12, s[98:99] offset:2048 nt
pa 44,144,188
ex 30
pa 44,148,192
ex 31
pa 12,140,192
lv 192,9,8192
cv 203,30,31
pa 12,136,188
ex 32
v_smfmac_f32_16x16x64_bf16 a[160:163], a[176:179], v[144:151], v14
s_waitcnt lgkmcnt(2)
lv 194,9,12288
qa 16,196,56,36
ex 33
pw 16,200,60
lv 188,9,0
cv 210,32,33
pw 16,204,64
ex 34
pw 16,208,68
lv 190,9,4096
qa 20,208,84,40
ex 35
pw 20,204,80
buffer_load_dwordx4 v[224:227], v15, s[4:7], s39 offen offset:32 nt
pw 20,200,76
s_add_u32 s39, s26, 4096
cv 211,34,35
pw 20,196,72
ex 16
qa 24,196,88,44
pw 24,200,92
ex 17
pw 24,204,96
cv 180,16,17
pw 24,208,100
ex 18
qa 28,208,116,48
pw 28,204,112
ex 19
pw 28,200,108
cv 181,18,19
pw 28,196,104
ex 20
qa 32,196,120,52
lk 196,0,28672
pw 32,200,124
lk 200,1,28672
pw 32,204,128
lk 204,2,28672
pw 32,208,132
lk 208,3,28672
pa 16,136,180
s_waitcnt lgkmcnt(4)
ex 21
pa 16,140,184
global_load_lds_dwordx4 v13, s[98:99] offset:3072 nt
cv 188,20,21
pa 48,148,184
s_add_u32 m0, s21, 49152
ex 22
pa 48,144,180
s_add_u32 s98, s98, 16384
s_addc_u32 s99, s99, 0
pa 80,152,180
ex 23
pa 80,156,184
cv 189,22,23
pa 112,164,184

LwX0_3:
s_cbranch_vccnz LwX0_7
ex 24
pa 112,160,180
ex 25
pa 144,168,180
ex 26
pa 144,172,184
ex 27
pa 148,172,192
lv 180,10,0
cv 196,24,25
pa 148,168,188
lv 182,10,4096
cv 197,26,27
pa 116,160,188
lv 184,10,8192
pa 116,164,192
lv 186,10,12288
pa 84,156,192
ex 28
pa 84,152,188
ex 29
pa 52,144,188
ex 30
pa 52,148,192
ex 31
pa 20,140,192
lv 192,11,8192
cv 204,28,29
pa 20,136,188
lv 194,11,12288
cv 205,30,31
v_smfmac_f32_16x16x64_bf16 a[164:167], a[172:175], v[152:159], v14
lv 188,11,0
v_smfmac_f32_16x16x64_bf16 a[164:167], a[176:179], v[160:167], v14
s_waitcnt lgkmcnt(3)
lv 190,11,4096
qa 16,196,56,36
s_waitcnt vmcnt(18)
ds_write_b32 v254, v255 offset:0
pw 16,200,60
ex 32
pw 16,204,64
ex 33
pw 16,208,68
ex 34
qa 20,208,84,40
ex 35
pw 20,204,80
cv 212,32,33
cv 213,34,35
pw 20,200,76
pw 20,196,72
ex 16
qa 24,196,88,44
pw 24,200,92
ex 17
pw 24,204,96
cv 182,16,17
pw 24,208,100
ex 18
qa 28,208,116,48
pw 28,204,112
ex 19
pw 28,200,108
cv 183,18,19
pw 28,196,104
ex 20
qa 32,196,120,52
pw 32,200,124
ex 21
pw 32,204,128
cv 190,20,21
pw 32,208,132
ex 22
pa 24,136,180
ds_read_b32 v255, v12 offset:1024
pa 24,140,184
ex 23
pa 56,148,184
cv 191,22,23
pa 56,144,180
ex 24
pa 88,152,180
pa 88,156,184
ex 25
pa 120,164,184
cv 198,24,25
pa 120,160,180
s_waitcnt lgkmcnt(0)
v_cmp_gt_u32 vcc, 4, v255
pa 152,168,180
ex 26
pa 152,172,184
s_cbranch_vccnz LsX4
LrX4:
lk 196,0,32768
global_load_lds_dwordx4 v12, s[96:97] offset:0 nt
pa 156,172,192
lk 200,1,32768
v_mov_b32 v255, 5
pa 156,168,188
lk 204,2,32768
pa 124,160,188
lk 208,3,32768
pa 124,164,192
ex 27
pa 92,156,192
lv 180,4,16384
cv 199,26,27
pa 92,152,188
ex 28
pa 60,144,188
ex 29
pa 60,148,192
ex 30
pa 28,140,192
ex 31
pa 28,136,188
lv 182,4,20480
cv 206,28,29
v_smfmac_f32_16x16x64_bf16 a[168:171], a[172:175], v[168:175], v14
s_waitcnt lgkmcnt(2)
lv 184,4,24576
qa 16,196,56,36
lv 186,4,28672
cv 207,30,31
pw 16,200,60
global_load_lds_dwordx4 v13, s[96:97] offset:1024 nt
lv 192,5,24576
pw 16,204,64
ex 32
pw 16,208,68
ex 33
qa 20,208,84,40
ex 34
pw 20,204,80
ex 35
pw 20,200,76
lv 194,5,28672
cv 214,32,33
pw 20,196,72
lv 188,5,16384
cv 215,34,35
qa 24,196,88,44
lv 190,5,20480
pw 24,200,92
ex 16
pw 24,204,96
ex 17
pw 24,208,100
ex 18
qa 28,208,116,48
cv 136,16,17
pw 28,204,112
ex 19
pw 28,200,108
cv 137,18,19
pw 28,196,104
ex 20
qa 32,196,120,52
global_load_lds_dwordx4 v12, s[96:97] offset:2048 nt
lk 196,0,36864
pw 32,200,124
lk 200,1,36864
pw 32,204,128
lk 204,2,36864
pw 32,208,132
s_waitcnt lgkmcnt(3)
lk 208,3,36864
pa 0,176,180
ex 21
pa 0,180,184
ex 22
pa 32,188,184
ex 23
pa 32,184,180
buffer_load_dwordx4 v[228:231], v15, s[4:7], s36 offen offset:128 nt
pa 64,192,180
s_add_u32 s36, s26, 4096
cv 144,20,21
cv 145,22,23
pa 64,196,184
ex 24
pa 96,204,184
ex 25
pa 96,200,180
ex 26
pa 128,208,180
lv 180,6,16384
cv 152,24,25
pa 128,212,184
ex 27
pa 132,212,192
lv 182,6,20480
cv 153,26,27
pa 132,208,188
ex 28
pa 100,200,188
lv 184,6,24576
pa 100,204,192
ex 29
pa 68,196,192
lv 186,6,28672
cv 160,28,29
pa 68,192,188
ex 30
pa 36,184,188
pa 36,188,192
ex 31
pa 4,180,192
lv 192,7,24576
cv 161,30,31
pa 4,176,188
s_waitcnt lgkmcnt(3)
global_load_lds_dwordx4 v13, s[96:97] offset:3072 nt
s_add_u32 m0, s21, 98304
v_smfmac_f32_16x16x64_bf16 a[160:163], a[172:175], v[176:183], v14
s_add_u32 s96, s96, 16384
s_addc_u32 s97, s97, 0
qa 16,196,56,36
ex 32
pw 16,200,60
ex 33
pw 16,204,64
ex 34
pw 16,208,68
lv 194,7,28672
cv 168,32,33
qa 20,208,84,40
ex 35
pw 20,204,80
global_load_lds_dwordx4 v12, s[98:99] offset:0 nt
cv 169,34,35
pw 20,200,76
lv 188,7,16384
pw 20,196,72
lv 190,7,20480
qa 24,196,88,44
ex 16
pw 24,200,92
ex 17
pw 24,204,96
buffer_load_dwordx4 v[232:235], v15, s[4:7], s37 offen offset:160 nt
pw 24,208,100
s_add_u32 s37, s26, 4096
ex 18
qa 28,208,116,48
cv 138,16,17
pw 28,204,112
ex 19
pw 28,200,108
cv 139,18,19
pw 28,196,104
ex 20
qa 32,196,120,52
lk 196,0,40960
pw 32,200,124
lk 200,1,40960
pw 32,204,128
lk 204,2,40960
pw 32,208,132
lk 208,3,40960
pa 8,176,180
s_waitcnt lgkmcnt(4)
ex 21
pa 8,180,184
ex 22
pa 40,188,184
ex 23
pa 40,184,180
cv 146,20,21
cv 147,22,23
pa 72,192,180
ex 24
pa 72,196,184
ex 25
pa 104,204,184
global_load_lds_dwordx4 v13, s[98:99] offset:1024 nt
cv 154,24,25
pa 104,200,180
ex 26
pa 136,208,180
lv 180,8,16384
pa 136,212,184
ex 27
pa 140,212,192
lv 182,8,20480
cv 155,26,27
pa 140,208,188
ex 28
pa 108,200,188
lv 184,8,24576
pa 108,204,192
ex 29
pa 76,196,192
lv 186,8,28672
cv 162,28,29
pa 76,192,188
global_load_lds_dwordx4 v12, s[98:99] offset:2048 nt
pa 44,184,188
ex 30
pa 44,188,192
ex 31
pa 12,180,192
lv 192,9,24576
cv 163,30,31
pa 12,176,188
ex 32
v_smfmac_f32_16x16x64_bf16 a[160:163], a[176:179], v[184:191], v14
s_waitcnt lgkmcnt(2)
lv 194,9,28672
qa 16,196,56,36
ex 33
pw 16,200,60
lv 188,9,16384
cv 170,32,33
pw 16,204,64
ex 34
pw 16,208,68
lv 190,9,20480
qa 20,208,84,40
ex 35
pw 20,204,80
cv 171,34,35
s_nop 0
pw 20,200,76
pw 20,196,72
ex 16
qa 24,196,88,44
pw 24,200,92
global_load_lds_dwordx4 v13, s[98:99] offset:3072 nt
s_add_u32 m0, s21, 65536
pw 24,204,96
s_add_u32 s98, s98, 16384
s_addc_u32 s99, s99, 0
pw 24,208,100
ex 17
qa 28,208,116,48
ex 18
pw 28,204,112
ex 19
pw 28,200,108
cv 140,16,17
cv 141,18,19
pw 28,196,104
ex 20
qa 32,196,120,52
lk 196,0,45056
pw 32,200,124
lk 200,1,45056
pw 32,204,128
lk 204,2,45056
pw 32,208,132
lk 208,3,45056
pa 16,176,180
s_waitcnt lgkmcnt(4)
ex 21
pa 16,180,184
ex 22
pa 48,188,184
ex 23
pa 48,184,180
cv 148,20,21
cv 149,22,23
pa 80,192,180
ex 24
pa 80,196,184
ex 25
pa 112,204,184
s_waitcnt vmcnt(14)
cv 156,24,25
v_lshlrev_b32 v252, 16, v220
pa 112,200,180
ex 26
pa 144,208,180
lv 180,10,16384
v_and_b32 v253, s28, v220
pa 144,212,184
ex 27
pa 148,212,192
lv 182,10,20480
cv 157,26,27
pa 148,208,188
lv 184,10,24576
v_mul_f32 v252, s22, v252
pa 116,200,188
lv 186,10,28672
v_mul_f32 v253, s22, v253
pa 116,204,192
ex 28
pa 84,196,192
ex 29
pa 84,192,188
ex 30
pa 52,184,188
cv 164,28,29
cv 252,252,253
pa 52,188,192
ex 31
pa 20,180,192
lv 192,11,24576
cv 165,30,31
pa 20,176,188
lv 194,11,28672
v_accvgpr_write_b32 a212, v252
v_smfmac_f32_16x16x64_bf16 a[164:167], a[172:175], v[192:199], v14
lv 188,11,16384
v_smfmac_f32_16x16x64_bf16 a[164:167], a[176:179], v[200:207], v14
s_waitcnt lgkmcnt(3)
lv 190,11,20480
qa 16,196,56,36
s_nop 0
ds_write_b32 v254, v255 offset:0
pw 16,200,60
ex 32
pw 16,204,64
ex 33
pw 16,208,68
ex 34
qa 20,208,84,40
ex 35
pw 20,204,80
cv 172,32,33
cv 173,34,35
pw 20,200,76
v_lshlrev_b32 v252, 16, v221
v_and_b32 v253, s28, v221
pw 20,196,72
ex 16
qa 24,196,88,44
v_mul_f32 v252, s22, v252
v_mul_f32 v253, s22, v253
pw 24,200,92
ex 17
pw 24,204,96
cv 142,16,17
cv 252,252,253
pw 24,208,100
ex 18
qa 28,208,116,48
v_accvgpr_write_b32 a213, v252
v_lshlrev_b32 v252, 16, v222
pw 28,204,112
ex 19
pw 28,200,108
cv 143,18,19
v_and_b32 v253, s28, v222
pw 28,196,104
ex 20
qa 32,196,120,52
v_mul_f32 v252, s22, v252
v_mul_f32 v253, s22, v253
pw 32,200,124
ex 21
pw 32,204,128
cv 150,20,21
cv 252,252,253
pw 32,208,132
ex 22
pa 24,176,180
ds_read_b32 v255, v12 offset:1024
v_accvgpr_write_b32 a214, v252
pa 24,180,184
ex 23
pa 56,188,184
cv 151,22,23
v_lshlrev_b32 v252, 16, v223
pa 56,184,180
ex 24
pa 88,192,180
v_and_b32 v253, s28, v223
v_mul_f32 v252, s22, v252
pa 88,196,184
ex 25
pa 120,204,184
cv 158,24,25
v_mul_f32 v253, s22, v253
pa 120,200,180
s_waitcnt lgkmcnt(0)
v_cmp_gt_u32 vcc, 5, v255
cv 252,252,253
pa 152,208,180
ex 26
pa 152,212,184
s_cbranch_vccnz LsX5
LrX5:
lk 196,0,49152
global_load_lds_dwordx4 v12, s[96:97] offset:0 nt
pa 156,212,192
lk 200,1,49152
v_mov_b32 v255, 6
pa 156,208,188
lk 204,2,49152
v_accvgpr_write_b32 a215, v252
pa 124,200,188
s_waitcnt vmcnt(12)
lk 208,3,49152
v_lshlrev_b32 v252, 16, v224
pa 124,204,192
ex 27
pa 92,196,192
lv 180,4,32768
cv 159,26,27
pa 92,192,188
ex 28
pa 60,184,188
ex 29
pa 60,188,192
ex 30
pa 28,180,192
ex 31
pa 28,176,188
lv 182,4,36864
cv 166,28,29
v_smfmac_f32_16x16x64_bf16 a[168:171], a[172:175], v[208:215], v14
s_waitcnt lgkmcnt(2)
lv 184,4,40960
qa 16,196,56,36
lv 186,4,45056
cv 167,30,31
pw 16,200,60
global_load_lds_dwordx4 v13, s[96:97] offset:1024 nt
lv 192,5,40960
pw 16,204,64
ex 32
pw 16,208,68
ex 33
qa 20,208,84,40
ex 34
pw 20,204,80
ex 35
pw 20,200,76
lv 194,5,45056
cv 174,32,33
pw 20,196,72
lv 188,5,32768
cv 175,34,35
qa 24,196,88,44
lv 190,5,36864
v_and_b32 v253, s28, v224
pw 24,200,92
ex 16
pw 24,204,96
ex 17
pw 24,208,100
ex 18
qa 28,208,116,48
buffer_load_dwordx4 v[236:239], v15, s[4:7], s38 offen offset:0 nt
pw 28,204,112
s_add_u32 s38, s26, 8192
ex 19
pw 28,200,108
cv 176,16,17
cv 177,18,19
pw 28,196,104
ex 20
qa 32,196,120,52
lk 196,0,53248
v_mul_f32 v252, s22, v252
pw 32,200,124
lk 200,1,53248
v_mul_f32 v253, s22, v253
pw 32,204,128
lk 204,2,53248
cv 252,252,253
pw 32,208,132
s_waitcnt lgkmcnt(3)
lk 208,3,53248
v_accvgpr_write_b32 a216, v252
pa 0,136,180
ex 21
pa 0,140,184
ex 22
pa 32,148,184
ex 23
pa 32,144,180
cv 184,20,21
cv 185,22,23
pa 64,152,180
ex 24
pa 64,156,184
ex 25
pa 96,164,184
cv 192,24,25
v_lshlrev_b32 v252, 16, v225
pa 96,160,180
ex 26
pa 128,168,180
global_load_lds_dwordx4 v12, s[96:97] offset:2048 nt
lv 180,6,32768
pa 128,172,184
ex 27
pa 132,172,192
lv 182,6,36864
cv 193,26,27
pa 132,168,188
ex 28
pa 100,160,188
global_load_lds_dwordx4 v13, s[96:97] offset:3072 nt
lv 184,6,40960
pa 100,164,192
s_add_u32 m0, s21, 114688
ex 29
pa 68,156,192
s_add_u32 s96, s96, 16384
s_addc_u32 s97, s97, 0

LwX0_4:
s_cbranch_vccnz LwX0_8
lv 186,6,45056
pa 68,152,188
ex 30
pa 36,144,188
buffer_load_dwordx4 v[240:243], v15, s[4:7], s39 offen offset:32 nt
pa 36,148,192
s_add_u32 s39, s26, 8192
ex 31
pa 4,140,192
lv 192,7,40960
cv 200,28,29
pa 4,136,188
lv 194,7,45056
cv 201,30,31
v_smfmac_f32_16x16x64_bf16 a[160:163], a[172:175], v[136:143], v14
s_waitcnt lgkmcnt(3)
lv 188,7,32768
qa 16,196,56,36
ex 32
pw 16,200,60
ex 33
pw 16,204,64
ex 34
pw 16,208,68
lv 190,7,36864
cv 208,32,33
qa 20,208,84,40
ex 35
pw 20,204,80
cv 209,34,35
v_and_b32 v253, s28, v225
pw 20,200,76
v_mul_f32 v252, s22, v252
v_mul_f32 v253, s22, v253
pw 20,196,72
ex 16
qa 24,196,88,44
cv 252,252,253
v_accvgpr_write_b32 a217, v252
pw 24,200,92
ex 17
pw 24,204,96
cv 178,16,17
v_lshlrev_b32 v252, 16, v226
pw 24,208,100
global_load_lds_dwordx4 v12, s[98:99] offset:0 nt
v_and_b32 v253, s28, v226
qa 28,208,116,48
ex 18
pw 28,204,112
ex 19
pw 28,200,108
cv 179,18,19
v_mul_f32 v252, s22, v252
pw 28,196,104
ex 20
qa 32,196,120,52
lk 196,0,57344
v_mul_f32 v253, s22, v253
pw 32,200,124
lk 200,1,57344
cv 252,252,253
pw 32,204,128
lk 204,2,57344
v_accvgpr_write_b32 a218, v252
pw 32,208,132
lk 208,3,57344
v_lshlrev_b32 v252, 16, v227
pa 8,136,180
s_waitcnt lgkmcnt(4)
global_load_lds_dwordx4 v13, s[98:99] offset:1024 nt
v_and_b32 v253, s28, v227
pa 8,140,184
ex 21
pa 40,148,184
ex 22
pa 40,144,180
ex 23
pa 72,152,180
cv 186,20,21
cv 187,22,23
pa 72,156,184
ex 24
pa 104,164,184
ex 25
pa 104,160,180
ex 26
pa 136,168,180
lv 180,8,32768
cv 194,24,25
pa 136,172,184
ex 27
pa 140,172,192
lv 182,8,36864
cv 195,26,27
pa 140,168,188
ex 28
pa 108,160,188
lv 184,8,40960
v_mul_f32 v252, s22, v252
pa 108,164,192
ex 29
pa 76,156,192
lv 186,8,45056
cv 202,28,29
pa 76,152,188
global_load_lds_dwordx4 v12, s[98:99] offset:2048 nt
v_mul_f32 v253, s22, v253
pa 44,144,188
ex 30
pa 44,148,192
ex 31
pa 12,140,192
lv 192,9,40960
cv 203,30,31
pa 12,136,188
ex 32
v_smfmac_f32_16x16x64_bf16 a[160:163], a[176:179], v[144:151], v14
s_waitcnt lgkmcnt(2)
lv 194,9,45056
qa 16,196,56,36
ex 33
pw 16,200,60
lv 188,9,32768
cv 210,32,33
pw 16,204,64
ex 34
pw 16,208,68
lv 190,9,36864
cv 252,252,253
qa 20,208,84,40
ex 35
pw 20,204,80
cv 211,34,35
v_accvgpr_write_b32 a219, v252
pw 20,200,76
s_waitcnt vmcnt(15)
v_lshlrev_b32 v252, 16, v228
v_and_b32 v253, s28, v228
pw 20,196,72
ex 16
qa 24,196,88,44
v_mul_f32 v252, s22, v252
v_mul_f32 v253, s22, v253
pw 24,200,92
global_load_lds_dwordx4 v13, s[98:99] offset:3072 nt
s_add_u32 m0, s21, 81920
pw 24,204,96
s_add_u32 s98, s98, 16384
s_addc_u32 s99, s99, 0
cv 252,252,253
pw 24,208,100
ex 17
qa 28,208,116,48
ex 18
pw 28,204,112
ex 19
pw 28,200,108
cv 180,16,17
cv 181,18,19
pw 28,196,104
ex 20
qa 32,196,120,52
lk 196,0,61440
v_accvgpr_write_b32 a220, v252
pw 32,200,124
lk 200,1,61440
v_lshlrev_b32 v252, 16, v229
pw 32,204,128
lk 204,2,61440
v_and_b32 v253, s28, v229
pw 32,208,132
lk 208,3,61440
v_mul_f32 v252, s22, v252
pa 16,136,180
s_waitcnt lgkmcnt(4)
ex 21
pa 16,140,184
ex 22
pa 48,148,184
ex 23
pa 48,144,180
cv 188,20,21
cv 189,22,23
pa 80,152,180
ex 24
pa 80,156,184
ex 25
pa 112,164,184
cv 196,24,25
v_mul_f32 v253, s22, v253
pa 112,160,180
ex 26
pa 144,168,180
lv 180,10,32768
cv 252,252,253
pa 144,172,184
ex 27
pa 148,172,192
lv 182,10,36864
cv 197,26,27
pa 148,168,188
lv 184,10,40960
v_accvgpr_write_b32 a221, v252
pa 116,160,188
lv 186,10,45056
v_lshlrev_b32 v252, 16, v230
pa 116,164,192
ex 28
pa 84,156,192
ex 29
pa 84,152,188
ex 30
pa 52,144,188
cv 204,28,29
v_and_b32 v253, s28, v230
pa 52,148,192
ex 31
pa 20,140,192
lv 192,11,40960
cv 205,30,31
pa 20,136,188
lv 194,11,45056
v_mul_f32 v252, s22, v252
v_smfmac_f32_16x16x64_bf16 a[164:167], a[172:175], v[152:159], v14
lv 188,11,32768
v_smfmac_f32_16x16x64_bf16 a[164:167], a[176:179], v[160:167], v14
s_waitcnt lgkmcnt(3)
lv 190,11,36864
qa 16,196,56,36
s_nop 0
ds_write_b32 v254, v255 offset:0
pw 16,200,60
ex 32
pw 16,204,64
ex 33
pw 16,208,68
ex 34
qa 20,208,84,40
ex 35
pw 20,204,80
cv 212,32,33
cv 213,34,35
pw 20,200,76
v_mul_f32 v253, s22, v253
cv 252,252,253
pw 20,196,72
ex 16
qa 24,196,88,44
buffer_load_dwordx4 v[244:247], v15, s[4:7], s36 offen offset:128 nt
pw 24,200,92
s_add_u32 s36, s26, 8192
ex 17
pw 24,204,96
cv 182,16,17
v_accvgpr_write_b32 a222, v252
pw 24,208,100
ex 18
qa 28,208,116,48
v_lshlrev_b32 v252, 16, v231
v_and_b32 v253, s28, v231
pw 28,204,112
ex 19
pw 28,200,108
cv 183,18,19
v_mul_f32 v252, s22, v252
pw 28,196,104
ex 20
qa 32,196,120,52
v_mul_f32 v253, s22, v253
cv 252,252,253
pw 32,200,124
ex 21
pw 32,204,128
cv 190,20,21
v_accvgpr_write_b32 a223, v252
pw 32,208,132
ex 22
pa 24,136,180
s_waitcnt vmcnt(14)
ds_read_b32 v255, v12 offset:1024
v_lshlrev_b32 v252, 16, v232
pa 24,140,184
ex 23
pa 56,148,184
cv 191,22,23
v_and_b32 v253, s28, v232
pa 56,144,180
ex 24
pa 88,152,180
buffer_load_dwordx4 v[248:251], v15, s[4:7], s37 offen offset:160 nt
pa 88,156,184
s_add_u32 s37, s26, 8192
ex 25
pa 120,164,184
cv 198,24,25
v_mul_f32 v252, s22, v252
pa 120,160,180
s_waitcnt lgkmcnt(0)
v_cmp_gt_u32 vcc, 6, v255
v_mul_f32 v253, s22, v253
pa 152,168,180
ex 26
pa 152,172,184
s_cbranch_vccnz LsX6
LrX6:
lk 196,0,0
v_mov_b32 v255, 7
pa 156,172,192
lk 200,1,0
cv 252,252,253
pa 156,168,188
lk 204,2,0
v_accvgpr_write_b32 a224, v252
pa 124,160,188
lk 208,3,0
v_lshlrev_b32 v252, 16, v233
pa 124,164,192
ex 27
pa 92,156,192
lv 180,4,49152
cv 199,26,27
pa 92,152,188
ex 28
pa 60,144,188
ex 29
pa 60,148,192
ex 30
pa 28,140,192
ex 31
pa 28,136,188
lv 182,4,53248
cv 206,28,29
v_smfmac_f32_16x16x64_bf16 a[168:171], a[172:175], v[168:175], v14
s_waitcnt lgkmcnt(2)
global_load_lds_dwordx4 v12, s[96:97] offset:0 nt
qa 16,196,56,36
lv 184,4,57344
cv 207,30,31
pw 16,200,60
lv 186,4,61440
v_and_b32 v253, s28, v233
pw 16,204,64
ex 32
pw 16,208,68
ex 33
qa 20,208,84,40
global_load_lds_dwordx4 v13, s[96:97] offset:1024 nt
cv 214,32,33
pw 20,204,80
ex 34
pw 20,200,76
ex 35
pw 20,196,72
lv 192,5,57344
cv 215,34,35
qa 24,196,88,44
lv 194,5,61440
v_mul_f32 v252, s22, v252
pw 24,200,92
lv 188,5,49152
v_mul_f32 v253, s22, v253
pw 24,204,96
lv 190,5,53248
cv 252,252,253
pw 24,208,100
ex 16
qa 28,208,116,48
ex 17
pw 28,204,112
ex 18
pw 28,200,108
ex 19
pw 28,196,104
cv 136,16,17
cv 137,18,19
qa 32,196,120,52
global_load_lds_dwordx4 v12, s[96:97] offset:2048 nt
lk 196,0,4096
pw 32,200,124
lk 200,1,4096
v_accvgpr_write_b32 a225, v252
pw 32,204,128
lk 204,2,4096
v_lshlrev_b32 v252, 16, v234
pw 32,208,132
s_waitcnt lgkmcnt(3)
lk 208,3,4096
v_and_b32 v253, s28, v234
pa 0,176,180
ex 20
pa 0,180,184
ex 21
pa 32,188,184
ex 22
pa 32,184,180
ex 23
pa 64,192,180
cv 144,20,21
cv 145,22,23
pa 64,196,184
ex 24
pa 96,204,184
ex 25
pa 96,200,180
ex 26
pa 128,208,180
lv 180,6,49152
cv 152,24,25
pa 128,212,184
ex 27
pa 132,212,192
lv 182,6,53248
cv 153,26,27
pa 132,208,188
global_load_lds_dwordx4 v13, s[96:97] offset:3072 nt
lv 184,6,57344
pa 100,200,188
s_add_u32 m0, s21, 131072
ex 28
pa 100,204,192
s_add_u32 s96, s96, 16384
s_addc_u32 s97, s97, 0
lv 186,6,61440
pa 68,196,192
ex 29
pa 68,192,188
ex 30
pa 36,184,188
cv 160,28,29
v_mul_f32 v252, s22, v252
pa 36,188,192
ex 31
pa 4,180,192
lv 192,7,57344
cv 161,30,31
pa 4,176,188
ex 32
v_smfmac_f32_16x16x64_bf16 a[160:163], a[172:175], v[176:183], v14
s_waitcnt lgkmcnt(2)
lv 194,7,61440
qa 16,196,56,36
ex 33
pw 16,200,60
lv 188,7,49152
cv 168,32,33
pw 16,204,64
ex 34
pw 16,208,68
lv 190,7,53248
v_mul_f32 v253, s22, v253
qa 20,208,84,40
ex 35
pw 20,204,80
global_load_lds_dwordx4 v12, s[98:99] offset:0 nt
cv 169,34,35
pw 20,200,76
cv 252,252,253
v_accvgpr_write_b32 a226, v252
pw 20,196,72
ex 16
qa 24,196,88,44
v_lshlrev_b32 v252, 16, v235
v_and_b32 v253, s28, v235
pw 24,200,92
ex 17
pw 24,204,96
cv 138,16,17
v_mul_f32 v252, s22, v252
pw 24,208,100
ex 18
qa 28,208,116,48
v_mul_f32 v253, s22, v253
cv 252,252,253
pw 28,204,112
ex 19
pw 28,200,108
cv 139,18,19
v_accvgpr_write_b32 a227, v252
pw 28,196,104
ex 20
qa 32,196,120,52
lk 196,0,8192
pw 32,200,124
lk 200,1,8192
pw 32,204,128
lk 204,2,8192
pw 32,208,132
lk 208,3,8192
pa 8,176,180
s_waitcnt lgkmcnt(4)
global_load_lds_dwordx4 v13, s[98:99] offset:1024 nt
pa 8,180,184
ex 21
pa 40,188,184
ex 22
pa 40,184,180
ex 23
pa 72,192,180
cv 146,20,21
cv 147,22,23
pa 72,196,184
ex 24
pa 104,204,184
ex 25
pa 104,200,180
ex 26
pa 136,208,180
lv 180,8,49152
cv 154,24,25
pa 136,212,184
ex 27
pa 140,212,192
lv 182,8,53248
cv 155,26,27
pa 140,208,188
ex 28
pa 108,200,188
s_waitcnt vmcnt(15)
lv 184,8,57344
v_lshlrev_b32 v252, 16, v236
pa 108,204,192
ex 29
pa 76,196,192
lv 186,8,61440
cv 162,28,29
pa 76,192,188
global_load_lds_dwordx4 v12, s[98:99] offset:2048 nt
v_and_b32 v253, s28, v236
pa 44,184,188
ex 30
pa 44,188,192
ex 31
pa 12,180,192
lv 192,9,57344
cv 163,30,31
pa 12,176,188
ex 32
v_smfmac_f32_16x16x64_bf16 a[160:163], a[176:179], v[184:191], v14
s_waitcnt lgkmcnt(2)
lv 194,9,61440
qa 16,196,56,36
ex 33
pw 16,200,60
lv 188,9,49152
cv 170,32,33
pw 16,204,64
ex 34
pw 16,208,68
lv 190,9,53248
v_mul_f32 v252, s22, v252
qa 20,208,84,40
ex 35
pw 20,204,80
cv 171,34,35
v_mul_f32 v253, s22, v253
pw 20,200,76
cv 252,252,253
v_accvgpr_write_b32 a228, v252
pw 20,196,72
ex 16
qa 24,196,88,44
v_lshlrev_b32 v252, 16, v237
v_and_b32 v253, s28, v237
pw 24,200,92
global_load_lds_dwordx4 v13, s[98:99] offset:3072 nt
s_add_u32 m0, s21, 32768
pw 24,204,96
s_add_u32 s98, s98, 16384
s_addc_u32 s99, s99, 0
v_mul_f32 v252, s22, v252
pw 24,208,100
ex 17
qa 28,208,116,48
ex 18
pw 28,204,112
ex 19
pw 28,200,108
cv 140,16,17
cv 141,18,19
pw 28,196,104
ex 20
qa 32,196,120,52
lk 196,0,12288
v_mul_f32 v253, s22, v253
pw 32,200,124
lk 200,1,12288
cv 252,252,253
pw 32,204,128
lk 204,2,12288
v_accvgpr_write_b32 a229, v252
pw 32,208,132
lk 208,3,12288
v_lshlrev_b32 v252, 16, v238
pa 16,176,180
s_waitcnt lgkmcnt(4)
ex 21
pa 16,180,184
ex 22
pa 48,188,184

LwX0_5:
s_cbranch_vccnz LwX0_9
ex 23
pa 48,184,180
cv 148,20,21
cv 149,22,23
pa 80,192,180
ex 24
pa 80,196,184
ex 25
pa 112,204,184
buffer_load_dwordx4 a[244:247], v15, s[4:7], s38 offen offset:0 nt
pa 112,200,180
s_add_u32 s38, s26, 12288
ex 26
pa 144,208,180
lv 180,10,49152
cv 156,24,25
pa 144,212,184
ex 27
pa 148,212,192
lv 182,10,53248
cv 157,26,27
pa 148,208,188
lv 184,10,57344
v_and_b32 v253, s28, v238
pa 116,200,188
lv 186,10,61440
v_mul_f32 v252, s22, v252
pa 116,204,192
ex 28
pa 84,196,192
ex 29
pa 84,192,188
ex 30
pa 52,184,188
cv 164,28,29
v_mul_f32 v253, s22, v253
pa 52,188,192
ex 31
pa 20,180,192
lv 192,11,57344
cv 165,30,31
pa 20,176,188
lv 194,11,61440
cv 252,252,253
v_smfmac_f32_16x16x64_bf16 a[164:167], a[172:175], v[192:199], v14
lv 188,11,49152
v_smfmac_f32_16x16x64_bf16 a[164:167], a[176:179], v[200:207], v14
s_waitcnt lgkmcnt(3)
lv 190,11,53248
qa 16,196,56,36
s_nop 0
ds_write_b32 v254, v255 offset:0
pw 16,200,60
ex 32
pw 16,204,64
ex 33
pw 16,208,68
ex 34
qa 20,208,84,40
ex 35
pw 20,204,80
buffer_load_dwordx4 a[248:251], v15, s[4:7], s39 offen offset:32 nt
pw 20,200,76
s_add_u32 s39, s26, 12288
cv 172,32,33
cv 173,34,35
pw 20,196,72
ex 16
qa 24,196,88,44
v_accvgpr_write_b32 a230, v252
v_lshlrev_b32 v252, 16, v239
pw 24,200,92
ex 17
pw 24,204,96
cv 142,16,17
v_and_b32 v253, s28, v239
pw 24,208,100
ex 18
qa 28,208,116,48
v_mul_f32 v252, s22, v252
v_mul_f32 v253, s22, v253
pw 28,204,112
ex 19
pw 28,200,108
cv 143,18,19
cv 252,252,253
pw 28,196,104
ex 20
qa 32,196,120,52
s_waitcnt vmcnt(16)
v_accvgpr_write_b32 a231, v252
v_lshlrev_b32 v252, 16, v240
pw 32,200,124
ex 21
pw 32,204,128
cv 150,20,21
v_and_b32 v253, s28, v240
pw 32,208,132
ex 22
pa 24,176,180
ds_read_b32 v255, v12 offset:1024
v_mul_f32 v252, s22, v252
pa 24,180,184
ex 23
pa 56,188,184
cv 151,22,23
v_mul_f32 v253, s22, v253
pa 56,184,180
ex 24
pa 88,192,180
cv 252,252,253
v_accvgpr_write_b32 a232, v252
pa 88,196,184
ex 25
pa 120,204,184
cv 158,24,25
v_lshlrev_b32 v252, 16, v241
pa 120,200,180
s_waitcnt lgkmcnt(0)
v_cmp_gt_u32 vcc, 7, v255
v_and_b32 v253, s28, v241
pa 152,208,180
ex 26
pa 152,212,184
s_cbranch_vccnz LsX7
LrX7:
lk 196,0,16384
global_load_lds_dwordx4 v12, s[96:97] offset:0 nt
pa 156,212,192
lk 200,1,16384
v_mov_b32 v255, 8
pa 156,208,188
lk 204,2,16384
v_mul_f32 v252, s22, v252
pa 124,200,188
lk 208,3,16384
v_mul_f32 v253, s22, v253
pa 124,204,192
ex 27
pa 92,196,192
lv 180,4,0
cv 159,26,27
pa 92,192,188
ex 28
pa 60,184,188
ex 29
pa 60,188,192
ex 30
pa 28,180,192
ex 31
pa 28,176,188
lv 182,4,4096
cv 166,28,29
v_smfmac_f32_16x16x64_bf16 a[168:171], a[172:175], v[208:215], v14
s_waitcnt lgkmcnt(2)
lv 184,4,8192
qa 16,196,56,36
lv 186,4,12288
cv 167,30,31
pw 16,200,60
global_load_lds_dwordx4 v13, s[96:97] offset:1024 nt
lv 192,5,8192
pw 16,204,64
ex 32
pw 16,208,68
ex 33
qa 20,208,84,40
ex 34
pw 20,204,80
ex 35
pw 20,200,76
lv 194,5,12288
cv 174,32,33
pw 20,196,72
lv 188,5,0
cv 175,34,35
qa 24,196,88,44
lv 190,5,4096
cv 252,252,253
pw 24,200,92
ex 16
pw 24,204,96
ex 17
pw 24,208,100
ex 18
qa 28,208,116,48
cv 176,16,17
v_accvgpr_write_b32 a233, v252
pw 28,204,112
ex 19
pw 28,200,108
cv 177,18,19
v_lshlrev_b32 v252, 16, v242
pw 28,196,104
ex 20
qa 32,196,120,52
global_load_lds_dwordx4 v12, s[96:97] offset:2048 nt
lk 196,0,20480
pw 32,200,124
lk 200,1,20480
v_and_b32 v253, s28, v242
pw 32,204,128
lk 204,2,20480
v_mul_f32 v252, s22, v252
pw 32,208,132
s_waitcnt lgkmcnt(3)
lk 208,3,20480
v_mul_f32 v253, s22, v253
pa 0,136,180
ex 21
pa 0,140,184
ex 22
pa 32,148,184
ex 23
pa 32,144,180
cv 184,20,21
cv 185,22,23
pa 64,152,180
ex 24
pa 64,156,184
ex 25
pa 96,164,184
cv 192,24,25
cv 252,252,253
pa 96,160,180
ex 26
pa 128,168,180
lv 180,6,0
v_accvgpr_write_b32 a234, v252
pa 128,172,184
ex 27
pa 132,172,192
lv 182,6,4096
cv 193,26,27
pa 132,168,188
global_load_lds_dwordx4 v13, s[96:97] offset:3072 nt
lv 184,6,8192
pa 100,160,188
s_add_u32 m0, s21, 147456
ex 28
pa 100,164,192
s_add_u32 s96, s96, 16384
s_addc_u32 s97, s97, 0
lv 186,6,12288
pa 68,156,192
ex 29
pa 68,152,188
ex 30
pa 36,144,188
cv 200,28,29
v_lshlrev_b32 v252, 16, v243
pa 36,148,192
ex 31
pa 4,140,192
lv 192,7,8192
cv 201,30,31
pa 4,136,188
ex 32
v_smfmac_f32_16x16x64_bf16 a[160:163], a[172:175], v[136:143], v14
s_waitcnt lgkmcnt(2)
lv 194,7,12288
qa 16,196,56,36
ex 33
pw 16,200,60
lv 188,7,0
cv 208,32,33
pw 16,204,64
ex 34
pw 16,208,68
lv 190,7,4096
v_and_b32 v253, s28, v243
qa 20,208,84,40
ex 35
pw 20,204,80
global_load_lds_dwordx4 v12, s[98:99] offset:0 nt
cv 209,34,35
pw 20,200,76
v_mul_f32 v252, s22, v252
v_mul_f32 v253, s22, v253
pw 20,196,72
ex 16
qa 24,196,88,44
cv 252,252,253
v_accvgpr_write_b32 a235, v252
pw 24,200,92
ex 17
pw 24,204,96
s_waitcnt vmcnt(16)
cv 178,16,17
v_lshlrev_b32 v252, 16, v244
pw 24,208,100
ex 18
qa 28,208,116,48
v_and_b32 v253, s28, v244
v_mul_f32 v252, s22, v252
pw 28,204,112
ex 19
pw 28,200,108
cv 179,18,19
v_mul_f32 v253, s22, v253
pw 28,196,104
ex 20
qa 32,196,120,52
lk 196,0,24576
cv 252,252,253
pw 32,200,124
lk 200,1,24576
v_accvgpr_write_b32 a236, v252
pw 32,204,128
lk 204,2,24576
v_lshlrev_b32 v252, 16, v245
pw 32,208,132
lk 208,3,24576
v_and_b32 v253, s28, v245
pa 8,136,180
s_waitcnt lgkmcnt(4)
global_load_lds_dwordx4 v13, s[98:99] offset:1024 nt
v_mul_f32 v252, s22, v252
pa 8,140,184
ex 21
pa 40,148,184
ex 22
pa 40,144,180
ex 23
pa 72,152,180
cv 186,20,21
cv 187,22,23
pa 72,156,184
ex 24
pa 104,164,184
ex 25
pa 104,160,180
ex 26
pa 136,168,180
lv 180,8,0
cv 194,24,25
pa 136,172,184
ex 27
pa 140,172,192
lv 182,8,4096
cv 195,26,27
pa 140,168,188
ex 28
pa 108,160,188
lv 184,8,8192
v_mul_f32 v253, s22, v253
pa 108,164,192
ex 29
pa 76,156,192
lv 186,8,12288
cv 202,28,29
pa 76,152,188
global_load_lds_dwordx4 v12, s[98:99] offset:2048 nt
cv 252,252,253
pa 44,144,188
ex 30
pa 44,148,192
ex 31
pa 12,140,192
lv 192,9,8192
cv 203,30,31
pa 12,136,188
ex 32
v_smfmac_f32_16x16x64_bf16 a[160:163], a[176:179], v[144:151], v14
s_waitcnt lgkmcnt(2)
lv 194,9,12288
qa 16,196,56,36
ex 33
pw 16,200,60
lv 188,9,0
cv 210,32,33
pw 16,204,64
ex 34
pw 16,208,68
lv 190,9,4096
v_accvgpr_write_b32 a237, v252
qa 20,208,84,40
ex 35
pw 20,204,80
buffer_load_dwordx4 a[252:255], v15, s[4:7], s36 offen offset:128 nt
pw 20,200,76
s_add_u32 s36, s26, 12288
cv 211,34,35
v_lshlrev_b32 v252, 16, v246
pw 20,196,72
ex 16
qa 24,196,88,44
v_and_b32 v253, s28, v246
v_mul_f32 v252, s22, v252
pw 24,200,92
ex 17
pw 24,204,96
cv 180,16,17
v_mul_f32 v253, s22, v253
pw 24,208,100
ex 18
qa 28,208,116,48
cv 252,252,253
v_accvgpr_write_b32 a238, v252
pw 28,204,112
ex 19
pw 28,200,108
cv 181,18,19
v_lshlrev_b32 v252, 16, v247
pw 28,196,104
ex 20
qa 32,196,120,52
lk 196,0,28672
v_and_b32 v253, s28, v247
pw 32,200,124
lk 200,1,28672
v_mul_f32 v252, s22, v252
pw 32,204,128
lk 204,2,28672
v_mul_f32 v253, s22, v253
pw 32,208,132
lk 208,3,28672
cv 252,252,253
pa 16,136,180
s_waitcnt lgkmcnt(4)
ex 21
pa 16,140,184
global_load_lds_dwordx4 v13, s[98:99] offset:3072 nt
cv 188,20,21
pa 48,148,184
s_add_u32 m0, s21, 49152
ex 22
pa 48,144,180
s_add_u32 s98, s98, 16384
s_addc_u32 s99, s99, 0
v_accvgpr_write_b32 a239, v252
pa 80,152,180
ex 23
pa 80,156,184
buffer_load_dwordx4 v[216:219], v15, s[4:7], s37 offen offset:160 nt
pa 112,164,184
s_add_u32 s37, s26, 12288
cv 189,22,23
s_waitcnt vmcnt(20)
v_lshlrev_b32 v252, 16, v248
pa 112,160,180
ex 24
pa 144,168,180
ex 25
pa 144,172,184
ex 26
pa 148,172,192
ex 27
pa 148,168,188
lv 180,10,0
cv 196,24,25
pa 116,160,188
lv 182,10,4096
cv 197,26,27
pa 116,164,192
lv 184,10,8192
v_and_b32 v253, s28, v248
pa 84,156,192
lv 186,10,12288
v_mul_f32 v252, s22, v252
pa 84,152,188
ex 28
pa 52,144,188
ex 29
pa 52,148,192
ex 30
pa 20,140,192
lv 192,11,8192
cv 204,28,29
pa 20,136,188
lv 194,11,12288
v_mul_f32 v253, s22, v253
v_smfmac_f32_16x16x64_bf16 a[164:167], a[172:175], v[152:159], v14
lv 188,11,0
v_smfmac_f32_16x16x64_bf16 a[164:167], a[176:179], v[160:167], v14
s_waitcnt lgkmcnt(4)
lv 190,11,4096
qa 16,196,56,36
s_nop 0
ds_write_b32 v254, v255 offset:0
pw 16,200,60
ex 31
pw 16,204,64
buffer_load_dwordx4 v[220:223], v15, s[4:7], s38 offen offset:0 nt
pw 16,208,68
s_mov_b32 s38, s27
cv 205,30,31
cv 252,252,253
qa 20,208,84,40
ex 32
pw 20,204,80
ex 33
pw 20,200,76
ex 34
pw 20,196,72
ex 35
qa 24,196,88,44
cv 212,32,33
cv 213,34,35
pw 24,200,92
ex 16
pw 24,204,96
ex 17
pw 24,208,100
ex 18
qa 28,208,116,48
cv 182,16,17
v_accvgpr_write_b32 a240, v252
pw 28,204,112
ex 19
pw 28,200,108
cv 183,18,19
v_lshlrev_b32 v252, 16, v249
pw 28,196,104
ex 20
qa 32,196,120,52
v_and_b32 v253, s28, v249
v_mul_f32 v252, s22, v252
pw 32,200,124
ex 21
pw 32,204,128
buffer_load_dwordx4 v[224:227], v15, s[4:7], s39 offen offset:32 nt
pw 32,208,132
s_mov_b32 s39, s27
ex 22
pa 24,136,180
s_waitcnt lgkmcnt(0)
ds_read_b32 v255, v12 offset:1024
cv 190,20,21
pa 24,140,184
ex 23
pa 56,148,184
cv 191,22,23
v_mul_f32 v253, s22, v253
pa 56,144,180
ex 24
pa 88,152,180
cv 252,252,253
v_accvgpr_write_b32 a241, v252
pa 88,156,184
ex 25
pa 120,164,184
cv 198,24,25
v_lshlrev_b32 v252, 16, v250
pa 120,160,180
s_waitcnt lgkmcnt(0)
v_cmp_gt_u32 vcc, 8, v255
v_and_b32 v253, s28, v250
pa 152,168,180
ex 26
pa 152,172,184
s_cbranch_vccnz LsX8
LrX8:
lk 196,0,32768
v_mov_b32 v255, 9
pa 156,172,192
lk 200,1,32768
v_mul_f32 v252, s22, v252
pa 156,168,188
lk 204,2,32768
v_mul_f32 v253, s22, v253
pa 124,160,188
lk 208,3,32768
cv 252,252,253
pa 124,164,192
ex 27
pa 92,156,192
global_load_lds_dwordx4 v12, s[96:97] offset:0 nt
cv 199,26,27
pa 92,152,188
ex 28
pa 60,144,188
ex 29
pa 60,148,192
ex 30
pa 28,140,192
ex 31
pa 28,136,188
lv 180,4,16384
cv 206,28,29
v_smfmac_f32_16x16x64_bf16 a[168:171], a[172:175], v[168:175], v14
s_waitcnt lgkmcnt(1)
lv 182,4,20480
qa 16,196,56,36
lv 184,4,24576
cv 207,30,31
pw 16,200,60
global_load_lds_dwordx4 v13, s[96:97] offset:1024 nt
lv 186,4,28672
pw 16,204,64
ex 32
pw 16,208,68
ex 33
qa 20,208,84,40
ex 34
pw 20,204,80
ex 35
pw 20,200,76
lv 192,5,24576
cv 214,32,33
pw 20,196,72
lv 194,5,28672
cv 215,34,35
qa 24,196,88,44
lv 188,5,16384
v_accvgpr_write_b32 a242, v252
pw 24,200,92
lv 190,5,20480
v_lshlrev_b32 v252, 16, v251
pw 24,204,96

LwX0_6:
s_cbranch_vccnz LwX0_10
ex 16
pw 24,208,100
ex 17
qa 28,208,116,48
ex 18
pw 28,204,112
ex 19
pw 28,200,108
buffer_load_dwordx4 v[228:231], v15, s[4:7], s36 offen offset:128 nt
pw 28,196,104
s_mov_b32 s36, s27
cv 136,16,17
cv 137,18,19
qa 32,196,120,52
lk 196,0,36864
v_and_b32 v253, s28, v251
pw 32,200,124
lk 200,1,36864
v_mul_f32 v252, s22, v252
pw 32,204,128
lk 204,2,36864
v_mul_f32 v253, s22, v253
pw 32,208,132
s_waitcnt lgkmcnt(3)
lk 208,3,36864
cv 252,252,253
pa 0,176,180
ex 20
pa 0,180,184
ex 21
pa 32,188,184
ex 22
pa 32,184,180
ex 23
pa 64,192,180
cv 144,20,21
cv 145,22,23
pa 64,196,184
ex 24
pa 96,204,184
ex 25
pa 96,200,180
ex 26
pa 128,208,180
lv 180,6,16384
cv 152,24,25
pa 128,212,184
ex 27
pa 132,212,192
global_load_lds_dwordx4 v12, s[96:97] offset:2048 nt
cv 153,26,27
pa 132,208,188
ex 28
pa 100,200,188
lv 182,6,20480
v_accvgpr_write_b32 a243, v252
pa 100,204,192
ex 29
pa 68,196,192
global_load_lds_dwordx4 v13, s[96:97] offset:3072 nt
cv 160,28,29
pa 68,192,188
s_add_u32 m0, s21, 98304
ex 30
pa 36,184,188
s_add_u32 s96, s96, 16384
s_addc_u32 s97, s97, 0
lv 184,6,24576
pa 36,188,192
ex 31
pa 4,180,192
lv 186,6,28672
cv 161,30,31
pa 4,176,188
ex 32
v_smfmac_f32_16x16x64_bf16 a[160:163], a[172:175], v[176:183], v14
s_waitcnt lgkmcnt(2)
lv 192,7,24576
qa 16,196,56,36
ex 33
pw 16,200,60
lv 194,7,28672
cv 168,32,33
pw 16,204,64
ex 34
pw 16,208,68
s_waitcnt vmcnt(18)
lv 188,7,16384
v_accvgpr_read_b32 v253, a244
qa 20,208,84,40
ex 35
pw 20,204,80
global_load_lds_dwordx4 v12, s[98:99] offset:0 nt
cv 169,34,35
pw 20,200,76
lv 190,7,20480
v_lshlrev_b32 v252, 16, v253
pw 20,196,72
ex 16
qa 24,196,88,44
v_and_b32 v253, s28, v253
v_mul_f32 v252, s22, v252
pw 24,200,92
ex 17
pw 24,204,96
buffer_load_dwordx4 v[232:235], v15, s[4:7], s37 offen offset:160 nt
pw 24,208,100
s_mov_b32 s37, s27
ex 18
qa 28,208,116,48
cv 138,16,17
v_mul_f32 v253, s22, v253
pw 28,204,112
ex 19
pw 28,200,108
cv 139,18,19
cv 252,252,253
pw 28,196,104
ex 20
qa 32,196,120,52
lk 196,0,40960
v_accvgpr_write_b32 a244, v252
pw 32,200,124
lk 200,1,40960
v_accvgpr_read_b32 v253, a245
pw 32,204,128
lk 204,2,40960
v_lshlrev_b32 v252, 16, v253
pw 32,208,132
lk 208,3,40960
v_and_b32 v253, s28, v253
pa 8,176,180
s_waitcnt lgkmcnt(4)
ex 21
pa 8,180,184
ex 22
pa 40,188,184
ex 23
pa 40,184,180
cv 146,20,21
cv 147,22,23
pa 72,192,180
ex 24
pa 72,196,184
ex 25
pa 104,204,184
global_load_lds_dwordx4 v13, s[98:99] offset:1024 nt
cv 154,24,25
pa 104,200,180
ex 26
pa 136,208,180
lv 180,8,16384
v_mul_f32 v252, s22, v252
pa 136,212,184
ex 27
pa 140,212,192
lv 182,8,20480
cv 155,26,27
pa 140,208,188
ex 28
pa 108,200,188
lv 184,8,24576
v_mul_f32 v253, s22, v253
pa 108,204,192
ex 29
pa 76,196,192
lv 186,8,28672
cv 162,28,29
pa 76,192,188
global_load_lds_dwordx4 v12, s[98:99] offset:2048 nt
cv 252,252,253
pa 44,184,188
ex 30
pa 44,188,192
ex 31
pa 12,180,192
lv 192,9,24576
cv 163,30,31
pa 12,176,188
ex 32
v_smfmac_f32_16x16x64_bf16 a[160:163], a[176:179], v[184:191], v14
s_waitcnt lgkmcnt(2)
lv 194,9,28672
qa 16,196,56,36
ex 33
pw 16,200,60
lv 188,9,16384
cv 170,32,33
pw 16,204,64
ex 34
pw 16,208,68
lv 190,9,20480
v_accvgpr_write_b32 a245, v252
qa 20,208,84,40
ex 35
pw 20,204,80
buffer_load_dwordx4 v[236:239], v15, s[4:7], s38 offen offset:0 nt
pw 20,200,76
s_add_u32 s38, s21, 2048
cv 171,34,35
v_accvgpr_read_b32 v253, a246
pw 20,196,72
ex 16
qa 24,196,88,44
v_lshlrev_b32 v252, 16, v253
v_and_b32 v253, s28, v253
pw 24,200,92
ex 17
pw 24,204,96
cv 140,16,17
v_mul_f32 v252, s22, v252
pw 24,208,100
ex 18
qa 28,208,116,48
v_mul_f32 v253, s22, v253
cv 252,252,253
pw 28,204,112
ex 19
pw 28,200,108
cv 141,18,19
v_accvgpr_write_b32 a246, v252
pw 28,196,104
ex 20
qa 32,196,120,52
lk 196,0,45056
v_accvgpr_read_b32 v253, a247
pw 32,200,124
lk 200,1,45056
v_lshlrev_b32 v252, 16, v253
pw 32,204,128
lk 204,2,45056
v_and_b32 v253, s28, v253
pw 32,208,132
lk 208,3,45056
v_mul_f32 v252, s22, v252
pa 16,176,180
s_waitcnt lgkmcnt(4)
ex 21
pa 16,180,184
global_load_lds_dwordx4 v13, s[98:99] offset:3072 nt
cv 148,20,21
pa 48,188,184
s_add_u32 m0, s21, 65536
ex 22
pa 48,184,180
s_add_u32 s98, s98, 16384
s_addc_u32 s99, s99, 0
v_mul_f32 v253, s22, v253
pa 80,192,180
ex 23
pa 80,196,184
buffer_load_dwordx4 v[240:243], v15, s[4:7], s39 offen offset:32 nt
pa 112,204,184
s_add_u32 s39, s21, 0
cv 149,22,23
cv 252,252,253
pa 112,200,180
ex 24
pa 144,208,180
ex 25
pa 144,212,184
ex 26
pa 148,212,192
ex 27
pa 148,208,188
lv 180,10,16384
cv 156,24,25
pa 116,200,188
lv 182,10,20480
cv 157,26,27
pa 116,204,192
lv 184,10,24576
v_accvgpr_write_b32 a247, v252
pa 84,196,192
s_waitcnt vmcnt(24)
lv 186,10,28672
v_accvgpr_read_b32 v253, a248
pa 84,192,188
ex 28
pa 52,184,188
ex 29
pa 52,188,192
ex 30
pa 20,180,192
lv 192,11,24576
cv 164,28,29
pa 20,176,188
lv 194,11,28672
v_lshlrev_b32 v252, 16, v253
v_smfmac_f32_16x16x64_bf16 a[164:167], a[172:175], v[192:199], v14
lv 188,11,16384
v_smfmac_f32_16x16x64_bf16 a[164:167], a[176:179], v[200:207], v14
s_waitcnt lgkmcnt(4)
lv 190,11,20480
qa 16,196,56,36
s_nop 0
ds_write_b32 v254, v255 offset:0
pw 16,200,60
ex 31
pw 16,204,64
buffer_load_dwordx4 v[244:247], v15, s[4:7], s36 offen offset:128 nt
pw 16,208,68
s_add_u32 s36, s24, 8192
cv 165,30,31
v_and_b32 v253, s28, v253
qa 20,208,84,40
ex 32
pw 20,204,80
ex 33
pw 20,200,76
ex 34
pw 20,196,72
ex 35
qa 24,196,88,44
cv 172,32,33
cv 173,34,35
pw 24,200,92
ex 16
pw 24,204,96
ex 17
pw 24,208,100
ex 18
qa 28,208,116,48
cv 142,16,17
v_mul_f32 v252, s22, v252
pw 28,204,112
ex 19
pw 28,200,108
cv 143,18,19
v_mul_f32 v253, s22, v253
pw 28,196,104
ex 20
qa 32,196,120,52
cv 252,252,253
v_accvgpr_write_b32 a248, v252
pw 32,200,124
ex 21
pw 32,204,128
buffer_load_dwordx4 v[248:251], v15, s[4:7], s37 offen offset:160 nt
pw 32,208,132
s_add_u32 s37, s24, 12288
ex 22
pa 24,176,180
s_waitcnt lgkmcnt(0)
ds_read_b32 v255, v12 offset:1024
cv 150,20,21
pa 24,180,184
ex 23
pa 56,188,184
cv 151,22,23
v_accvgpr_read_b32 v253, a249
pa 56,184,180
ex 24
pa 88,192,180
v_lshlrev_b32 v252, 16, v253
v_and_b32 v253, s28, v253
pa 88,196,184
ex 25
pa 120,204,184
cv 158,24,25
v_mul_f32 v252, s22, v252
pa 120,200,180
s_waitcnt lgkmcnt(0)
v_cmp_gt_u32 vcc, 9, v255
v_mul_f32 v253, s22, v253
pa 152,208,180
ex 26
pa 152,212,184
s_cbranch_vccnz LsX9
LrX9:
lk 196,0,49152
v_mov_b32 v255, 10
pa 156,212,192
lk 200,1,49152
cv 252,252,253
pa 156,208,188
lk 204,2,49152
v_accvgpr_write_b32 a249, v252
pa 124,200,188
lk 208,3,49152
v_accvgpr_read_b32 v253, a250
pa 124,204,192
ex 27
pa 92,196,192
global_load_lds_dwordx4 v12, s[96:97] offset:0 nt
cv 159,26,27
pa 92,192,188
ex 28
pa 60,184,188
ex 29
pa 60,188,192
ex 30
pa 28,180,192
ex 31
pa 28,176,188
lv 180,4,32768
cv 166,28,29
v_smfmac_f32_16x16x64_bf16 a[168:171], a[172:175], v[208:215], v14
s_waitcnt lgkmcnt(1)
lv 182,4,36864
qa 16,196,56,36
lv 184,4,40960
cv 167,30,31
pw 16,200,60
global_load_lds_dwordx4 v13, s[96:97] offset:1024 nt
lv 186,4,45056
pw 16,204,64
ex 32
pw 16,208,68
ex 33
qa 20,208,84,40
ex 34
pw 20,204,80
ex 35
pw 20,200,76
lv 192,5,40960
cv 174,32,33
pw 20,196,72
lv 194,5,45056
cv 175,34,35
qa 24,196,88,44
lv 188,5,32768
v_lshlrev_b32 v252, 16, v253
pw 24,200,92
lv 190,5,36864
v_and_b32 v253, s28, v253
pw 24,204,96
ex 16
pw 24,208,100
ex 17
qa 28,208,116,48
ex 18
pw 28,204,112
ex 19
pw 28,200,108
cv 176,16,17
cv 177,18,19
pw 28,196,104
ex 20
qa 32,196,120,52
global_load_lds_dwordx4 v12, s[96:97] offset:2048 nt
lk 196,0,53248
pw 32,200,124
lk 200,1,53248
v_mul_f32 v252, s22, v252
pw 32,204,128
lk 204,2,53248
v_mul_f32 v253, s22, v253
pw 32,208,132
s_waitcnt lgkmcnt(3)
lk 208,3,53248
cv 252,252,253
pa 0,136,180
ex 21
pa 0,140,184
ex 22
pa 32,148,184
ex 23
pa 32,144,180
cv 184,20,21
cv 185,22,23
pa 64,152,180
ex 24
pa 64,156,184
ex 25
pa 96,164,184
cv 192,24,25
v_accvgpr_write_b32 a250, v252
pa 96,160,180
ex 26
pa 128,168,180
lv 180,6,32768
v_accvgpr_read_b32 v253, a251
pa 128,172,184
ex 27
pa 132,172,192
lv 182,6,36864
cv 193,26,27
pa 132,168,188
global_load_lds_dwordx4 v13, s[96:97] offset:3072 nt
lv 184,6,40960
pa 100,160,188
s_add_u32 m0, s21, 114688
ex 28
pa 100,164,192
s_add_u32 s96, s96, 16384
s_addc_u32 s97, s97, 0
lv 186,6,45056
pa 68,156,192
ex 29
pa 68,152,188
ex 30
pa 36,144,188
cv 200,28,29
v_lshlrev_b32 v252, 16, v253
pa 36,148,192
ex 31
pa 4,140,192
lv 192,7,40960
cv 201,30,31
pa 4,136,188
ex 32
v_smfmac_f32_16x16x64_bf16 a[160:163], a[172:175], v[136:143], v14
s_waitcnt lgkmcnt(2)
lv 194,7,45056
qa 16,196,56,36
ex 33
pw 16,200,60
lv 188,7,32768
cv 208,32,33
pw 16,204,64
ex 34
pw 16,208,68
lv 190,7,36864
v_and_b32 v253, s28, v253
qa 20,208,84,40
ex 35
pw 20,204,80
global_load_lds_dwordx4 v12, s[98:99] offset:0 nt
cv 209,34,35
pw 20,200,76
v_mul_f32 v252, s22, v252
v_mul_f32 v253, s22, v253
pw 20,196,72
ex 16
qa 24,196,88,44
cv 252,252,253
v_accvgpr_write_b32 a251, v252
pw 24,200,92
ex 17
pw 24,204,96
s_waitcnt vmcnt(23)
cv 178,16,17
v_accvgpr_read_b32 v253, a252
pw 24,208,100
ex 18
qa 28,208,116,48
v_lshlrev_b32 v252, 16, v253
v_and_b32 v253, s28, v253
pw 28,204,112
ex 19
pw 28,200,108
cv 179,18,19
v_mul_f32 v252, s22, v252
pw 28,196,104
ex 20
qa 32,196,120,52
lk 196,0,57344
v_mul_f32 v253, s22, v253
pw 32,200,124
lk 200,1,57344
cv 252,252,253
pw 32,204,128
lk 204,2,57344
v_accvgpr_write_b32 a252, v252
pw 32,208,132
lk 208,3,57344
v_accvgpr_read_b32 v253, a253
pa 8,136,180
s_waitcnt lgkmcnt(4)
global_load_lds_dwordx4 v13, s[98:99] offset:1024 nt
v_lshlrev_b32 v252, 16, v253
pa 8,140,184
ex 21
pa 40,148,184
ex 22
pa 40,144,180
ex 23
pa 72,152,180
cv 186,20,21
cv 187,22,23
pa 72,156,184
ex 24
pa 104,164,184
ex 25
pa 104,160,180
ex 26
pa 136,168,180
lv 180,8,32768
cv 194,24,25
pa 136,172,184
ex 27
pa 140,172,192
lv 182,8,36864
cv 195,26,27
pa 140,168,188
ex 28
pa 108,160,188
lv 184,8,40960
v_and_b32 v253, s28, v253
pa 108,164,192
ex 29
pa 76,156,192
lv 186,8,45056
cv 202,28,29
pa 76,152,188
global_load_lds_dwordx4 v12, s[98:99] offset:2048 nt
v_mul_f32 v252, s22, v252
pa 44,144,188
ex 30
pa 44,148,192
ex 31
pa 12,140,192
lv 192,9,40960
cv 203,30,31
pa 12,136,188

LwX0_7:
s_cbranch_vccnz LwX0_11
ex 32
v_smfmac_f32_16x16x64_bf16 a[160:163], a[176:179], v[144:151], v14
s_waitcnt lgkmcnt(2)
lv 194,9,45056
qa 16,196,56,36
ex 33
pw 16,200,60
lv 188,9,32768
cv 210,32,33
pw 16,204,64
ex 34
pw 16,208,68
lv 190,9,36864
v_mul_f32 v253, s22, v253
qa 20,208,84,40
ex 35
pw 20,204,80
cv 211,34,35
cv 252,252,253
pw 20,200,76
v_accvgpr_write_b32 a253, v252
v_accvgpr_read_b32 v253, a254
pw 20,196,72
ex 16
qa 24,196,88,44
v_lshlrev_b32 v252, 16, v253
v_and_b32 v253, s28, v253
pw 24,200,92
global_load_lds_dwordx4 v13, s[98:99] offset:3072 nt
s_add_u32 m0, s21, 81920
pw 24,204,96
s_add_u32 s98, s98, 16384
s_addc_u32 s99, s99, 0
v_mul_f32 v252, s22, v252
pw 24,208,100
ex 17
qa 28,208,116,48
ex 18
pw 28,204,112
ex 19
pw 28,200,108
cv 180,16,17
cv 181,18,19
pw 28,196,104
ex 20
qa 32,196,120,52
lk 196,0,61440
v_mul_f32 v253, s22, v253
pw 32,200,124
lk 200,1,61440
cv 252,252,253
pw 32,204,128
lk 204,2,61440
v_accvgpr_write_b32 a254, v252
pw 32,208,132
lk 208,3,61440
v_accvgpr_read_b32 v253, a255
pa 16,136,180
s_waitcnt lgkmcnt(4)
ex 21
pa 16,140,184
ex 22
pa 48,148,184
ex 23
pa 48,144,180
cv 188,20,21
cv 189,22,23
pa 80,152,180
ex 24
pa 80,156,184
ex 25
pa 112,164,184
cv 196,24,25
v_lshlrev_b32 v252, 16, v253
pa 112,160,180
ex 26
pa 144,168,180
lv 180,10,32768
v_and_b32 v253, s28, v253
pa 144,172,184
ex 27
pa 148,172,192
lv 182,10,36864
cv 197,26,27
pa 148,168,188
lv 184,10,40960
v_mul_f32 v252, s22, v252
pa 116,160,188
lv 186,10,45056
v_mul_f32 v253, s22, v253
pa 116,164,192
ex 28
pa 84,156,192
ex 29
pa 84,152,188
ex 30
pa 52,144,188
cv 204,28,29
cv 252,252,253
pa 52,148,192
ex 31
pa 20,140,192
lv 192,11,40960
cv 205,30,31
pa 20,136,188
lv 194,11,45056
v_accvgpr_write_b32 a255, v252
v_smfmac_f32_16x16x64_bf16 a[164:167], a[172:175], v[152:159], v14
lv 188,11,32768
v_smfmac_f32_16x16x64_bf16 a[164:167], a[176:179], v[160:167], v14
s_waitcnt lgkmcnt(3)
lv 190,11,36864
qa 16,196,56,36
s_waitcnt vmcnt(25)
ds_write_b32 v254, v255 offset:0
pw 16,200,60
ex 32
pw 16,204,64
ex 33
pw 16,208,68
ex 34
qa 20,208,84,40
ex 35
pw 20,204,80
cv 212,32,33
cv 213,34,35
pw 20,200,76
s_waitcnt vmcnt(24)
v_lshlrev_b32 v252, 16, v216
v_and_b32 v253, s28, v216
pw 20,196,72
ex 16
qa 24,196,88,44
v_mul_f32 v252, s22, v252
v_mul_f32 v253, s22, v253
pw 24,200,92
ex 17
pw 24,204,96
cv 182,16,17
cv 216,252,253
pw 24,208,100
ex 18
qa 28,208,116,48
v_lshlrev_b32 v252, 16, v217
v_and_b32 v253, s28, v217
pw 28,204,112
ex 19
pw 28,200,108
cv 183,18,19
v_mul_f32 v252, s22, v252
pw 28,196,104
ex 20
qa 32,196,120,52
v_mul_f32 v253, s22, v253
cv 217,252,253
pw 32,200,124
ex 21
pw 32,204,128
cv 190,20,21
v_lshlrev_b32 v252, 16, v218
pw 32,208,132
ex 22
pa 24,136,180
ds_read_b32 v255, v12 offset:1024
v_and_b32 v253, s28, v218
pa 24,140,184
ex 23
pa 56,148,184
cv 191,22,23
v_mul_f32 v252, s22, v252
pa 56,144,180
ex 24
pa 88,152,180
v_mul_f32 v253, s22, v253
cv 218,252,253
pa 88,156,184
ex 25
pa 120,164,184
cv 198,24,25
v_lshlrev_b32 v252, 16, v219
pa 120,160,180
s_waitcnt lgkmcnt(0)
v_cmp_gt_u32 vcc, 10, v255
v_and_b32 v253, s28, v219
pa 152,168,180
ex 26
pa 152,172,184
s_cbranch_vccnz LsX10
LrX10:
lk 196,0,0
global_load_lds_dwordx4 v12, s[96:97] offset:0 nt
pa 156,172,192
lk 200,1,0
v_mov_b32 v255, 11
pa 156,168,188
lk 204,2,0
v_mul_f32 v252, s22, v252
pa 124,160,188
lk 208,3,0
v_mul_f32 v253, s22, v253
pa 124,164,192
ex 27
pa 92,156,192
lv 180,4,49152
cv 199,26,27
pa 92,152,188
ex 28
pa 60,144,188
ex 29
pa 60,148,192
ex 30
pa 28,140,192
ex 31
pa 28,136,188
lv 182,4,53248
cv 206,28,29
v_smfmac_f32_16x16x64_bf16 a[168:171], a[172:175], v[168:175], v14
s_waitcnt lgkmcnt(2)
lv 184,4,57344
qa 16,196,56,36
lv 186,4,61440
cv 207,30,31
pw 16,200,60
global_load_lds_dwordx4 v13, s[96:97] offset:1024 nt
lv 192,5,57344
pw 16,204,64
ex 32
pw 16,208,68
ex 33
qa 20,208,84,40
ex 34
pw 20,204,80
ex 35
pw 20,200,76
lv 194,5,61440
cv 214,32,33
pw 20,196,72
lv 188,5,49152
cv 215,34,35
qa 24,196,88,44
lv 190,5,53248
cv 219,252,253
pw 24,200,92
ex 16
pw 24,204,96
ex 17
pw 24,208,100
ex 18
qa 28,208,116,48
s_waitcnt vmcnt(25)
cv 136,16,17
v_lshlrev_b32 v252, 16, v220
pw 28,204,112
ex 19
pw 28,200,108
cv 137,18,19
v_and_b32 v253, s28, v220
pw 28,196,104
ex 20
qa 32,196,120,52
global_load_lds_dwordx4 v12, s[96:97] offset:2048 nt
lk 196,0,4096
pw 32,200,124
lk 200,1,4096
v_mul_f32 v252, s22, v252
pw 32,204,128
lk 204,2,4096
v_mul_f32 v253, s22, v253
pw 32,208,132
s_waitcnt lgkmcnt(3)
lk 208,3,4096
cv 220,252,253
pa 0,176,180
ex 21
pa 0,180,184
ex 22
pa 32,188,184
ex 23
pa 32,184,180
cv 144,20,21
cv 145,22,23
pa 64,192,180
ex 24
pa 64,196,184
ex 25
pa 96,204,184
cv 152,24,25
v_lshlrev_b32 v252, 16, v221
pa 96,200,180
ex 26
pa 128,208,180
lv 180,6,49152
v_and_b32 v253, s28, v221
pa 128,212,184
ex 27
pa 132,212,192
lv 182,6,53248
cv 153,26,27
pa 132,208,188
global_load_lds_dwordx4 v13, s[96:97] offset:3072 nt
lv 184,6,57344
pa 100,200,188
s_add_u32 m0, s21, 131072
ex 28
pa 100,204,192
s_add_u32 s96, s96, 16384
s_addc_u32 s97, s97, 0
lv 186,6,61440
pa 68,196,192
ex 29
pa 68,192,188
ex 30
pa 36,184,188
cv 160,28,29
v_mul_f32 v252, s22, v252
pa 36,188,192
ex 31
pa 4,180,192
lv 192,7,57344
cv 161,30,31
pa 4,176,188
ex 32
v_smfmac_f32_16x16x64_bf16 a[160:163], a[172:175], v[176:183], v14
s_waitcnt lgkmcnt(2)
lv 194,7,61440
qa 16,196,56,36
ex 33
pw 16,200,60
lv 188,7,49152
cv 168,32,33
pw 16,204,64
ex 34
pw 16,208,68
lv 190,7,53248
v_mul_f32 v253, s22, v253
qa 20,208,84,40
ex 35
pw 20,204,80
global_load_lds_dwordx4 v12, s[98:99] offset:0 nt
cv 169,34,35
pw 20,200,76
cv 221,252,253
v_lshlrev_b32 v252, 16, v222
pw 20,196,72
ex 16
qa 24,196,88,44
v_and_b32 v253, s28, v222
v_mul_f32 v252, s22, v252
pw 24,200,92
ex 17
pw 24,204,96
cv 138,16,17
v_mul_f32 v253, s22, v253
pw 24,208,100
ex 18
qa 28,208,116,48
cv 222,252,253
v_lshlrev_b32 v252, 16, v223
pw 28,204,112
ex 19
pw 28,200,108
cv 139,18,19
v_and_b32 v253, s28, v223
pw 28,196,104
ex 20
qa 32,196,120,52
lk 196,0,8192
v_mul_f32 v252, s22, v252
pw 32,200,124
lk 200,1,8192
v_mul_f32 v253, s22, v253
pw 32,204,128
lk 204,2,8192
cv 223,252,253
pw 32,208,132
s_waitcnt vmcnt(27)
lk 208,3,8192
v_lshlrev_b32 v252, 16, v224
pa 8,176,180
s_waitcnt lgkmcnt(4)
global_load_lds_dwordx4 v13, s[98:99] offset:1024 nt
v_and_b32 v253, s28, v224
pa 8,180,184
ex 21
pa 40,188,184
ex 22
pa 40,184,180
ex 23
pa 72,192,180
cv 146,20,21
cv 147,22,23
pa 72,196,184
ex 24
pa 104,204,184
ex 25
pa 104,200,180
ex 26
pa 136,208,180
lv 180,8,49152
cv 154,24,25
pa 136,212,184
ex 27
pa 140,212,192
lv 182,8,53248
cv 155,26,27
pa 140,208,188
ex 28
pa 108,200,188
lv 184,8,57344
v_mul_f32 v252, s22, v252
pa 108,204,192
ex 29
pa 76,196,192
lv 186,8,61440
cv 162,28,29
pa 76,192,188
global_load_lds_dwordx4 v12, s[98:99] offset:2048 nt
v_mul_f32 v253, s22, v253
pa 44,184,188
ex 30
pa 44,188,192
ex 31
pa 12,180,192
lv 192,9,57344
cv 163,30,31
pa 12,176,188
ex 32
v_smfmac_f32_16x16x64_bf16 a[160:163], a[176:179], v[184:191], v14
s_waitcnt lgkmcnt(2)
lv 194,9,61440
qa 16,196,56,36
ex 33
pw 16,200,60
lv 188,9,49152
cv 170,32,33
pw 16,204,64
ex 34
pw 16,208,68
lv 190,9,53248
cv 224,252,253
qa 20,208,84,40
ex 35
pw 20,204,80
cv 171,34,35
v_lshlrev_b32 v252, 16, v225
pw 20,200,76
v_and_b32 v253, s28, v225
v_mul_f32 v252, s22, v252
pw 20,196,72
ex 16
qa 24,196,88,44
v_mul_f32 v253, s22, v253
cv 225,252,253
pw 24,200,92
global_load_lds_dwordx4 v13, s[98:99] offset:3072 nt
s_add_u32 m0, s21, 32768
pw 24,204,96
s_add_u32 s98, s98, 16384
s_addc_u32 s99, s99, 0
v_lshlrev_b32 v252, 16, v226
pw 24,208,100
ex 17
qa 28,208,116,48
ex 18
pw 28,204,112
ex 19
pw 28,200,108
cv 140,16,17
cv 141,18,19
pw 28,196,104
ex 20
qa 32,196,120,52
lk 196,0,12288
v_and_b32 v253, s28, v226
pw 32,200,124
lk 200,1,12288
v_mul_f32 v252, s22, v252
pw 32,204,128
lk 204,2,12288
v_mul_f32 v253, s22, v253
pw 32,208,132
lk 208,3,12288
cv 226,252,253
pa 16,176,180
s_waitcnt lgkmcnt(4)
ex 21
pa 16,180,184
ex 22
pa 48,188,184
ex 23
pa 48,184,180
cv 148,20,21
cv 149,22,23
pa 80,192,180
ex 24
pa 80,196,184
ex 25
pa 112,204,184
cv 156,24,25
v_lshlrev_b32 v252, 16, v227
pa 112,200,180
ex 26
pa 144,208,180
lv 180,10,49152
v_and_b32 v253, s28, v227
pa 144,212,184
ex 27
pa 148,212,192
lv 182,10,53248
cv 157,26,27
pa 148,208,188
lv 184,10,57344
v_mul_f32 v252, s22, v252
pa 116,200,188
lv 186,10,61440
v_mul_f32 v253, s22, v253
pa 116,204,192
ex 28
pa 84,196,192
ex 29
pa 84,192,188
ex 30
pa 52,184,188
cv 164,28,29
cv 227,252,253
pa 52,188,192
ex 31
pa 20,180,192
lv 192,11,57344
cv 165,30,31
pa 20,176,188
s_waitcnt vmcnt(27)
lv 194,11,61440
v_lshlrev_b32 v252, 16, v228
v_smfmac_f32_16x16x64_bf16 a[164:167], a[172:175], v[192:199], v14
lv 188,11,49152
v_smfmac_f32_16x16x64_bf16 a[164:167], a[176:179], v[200:207], v14
s_waitcnt lgkmcnt(3)
lv 190,11,53248
qa 16,196,56,36
s_waitcnt vmcnt(19)
ds_write_b32 v254, v255 offset:0
pw 16,200,60
ex 32
pw 16,204,64
ex 33
pw 16,208,68
ex 34
qa 20,208,84,40
ex 35
pw 20,204,80
cv 172,32,33
cv 173,34,35
pw 20,200,76
v_and_b32 v253, s28, v228
v_mul_f32 v252, s22, v252
pw 20,196,72
ex 16
qa 24,196,88,44
v_mul_f32 v253, s22, v253
cv 228,252,253
pw 24,200,92
ex 17
pw 24,204,96
cv 142,16,17
v_lshlrev_b32 v252, 16, v229
pw 24,208,100
ex 18
qa 28,208,116,48
v_and_b32 v253, s28, v229
v_mul_f32 v252, s22, v252
pw 28,204,112
ex 19
pw 28,200,108
cv 143,18,19
v_mul_f32 v253, s22, v253
pw 28,196,104
ex 20
qa 32,196,120,52
cv 229,252,253
v_lshlrev_b32 v252, 16, v230
pw 32,200,124
ex 21
pw 32,204,128
cv 150,20,21
v_and_b32 v253, s28, v230
pw 32,208,132
ex 22
pa 24,176,180
ds_read_b32 v255, v12 offset:1024
v_mul_f32 v252, s22, v252
pa 24,180,184
ex 23
pa 56,188,184
cv 151,22,23
v_mul_f32 v253, s22, v253
pa 56,184,180
ex 24
pa 88,192,180
cv 230,252,253
v_lshlrev_b32 v252, 16, v231
pa 88,196,184
ex 25
pa 120,204,184
cv 158,24,25
v_and_b32 v253, s28, v231
pa 120,200,180
s_waitcnt lgkmcnt(0)
v_cmp_gt_u32 vcc, 11, v255
v_mul_f32 v252, s22, v252
pa 152,208,180
ex 26
pa 152,212,184
s_cbranch_vccnz LsX11
LrX11:
lk 196,0,16384
global_load_lds_dwordx4 v12, s[96:97] offset:0 nt
pa 156,212,192

LwX0_8:
s_cbranch_vccnz LwX0_12
lk 200,1,16384
v_mov_b32 v255, 12
pa 156,208,188
lk 204,2,16384
v_mul_f32 v253, s22, v253
pa 124,200,188
lk 208,3,16384
cv 231,252,253
pa 124,204,192
ex 27
pa 92,196,192
lv 180,4,0
cv 159,26,27
pa 92,192,188
ex 28
pa 60,184,188
ex 29
pa 60,188,192
ex 30
pa 28,180,192
ex 31
pa 28,176,188
lv 182,4,4096
cv 166,28,29
v_smfmac_f32_16x16x64_bf16 a[168:171], a[172:175], v[208:215], v14
s_waitcnt lgkmcnt(2)
lv 184,4,8192
qa 16,196,56,36
lv 186,4,12288
cv 167,30,31
pw 16,200,60
global_load_lds_dwordx4 v13, s[96:97] offset:1024 nt
lv 192,5,8192
pw 16,204,64
ex 32
pw 16,208,68
ex 33
qa 20,208,84,40
ex 34
pw 20,204,80
ex 35
pw 20,200,76
lv 194,5,12288
cv 174,32,33
pw 20,196,72
lv 188,5,0
cv 175,34,35
qa 24,196,88,44
lv 190,5,4096
v_lshlrev_b32 v252, 16, v232
pw 24,200,92
ex 16
pw 24,204,96
ex 17
pw 24,208,100
ex 18
qa 28,208,116,48
cv 176,16,17
v_and_b32 v253, s28, v232
pw 28,204,112
ex 19
pw 28,200,108
cv 177,18,19
v_mul_f32 v252, s22, v252
pw 28,196,104
ex 20
qa 32,196,120,52
global_load_lds_dwordx4 v12, s[96:97] offset:2048 nt
lk 196,0,20480
pw 32,200,124
lk 200,1,20480
v_mul_f32 v253, s22, v253
pw 32,204,128
lk 204,2,20480
cv 232,252,253
pw 32,208,132
s_waitcnt lgkmcnt(3)
lk 208,3,20480
v_lshlrev_b32 v252, 16, v233
pa 0,136,180
ex 21
pa 0,140,184
ex 22
pa 32,148,184
ex 23
pa 32,144,180
cv 184,20,21
cv 185,22,23
pa 64,152,180
ex 24
pa 64,156,184
ex 25
pa 96,164,184
cv 192,24,25
v_and_b32 v253, s28, v233
pa 96,160,180
ex 26
pa 128,168,180
lv 180,6,0
v_mul_f32 v252, s22, v252
pa 128,172,184
ex 27
pa 132,172,192
lv 182,6,4096
cv 193,26,27
pa 132,168,188
global_load_lds_dwordx4 v13, s[96:97] offset:3072 nt
lv 184,6,8192
pa 100,160,188
s_add_u32 m0, s21, 147456
ex 28
pa 100,164,192
s_add_u32 s96, s96, 16384
s_addc_u32 s97, s97, 0
lv 186,6,12288
pa 68,156,192
ex 29
pa 68,152,188
ex 30
pa 36,144,188
cv 200,28,29
v_mul_f32 v253, s22, v253
pa 36,148,192
ex 31
pa 4,140,192
lv 192,7,8192
cv 201,30,31
pa 4,136,188
ex 32
v_smfmac_f32_16x16x64_bf16 a[160:163], a[172:175], v[136:143], v14
s_waitcnt lgkmcnt(2)
lv 194,7,12288
qa 16,196,56,36
ex 33
pw 16,200,60
lv 188,7,0
cv 208,32,33
pw 16,204,64
ex 34
pw 16,208,68
lv 190,7,4096
cv 233,252,253
qa 20,208,84,40
ex 35
pw 20,204,80
global_load_lds_dwordx4 v12, s[98:99] offset:0 nt
cv 209,34,35
pw 20,200,76
v_lshlrev_b32 v252, 16, v234
v_and_b32 v253, s28, v234
pw 20,196,72
ex 16
qa 24,196,88,44
v_mul_f32 v252, s22, v252
v_mul_f32 v253, s22, v253
pw 24,200,92
ex 17
pw 24,204,96
cv 178,16,17
cv 234,252,253
pw 24,208,100
ex 18
qa 28,208,116,48
v_lshlrev_b32 v252, 16, v235
v_and_b32 v253, s28, v235
pw 28,204,112
ex 19
pw 28,200,108
cv 179,18,19
v_mul_f32 v252, s22, v252
pw 28,196,104
ex 20
qa 32,196,120,52
lk 196,0,24576
v_mul_f32 v253, s22, v253
pw 32,200,124
lk 200,1,24576
cv 235,252,253
pw 32,204,128
lk 204,2,24576
v_lshlrev_b32 v252, 16, v236
pw 32,208,132
lk 208,3,24576
v_and_b32 v253, s28, v236
pa 8,136,180
s_waitcnt lgkmcnt(4)
global_load_lds_dwordx4 v13, s[98:99] offset:1024 nt
v_mul_f32 v252, s22, v252
pa 8,140,184
ex 21
pa 40,148,184
ex 22
pa 40,144,180
ex 23
pa 72,152,180
cv 186,20,21
cv 187,22,23
pa 72,156,184
ex 24
pa 104,164,184
ex 25
pa 104,160,180
ex 26
pa 136,168,180
lv 180,8,0
cv 194,24,25
pa 136,172,184
ex 27
pa 140,172,192
lv 182,8,4096
cv 195,26,27
pa 140,168,188
ex 28
pa 108,160,188
lv 184,8,8192
v_mul_f32 v253, s22, v253
pa 108,164,192
ex 29
pa 76,156,192
lv 186,8,12288
cv 202,28,29
pa 76,152,188
global_load_lds_dwordx4 v12, s[98:99] offset:2048 nt
cv 236,252,253
pa 44,144,188
ex 30
pa 44,148,192
ex 31
pa 12,140,192
lv 192,9,8192
cv 203,30,31
pa 12,136,188
ex 32
v_smfmac_f32_16x16x64_bf16 a[160:163], a[176:179], v[144:151], v14
s_waitcnt lgkmcnt(2)
lv 194,9,12288
qa 16,196,56,36
ex 33
pw 16,200,60
lv 188,9,0
cv 210,32,33
pw 16,204,64
ex 34
pw 16,208,68
lv 190,9,4096
v_lshlrev_b32 v252, 16, v237
qa 20,208,84,40
ex 35
pw 20,204,80
cv 211,34,35
v_and_b32 v253, s28, v237
pw 20,200,76
v_mul_f32 v252, s22, v252
v_mul_f32 v253, s22, v253
pw 20,196,72
ex 16
qa 24,196,88,44
cv 237,252,253
v_lshlrev_b32 v252, 16, v238
pw 24,200,92
global_load_lds_dwordx4 v13, s[98:99] offset:3072 nt
s_add_u32 m0, s21, 49152
pw 24,204,96
s_add_u32 s98, s98, 16384
s_addc_u32 s99, s99, 0
v_and_b32 v253, s28, v238
pw 24,208,100
ex 17
qa 28,208,116,48
ex 18
pw 28,204,112
ex 19
pw 28,200,108
cv 180,16,17
cv 181,18,19
pw 28,196,104
ex 20
qa 32,196,120,52
lk 196,0,28672
v_mul_f32 v252, s22, v252
pw 32,200,124
lk 200,1,28672
v_mul_f32 v253, s22, v253
pw 32,204,128
lk 204,2,28672
cv 238,252,253
pw 32,208,132
lk 208,3,28672
v_lshlrev_b32 v252, 16, v239
pa 16,136,180
s_waitcnt lgkmcnt(4)
ex 21
pa 16,140,184
ex 22
pa 48,148,184
ex 23
pa 48,144,180
cv 188,20,21
cv 189,22,23
pa 80,152,180
ex 24
pa 80,156,184
ex 25
pa 112,164,184
cv 196,24,25
v_and_b32 v253, s28, v239
pa 112,160,180
ex 26
pa 144,168,180
lv 180,10,0
v_mul_f32 v252, s22, v252
pa 144,172,184
ex 27
pa 148,172,192
lv 182,10,4096
cv 197,26,27
pa 148,168,188
lv 184,10,8192
v_mul_f32 v253, s22, v253
pa 116,160,188
lv 186,10,12288
cv 239,252,253
pa 116,164,192
ex 28
pa 84,156,192
ex 29
pa 84,152,188
ex 30
pa 52,144,188
s_waitcnt vmcnt(26)
cv 204,28,29
v_lshlrev_b32 v252, 16, v240
pa 52,148,192
ex 31
pa 20,140,192
lv 192,11,8192
cv 205,30,31
pa 20,136,188
lv 194,11,12288
v_and_b32 v253, s28, v240
v_smfmac_f32_16x16x64_bf16 a[164:167], a[172:175], v[152:159], v14
lv 188,11,0
v_smfmac_f32_16x16x64_bf16 a[164:167], a[176:179], v[160:167], v14
s_waitcnt lgkmcnt(3)
lv 190,11,4096
qa 16,196,56,36
s_waitcnt vmcnt(16)
ds_write_b32 v254, v255 offset:0
pw 16,200,60
ex 32
pw 16,204,64
ex 33
pw 16,208,68
ex 34
qa 20,208,84,40
ex 35
pw 20,204,80
cv 212,32,33
cv 213,34,35
pw 20,200,76
v_mul_f32 v252, s22, v252
v_mul_f32 v253, s22, v253
pw 20,196,72
ex 16
qa 24,196,88,44
cv 240,252,253
v_lshlrev_b32 v252, 16, v241
pw 24,200,92
ex 17
pw 24,204,96
cv 182,16,17
v_and_b32 v253, s28, v241
pw 24,208,100
ex 18
qa 28,208,116,48
v_mul_f32 v252, s22, v252
v_mul_f32 v253, s22, v253
pw 28,204,112
ex 19
pw 28,200,108
cv 183,18,19
cv 241,252,253
pw 28,196,104
ex 20
qa 32,196,120,52
v_lshlrev_b32 v252, 16, v242
v_and_b32 v253, s28, v242
pw 32,200,124
ex 21
pw 32,204,128
cv 190,20,21
v_mul_f32 v252, s22, v252
pw 32,208,132
ex 22
pa 24,136,180
ds_read_b32 v255, v12 offset:1024
v_mul_f32 v253, s22, v253
pa 24,140,184
ex 23
pa 56,148,184
cv 191,22,23
cv 242,252,253
pa 56,144,180
ex 24
pa 88,152,180
v_lshlrev_b32 v252, 16, v243
v_and_b32 v253, s28, v243
pa 88,156,184
ex 25
pa 120,164,184
cv 198,24,25
v_mul_f32 v252, s22, v252
pa 120,160,180
s_waitcnt lgkmcnt(0)
v_cmp_gt_u32 vcc, 12, v255
v_mul_f32 v253, s22, v253
pa 152,168,180
ex 26
pa 152,172,184
s_cbranch_vccnz LsX12
LrX12:
lk 196,0,32768
global_load_lds_dwordx4 v12, s[96:97] offset:0 nt
pa 156,172,192
lk 200,1,32768
v_mov_b32 v255, 13
pa 156,168,188
lk 204,2,32768
cv 243,252,253
pa 124,160,188
lk 208,3,32768
v_lshlrev_b32 v252, 16, v244
pa 124,164,192
ex 27
pa 92,156,192
lv 180,4,16384
cv 199,26,27
pa 92,152,188
ex 28
pa 60,144,188
ex 29
pa 60,148,192
ex 30
pa 28,140,192
ex 31
pa 28,136,188
lv 182,4,20480
cv 206,28,29
v_smfmac_f32_16x16x64_bf16 a[168:171], a[172:175], v[168:175], v14
s_waitcnt lgkmcnt(2)
lv 184,4,24576
qa 16,196,56,36
lv 186,4,28672
cv 207,30,31
pw 16,200,60
global_load_lds_dwordx4 v13, s[96:97] offset:1024 nt
lv 192,5,24576
pw 16,204,64
ex 32
pw 16,208,68
ex 33
qa 20,208,84,40
ex 34
pw 20,204,80
ex 35
pw 20,200,76
lv 194,5,28672
cv 214,32,33
pw 20,196,72
lv 188,5,16384
cv 215,34,35
qa 24,196,88,44
lv 190,5,20480
v_and_b32 v253, s28, v244
pw 24,200,92
ex 16
pw 24,204,96
ex 17
pw 24,208,100
ex 18
qa 28,208,116,48
cv 136,16,17
v_mul_f32 v252, s22, v252
pw 28,204,112
ex 19
pw 28,200,108
cv 137,18,19
v_mul_f32 v253, s22, v253
pw 28,196,104
ex 20
qa 32,196,120,52
global_load_lds_dwordx4 v12, s[96:97] offset:2048 nt
lk 196,0,36864
pw 32,200,124
lk 200,1,36864
cv 244,252,253
pw 32,204,128
lk 204,2,36864
v_lshlrev_b32 v252, 16, v245
pw 32,208,132
s_waitcnt lgkmcnt(3)
lk 208,3,36864
v_and_b32 v253, s28, v245
pa 0,176,180
ex 21
pa 0,180,184
ex 22
pa 32,188,184
ex 23
pa 32,184,180
cv 144,20,21
cv 145,22,23
pa 64,192,180
ex 24
pa 64,196,184
ex 25
pa 96,204,184
cv 152,24,25
v_mul_f32 v252, s22, v252
pa 96,200,180
ex 26
pa 128,208,180
lv 180,6,16384
v_mul_f32 v253, s22, v253
pa 128,212,184
ex 27
pa 132,212,192
lv 182,6,20480
cv 153,26,27
pa 132,208,188
global_load_lds_dwordx4 v13, s[96:97] offset:3072 nt
lv 184,6,24576
pa 100,200,188
s_add_u32 m0, s21, 98304
ex 28
pa 100,204,192
s_add_u32 s96, s96, 16384
s_addc_u32 s97, s97, 0
lv 186,6,28672
pa 68,196,192
ex 29
pa 68,192,188
ex 30
pa 36,184,188
cv 160,28,29
cv 245,252,253
pa 36,188,192
ex 31
pa 4,180,192
lv 192,7,24576
cv 161,30,31
pa 4,176,188
ex 32
v_smfmac_f32_16x16x64_bf16 a[160:163], a[172:175], v[176:183], v14
s_waitcnt lgkmcnt(2)
lv 194,7,28672
qa 16,196,56,36
ex 33
pw 16,200,60
lv 188,7,16384
cv 168,32,33
pw 16,204,64
ex 34
pw 16,208,68
lv 190,7,20480
v_lshlrev_b32 v252, 16, v246
qa 20,208,84,40
ex 35
pw 20,204,80
global_load_lds_dwordx4 v12, s[98:99] offset:0 nt
cv 169,34,35
pw 20,200,76
v_and_b32 v253, s28, v246
v_mul_f32 v252, s22, v252
pw 20,196,72
ex 16
qa 24,196,88,44
v_mul_f32 v253, s22, v253
cv 246,252,253
pw 24,200,92
ex 17
pw 24,204,96
cv 138,16,17
v_lshlrev_b32 v252, 16, v247
pw 24,208,100
ex 18
qa 28,208,116,48
v_and_b32 v253, s28, v247
v_mul_f32 v252, s22, v252
pw 28,204,112
ex 19
pw 28,200,108
cv 139,18,19
v_mul_f32 v253, s22, v253
pw 28,196,104
ex 20
qa 32,196,120,52
lk 196,0,40960
cv 247,252,253
pw 32,200,124
lk 200,1,40960
v_lshlrev_b32 v252, 16, v248
pw 32,204,128
lk 204,2,40960
v_and_b32 v253, s28, v248
pw 32,208,132
lk 208,3,40960
v_mul_f32 v252, s22, v252
pa 8,176,180
s_waitcnt lgkmcnt(4)
global_load_lds_dwordx4 v13, s[98:99] offset:1024 nt
v_mul_f32 v253, s22, v253
pa 8,180,184
ex 21
pa 40,188,184

LwX0_9:
s_cbranch_vccnz LwX0_13
ex 22
pa 40,184,180
ex 23
pa 72,192,180
cv 146,20,21
cv 147,22,23
pa 72,196,184
ex 24
pa 104,204,184
ex 25
pa 104,200,180
ex 26
pa 136,208,180
lv 180,8,16384
cv 154,24,25
pa 136,212,184
ex 27
pa 140,212,192
lv 182,8,20480
cv 155,26,27
pa 140,208,188
ex 28
pa 108,200,188
lv 184,8,24576
cv 248,252,253
pa 108,204,192
ex 29
pa 76,196,192
lv 186,8,28672
cv 162,28,29
pa 76,192,188
global_load_lds_dwordx4 v12, s[98:99] offset:2048 nt
v_lshlrev_b32 v252, 16, v249
pa 44,184,188
ex 30
pa 44,188,192
ex 31
pa 12,180,192
lv 192,9,24576
cv 163,30,31
pa 12,176,188
ex 32
v_smfmac_f32_16x16x64_bf16 a[160:163], a[176:179], v[184:191], v14
s_waitcnt lgkmcnt(2)
lv 194,9,28672
qa 16,196,56,36
ex 33
pw 16,200,60
lv 188,9,16384
cv 170,32,33
pw 16,204,64
ex 34
pw 16,208,68
lv 190,9,20480
v_and_b32 v253, s28, v249
qa 20,208,84,40
ex 35
pw 20,204,80
cv 171,34,35
v_mul_f32 v252, s22, v252
pw 20,200,76
v_mul_f32 v253, s22, v253
cv 249,252,253
pw 20,196,72
ex 16
qa 24,196,88,44
v_lshlrev_b32 v252, 16, v250
v_and_b32 v253, s28, v250
pw 24,200,92
global_load_lds_dwordx4 v13, s[98:99] offset:3072 nt
s_add_u32 m0, s21, 65536
pw 24,204,96
s_add_u32 s98, s98, 16384
s_addc_u32 s99, s99, 0
v_mul_f32 v252, s22, v252
pw 24,208,100
ex 17
qa 28,208,116,48
ex 18
pw 28,204,112
ex 19
pw 28,200,108
cv 140,16,17
cv 141,18,19
pw 28,196,104
ex 20
qa 32,196,120,52
lk 196,0,45056
v_mul_f32 v253, s22, v253
pw 32,200,124
lk 200,1,45056
cv 250,252,253
pw 32,204,128
lk 204,2,45056
v_lshlrev_b32 v252, 16, v251
pw 32,208,132
lk 208,3,45056
v_and_b32 v253, s28, v251
pa 16,176,180
s_waitcnt lgkmcnt(4)
ex 21
pa 16,180,184
ex 22
pa 48,188,184
ex 23
pa 48,184,180
cv 148,20,21
cv 149,22,23
pa 80,192,180
ex 24
pa 80,196,184
ex 25
pa 112,204,184
cv 156,24,25
v_mul_f32 v252, s22, v252
pa 112,200,180
ex 26
pa 144,208,180
lv 180,10,16384
v_mul_f32 v253, s22, v253
pa 144,212,184
ex 27
pa 148,212,192
lv 182,10,20480
cv 157,26,27
pa 148,208,188
lv 184,10,24576
cv 251,252,253
pa 116,200,188
lv 186,10,28672
pa 116,204,192
ex 28
pa 84,196,192
ex 29
pa 84,192,188
ex 30
pa 52,184,188
cv 164,28,29
pa 52,188,192
ex 31
pa 20,180,192
lv 192,11,24576
cv 165,30,31
pa 20,176,188
lv 194,11,28672
v_smfmac_f32_16x16x64_bf16 a[164:167], a[172:175], v[192:199], v14
lv 188,11,16384
v_smfmac_f32_16x16x64_bf16 a[164:167], a[176:179], v[200:207], v14
s_waitcnt lgkmcnt(3)
lv 190,11,20480
qa 16,196,56,36
s_waitcnt vmcnt(16)
ds_write_b32 v254, v255 offset:0
pw 16,200,60
ex 32
pw 16,204,64
ex 33
pw 16,208,68
ex 34
qa 20,208,84,40
ex 35
pw 20,204,80
cv 172,32,33
cv 173,34,35
pw 20,200,76
pw 20,196,72
ex 16
qa 24,196,88,44
pw 24,200,92
ex 17
pw 24,204,96
cv 142,16,17
pw 24,208,100
ex 18
qa 28,208,116,48
pw 28,204,112
ex 19
pw 28,200,108
cv 143,18,19
pw 28,196,104
ex 20
qa 32,196,120,52
pw 32,200,124
ex 21
pw 32,204,128
cv 150,20,21
pw 32,208,132
ex 22
pa 24,176,180
ds_read_b32 v255, v12 offset:1024
pa 24,180,184
ex 23
pa 56,188,184
cv 151,22,23
pa 56,184,180
ex 24
pa 88,192,180
pa 88,196,184
ex 25
pa 120,204,184
cv 158,24,25
pa 120,200,180
s_waitcnt lgkmcnt(0)
v_cmp_gt_u32 vcc, 13, v255
pa 152,208,180
ex 26
pa 152,212,184
s_cbranch_vccnz LsX13
LrX13:
lk 196,0,49152
global_load_lds_dwordx4 v12, s[96:97] offset:0 nt
pa 156,212,192
lk 200,1,49152
v_mov_b32 v255, 14
pa 156,208,188
lk 204,2,49152
pa 124,200,188
lk 208,3,49152
pa 124,204,192
ex 27
pa 92,196,192
lv 180,4,32768
cv 159,26,27
pa 92,192,188
ex 28
pa 60,184,188
ex 29
pa 60,188,192
ex 30
pa 28,180,192
ex 31
pa 28,176,188
lv 182,4,36864
cv 166,28,29
v_smfmac_f32_16x16x64_bf16 a[168:171], a[172:175], v[208:215], v14
s_waitcnt lgkmcnt(2)
lv 184,4,40960
qa 16,196,56,36
lv 186,4,45056
cv 167,30,31
pw 16,200,60
global_load_lds_dwordx4 v13, s[96:97] offset:1024 nt
lv 192,5,40960
pw 16,204,64
ex 32
pw 16,208,68
ex 33
qa 20,208,84,40
ex 34
pw 20,204,80
ex 35
pw 20,200,76
lv 194,5,45056
cv 174,32,33
pw 20,196,72
lv 188,5,32768
cv 175,34,35
qa 24,196,88,44
lv 190,5,36864
pw 24,200,92
ex 16
pw 24,204,96
ex 17
pw 24,208,100
ex 18
qa 28,208,116,48
cv 176,16,17
pw 28,204,112
ex 19
pw 28,200,108
cv 177,18,19
pw 28,196,104
ex 20
qa 32,196,120,52
global_load_lds_dwordx4 v12, s[96:97] offset:2048 nt
lk 196,0,53248
pw 32,200,124
lk 200,1,53248
pw 32,204,128
lk 204,2,53248
pw 32,208,132
s_waitcnt lgkmcnt(3)
lk 208,3,53248
pa 0,136,180
ex 21
pa 0,140,184
ex 22
pa 32,148,184
ex 23
pa 32,144,180
cv 184,20,21
cv 185,22,23
pa 64,152,180
ex 24
pa 64,156,184
ex 25
pa 96,164,184
cv 192,24,25
pa 96,160,180
ex 26
pa 128,168,180
lv 180,6,32768
pa 128,172,184
ex 27
pa 132,172,192
lv 182,6,36864
cv 193,26,27
pa 132,168,188
global_load_lds_dwordx4 v13, s[96:97] offset:3072 nt
lv 184,6,40960
pa 100,160,188
s_add_u32 m0, s21, 114688
ex 28
pa 100,164,192
s_add_u32 s96, s96, 16384
s_addc_u32 s97, s97, 0
lv 186,6,45056
pa 68,156,192
ex 29
pa 68,152,188
ex 30
pa 36,144,188
cv 200,28,29
pa 36,148,192
ex 31
pa 4,140,192
lv 192,7,40960
cv 201,30,31
pa 4,136,188
ex 32
v_smfmac_f32_16x16x64_bf16 a[160:163], a[172:175], v[136:143], v14
s_waitcnt lgkmcnt(2)
lv 194,7,45056
qa 16,196,56,36
ex 33
pw 16,200,60
lv 188,7,32768
cv 208,32,33
pw 16,204,64
ex 34
pw 16,208,68
lv 190,7,36864
qa 20,208,84,40
ex 35
pw 20,204,80
global_load_lds_dwordx4 v12, s[98:99] offset:0 nt
cv 209,34,35
pw 20,200,76
pw 20,196,72
ex 16
qa 24,196,88,44
pw 24,200,92
ex 17
pw 24,204,96
cv 178,16,17
pw 24,208,100
ex 18
qa 28,208,116,48
pw 28,204,112
ex 19
pw 28,200,108
cv 179,18,19
pw 28,196,104
ex 20
qa 32,196,120,52
lk 196,0,57344
pw 32,200,124
lk 200,1,57344
pw 32,204,128
lk 204,2,57344
pw 32,208,132
lk 208,3,57344
pa 8,136,180
s_waitcnt lgkmcnt(4)
global_load_lds_dwordx4 v13, s[98:99] offset:1024 nt
pa 8,140,184
ex 21
pa 40,148,184
ex 22
pa 40,144,180
ex 23
pa 72,152,180
cv 186,20,21
cv 187,22,23
pa 72,156,184
ex 24
pa 104,164,184
ex 25
pa 104,160,180
ex 26
pa 136,168,180
lv 180,8,32768
cv 194,24,25
pa 136,172,184
ex 27
pa 140,172,192
lv 182,8,36864
cv 195,26,27
pa 140,168,188
ex 28
pa 108,160,188
lv 184,8,40960
pa 108,164,192
ex 29
pa 76,156,192
lv 186,8,45056
cv 202,28,29
pa 76,152,188
global_load_lds_dwordx4 v12, s[98:99] offset:2048 nt
pa 44,144,188
ex 30
pa 44,148,192
ex 31
pa 12,140,192
lv 192,9,40960
cv 203,30,31
pa 12,136,188
ex 32
v_smfmac_f32_16x16x64_bf16 a[160:163], a[176:179], v[144:151], v14
s_waitcnt lgkmcnt(2)
lv 194,9,45056
qa 16,196,56,36
ex 33
pw 16,200,60
lv 188,9,32768
cv 210,32,33
pw 16,204,64
ex 34
pw 16,208,68
lv 190,9,36864
qa 20,208,84,40
ex 35
pw 20,204,80
cv 211,34,35
s_nop 0
pw 20,200,76
pw 20,196,72
ex 16
qa 24,196,88,44
pw 24,200,92
global_load_lds_dwordx4 v13, s[98:99] offset:3072 nt
s_add_u32 m0, s21, 81920
pw 24,204,96
s_add_u32 s98, s98, 16384
s_addc_u32 s99, s99, 0
pw 24,208,100
ex 17
qa 28,208,116,48
ex 18
pw 28,204,112
ex 19
pw 28,200,108
cv 180,16,17
cv 181,18,19
pw 28,196,104
ex 20
qa 32,196,120,52
lk 196,0,61440
v_xor_b32 v0, s34, v0
pw 32,200,124
lk 200,1,61440
v_xor_b32 v1, s34, v1
pw 32,204,128
lk 204,2,61440
v_xor_b32 v2, s34, v2
pw 32,208,132
lk 208,3,61440
v_xor_b32 v3, s34, v3
pa 16,136,180
s_waitcnt lgkmcnt(4)
ex 21
pa 16,140,184
ex 22
pa 48,148,184
ex 23
pa 48,144,180
cv 188,20,21
cv 189,22,23
pa 80,152,180
ex 24
pa 80,156,184
ex 25
pa 112,164,184
cv 196,24,25
pa 112,160,180
ex 26
pa 144,168,180
lv 180,10,32768
pa 144,172,184
ex 27
pa 148,172,192
lv 182,10,36864
cv 197,26,27
pa 148,168,188
lv 184,10,40960
pa 116,160,188
lv 186,10,45056
pa 116,164,192
ex 28
pa 84,156,192
ex 29
pa 84,152,188
ex 30
pa 52,144,188
cv 204,28,29
pa 52,148,192
ex 31
pa 20,140,192
lv 192,11,40960
cv 205,30,31
pa 20,136,188
lv 194,11,45056
v_smfmac_f32_16x16x64_bf16 a[164:167], a[172:175], v[152:159], v14
lv 188,11,32768
v_smfmac_f32_16x16x64_bf16 a[164:167], a[176:179], v[160:167], v14
s_waitcnt lgkmcnt(3)
lv 190,11,36864
qa 16,196,56,36
s_waitcnt vmcnt(16)
ds_write_b32 v254, v255 offset:0
pw 16,200,60
ex 32
pw 16,204,64
ex 33
pw 16,208,68
ex 34
qa 20,208,84,40
ex 35
pw 20,204,80
cv 212,32,33
cv 213,34,35
pw 20,200,76
v_mbcnt_lo_u32_b32 v58, -1, 0
v_mbcnt_hi_u32_b32 v58, -1, v58
pw 20,196,72
ex 16
qa 24,196,88,44
v_and_b32 v59, 15, v58
v_lshl_add_u32 v80, v59, 2, s39
pw 24,200,92
ex 17
pw 24,204,96
cv 182,16,17
v_mov_b32 v84, s41
pw 24,208,100
ex 18
qa 28,208,116,48
v_mov_b32 v85, s41
v_mov_b32 v86, s41
pw 28,204,112
ex 19
pw 28,200,108
cv 183,18,19
v_mov_b32 v87, s41
pw 28,196,104
ex 20
qa 32,196,120,52
v_lshl_add_u32 v120, v59, 3, s38
v_lshrrev_b32 v59, 4, v58
pw 32,200,124
ex 21
pw 32,204,128
cv 190,20,21
v_lshl_add_u32 v123, v59, 4, s39
pw 32,208,132
s_add_u32 s39, s24, 8192
ex 22
pa 24,136,180
ds_read_b32 v255, v12 offset:1024
v_lshl_add_u32 v120, v59, 9, v120
pa 24,140,184
ex 23
pa 56,148,184
cv 191,22,23
v_lshl_add_u32 v121, v59, 8, s38
pa 56,144,180
s_mov_b32 s38, s25
ex 24
pa 88,152,180
v_and_b32 v59, 3, v58
v_lshl_add_u32 v121, v59, 6, v121
pa 88,156,184
ex 25
pa 120,164,184
cv 198,24,25
v_and_b32 v59, 12, v58
pa 120,160,180
s_waitcnt lgkmcnt(0)
v_cmp_gt_u32 vcc, 14, v255
v_lshl_add_u32 v121, v59, 1, v121
pa 152,168,180
ex 26
pa 152,172,184
s_cbranch_vccnz LsX14
LrX14:
lk 196,0,0
global_load_lds_dwordx4 v12, s[96:97] offset:0 nt
pa 156,172,192
lk 200,1,0
v_and_b32 v59, 7, v58
pa 156,168,188

LwX0_10:
s_cbranch_vccnz LwrX0
lk 204,2,0
v_lshlrev_b32 v59, 4, v59
pa 124,160,188
lk 208,3,0
v_lshrrev_b32 v58, 3, v58
pa 124,164,192
ex 27
pa 92,156,192
lv 180,4,49152
cv 199,26,27
pa 92,152,188
ex 28
pa 60,144,188
ex 29
pa 60,148,192
ex 30
pa 28,140,192
ex 31
pa 28,136,188
lv 182,4,53248
cv 206,28,29
v_smfmac_f32_16x16x64_bf16 a[168:171], a[172:175], v[168:175], v14
s_waitcnt lgkmcnt(2)
lv 184,4,57344
v_mfma_f32_16x16x32_bf16 v[16:19], a[196:199], a[212:215], 0
lv 186,4,61440
cv 207,30,31
qb 16,200,216,16
global_load_lds_dwordx4 v13, s[96:97] offset:1024 nt
lv 192,5,57344
qb 16,204,220,16
ex 32
qb 16,208,224,16
ex 33
v_mfma_f32_16x16x32_bf16 v[20:23], a[208:211], a[240:243], 0
ex 34
qb 20,204,236,20
ex 35
qb 20,200,232,20
lv 194,5,61440
cv 214,32,33
qb 20,196,228,20
lv 188,5,49152
cv 215,34,35
v_mfma_f32_16x16x32_bf16 v[24:27], a[196:199], a[244:247], 0
lv 190,5,53248
v_max3_f32 v56, v16, v17, v18
qb 24,200,248,24
v_max_f32 v56, v56, v19
v_add_f32 v56, 0x41200000, v56
qb 24,204,252,24
v_mov_b32 v57, v56
v_lshl_add_u32 v122, v58, 8, v59
pw 24,208,216
v_permlane16_swap_b32 v56, v57
v_mfma_f32_16x16x32_bf16 v[28:31], a[208:211], v[232:235], 0
v_max_f32 v56, v56, v57
v_mov_b32 v57, v56
pw 28,204,228
v_mov_b32 v255, 15
v_xor_b32 v4, s35, v4
pw 28,200,224
v_permlane32_swap_b32 v56, v57
pw 28,196,220
v_min_f32 v36, -v56, -v57
v_min_f32 v37, -v56, -v57
v_mfma_f32_16x16x32_bf16 v[32:35], a[196:199], v[236:239], 0
global_load_lds_dwordx4 v12, s[96:97] offset:2048 nt
v_min_f32 v38, -v56, -v57
pw 32,200,240
lk 196,0,4096
v_min_f32 v39, -v56, -v57
pw 32,204,244
lk 200,1,4096
v_max3_f32 v56, v20, v21, v22
pw 32,208,248
lk 204,2,4096
v_max_f32 v56, v56, v23
v_smfmac_f32_16x16x64_bf16 a[160:163], a[172:175], v[176:183], v14
lk 208,3,4096
v_smfmac_f32_16x16x64_bf16 a[160:163], a[176:179], v[184:191], v14
v_add_f32 v56, 0x41200000, v56
v_smfmac_f32_16x16x64_bf16 a[164:167], a[172:175], v[192:199], v14
v_mov_b32 v57, v56
v_smfmac_f32_16x16x64_bf16 a[164:167], a[176:179], v[200:207], v14
v_add_f32 v16, v16, v36
v_smfmac_f32_16x16x64_bf16 a[168:171], a[172:175], v[208:215], v14
s_waitcnt lgkmcnt(4)
v_add_f32 v17, v17, v36
pa 0,176,180
v_permlane16_swap_b32 v56, v57
pa 0,180,184
v_max_f32 v56, v56, v57
v_mov_b32 v57, v56
pa 32,188,184
v_add_f32 v18, v18, v36
v_add_f32 v19, v19, v36
pa 32,184,180
v_permlane32_swap_b32 v56, v57
pa 64,192,180
v_min_f32 v40, -v56, -v57
v_min_f32 v41, -v56, -v57
pa 64,196,184
v_min_f32 v42, -v56, -v57
v_min_f32 v43, -v56, -v57
pa 96,204,184
global_load_lds_dwordx4 v13, s[96:97] offset:3072 nt
v_max3_f32 v56, v24, v25, v26
pa 96,200,180
s_add_u32 m0, s21, 131072
v_max_f32 v56, v56, v27
v_add_f32 v56, 0x41200000, v56
pa 128,208,180
s_add_u32 s96, s96, 16384
s_addc_u32 s97, s97, 0
v_mov_b32 v57, v56
pa 128,212,184
ex 16
pa 132,212,192
ex 17
pa 132,208,188
ex 18
pa 100,200,188
ex 19
pa 100,204,192
lv 180,6,49152
cv 136,16,17
pa 68,196,192
lv 182,6,53248
cv 137,18,19
pa 68,192,188
v_permlane16_swap_b32 v56, v57
pa 36,184,188
lv 184,6,57344
v_max_f32 v56, v56, v57
pa 36,188,192
lv 186,6,61440
v_mov_b32 v57, v56
pa 4,180,192
lv 192,7,57344
v_add_f32 v20, v20, v40
pa 4,176,188
s_waitcnt lgkmcnt(5)
v_permlane32_swap_b32 v56, v57
qb 16,196,212,36
lv 194,7,61440
v_add_f32 v21, v21, v40
qb 16,200,216,16
global_load_lds_dwordx4 v12, s[98:99] offset:0 nt
v_add_f32 v22, v22, v40
v_add_f32 v23, v23, v40
qb 16,204,220,16
ex 20
ex 21
ex 22
ex 23
v_min_f32 v44, -v56, -v57
v_min_f32 v45, -v56, -v57
v_min_f32 v46, -v56, -v57
v_min_f32 v47, -v56, -v57
v_max3_f32 v56, v28, v29, v30
qb 16,208,224,16
lv 188,7,49152
cv 144,20,21
cv 145,22,23
v_max_f32 v56, v56, v31
v_add_f32 v56, 0x41200000, v56
qb 20,208,240,40
lv 190,7,53248
v_mov_b32 v57, v56
qb 20,204,236,20
v_add_f32 v24, v24, v44
v_add_f32 v25, v25, v44
v_permlane16_swap_b32 v56, v57
v_add_f32 v26, v26, v44
v_add_f32 v27, v27, v44
v_max_f32 v56, v56, v57
qb 20,200,232,20
ex 24
ex 25
ex 26
ex 27
v_mov_b32 v57, v56
qb 20,196,228,20
cv 152,24,25
cv 153,26,27
v_permlane32_swap_b32 v56, v57
v_min_f32 v48, -v56, -v57
v_min_f32 v49, -v56, -v57
v_min_f32 v50, -v56, -v57
v_min_f32 v51, -v56, -v57
qb 24,196,244,44
v_max3_f32 v56, v32, v33, v34
v_max_f32 v56, v56, v35
qb 24,200,248,24
v_add_f32 v56, 0x41200000, v56
v_add_f32 v28, v28, v48
v_add_f32 v29, v29, v48
v_add_f32 v30, v30, v48
v_add_f32 v31, v31, v48
v_mov_b32 v57, v56
qb 24,204,252,24
ex 28
ex 29
ex 30
ex 31
v_permlane16_swap_b32 v56, v57
pw 24,208,216
cv 160,28,29
cv 161,30,31
v_max_f32 v56, v56, v57
v_mov_b32 v57, v56
qa 28,208,232,48
v_xor_b32 v0, 0x2000, v0
v_xor_b32 v1, 0x2000, v1
v_permlane32_swap_b32 v56, v57
pw 28,204,228
v_min_f32 v52, -v56, -v57
v_add_f32 v32, v32, v52
v_add_f32 v33, v33, v52
v_add_f32 v34, v34, v52
v_add_f32 v35, v35, v52
pw 28,200,224
ex 32
ex 33
ex 34
ex 35
pw 28,196,220
v_min_f32 v53, -v56, -v57
v_min_f32 v54, -v56, -v57
v_min_f32 v55, -v56, -v57
cv 168,32,33
cv 169,34,35
qa 32,196,236,52
global_load_lds_dwordx4 v13, s[98:99] offset:1024 nt
lk 196,0,0
pw 32,200,240
lk 200,1,0
v_xor_b32 v2, 0x2000, v2
pw 32,204,244
lk 204,2,0
v_xor_b32 v3, 0x2000, v3
pw 32,208,248
s_waitcnt lgkmcnt(3)
lk 208,3,0
v_accvgpr_read_b32 v60, a164
pa 8,176,180
ex 16
pa 8,180,184
ex 17
pa 40,188,184
ex 18
pa 40,184,180
ex 19
pa 72,192,180
cv 138,16,17
cv 139,18,19
pa 72,196,184
ex 20
pa 104,204,184
ex 21
pa 104,200,180
ex 22
pa 136,208,180
ex 23
pa 136,212,184
lv 180,8,49152
cv 146,20,21
pa 140,212,192
lv 182,8,53248
cv 147,22,23
pa 140,208,188
global_load_lds_dwordx4 v12, s[98:99] offset:2048 nt
v_accvgpr_read_b32 v61, a165
pa 108,200,188
ex 24
pa 108,204,192
ex 25
pa 76,196,192
ex 26
pa 76,192,188
ex 27
pa 44,184,188
lv 184,8,57344
v_add_f32 v60, v60, v61
pa 44,188,192
lv 186,8,61440
v_cmp_nge_f32 s[42:43], s29, v60
pa 12,180,192
s_or_b64 s[30:31], s[30:31], s[42:43]
lv 192,9,57344
cv 154,24,25
pa 12,176,188
s_waitcnt lgkmcnt(3)
lv 194,9,61440
cv 155,26,27
qb 16,196,212,36
v_rcp_f32 v60, v60
qb 16,200,216,16
lv 188,9,49152
v_mul_f32_e64 v61, -s40, v60
qb 16,204,220,16
ds_write2_b32 v80, v60, v61 offset0:64 offset1:80
qb 16,208,224,16
ex 28
qb 20,208,240,40
ex 29
qb 20,204,236,20
ex 30
qb 20,200,232,20
ex 31
qb 20,196,228,20
ds_read_b128 v[124:127], v123 offset:256
cv 162,28,29
qb 24,196,244,44
ds_read_b128 v[128:131], v123 offset:320
cv 163,30,31
qb 24,200,248,24
global_load_lds_dwordx4 v13, s[98:99] offset:3072 nt
v_accvgpr_read_b32 v72, a64
qb 24,204,252,24
s_add_u32 m0, s21, 32768
lv 190,9,53248
v_accvgpr_read_b32 v73, a65
pw 24,208,216
s_add_u32 s98, s98, 16384
s_addc_u32 s99, s99, 0
v_accvgpr_read_b32 v74, a68
qa 28,208,232,48
lk 208,3,4096
v_accvgpr_read_b32 v75, a69
pw 28,204,228
lk 204,2,4096
v_accvgpr_read_b32 v104, a66
pw 28,200,224
lk 200,1,4096
v_accvgpr_read_b32 v105, a67
pw 28,196,220
lk 196,0,4096
v_accvgpr_read_b32 v106, a70
pa 16,176,180
s_waitcnt lgkmcnt(5)
v_accvgpr_read_b32 v107, a71
v_fma_f32 v72, v72, v124, v128
pa 16,180,184
v_fma_f32 v73, v73, v125, v129
v_fma_f32 v74, v74, v124, v128
pa 48,188,184
v_fma_f32 v75, v75, v125, v129
v_accvgpr_read_b32 v76, a72
v_accvgpr_read_b32 v77, a73
v_accvgpr_read_b32 v78, a76
v_accvgpr_read_b32 v79, a77
v_pk_fma_f32 v[104:105], v[104:105], v[126:127], v[130:131]
v_pk_fma_f32 v[106:107], v[106:107], v[126:127], v[130:131]
cv 72,72,74
v_accvgpr_read_b32 v108, a74
v_accvgpr_read_b32 v109, a75
v_accvgpr_read_b32 v110, a78
v_accvgpr_read_b32 v111, a79
cv 104,104,106
pa 48,184,180
cv 74,73,75
cv 106,105,107
v_fma_f32 v76, v76, v124, v128
v_fma_f32 v77, v77, v125, v129
v_fma_f32 v78, v78, v124, v128
v_fma_f32 v79, v79, v125, v129
v_pk_fma_f32 v[108:109], v[108:109], v[126:127], v[130:131]
v_pk_fma_f32 v[110:111], v[110:111], v[126:127], v[130:131]
cv 73,76,78
cv 75,77,79
cv 105,108,110
cv 107,109,111
pa 80,192,180
ds_write_b64 v120, v[72:73] offset:0
pa 80,196,184
ds_write_b64 v120, v[74:75] offset:128
pa 112,204,184
ds_write_b64 v120, v[104:105] offset:256
pa 112,200,180
ds_write_b64 v120, v[106:107] offset:384
pa 144,208,180
ds_read_b64_tr_b16 v[64:65], v121 offset:0
v_accvgpr_read_b32 v60, a166
pa 144,212,184
ds_read_b64_tr_b16 v[66:67], v121 offset:32
v_accvgpr_read_b32 v61, a167
pa 148,212,192
s_waitcnt lgkmcnt(6)
ds_read_b64_tr_b16 v[68:69], v121 offset:1024
v_add_f32 v60, v60, v61
pa 148,208,188
ds_read_b64_tr_b16 v[70:71], v121 offset:1056
v_cmp_nge_f32 s[42:43], s29, v60
pa 116,200,188
s_or_b64 s[30:31], s[30:31], s[42:43]
ex 16
pa 116,204,192
ex 17
pa 84,196,192
ex 18
pa 84,192,188
ex 19
pa 52,184,188
s_waitcnt lgkmcnt(2)
buffer_store_dwordx4 v[64:67], v122, s[16:19], s36 offen offset:0 sc0 sc1
cv 140,16,17
cv 141,18,19
v_rcp_f32 v60, v60
pa 52,188,192
ex 20
pa 20,180,192
ex 21
pa 20,176,188
s_waitcnt lgkmcnt(0)
ex 22
qb 16,196,212,36
s_waitcnt vmcnt(17)
buffer_store_dwordx4 v[68:71], v122, s[16:19], s36 offen offset:2048 sc0 sc1
ex 23
v_mul_f32_e64 v61, -s40, v60
cv 148,20,21
qb 16,200,216,16
s_add_u32 s36, s24, 12288
ds_write2_b32 v80, v60, v61 offset0:96 offset1:112
qb 16,204,220,16
ds_read_b128 v[124:127], v123 offset:384
cv 149,22,23
qb 16,208,224,16
ds_read_b128 v[128:131], v123 offset:448
v_accvgpr_read_b32 v72, a96
qb 20,208,240,40
lv 180,10,49152
v_accvgpr_read_b32 v73, a97
qb 20,204,236,20
lv 182,10,53248
v_accvgpr_read_b32 v74, a100
qb 20,200,232,20
lv 184,10,57344
v_accvgpr_read_b32 v75, a101
qb 20,196,228,20
lv 186,10,61440
v_accvgpr_read_b32 v104, a98
lv 192,11,57344
lv 194,11,61440
lv 188,11,49152
lv 190,11,53248
ds_write_b32 v254, v255 offset:0
ex 24
ex 25
ex 26
ex 27
cv 156,24,25
cv 157,26,27
qb 24,196,244,44
ex 28
qb 24,200,248,24
ex 29
qb 24,204,252,24
ex 30
ex 31
pw 24,208,216
cv 164,28,29
cv 165,30,31
v_accvgpr_read_b32 v105, a99
v_accvgpr_read_b32 v106, a102
v_accvgpr_read_b32 v107, a103
qa 28,208,232,48
s_waitcnt lgkmcnt(0)
v_accvgpr_read_b32 v76, a104
v_accvgpr_read_b32 v77, a105
v_accvgpr_read_b32 v78, a108
v_accvgpr_read_b32 v79, a109
v_accvgpr_read_b32 v108, a106
v_pk_fma_f32 v[72:73], v[72:73], v[124:125], v[128:129]
v_pk_fma_f32 v[74:75], v[74:75], v[124:125], v[128:129]
v_pk_fma_f32 v[104:105], v[104:105], v[126:127], v[130:131]
v_pk_fma_f32 v[106:107], v[106:107], v[126:127], v[130:131]
cv 72,72,74
v_accvgpr_read_b32 v109, a107
v_accvgpr_read_b32 v110, a110
v_accvgpr_read_b32 v111, a111
cv 104,104,106
pw 28,204,228
cv 74,73,75
cv 106,105,107
v_fma_f32 v76, v76, v124, v128
v_fma_f32 v77, v77, v125, v129
v_fma_f32 v78, v78, v124, v128
v_fma_f32 v79, v79, v125, v129
v_pk_fma_f32 v[108:109], v[108:109], v[126:127], v[130:131]
v_pk_fma_f32 v[110:111], v[110:111], v[126:127], v[130:131]
cv 73,76,78
cv 75,77,79
cv 105,108,110
cv 107,109,111
pw 28,200,224
ds_write_b64 v120, v[72:73] offset:14336
pw 28,196,220
ds_write_b64 v120, v[74:75] offset:14464
pa 24,176,180
ds_write_b64 v120, v[104:105] offset:14592
pa 24,180,184
ds_write_b64 v120, v[106:107] offset:14720
pa 56,188,184
ds_read_b64_tr_b16 v[64:65], v121 offset:14336
v_accvgpr_read_b32 v60, a168
pa 56,184,180
ds_read_b64_tr_b16 v[66:67], v121 offset:14368
v_accvgpr_read_b32 v61, a169
pa 88,192,180
ds_read_b64_tr_b16 v[68:69], v121 offset:15360
v_add_f32 v60, v60, v61
pa 88,196,184
ds_read_b64_tr_b16 v[70:71], v121 offset:15392
v_cmp_nge_f32 s[42:43], s29, v60
pa 120,204,184
s_or_b64 s[30:31], s[30:31], s[42:43]
ds_read_b32 v255, v12 offset:1024
v_accvgpr_read_b32 v72, a128
pa 120,200,180
v_rcp_f32 v60, v60
pa 152,208,180
v_mul_f32_e64 v61, -s40, v60
v_accvgpr_read_b32 v73, a129
pa 152,212,184
ds_write2_b32 v80, v60, v61 offset0:128 offset1:144
pa 156,212,192
s_waitcnt lgkmcnt(4)
buffer_store_dwordx4 v[64:67], v122, s[16:19], s37 offen offset:0 sc0 sc1
ex 16
ex 17
pa 156,208,188
ex 18
pa 124,200,188
s_waitcnt lgkmcnt(1)
ds_read_b128 v[124:127], v123 offset:512
v_cmp_gt_u32 vcc, 15, v255
pa 124,204,192
s_cbranch_vccnz LsX15
LrX15:
lk 196,0,16384
global_load_lds_dwordx4 v12, s[96:97] offset:0 nt
pa 92,196,192
lk 200,1,16384
cv 142,16,17
pa 92,192,188
lk 204,2,16384
v_accvgpr_read_b32 v74, a132
pa 60,184,188
lk 208,3,16384
v_accvgpr_read_b32 v75, a133
pa 60,188,192
ds_read_b128 v[128:131], v123 offset:576
v_accvgpr_read_b32 v104, a130
pa 28,180,192
buffer_store_dwordx4 v[68:71], v122, s[16:19], s37 offen offset:2048 sc0 sc1
ex 19
ex 20
pa 28,176,188
s_mov_b32 s37, s25
lv 180,4,0
cv 143,18,19
s_waitcnt lgkmcnt(5)
qb 16,196,212,36
s_waitcnt lgkmcnt(4)
ex 21
qb 16,200,216,16
s_waitcnt lgkmcnt(3)
ex 22
qb 16,204,220,16
s_waitcnt lgkmcnt(2)
ex 23
qb 16,208,224,16
lv 182,4,4096
cv 150,20,21
cv 151,22,23
qb 20,208,240,40
global_load_lds_dwordx4 v13, s[96:97] offset:1024 nt
v_accvgpr_read_b32 v105, a131
qb 20,204,236,20
v_accvgpr_read_b32 v106, a134
v_accvgpr_read_b32 v107, a135
qb 20,200,232,20
s_waitcnt lgkmcnt(2)
ex 24
ex 25
ex 26
v_pk_fma_f32 v[72:73], v[72:73], v[124:125], v[128:129]
v_pk_fma_f32 v[74:75], v[74:75], v[124:125], v[128:129]
v_pk_fma_f32 v[104:105], v[104:105], v[126:127], v[130:131]
v_pk_fma_f32 v[106:107], v[106:107], v[126:127], v[130:131]
ex 27
v_accvgpr_read_b32 v76, a136
v_accvgpr_read_b32 v77, a137

LwX0_11:
s_cbranch_vccnz LwrX0
v_accvgpr_read_b32 v78, a140
v_accvgpr_read_b32 v79, a141
cv 72,72,74
v_accvgpr_read_b32 v108, a138
v_accvgpr_read_b32 v109, a139
v_accvgpr_read_b32 v110, a142
v_accvgpr_read_b32 v111, a143
cv 104,104,106
qb 20,196,228,20
cv 74,73,75
cv 106,105,107
cv 158,24,25
cv 159,26,27
v_xor_b32 v172, 0x2000, v4
v_pk_fma_f32 v[76:77], v[76:77], v[124:125], v[128:129]
v_pk_fma_f32 v[78:79], v[78:79], v[124:125], v[128:129]
v_pk_fma_f32 v[108:109], v[108:109], v[126:127], v[130:131]
v_pk_fma_f32 v[110:111], v[110:111], v[126:127], v[130:131]
cv 73,76,78
cv 75,77,79
cv 105,108,110
cv 107,109,111
qb 24,196,244,44
ds_write_b64 v120, v[72:73] offset:16384
qb 24,200,248,24
ds_write_b64 v120, v[74:75] offset:16512
qb 24,204,252,24
ds_write_b64 v120, v[104:105] offset:16640
pw 24,208,216
ds_write_b64 v120, v[106:107] offset:16768
lv 184,172,0
lv 186,172,4096
ds_read_b64_tr_b16 v[64:65], v121 offset:16384
ds_read_b64_tr_b16 v[66:67], v121 offset:16416
ds_read_b64_tr_b16 v[68:69], v121 offset:17408
ds_read_b64_tr_b16 v[70:71], v121 offset:17440
ex 28
ex 29
ex 30
ex 31
cv 166,28,29
cv 167,30,31
qa 28,208,232,48
ds_read_b128 v[124:127], v123 offset:256
v_xor_b32 v5, s35, v5
pw 28,204,228
lv 188,5,0
v_xor_b32 v173, 0x2000, v5
pw 28,200,224
lv 190,5,4096
v_accvgpr_write_b32 a76, s41
pw 28,196,220
s_waitcnt lgkmcnt(5)
buffer_store_dwordx4 v[64:67], v122, s[16:19], s38 offen offset:0 sc0 sc1
ds_read_b128 v[128:131], v123 offset:320
v_accvgpr_write_b32 a77, s41
v_accvgpr_write_b32 a78, s41
v_accvgpr_write_b32 a79, s41
v_mfma_f32_16x16x32_bf16 v[56:59], v[136:139], a[180:183], v[84:87]
lv 192,173,0
v_accvgpr_read_b32 v60, a160
pb 56,140,184
lv 194,173,4096
v_accvgpr_read_b32 v61, a161
v_mfma_f32_16x16x32_bf16 v[88:91], v[148:151], a[184:187], v[84:87]
ex 32
pb 88,144,180
s_waitcnt lgkmcnt(5)
buffer_store_dwordx4 v[68:71], v122, s[16:19], s38 offen offset:2048 sc0 sc1
ex 33
ex 34
v_mfma_f32_16x16x32_bf16 a[64:67], v[152:155], a[180:183], a[76:79]
s_add_u32 s38, s24, 0
ex 35
pa 64,156,184
lk 196,0,20480
v_add_f32 v60, v60, v61
v_mfma_f32_16x16x32_bf16 a[96:99], v[164:167], a[184:187], a[76:79]
lk 200,1,20480
cv 170,32,33
pa 96,160,180
s_waitcnt lgkmcnt(3)
global_load_lds_dwordx4 v12, s[96:97] offset:2048 nt
cv 171,34,35
v_cmp_nge_f32 s[42:43], s29, v60
v_rcp_f32 v60, v60
v_mfma_f32_16x16x32_bf16 a[128:131], v[168:171], a[180:183], a[76:79]
s_or_b64 s[30:31], s[30:31], s[42:43]
lk 204,2,20480
v_mul_f32_e64 v61, -s40, v60
v_mfma_f32_16x16x32_bf16 a[132:135], v[168:171], a[188:191], a[76:79]
ds_write2_b32 v80, v60, v61 offset0:0 offset1:16
v_accvgpr_read_b32 v72, a80
v_accvgpr_read_b32 v73, a81
v_accvgpr_read_b32 v74, a84
v_accvgpr_read_b32 v75, a85
v_accvgpr_read_b32 v104, a82
v_accvgpr_read_b32 v105, a83
v_accvgpr_read_b32 v106, a86
v_accvgpr_read_b32 v107, a87
v_mfma_f32_16x16x32_bf16 a[100:103], v[160:163], a[188:191], a[76:79]
s_waitcnt lgkmcnt(3)
lk 208,3,20480
v_accvgpr_read_b32 v76, a88
v_accvgpr_read_b32 v77, a89
v_accvgpr_read_b32 v78, a92
v_accvgpr_read_b32 v79, a93
v_pk_fma_f32 v[72:73], v[72:73], v[124:125], v[128:129]
v_pk_fma_f32 v[74:75], v[74:75], v[124:125], v[128:129]
v_pk_fma_f32 v[104:105], v[104:105], v[126:127], v[130:131]
v_pk_fma_f32 v[106:107], v[106:107], v[126:127], v[130:131]
cv 72,72,74
v_accvgpr_read_b32 v108, a90
v_accvgpr_read_b32 v109, a91
v_accvgpr_read_b32 v110, a94
v_accvgpr_read_b32 v111, a95
cv 104,104,106
pa 100,164,192
v_accvgpr_read_b32 v60, a162
v_accvgpr_read_b32 v61, a163
cv 74,73,75
cv 106,105,107
v_add_f32 v60, v60, v61
v_pk_fma_f32 v[76:77], v[76:77], v[124:125], v[128:129]
v_pk_fma_f32 v[78:79], v[78:79], v[124:125], v[128:129]
v_pk_fma_f32 v[108:109], v[108:109], v[126:127], v[130:131]
v_pk_fma_f32 v[110:111], v[110:111], v[126:127], v[130:131]
cv 73,76,78
cv 75,77,79
cv 105,108,110
cv 107,109,111
v_mfma_f32_16x16x32_bf16 a[68:71], v[156:159], a[192:195], a[76:79]
ds_write_b64 v120, v[72:73] offset:0
v_cmp_nge_f32 s[42:43], s29, v60
pa 68,152,188
s_or_b64 s[30:31], s[30:31], s[42:43]
ds_write_b64 v120, v[74:75] offset:128
v_mfma_f32_16x16x32_bf16 v[92:95], v[144:147], a[188:191], v[84:87]
ds_write_b64 v120, v[104:105] offset:256
pb 92,148,192
ds_write_b64 v120, v[106:107] offset:384
v_rcp_f32 v60, v60
ds_read_b64_tr_b16 v[112:113], v121 offset:0
v_mul_f32_e64 v61, -s40, v60
ds_read_b64_tr_b16 v[114:115], v121 offset:32
ds_write2_b32 v80, v60, v61 offset0:32 offset1:48
v_mfma_f32_16x16x32_bf16 v[60:63], v[140:143], a[192:195], v[84:87]
ds_read_b64_tr_b16 v[116:117], v121 offset:1024
v_accvgpr_write_b32 a160, 0
pb 60,136,188
ds_read_b64_tr_b16 v[118:119], v121 offset:1056
v_accvgpr_write_b32 a161, 0
v_accvgpr_write_b32 a162, 0
v_accvgpr_write_b32 a163, 0
ex 16
ex 17
ex 18
ex 19
v_smfmac_f32_16x16x64_bf16 a[160:163], a[172:175], v[136:143], v14
s_waitcnt lgkmcnt(4)
global_load_lds_dwordx4 v13, s[96:97] offset:3072 nt
cv 180,16,17
cv 181,18,19
qb 16,196,212,36
s_add_u32 m0, s21, 147456
ex 20
qb 16,200,216,16
s_add_u32 s96, s96, 16384
s_addc_u32 s97, s97, 0
v_xor_b32 v6, s35, v6
qb 16,204,220,16
ex 21
ex 22
qb 16,208,224,16
s_waitcnt lgkmcnt(0)
buffer_store_dwordx4 v[112:115], v122, s[16:19], s39 offen offset:128 sc0 sc1
ex 23
cv 188,20,21
cv 189,22,23
qb 20,208,240,40
ex 24
qb 20,204,236,20
ex 25
qb 20,200,232,20
ex 26
qb 20,196,228,20
buffer_store_dwordx4 v[116:119], v122, s[16:19], s39 offen offset:2176 sc0 sc1
ex 27
cv 196,24,25
cv 197,26,27
qb 24,196,244,44
s_add_u32 s39, s24, 0
lv 180,6,0
v_xor_b32 v174, 0x2000, v6
qb 24,200,248,24
lv 182,6,4096
v_xor_b32 v7, s35, v7
qb 24,204,252,24
lv 184,174,0
v_xor_b32 v175, 0x2000, v7
pw 24,208,216
lv 186,174,4096
v_accvgpr_read_b32 v72, a112
ex 28
ex 29
ex 30
ex 31
cv 204,28,29
cv 205,30,31
qa 28,208,232,48
ds_read_b128 v[124:127], v123 offset:384
v_accvgpr_read_b32 v73, a113
pw 28,204,228
ds_read_b128 v[128:131], v123 offset:448
v_accvgpr_read_b32 v74, a116
pw 28,200,224
lv 188,7,0
v_accvgpr_read_b32 v75, a117
pw 28,196,220
s_waitcnt lgkmcnt(4)
lv 190,7,4096
v_accvgpr_read_b32 v104, a114
v_mfma_f32_16x16x32_bf16 v[64:67], v[136:139], a[180:183], v[84:87]
s_waitcnt lgkmcnt(4)
lv 192,175,0
v_accvgpr_read_b32 v105, a115
pb 64,140,184
lv 194,175,4096
v_accvgpr_read_b32 v106, a118
v_mfma_f32_16x16x32_bf16 v[96:99], v[148:151], a[184:187], v[84:87]
global_load_lds_dwordx4 v12, s[98:99] offset:0 nt
v_accvgpr_read_b32 v107, a119
pb 96,144,180
v_accvgpr_read_b32 v76, a120
v_accvgpr_read_b32 v77, a121
v_mfma_f32_16x16x32_bf16 a[72:75], v[152:155], a[180:183], a[76:79]
s_waitcnt lgkmcnt(4)
v_fma_f32 v72, v72, v124, v128
v_fma_f32 v73, v73, v125, v129
pa 72,156,184
v_accvgpr_read_b32 v78, a124
v_accvgpr_read_b32 v79, a125
v_accvgpr_read_b32 v108, a122
v_accvgpr_read_b32 v109, a123
v_accvgpr_read_b32 v110, a126
v_pk_fma_f32 v[74:75], v[74:75], v[124:125], v[128:129]
v_pk_fma_f32 v[104:105], v[104:105], v[126:127], v[130:131]
v_pk_fma_f32 v[106:107], v[106:107], v[126:127], v[130:131]
cv 72,72,74
v_accvgpr_read_b32 v111, a127
cv 104,104,106
v_mfma_f32_16x16x32_bf16 a[104:107], v[164:167], a[184:187], a[76:79]
cv 74,73,75
cv 106,105,107
v_xor_b32 v0, 0x2000, v0
v_xor_b32 v1, 0x2000, v1
v_xor_b32 v2, 0x2000, v2
v_pk_fma_f32 v[76:77], v[76:77], v[124:125], v[128:129]
v_pk_fma_f32 v[78:79], v[78:79], v[124:125], v[128:129]
v_pk_fma_f32 v[108:109], v[108:109], v[126:127], v[130:131]
v_pk_fma_f32 v[110:111], v[110:111], v[126:127], v[130:131]
cv 73,76,78
cv 75,77,79
cv 105,108,110
cv 107,109,111
pa 104,160,180
ds_write_b64 v120, v[72:73] offset:14336
v_mfma_f32_16x16x32_bf16 a[136:139], v[168:171], a[180:183], a[76:79]
s_waitcnt lgkmcnt(1)
ds_write_b64 v120, v[74:75] offset:14464
v_mfma_f32_16x16x32_bf16 a[140:143], v[168:171], a[188:191], a[76:79]
ds_write_b64 v120, v[104:105] offset:14592
v_mfma_f32_16x16x32_bf16 a[108:111], v[160:163], a[188:191], a[76:79]
ds_write_b64 v120, v[106:107] offset:14720
pa 108,164,192
ds_read_b64_tr_b16 v[112:113], v121 offset:14336
v_xor_b32 v3, 0x2000, v3
pa 76,156,192
ds_read_b64_tr_b16 v[114:115], v121 offset:14368
global_load_lds_dwordx4 v13, s[98:99] offset:1024 nt
pa 76,152,188
ds_read_b64_tr_b16 v[116:117], v121 offset:15360
v_xor_b32 v8, s35, v8
v_mfma_f32_16x16x32_bf16 v[100:103], v[144:147], a[188:191], v[84:87]
ds_read_b64_tr_b16 v[118:119], v121 offset:15392
v_xor_b32 v212, 0x2000, v8
pb 100,148,192
lk 196,0,16384
v_accvgpr_read_b32 v72, a144
v_mfma_f32_16x16x32_bf16 v[68:71], v[140:143], a[192:195], v[84:87]
lk 200,1,16384
v_accvgpr_read_b32 v73, a145
pb 68,136,188
lk 204,2,16384
v_accvgpr_read_b32 v74, a148
v_smfmac_f32_16x16x64_bf16 a[160:163], a[176:179], v[144:151], v14
s_waitcnt lgkmcnt(2)
lk 208,3,16384
ex 16
buffer_store_dwordx4 v[112:115], v122, s[16:19], s36 offen offset:128 sc0 sc1
ex 17
ex 18
ex 19
cv 182,16,17
cv 183,18,19
ex 20
qb 16,196,212,36
s_waitcnt lgkmcnt(2)
ex 21
qb 16,200,216,16
s_waitcnt lgkmcnt(1)
buffer_store_dwordx4 v[116:119], v122, s[16:19], s36 offen offset:2176 sc0 sc1
ex 22
ex 23
qb 16,204,220,16
s_add_u32 s36, s24, 4096
ds_read_b128 v[124:127], v123 offset:512
cv 190,20,21
s_waitcnt lgkmcnt(1)
qb 16,208,224,16
ds_read_b128 v[128:131], v123 offset:576
cv 191,22,23
qb 20,208,240,40
ex 24
qb 20,204,236,20
ex 25
qb 20,200,232,20
ex 26
ex 27
qb 20,196,228,20
lv 180,8,0
cv 198,24,25
cv 199,26,27
qb 24,196,244,44
ex 28
qb 24,200,248,24
ex 29
qb 24,204,252,24
ex 30
ex 31
pw 24,208,216
lv 182,8,4096
cv 206,28,29
cv 207,30,31
qa 28,208,232,48
lv 184,212,0
v_accvgpr_read_b32 v75, a149
pw 28,204,228
lv 186,212,4096
v_accvgpr_read_b32 v104, a146
pw 28,200,224
global_load_lds_dwordx4 v12, s[98:99] offset:2048 nt
v_accvgpr_read_b32 v105, a147
pw 28,196,220
v_accvgpr_read_b32 v106, a150
v_accvgpr_read_b32 v107, a151
qa 32,196,236,52
s_waitcnt lgkmcnt(3)
lk 196,0,20480
v_accvgpr_read_b32 v76, a152
v_accvgpr_read_b32 v77, a153
v_accvgpr_read_b32 v78, a156
v_accvgpr_read_b32 v79, a157
v_pk_fma_f32 v[72:73], v[72:73], v[124:125], v[128:129]
v_pk_fma_f32 v[74:75], v[74:75], v[124:125], v[128:129]
v_pk_fma_f32 v[104:105], v[104:105], v[126:127], v[130:131]
v_pk_fma_f32 v[106:107], v[106:107], v[126:127], v[130:131]
cv 72,72,74
v_accvgpr_read_b32 v108, a154
v_accvgpr_read_b32 v109, a155
v_accvgpr_read_b32 v110, a158
v_accvgpr_read_b32 v111, a159
cv 104,104,106
pw 32,200,240
lk 200,1,20480
cv 74,73,75
cv 106,105,107
v_xor_b32 v9, s35, v9
v_xor_b32 v213, 0x2000, v9
v_pk_fma_f32 v[76:77], v[76:77], v[124:125], v[128:129]
v_pk_fma_f32 v[78:79], v[78:79], v[124:125], v[128:129]
v_pk_fma_f32 v[108:109], v[108:109], v[126:127], v[130:131]
v_pk_fma_f32 v[110:111], v[110:111], v[126:127], v[130:131]
cv 73,76,78
cv 75,77,79
cv 105,108,110
cv 107,109,111
pw 32,204,244
ds_write_b64 v120, v[72:73] offset:16384
pw 32,208,248
s_waitcnt lgkmcnt(2)
ds_write_b64 v120, v[74:75] offset:16512
v_mfma_f32_16x16x32_bf16 v[72:75], v[136:139], a[180:183], v[84:87]
ds_write_b64 v120, v[104:105] offset:16640
pb 72,140,184
ds_write_b64 v120, v[106:107] offset:16768
v_mfma_f32_16x16x32_bf16 v[104:107], v[148:151], a[184:187], v[84:87]
ds_read_b64_tr_b16 v[112:113], v121 offset:16384
v_accvgpr_write_b32 a92, s41
pb 104,144,180
ds_read_b64_tr_b16 v[114:115], v121 offset:16416
v_accvgpr_write_b32 a93, s41
ds_read_b64_tr_b16 v[116:117], v121 offset:17408
ds_read_b64_tr_b16 v[118:119], v121 offset:17440
lv 188,9,0
lv 190,9,4096
v_accvgpr_write_b32 a94, s41
v_accvgpr_write_b32 a95, s41
lv 192,213,0
lv 194,213,4096
v_mfma_f32_16x16x32_bf16 a[80:83], v[152:155], a[180:183], a[92:95]
s_waitcnt lgkmcnt(9)
global_load_lds_dwordx4 v13, s[98:99] offset:3072 nt
lk 204,2,20480
pa 80,156,184
s_add_u32 m0, s21, 49152
lk 208,3,20480
v_accvgpr_write_b32 a164, 0
v_mfma_f32_16x16x32_bf16 a[112:115], v[164:167], a[184:187], a[92:95]
s_add_u32 s98, s98, 16384
s_addc_u32 s99, s99, 0
ds_read_b128 v[124:127], v123 offset:0
pa 112,160,180
ds_read_b128 v[128:131], v123 offset:64
v_accvgpr_write_b32 a165, 0
v_mfma_f32_16x16x32_bf16 a[144:147], v[168:171], a[180:183], a[92:95]
s_waitcnt lgkmcnt(6)
buffer_store_dwordx4 v[112:115], v122, s[16:19], s37 offen offset:128 sc0 sc1
v_accvgpr_write_b32 a166, 0
v_accvgpr_write_b32 a167, 0
ex 16
v_mfma_f32_16x16x32_bf16 a[148:151], v[168:171], a[188:191], a[92:95]
ex 17
v_mfma_f32_16x16x32_bf16 a[116:119], v[160:163], a[188:191], a[92:95]
s_waitcnt lgkmcnt(4)
ex 18
pa 116,164,192
ex 19
v_mfma_f32_16x16x32_bf16 a[84:87], v[156:159], a[192:195], a[92:95]
buffer_store_dwordx4 v[116:119], v122, s[16:19], s37 offen offset:2176 sc0 sc1
cv 176,16,17
cv 177,18,19
ex 20
pa 84,152,188
s_add_u32 s37, s24, 4096
ex 21
v_mfma_f32_16x16x32_bf16 v[108:111], v[144:147], a[188:191], v[84:87]
ex 22
pb 108,148,192
ex 23
v_mfma_f32_16x16x32_bf16 v[76:79], v[140:143], a[192:195], v[84:87]
cv 184,20,21
cv 185,22,23
pb 76,136,188
ex 24
v_smfmac_f32_16x16x64_bf16 a[164:167], a[172:175], v[152:159], v14
v_xor_b32 v10, s35, v10
v_smfmac_f32_16x16x64_bf16 a[164:167], a[176:179], v[160:167], v14
v_xor_b32 v11, s35, v11
qb 16,196,212,36
s_waitcnt vmcnt(28)
ex 25
qb 16,200,216,16
s_waitcnt lgkmcnt(0)
ex 26
qb 16,204,220,16
ex 27
qb 16,208,224,16
lv 180,10,0
cv 192,24,25
qb 20,208,240,40
lv 182,10,4096
cv 193,26,27
qb 20,204,236,20
lv 188,11,0
v_xor_b32 v214, 0x2000, v10
qb 20,200,232,20
lv 184,214,0
v_xor_b32 v215, 0x2000, v11
qb 20,196,228,20
lv 186,214,4096
v_mov_b32 v255, 16
qb 24,196,244,44
lv 190,11,4096
v_accvgpr_write_b32 a168, 0
qb 24,200,248,24
lv 192,215,0
v_accvgpr_write_b32 a169, 0
qb 24,204,252,24
lv 194,215,4096
v_accvgpr_read_b32 v132, a0
pw 24,208,216
ds_write_b32 v254, v255 offset:0
ex 28
ex 29
ex 30
ex 31
cv 200,28,29
cv 201,30,31
qa 28,208,232,48
ex 32
pw 28,204,228
ex 33
pw 28,200,224
ex 34
ex 35
pw 28,196,220
cv 208,32,33
cv 209,34,35
qa 32,196,236,52
ex 16
pw 32,200,240
ex 17
pw 32,204,244
ex 18
pw 32,208,248
s_waitcnt lgkmcnt(0)
ex 19
v_mfma_f32_16x16x32_bf16 v[80:83], v[136:139], a[180:183], v[84:87]
ds_read_b32 v255, v12 offset:1024
cv 178,16,17
pb 80,140,184
cv 179,18,19
v_accvgpr_read_b32 v133, a4
v_mfma_f32_16x16x32_bf16 v[112:115], v[148:151], a[184:187], v[84:87]
ex 20
pb 112,144,180
ex 21
v_mfma_f32_16x16x32_bf16 a[88:91], v[152:155], a[180:183], a[92:95]
ex 22
pa 88,156,184
ex 23
v_mfma_f32_16x16x32_bf16 a[120:123], v[164:167], a[184:187], a[92:95]
cv 186,20,21
cv 187,22,23
pa 120,160,180
s_waitcnt lgkmcnt(0)
v_cmp_gt_u32 vcc, 16, v255
v_accvgpr_read_b32 v134, a8
v_mfma_f32_16x16x32_bf16 a[152:155], v[168:171], a[180:183], a[92:95]
ex 24
v_mfma_f32_16x16x32_bf16 a[156:159], v[168:171], a[188:191], a[92:95]
s_cbranch_vccnz LsX16
LrX16:
lk 196,0,32768
global_load_lds_dwordx4 v12, s[96:97] offset:0 nt
v_mfma_f32_16x16x32_bf16 a[124:127], v[160:163], a[188:191], a[92:95]
lk 200,1,32768
v_mov_b32 v255, 17
pa 124,164,192
lk 204,2,32768
v_accvgpr_read_b32 v135, a12
pa 92,156,192
lk 208,3,32768
v_fma_f32 v132, v132, v124, v128
pa 92,152,188
ex 25
v_mfma_f32_16x16x32_bf16 v[116:119], v[144:147], a[188:191], v[84:87]
ex 26
pb 116,148,192
ex 27
pb 84,140,192
lv 180,4,16384
cv 194,24,25
pb 84,136,188
lv 182,4,20480
cv 195,26,27
pv 168,172,168
s_waitcnt lgkmcnt(4)
ex 28
qb 16,196,212,36

LwX0_12:
s_cbranch_vccnz LwrX0
ex 29
qb 16,200,216,16
s_waitcnt lgkmcnt(2)
ex 30
qb 16,204,220,16
ex 31
qb 16,208,224,16
global_load_lds_dwordx4 v13, s[96:97] offset:1024 nt
cv 202,28,29
qb 20,208,240,40
lv 184,172,16384
cv 203,30,31
qb 20,204,236,20
lv 186,172,20480
v_fma_f32 v133, v133, v124, v128
qb 20,200,232,20
ex 32
qb 20,196,228,20
ex 33
qb 24,196,244,44
ex 34
qb 24,200,248,24
ex 35
qb 24,204,252,24
lv 188,5,16384
cv 210,32,33
pw 24,208,216
lv 190,5,20480
cv 211,34,35
qa 28,208,232,48
lv 192,173,16384
v_fma_f32 v134, v134, v124, v128
pw 28,204,228
lv 194,173,20480
v_fma_f32 v135, v135, v124, v128
pw 28,200,224
ex 16
pw 28,196,220
ex 17
qa 32,196,236,52
global_load_lds_dwordx4 v12, s[96:97] offset:2048 nt
lk 196,0,36864
pw 32,200,240
lk 200,1,36864
cv 136,16,17
pw 32,204,244
lk 204,2,36864
v_xor_b32 v0, 0x2000, v0
pw 32,208,248
s_waitcnt lgkmcnt(5)
lk 208,3,36864
v_xor_b32 v1, 0x2000, v1
pb 56,176,180
ex 18
pb 56,180,184
ex 19
pb 88,188,184
cv 137,18,19
v_xor_b32 v2, 0x2000, v2
pb 88,184,180
ex 20
pa 64,192,180
ex 21
pa 64,196,184
ex 22
pa 96,204,184
ex 23
pa 96,200,180
lv 184,174,16384
cv 144,20,21
pa 128,208,180
lv 180,6,16384
cv 145,22,23
pa 132,208,188
ex 24
pa 100,200,188
s_waitcnt lgkmcnt(2)
ex 25
pa 100,204,192
global_load_lds_dwordx4 v13, s[96:97] offset:3072 nt
cv 152,24,25
pa 68,196,192
s_add_u32 m0, s21, 98304
ex 26
pa 68,192,188
s_add_u32 s96, s96, 16384
s_addc_u32 s97, s97, 0
lv 182,6,20480
pb 92,184,188
ex 27
pb 92,188,192
lv 186,174,20480
cv 153,26,27
pb 60,180,192
ex 28
pb 60,176,188
ex 29
v_smfmac_f32_16x16x64_bf16 a[160:163], a[172:175], v[176:183], v14
cv 160,28,29
qb 16,196,212,36
ex 30
qb 16,200,216,16
ex 31
qb 16,204,220,16
lv 188,7,16384
cv 161,30,31
qb 16,208,224,16
ex 32
qb 20,208,240,40
ex 33
qb 20,204,236,20
ex 34
qb 20,200,232,20
ex 35
qb 20,196,228,20
global_load_lds_dwordx4 v12, s[98:99] offset:0 nt
cv 168,32,33
qb 24,196,244,44
lv 190,7,20480
cv 169,34,35
qb 24,200,248,24
lv 192,175,16384
v_xor_b32 v3, 0x2000, v3
qb 24,204,252,24
lv 194,175,20480
cv 132,132,133
pw 24,208,216
ex 16
qa 28,208,232,48
ex 17
pw 28,204,228
ex 18
pw 28,200,224
ex 19
pw 28,196,220
cv 138,16,17
cv 139,18,19
qa 32,196,236,52
lk 196,0,32768
cv 133,134,135
pw 32,200,240
lk 200,1,32768
v_accvgpr_read_b32 v134, a9
pw 32,204,244
lk 204,2,32768
v_accvgpr_read_b32 v135, a13
pw 32,208,248
s_waitcnt lgkmcnt(3)
lk 208,3,32768
v_fma_f32 v134, v134, v125, v129
pb 64,176,180
ex 20
pb 64,180,184
ex 21
pb 96,188,184
global_load_lds_dwordx4 v13, s[98:99] offset:1024 nt
cv 146,20,21
pb 96,184,180
ex 22
pa 72,192,180
ex 23
pa 72,196,184
ds_write_b64 v120, v[132:133] offset:0
pa 104,204,184
lv 184,212,16384
cv 147,22,23
pa 104,200,180
ex 24
pa 136,208,180
ex 25
pa 140,208,188
ex 26
pa 108,200,188
ex 27
pa 108,204,192
lv 180,8,16384
cv 154,24,25
pa 76,196,192
lv 182,8,20480
cv 155,26,27
pa 76,192,188
lv 186,212,20480
v_accvgpr_read_b32 v132, a1
pb 100,184,188
ex 28
pb 100,188,192
ex 29
pb 68,180,192
ex 30
pb 68,176,188
global_load_lds_dwordx4 v12, s[98:99] offset:2048 nt
cv 162,28,29
v_smfmac_f32_16x16x64_bf16 a[160:163], a[176:179], v[184:191], v14
s_waitcnt lgkmcnt(3)
lv 188,9,16384
qb 16,196,212,36
ex 31
qb 16,200,216,16
lv 190,9,20480
cv 163,30,31
qb 16,204,220,16
lv 192,213,16384
v_accvgpr_read_b32 v133, a5
qb 16,208,224,16
lv 194,213,20480
v_fma_f32 v132, v132, v125, v129
qb 20,208,240,40
ex 32
qb 20,204,236,20
ex 33
qb 20,200,232,20
ex 34
qb 20,196,228,20
ex 16
qb 24,196,244,44
ex 35
qb 24,200,248,24
ex 17
qb 24,204,252,24
cv 140,16,17
cv 170,32,33
pw 24,208,216
ex 18
qa 28,208,232,48
lk 208,3,36864
cv 171,34,35
pw 28,204,228
s_waitcnt lgkmcnt(1)
global_load_lds_dwordx4 v13, s[98:99] offset:3072 nt
lk 204,2,36864
pw 28,200,224
s_add_u32 m0, s21, 65536
lk 200,1,36864
v_fma_f32 v133, v133, v125, v129
pw 28,196,220
s_add_u32 s98, s98, 16384
s_addc_u32 s99, s99, 0
lk 196,0,36864
pb 72,176,180
ex 19
pb 72,180,184
cv 141,18,19
v_fma_f32 v135, v135, v125, v129
pb 104,188,184
ex 20
pb 104,184,180
ex 21
pa 80,192,180
ex 22
pa 80,196,184
cv 148,20,21
cv 132,132,133
pa 112,204,184
ex 23
pa 112,200,180
lv 184,214,16384
cv 149,22,23
pa 144,208,180
lv 180,10,16384
cv 133,134,135
pa 148,208,188
lv 182,10,20480
v_accvgpr_read_b32 v134, a10
pa 116,200,188
lv 186,214,20480
v_accvgpr_read_b32 v135, a14
pa 116,204,192
ex 24
pa 84,196,192
ex 25
pa 84,192,188
ex 26
pb 108,184,188
ds_write_b64 v120, v[132:133] offset:128
pb 108,188,192
ex 27
pb 76,180,192
lv 192,215,16384
cv 156,24,25
pb 76,176,188
lv 188,11,16384
cv 157,26,27
v_smfmac_f32_16x16x64_bf16 a[164:167], a[172:175], v[192:199], v14
lv 190,11,20480
v_smfmac_f32_16x16x64_bf16 a[164:167], a[176:179], v[200:207], v14
s_waitcnt lgkmcnt(4)
lv 194,215,20480
qb 16,196,212,36
s_waitcnt vmcnt(28)
ds_write_b32 v254, v255 offset:0
qb 16,200,216,16
ex 28
qb 16,204,220,16
ex 29
qb 16,208,224,16
ex 30
qb 20,208,240,40
ex 31
qb 20,204,236,20
cv 164,28,29
cv 165,30,31
qb 20,200,232,20
v_accvgpr_read_b32 v132, a2
v_accvgpr_read_b32 v133, a6
qb 20,196,228,20
ex 16
qb 24,196,244,44
v_fma_f32 v132, v132, v126, v130
v_fma_f32 v133, v133, v126, v130
qb 24,200,248,24
ex 17
qb 24,204,252,24
cv 142,16,17
v_fma_f32 v134, v134, v126, v130
pw 24,208,216
ex 18
qa 28,208,232,48
v_fma_f32 v135, v135, v126, v130
cv 132,132,133
pw 28,204,228
ex 19
pw 28,200,224
cv 143,18,19
cv 133,134,135
pw 28,196,220
ex 20
pb 80,176,180
ds_read_b32 v255, v12 offset:1024
v_accvgpr_read_b32 v134, a11
pb 80,180,184
ex 21
pb 112,188,184
ds_write_b64 v120, v[132:133] offset:256
pb 112,184,180
cv 150,20,21
v_accvgpr_read_b32 v132, a3
pa 88,192,180
ex 22
pa 88,196,184
v_accvgpr_read_b32 v133, a7
v_accvgpr_read_b32 v135, a15
pa 120,204,184
ex 23
pa 120,200,180
s_waitcnt lgkmcnt(1)
v_cmp_gt_u32 vcc, 17, v255
cv 151,22,23
pa 152,208,180
ex 24
pa 156,208,188
s_cbranch_vccnz LsX17
LrX17:
lk 196,0,49152
global_load_lds_dwordx4 v12, s[96:97] offset:0 nt
pa 124,200,188
lk 200,1,49152
v_fma_f32 v132, v132, v127, v131
pa 124,204,192
lk 204,2,49152
v_fma_f32 v133, v133, v127, v131
pa 92,196,192
lk 208,3,49152
v_fma_f32 v134, v134, v127, v131
pa 92,192,188
ex 25
pb 116,184,188
ex 26
pb 116,188,192
ex 27
pb 84,180,192
lv 180,4,32768
cv 158,24,25
pb 84,176,188
lv 182,4,36864
cv 159,26,27
pv 168,172,208
s_waitcnt lgkmcnt(4)
lv 184,172,32768
v_fma_f32 v135, v135, v127, v131
qb 16,196,212,36
lv 186,172,36864
cv 132,132,133
qb 16,200,216,16
s_waitcnt lgkmcnt(4)
ex 28
qb 16,204,220,16
ex 29
qb 16,208,224,16
ex 30
qb 20,208,240,40
ex 31
qb 20,204,236,20
global_load_lds_dwordx4 v13, s[96:97] offset:1024 nt
cv 166,28,29
qb 20,200,232,20
lv 188,5,32768
cv 167,30,31
qb 20,196,228,20
lv 190,5,36864
cv 133,134,135
qb 24,196,244,44
lv 192,173,32768
v_mov_b32 v255, 18
qb 24,200,248,24
lv 194,173,36864
qb 24,204,252,24
ex 16
pw 24,208,216
ex 17
qa 28,208,232,48
lk 208,3,53248
cv 180,16,17
pw 28,204,228
lk 204,2,53248
v_xor_b32 v2, 0x2000, v2
pw 28,200,224
lk 200,1,53248
v_xor_b32 v1, 0x2000, v1
pw 28,196,220
s_waitcnt lgkmcnt(5)
lk 196,0,53248
v_xor_b32 v0, 0x2000, v0
pb 56,136,180
global_load_lds_dwordx4 v12, s[96:97] offset:2048 nt
v_xor_b32 v3, 0x2000, v3
pb 56,140,184
ex 18
pb 88,148,184
ex 19
pb 88,144,180
ds_write_b64 v120, v[132:133] offset:384
pa 64,152,180
ds_read_b64_tr_b16 v[132:133], v121 offset:0
cv 181,18,19
pa 64,156,184
ex 20
pa 96,164,184
ex 21
pa 96,160,180
ex 22
pa 128,168,180
ex 23
pa 132,168,188
lv 180,6,32768
cv 188,20,21
pa 100,160,188
s_waitcnt lgkmcnt(3)
lv 182,6,36864
cv 189,22,23
pa 100,164,192
ex 24
pa 68,156,192
ex 25
pa 68,152,188
ex 26
pb 92,144,188
lv 184,174,32768
cv 196,24,25
pb 92,148,192
global_load_lds_dwordx4 v13, s[96:97] offset:3072 nt
lv 186,174,36864
pb 60,140,192
s_add_u32 m0, s21, 114688
ex 27
pb 60,136,188
s_add_u32 s96, s96, 16384
s_addc_u32 s97, s97, 0
lv 188,7,32768
v_smfmac_f32_16x16x64_bf16 a[160:163], a[172:175], v[136:143], v14
lv 190,7,36864
qb 16,196,212,36
lv 192,175,32768
cv 197,26,27
qb 16,200,216,16
ex 28
qb 16,204,220,16
ex 29
qb 16,208,224,16
ex 30
qb 20,208,240,40
ex 31
qb 20,204,236,20
lv 194,175,36864
cv 204,28,29
qb 20,200,232,20
ds_read_b64_tr_b16 v[134:135], v121 offset:32
cv 205,30,31
qb 20,196,228,20
ex 16
qb 24,196,244,44
qb 24,200,248,24
ex 17
qb 24,204,252,24
cv 182,16,17
pw 24,208,216
global_load_lds_dwordx4 v12, s[98:99] offset:0 nt
qa 28,208,232,48
lk 208,3,49152
pw 28,204,228
lk 204,2,49152
pw 28,200,224
lk 200,1,49152
pw 28,196,220
s_waitcnt lgkmcnt(3)
lk 196,0,49152
pb 64,136,180
ex 18
pb 64,140,184
ex 19
pb 96,148,184
buffer_store_dwordx4 v[132:135], v122, s[16:19], s38 offen offset:0 sc0 sc1
cv 183,18,19
ex 20
pb 96,144,180
ex 21
pa 72,152,180
ex 22
pa 72,156,184
ds_read_b64_tr_b16 v[132:133], v121 offset:1024
cv 190,20,21
pa 104,164,184
ex 23
pa 104,160,180
lv 184,212,32768
cv 191,22,23
pa 136,168,180
ex 24
pa 140,168,188
lv 180,8,32768
pa 108,160,188
global_load_lds_dwordx4 v13, s[98:99] offset:1024 nt
lv 182,8,36864
pa 108,164,192
ex 25
pa 76,156,192
ex 26
pa 76,152,188
lv 186,212,36864
cv 198,24,25
pb 100,144,188
ds_read_b64_tr_b16 v[134:135], v121 offset:1056
pb 100,148,192
ex 27
pb 68,140,192
lv 192,213,32768
cv 199,26,27
pb 68,136,188
ex 28
v_smfmac_f32_16x16x64_bf16 a[160:163], a[176:179], v[144:151], v14
s_waitcnt lgkmcnt(3)
lv 188,9,32768
qb 16,196,212,36
ex 29
qb 16,200,216,16
lv 190,9,36864
cv 206,28,29
qb 16,204,220,16
ex 30
qb 16,208,224,16
lv 194,213,36864
qb 20,208,240,40
ex 31
qb 20,204,236,20
s_waitcnt lgkmcnt(3)
buffer_store_dwordx4 v[132:135], v122, s[16:19], s38 offen offset:2048 sc0 sc1
cv 207,30,31
s_nop 0
v_accvgpr_read_b32 v132, a16
v_accvgpr_read_b32 v133, a20
qb 20,200,232,20
v_accvgpr_read_b32 v134, a24
v_accvgpr_read_b32 v135, a28
qb 20,196,228,20
ex 16
qb 24,196,244,44
ex 17
qb 24,200,248,24

LwX0_13:
s_cbranch_vccnz LwrX0
global_load_lds_dwordx4 v12, s[98:99] offset:2048 nt
cv 176,16,17
qb 24,204,252,24
ex 18
pw 24,208,216
v_fma_f32 v132, v132, v124, v128
v_fma_f32 v133, v133, v124, v128
qa 28,208,232,48
ex 19
pw 28,204,228
cv 177,18,19
v_fma_f32 v134, v134, v124, v128
pw 28,200,224
ex 20
pw 28,196,220
v_fma_f32 v135, v135, v124, v128
cv 132,132,133
qa 32,196,236,52
lk 196,0,53248
cv 133,134,135
pw 32,200,240
lk 200,1,53248
v_accvgpr_read_b32 v134, a25
pw 32,204,244
lk 204,2,53248
v_accvgpr_read_b32 v135, a29
pw 32,208,248
lk 208,3,53248
v_fma_f32 v134, v134, v125, v129
pb 72,136,180
ex 21
pb 72,140,184
global_load_lds_dwordx4 v13, s[98:99] offset:3072 nt
cv 184,20,21
pb 104,148,184
s_add_u32 m0, s21, 81920
ex 22
pb 104,144,180
s_add_u32 s98, s98, 16384
s_addc_u32 s99, s99, 0
v_fma_f32 v135, v135, v125, v129
pa 80,152,180
ex 23
pa 80,156,184
ds_write_b64 v120, v[132:133] offset:0
pa 112,164,184
lv 184,214,32768
cv 185,22,23
pa 112,160,180
ex 24
pa 144,168,180
s_waitcnt lgkmcnt(2)
ex 25
pa 148,168,188
ex 26
pa 116,160,188
ex 27
pa 116,164,192
lv 180,10,32768
cv 192,24,25
pa 84,156,192
lv 182,10,36864
cv 193,26,27
pa 84,152,188
lv 186,214,36864
v_accvgpr_read_b32 v132, a17
pb 108,144,188
ex 28
pb 108,148,192
ex 29
pb 76,140,192
lv 192,215,32768
cv 200,28,29
pb 76,136,188
lv 188,11,32768
v_accvgpr_read_b32 v133, a21
v_smfmac_f32_16x16x64_bf16 a[164:167], a[172:175], v[152:159], v14
lv 190,11,36864
v_smfmac_f32_16x16x64_bf16 a[164:167], a[176:179], v[160:167], v14
lv 194,215,36864
qb 16,196,212,36
s_waitcnt vmcnt(20)
ds_write_b32 v254, v255 offset:0
qb 16,200,216,16
ex 30
qb 16,204,220,16
ex 31
qb 16,208,224,16
cv 201,30,31
v_fma_f32 v132, v132, v125, v129
qb 20,208,240,40
ex 32
qb 20,204,236,20
ex 33
qb 20,200,232,20
ex 34
qb 20,196,228,20
ex 35
qb 24,196,244,44
cv 208,32,33
cv 209,34,35
qb 24,200,248,24
ex 16
qb 24,204,252,24
ex 17
pw 24,208,216
ex 18
qa 28,208,232,48
ex 19
pw 28,204,228
cv 178,16,17
cv 179,18,19
pw 28,200,224
ex 20
pw 28,196,220
v_fma_f32 v133, v133, v125, v129
cv 132,132,133
qa 32,196,236,52
ex 21
pw 32,200,240
cv 186,20,21
cv 133,134,135
pw 32,204,244
ex 22
pw 32,208,248
s_waitcnt lgkmcnt(0)
ds_write_b64 v120, v[132:133] offset:128
pb 80,136,180
ds_read_b32 v255, v12 offset:1024
v_accvgpr_read_b32 v132, a18
pb 80,140,184
ex 23
pb 112,148,184
cv 187,22,23
v_accvgpr_read_b32 v133, a22
pb 112,144,180
ex 24
pa 88,152,180
ex 25
pa 88,156,184
cv 194,24,25
v_accvgpr_read_b32 v134, a26
pa 120,164,184
s_mov_b64 vcc, -1
s_cmp_eq_u32 s21, 0
s_cbranch_scc1 LwX1_0
s_cmp_eq_u32 s21, 4096
s_cbranch_scc1 LwX1_1
s_cmp_eq_u32 s21, 8192
s_cbranch_scc1 LwX1_2
s_branch LwX1_3
LwrX1:
s_mov_b64 vcc, 0
ex 26
pa 120,160,180
s_waitcnt lgkmcnt(0)
v_cmp_gt_u32 vcc, 18, v255
v_accvgpr_read_b32 v135, a30
pa 152,168,180
ex 27
pa 156,168,188
s_cbranch_vccnz LsX18
LrX18:
lk 196,0,0
global_load_lds_dwordx4 v12, s[96:97] offset:0 nt
pa 124,160,188
lk 200,1,0
cv 195,26,27
pa 124,164,192
lk 204,2,0
v_mov_b32 v255, 19
pa 92,156,192
lk 208,3,0
v_fma_f32 v132, v132, v126, v130
pa 92,152,188
ex 28
pb 116,144,188
ex 29
pb 116,148,192
ex 30
pb 84,140,192
ex 31
pb 84,136,188
lv 180,4,49152
cv 202,28,29
pv 168,172,168
s_waitcnt lgkmcnt(3)
lv 182,4,53248
cv 203,30,31
qb 16,196,212,36
lv 184,172,49152
v_fma_f32 v133, v133, v126, v130
qb 16,200,216,16
s_waitcnt lgkmcnt(3)
global_load_lds_dwordx4 v13, s[96:97] offset:1024 nt
lv 186,172,53248
qb 16,204,220,16
ex 32
qb 16,208,224,16
ex 33
qb 20,208,240,40
ex 34
qb 20,204,236,20
ex 35
qb 20,200,232,20
lv 188,5,49152
cv 210,32,33
qb 20,196,228,20
lv 190,5,53248
cv 211,34,35
qb 24,196,244,44
lv 192,173,49152
v_fma_f32 v134, v134, v126, v130
qb 24,200,248,24
lv 194,173,53248
v_fma_f32 v135, v135, v126, v130
qb 24,204,252,24
ex 16
pw 24,208,216
ex 17
qa 28,208,232,48
ex 18
pw 28,204,228
ex 19
pw 28,200,224
cv 136,16,17
cv 137,18,19
pw 28,196,220
ex 20
qa 32,196,236,52
global_load_lds_dwordx4 v12, s[96:97] offset:2048 nt
lk 196,0,4096
pw 32,200,240
lk 200,1,4096
v_xor_b32 v0, 0x2000, v0
pw 32,204,244
lk 204,2,4096
v_xor_b32 v1, 0x2000, v1
pw 32,208,248
s_waitcnt lgkmcnt(3)
lk 208,3,4096
v_xor_b32 v2, 0x2000, v2
pb 56,176,180
ex 21
pb 56,180,184
ex 22
pb 88,188,184
ex 23
pb 88,184,180
cv 144,20,21
cv 145,22,23
pa 64,192,180
ex 24
pa 64,196,184
ex 25
pa 96,204,184
ex 26
pa 96,200,180
lv 184,174,49152
cv 152,24,25
pa 128,208,180
ex 27
pa 132,208,188
lv 180,6,49152
cv 153,26,27
pa 100,200,188
ex 28
pa 100,204,192
global_load_lds_dwordx4 v13, s[96:97] offset:3072 nt
lv 182,6,53248
pa 68,196,192
s_add_u32 m0, s21, 131072
ex 29
pa 68,192,188
s_add_u32 s96, s96, 16384
s_addc_u32 s97, s97, 0
lv 186,174,53248
pb 92,184,188
ex 30
pb 92,188,192
cv 160,28,29
v_xor_b32 v3, 0x2000, v3
pb 60,180,192
ex 31
pb 60,176,188
lv 188,7,49152
cv 161,30,31
v_smfmac_f32_16x16x64_bf16 a[160:163], a[172:175], v[176:183], v14
s_waitcnt lgkmcnt(3)
lv 190,7,53248
qb 16,196,212,36
ex 32
qb 16,200,216,16
ex 33
qb 16,204,220,16
lv 192,175,49152
cv 168,32,33
qb 16,208,224,16
ex 34
qb 20,208,240,40
lv 194,175,53248
cv 132,132,133
qb 20,204,236,20
ex 35
qb 20,200,232,20
cv 169,34,35
cv 133,134,135
qb 20,196,228,20
global_load_lds_dwordx4 v12, s[98:99] offset:0 nt
v_accvgpr_read_b32 v134, a27
qb 24,196,244,44
ex 16
qb 24,200,248,24
ex 17
qb 24,204,252,24
ex 18
pw 24,208,216
ds_write_b64 v120, v[132:133] offset:256
qa 28,208,232,48
ex 19
pw 28,204,228
cv 138,16,17
cv 139,18,19
pw 28,200,224
ex 20
pw 28,196,220
v_accvgpr_read_b32 v132, a19
v_accvgpr_read_b32 v133, a23
qa 32,196,236,52
lk 196,0,0
v_accvgpr_read_b32 v135, a31
pw 32,200,240
lk 200,1,0
v_fma_f32 v132, v132, v127, v131
pw 32,204,244
lk 204,2,0
v_fma_f32 v133, v133, v127, v131
pw 32,208,248
s_waitcnt lgkmcnt(3)
lk 208,3,0
v_fma_f32 v134, v134, v127, v131
pb 64,176,180
ex 21
pb 64,180,184
ex 22
pb 96,188,184
global_load_lds_dwordx4 v13, s[98:99] offset:1024 nt
cv 146,20,21
pb 96,184,180
ex 23
pa 72,192,180
cv 147,22,23
v_fma_f32 v135, v135, v127, v131
pa 72,196,184
ex 24
pa 104,204,184
ex 25
pa 104,200,180
ex 26
pa 136,208,180
ex 27
pa 140,208,188
lv 180,8,49152
cv 154,24,25
pa 108,200,188
lv 182,8,53248
cv 155,26,27
pa 108,204,192
lv 184,212,49152
cv 132,132,133
pa 76,196,192
lv 186,212,53248
cv 133,134,135
pa 76,192,188
ex 28
pb 100,184,188
ex 29
pb 100,188,192
ex 30
pb 68,180,192
ex 31
pb 68,176,188
global_load_lds_dwordx4 v12, s[98:99] offset:2048 nt
cv 162,28,29
v_smfmac_f32_16x16x64_bf16 a[160:163], a[176:179], v[184:191], v14
s_waitcnt lgkmcnt(2)
lv 188,9,49152
qb 16,196,212,36
lv 190,9,53248
cv 163,30,31
qb 16,200,216,16
lv 192,213,49152
qb 16,204,220,16
lv 194,213,53248
qb 16,208,224,16
ex 32
qb 20,208,240,40
ex 33
qb 20,204,236,20
ex 34
qb 20,200,232,20
ex 35
qb 20,196,228,20
ex 16
qb 24,196,244,44
ds_write_b64 v120, v[132:133] offset:384
qb 24,200,248,24
ex 17
qb 24,204,252,24
ds_read_b64_tr_b16 v[132:133], v121 offset:0
cv 140,16,17
pw 24,208,216
ex 18
qa 28,208,232,48
lk 208,3,4096
cv 170,32,33
pw 28,204,228
global_load_lds_dwordx4 v13, s[98:99] offset:3072 nt
lk 204,2,4096
pw 28,200,224
s_add_u32 m0, s21, 32768
lk 200,1,4096
cv 171,34,35
pw 28,196,220
s_add_u32 s98, s98, 16384
s_addc_u32 s99, s99, 0
lk 196,0,4096
pb 72,176,180
s_waitcnt lgkmcnt(5)
ex 19
pb 72,180,184
ds_read_b64_tr_b16 v[134:135], v121 offset:32
cv 141,18,19
pb 104,188,184
ex 20
pb 104,184,180
ex 21
pa 80,192,180
ex 22
pa 80,196,184
ds_read_b128 v[124:127], v123 offset:128
cv 148,20,21
pa 112,204,184
ex 23
pa 112,200,180
lv 184,214,49152
cv 149,22,23
pa 144,208,180
lv 180,10,49152
pa 148,208,188
lv 182,10,53248
pa 116,200,188
lv 186,214,53248
pa 116,204,192
ex 24
pa 84,196,192
ex 25
pa 84,192,188
ex 26
pb 108,184,188
s_waitcnt lgkmcnt(4)
buffer_store_dwordx4 v[132:135], v122, s[16:19], s39 offen offset:128 sc0 sc1
cv 156,24,25
ds_read_b128 v[128:131], v123 offset:192
pb 108,188,192
ex 27
pb 76,180,192
lv 192,215,49152
cv 157,26,27
pb 76,176,188
lv 188,11,49152
v_smfmac_f32_16x16x64_bf16 a[164:167], a[172:175], v[192:199], v14
lv 190,11,53248
v_smfmac_f32_16x16x64_bf16 a[164:167], a[176:179], v[200:207], v14
lv 194,215,53248
qb 16,196,212,36
s_waitcnt vmcnt(19)
ds_write_b32 v254, v255 offset:0
qb 16,200,216,16
ex 28
qb 16,204,220,16
ex 29
qb 16,208,224,16
ex 30
qb 20,208,240,40
ex 31
qb 20,204,236,20
ds_read_b64_tr_b16 v[132:133], v121 offset:1024
cv 164,28,29
qb 20,200,232,20
ds_read_b64_tr_b16 v[134:135], v121 offset:1056
cv 165,30,31
qb 20,196,228,20
ex 16
qb 24,196,244,44
qb 24,200,248,24
ex 17
qb 24,204,252,24
cv 142,16,17
pw 24,208,216
ex 18
qa 28,208,232,48
pw 28,204,228
ex 19
pw 28,200,224
s_waitcnt lgkmcnt(0)
buffer_store_dwordx4 v[132:135], v122, s[16:19], s39 offen offset:2176 sc0 sc1
cv 143,18,19
pw 28,196,220
ex 20
pb 80,176,180
ds_read_b32 v255, v12 offset:1024
v_accvgpr_read_b32 v132, a32
pb 80,180,184
ex 21
pb 112,188,184
cv 150,20,21
v_accvgpr_read_b32 v133, a36
pb 112,184,180
v_accvgpr_read_b32 v134, a40
v_accvgpr_read_b32 v135, a44
pa 88,192,180
ex 22
pa 88,196,184
v_fma_f32 v132, v132, v124, v128
v_fma_f32 v133, v133, v124, v128
pa 120,204,184
ex 23
pa 120,200,180
s_waitcnt lgkmcnt(0)
v_cmp_gt_u32 vcc, 19, v255
cv 151,22,23
pa 152,208,180
ex 24
pa 156,208,188
s_cbranch_vccnz LsX19
LrX19:
lk 196,0,16384
global_load_lds_dwordx4 v12, s[96:97] offset:0 nt
pa 124,200,188
lk 200,1,16384
v_mov_b32 v255, 20
pa 124,204,192
lk 204,2,16384
v_fma_f32 v134, v134, v124, v128
pa 92,196,192
lk 208,3,16384
v_fma_f32 v135, v135, v124, v128
pa 92,192,188
ex 25
pb 116,184,188
ex 26
pb 116,188,192
ex 27
pb 84,180,192
lv 180,4,0
cv 158,24,25
pb 84,176,188
lv 182,4,4096
cv 159,26,27
pv 168,172,208
s_waitcnt lgkmcnt(4)
lv 184,172,0
cv 132,132,133
qb 16,196,212,36
lv 186,172,4096
cv 133,134,135
qb 16,200,216,16
s_waitcnt lgkmcnt(4)
ex 28
qb 16,204,220,16
ex 29
qb 16,208,224,16
ex 30
qb 20,208,240,40
ex 31
qb 20,204,236,20
global_load_lds_dwordx4 v13, s[96:97] offset:1024 nt
cv 166,28,29
qb 20,200,232,20
lv 188,5,0
cv 167,30,31
qb 20,196,228,20
lv 190,5,4096
v_accvgpr_read_b32 v134, a41
qb 24,196,244,44

LwX1_0:
s_cbranch_vccnz LwX1_4
lv 192,173,0
v_accvgpr_read_b32 v135, a45
qb 24,200,248,24
lv 194,173,4096
v_fma_f32 v134, v134, v125, v129
qb 24,204,252,24
ex 16
pw 24,208,216
ex 17
qa 28,208,232,48
lk 208,3,20480
cv 180,16,17
pw 28,204,228
lk 204,2,20480
v_xor_b32 v2, 0x2000, v2
pw 28,200,224
lk 200,1,20480
v_xor_b32 v1, 0x2000, v1
pw 28,196,220
s_waitcnt lgkmcnt(5)
lk 196,0,20480
v_xor_b32 v0, 0x2000, v0
pb 56,136,180
global_load_lds_dwordx4 v12, s[96:97] offset:2048 nt
v_xor_b32 v3, 0x2000, v3
pb 56,140,184
ex 18
pb 88,148,184
ex 19
pb 88,144,180
ds_write_b64 v120, v[132:133] offset:0
pa 64,152,180
cv 181,18,19
v_accvgpr_read_b32 v132, a33
pa 64,156,184
ex 20
pa 96,164,184
ex 21
pa 96,160,180
ex 22
pa 128,168,180
ex 23
pa 132,168,188
lv 180,6,0
cv 188,20,21
pa 100,160,188
s_waitcnt lgkmcnt(2)
lv 182,6,4096
cv 189,22,23
pa 100,164,192
ex 24
pa 68,156,192
ex 25
pa 68,152,188
ex 26
pb 92,144,188
lv 184,174,0
cv 196,24,25
pb 92,148,192
global_load_lds_dwordx4 v13, s[96:97] offset:3072 nt
lv 186,174,4096
pb 60,140,192
s_add_u32 m0, s21, 147456
ex 27
pb 60,136,188
s_add_u32 s96, s96, 16384
s_addc_u32 s97, s97, 0
lv 188,7,0
v_smfmac_f32_16x16x64_bf16 a[160:163], a[172:175], v[136:143], v14
lv 190,7,4096
qb 16,196,212,36
lv 192,175,0
cv 197,26,27
qb 16,200,216,16
ex 28
qb 16,204,220,16
ex 29
qb 16,208,224,16
ex 30
qb 20,208,240,40
ex 31
qb 20,204,236,20
lv 194,175,4096
cv 204,28,29
qb 20,200,232,20
cv 205,30,31
v_accvgpr_read_b32 v133, a37
qb 20,196,228,20
ex 16
qb 24,196,244,44
v_fma_f32 v132, v132, v125, v129
v_fma_f32 v133, v133, v125, v129
qb 24,200,248,24
ex 17
qb 24,204,252,24
cv 182,16,17
v_fma_f32 v135, v135, v125, v129
pw 24,208,216
global_load_lds_dwordx4 v12, s[98:99] offset:0 nt
cv 132,132,133
qa 28,208,232,48
lk 208,3,16384
cv 133,134,135
pw 28,204,228
lk 204,2,16384
v_accvgpr_read_b32 v134, a42
pw 28,200,224
lk 200,1,16384
v_accvgpr_read_b32 v135, a46
pw 28,196,220
s_waitcnt lgkmcnt(3)
lk 196,0,16384
v_fma_f32 v134, v134, v126, v130
pb 64,136,180
ex 18
pb 64,140,184
ex 19
pb 96,148,184
ds_write_b64 v120, v[132:133] offset:128
pb 96,144,180
cv 183,18,19
v_accvgpr_read_b32 v132, a34
pa 72,152,180
ex 20
pa 72,156,184
ex 21
pa 104,164,184
ex 22
pa 104,160,180
ex 23
pa 136,168,180
lv 180,8,0
cv 190,20,21
pa 140,168,188
lv 182,8,4096
cv 191,22,23
pa 108,160,188
global_load_lds_dwordx4 v13, s[98:99] offset:1024 nt
lv 184,212,0
pa 108,164,192
ex 24
pa 76,156,192
ex 25
pa 76,152,188
ex 26
pb 100,144,188
lv 186,212,4096
cv 198,24,25
pb 100,148,192
ex 27
pb 68,140,192
lv 192,213,0
cv 199,26,27
pb 68,136,188
ex 28
v_smfmac_f32_16x16x64_bf16 a[160:163], a[176:179], v[144:151], v14
s_waitcnt lgkmcnt(2)
lv 188,9,0
qb 16,196,212,36
ex 29
qb 16,200,216,16
lv 190,9,4096
cv 206,28,29
qb 16,204,220,16
ex 30
qb 16,208,224,16
lv 194,213,4096
v_accvgpr_read_b32 v133, a38
qb 20,208,240,40
ex 31
qb 20,204,236,20
cv 207,30,31
v_fma_f32 v132, v132, v126, v130
qb 20,200,232,20
global_load_lds_dwordx4 v12, s[98:99] offset:2048 nt
v_fma_f32 v133, v133, v126, v130
qb 20,196,228,20
ex 16
qb 24,196,244,44
ex 17
qb 24,200,248,24
cv 176,16,17
v_fma_f32 v135, v135, v126, v130
qb 24,204,252,24
ex 18
pw 24,208,216
cv 132,132,133
cv 133,134,135
qa 28,208,232,48
ex 19
pw 28,204,228
ds_write_b64 v120, v[132:133] offset:256
pw 28,200,224
cv 177,18,19
v_accvgpr_read_b32 v132, a35
pw 28,196,220
ex 20
qa 32,196,236,52
lk 196,0,20480
v_accvgpr_read_b32 v133, a39
pw 32,200,240
lk 200,1,20480
v_accvgpr_read_b32 v134, a43
pw 32,204,244
lk 204,2,20480
v_accvgpr_read_b32 v135, a47
pw 32,208,248
lk 208,3,20480
v_fma_f32 v132, v132, v127, v131
pb 72,136,180
s_waitcnt lgkmcnt(5)
ex 21
pb 72,140,184
global_load_lds_dwordx4 v13, s[98:99] offset:3072 nt
cv 184,20,21
pb 104,148,184
s_add_u32 m0, s21, 49152
ex 22
pb 104,144,180
s_add_u32 s98, s98, 16384
s_addc_u32 s99, s99, 0
v_fma_f32 v133, v133, v127, v131
pa 80,152,180
ex 23
pa 80,156,184
cv 185,22,23
v_fma_f32 v134, v134, v127, v131
pa 112,164,184
ex 24
pa 112,160,180
ex 25
pa 144,168,180
ex 26
pa 148,168,188
ex 27
pa 116,160,188
lv 180,10,0
cv 192,24,25
pa 116,164,192
lv 182,10,4096
cv 193,26,27
pa 84,156,192
lv 184,214,0
v_fma_f32 v135, v135, v127, v131
pa 84,152,188
lv 186,214,4096
cv 132,132,133
pb 108,144,188
ex 28
pb 108,148,192
ex 29
pb 76,140,192
lv 192,215,0
cv 200,28,29
pb 76,136,188
lv 188,11,0
cv 133,134,135
v_smfmac_f32_16x16x64_bf16 a[164:167], a[172:175], v[152:159], v14
lv 190,11,4096
v_smfmac_f32_16x16x64_bf16 a[164:167], a[176:179], v[160:167], v14
s_waitcnt lgkmcnt(5)
lv 194,215,4096
qb 16,196,212,36
s_waitcnt vmcnt(18)
ds_write_b32 v254, v255 offset:0
qb 16,200,216,16
ex 30
qb 16,204,220,16
ex 31
qb 16,208,224,16
ds_write_b64 v120, v[132:133] offset:384
qb 20,208,240,40
ds_read_b64_tr_b16 v[132:133], v121 offset:0
cv 201,30,31
qb 20,204,236,20
ex 32
qb 20,200,232,20
ex 33
qb 20,196,228,20
ex 34
qb 24,196,244,44
ex 35
qb 24,200,248,24
ds_read_b64_tr_b16 v[134:135], v121 offset:32
cv 208,32,33
qb 24,204,252,24
cv 209,34,35
pw 24,208,216
ex 16
qa 28,208,232,48
ex 17
pw 28,204,228
ex 18
pw 28,200,224
ex 19
pw 28,196,220
cv 178,16,17
cv 179,18,19
qa 32,196,236,52
ex 20
pw 32,200,240
ex 21
pw 32,204,244
ex 22
pw 32,208,248
s_waitcnt lgkmcnt(0)
buffer_store_dwordx4 v[132:135], v122, s[16:19], s36 offen offset:0 sc0 sc1
cv 186,20,21
pb 80,136,180
ds_read_b32 v255, v12 offset:1024
pb 80,140,184
ex 23
pb 112,148,184
ds_read_b64_tr_b16 v[132:133], v121 offset:1024
cv 187,22,23
pb 112,144,180
ex 24
pa 88,152,180
ex 25
pa 88,156,184
ds_read_b64_tr_b16 v[134:135], v121 offset:1056
cv 194,24,25
pa 120,164,184
ex 26
pa 120,160,180
s_waitcnt lgkmcnt(2)
v_cmp_gt_u32 vcc, 20, v255
pa 152,168,180
ex 27
pa 156,168,188
s_cbranch_vccnz LsX20
LrX20:
lk 196,0,32768
global_load_lds_dwordx4 v12, s[96:97] offset:0 nt
pa 124,160,188
lk 200,1,32768
cv 195,26,27
pa 124,164,192
lk 204,2,32768
v_mov_b32 v255, 21
pa 92,156,192
lk 208,3,32768
pa 92,152,188
ex 28
pb 116,144,188
ex 29
pb 116,148,192
ex 30
pb 84,140,192
ex 31
pb 84,136,188
lv 180,4,16384
cv 202,28,29
pv 168,172,168
s_waitcnt lgkmcnt(3)
lv 182,4,20480
cv 203,30,31
qb 16,196,212,36
lv 184,172,16384
qb 16,200,216,16
s_waitcnt lgkmcnt(3)
global_load_lds_dwordx4 v13, s[96:97] offset:1024 nt
lv 186,172,20480
qb 16,204,220,16
ex 32
qb 16,208,224,16
ex 33
qb 20,208,240,40
ex 34
qb 20,204,236,20
ex 35
qb 20,200,232,20
lv 188,5,16384
cv 210,32,33
qb 20,196,228,20
lv 190,5,20480
cv 211,34,35
qb 24,196,244,44
lv 192,173,16384
qb 24,200,248,24
lv 194,173,20480
qb 24,204,252,24
ex 16
pw 24,208,216
ex 17
qa 28,208,232,48
ex 18
pw 28,204,228
ex 19
pw 28,200,224
buffer_store_dwordx4 v[132:135], v122, s[16:19], s36 offen offset:2048 sc0 sc1
cv 136,16,17
cv 137,18,19
ex 20
pw 28,196,220
s_add_u32 s36, s26, 12288
v_accvgpr_read_b32 v132, a48
v_accvgpr_read_b32 v133, a52
qa 32,196,236,52
s_add_u32 s36, s36, s3
lk 196,0,36864
v_xor_b32 v0, 0x2000, v0
pw 32,200,240
lk 200,1,36864
global_load_lds_dwordx4 v12, s[96:97] offset:2048 nt
pw 32,204,244
lk 204,2,36864
v_xor_b32 v1, 0x2000, v1
pw 32,208,248
s_waitcnt lgkmcnt(3)
lk 208,3,36864
v_xor_b32 v2, 0x2000, v2
pb 56,176,180
ex 21
pb 56,180,184
ex 22
pb 88,188,184
ex 23
pb 88,184,180
cv 144,20,21
cv 145,22,23
pa 64,192,180
ex 24
pa 64,196,184
ex 25
pa 96,204,184
ex 26
pa 96,200,180
lv 184,174,16384
cv 152,24,25
pa 128,208,180
ex 27
pa 132,208,188
lv 180,6,16384
cv 153,26,27
pa 100,200,188
ex 28
pa 100,204,192
global_load_lds_dwordx4 v13, s[96:97] offset:3072 nt
lv 182,6,20480
pa 68,196,192
s_add_u32 m0, s21, 98304
ex 29
pa 68,192,188
s_add_u32 s96, s96, 16384
s_addc_u32 s97, s97, 0
lv 186,174,20480
pb 92,184,188
ex 30
pb 92,188,192
cv 160,28,29
v_xor_b32 v3, 0x2000, v3
pb 60,180,192
ex 31
pb 60,176,188
lv 188,7,16384
cv 161,30,31
v_smfmac_f32_16x16x64_bf16 a[160:163], a[172:175], v[176:183], v14
s_waitcnt lgkmcnt(3)
lv 190,7,20480
qb 16,196,212,36
ex 32
qb 16,200,216,16
ex 33
qb 16,204,220,16
lv 192,175,16384
cv 168,32,33
qb 16,208,224,16
ex 34
qb 20,208,240,40
lv 194,175,20480
v_accvgpr_read_b32 v134, a56
qb 20,204,236,20
ex 35
qb 20,200,232,20
cv 169,34,35
v_accvgpr_read_b32 v135, a60
qb 20,196,228,20
global_load_lds_dwordx4 v12, s[98:99] offset:0 nt
v_fma_f32 v132, v132, v124, v128
qb 24,196,244,44
ex 16
qb 24,200,248,24
ex 17
qb 24,204,252,24
ex 18
pw 24,208,216
cv 138,16,17
v_fma_f32 v133, v133, v124, v128
qa 28,208,232,48
ex 19
pw 28,204,228
cv 139,18,19
v_fma_f32 v134, v134, v124, v128
pw 28,200,224
ex 20
pw 28,196,220
v_fma_f32 v135, v135, v124, v128
cv 132,132,133
qa 32,196,236,52
lk 196,0,32768
cv 133,134,135
pw 32,200,240
lk 200,1,32768
v_accvgpr_read_b32 v134, a57
pw 32,204,244
lk 204,2,32768
v_accvgpr_read_b32 v135, a61
pw 32,208,248
s_waitcnt lgkmcnt(3)
lk 208,3,32768
v_fma_f32 v134, v134, v125, v129
pb 64,176,180
ex 21
pb 64,180,184
ex 22
pb 96,188,184
global_load_lds_dwordx4 v13, s[98:99] offset:1024 nt
cv 146,20,21
pb 96,184,180
ex 23
pa 72,192,180
ds_write_b64 v120, v[132:133] offset:0
pa 72,196,184
cv 147,22,23
v_accvgpr_read_b32 v132, a49
pa 104,204,184
ex 24
pa 104,200,180
ex 25
pa 136,208,180
ex 26
pa 140,208,188
ex 27
pa 108,200,188
lv 180,8,16384
cv 154,24,25
pa 108,204,192
lv 182,8,20480
cv 155,26,27
pa 76,196,192
lv 184,212,16384
v_accvgpr_read_b32 v133, a53
pa 76,192,188
lv 186,212,20480
v_fma_f32 v132, v132, v125, v129
pb 100,184,188
ex 28
pb 100,188,192
ex 29
pb 68,180,192
ex 30
pb 68,176,188
global_load_lds_dwordx4 v12, s[98:99] offset:2048 nt
cv 162,28,29
v_smfmac_f32_16x16x64_bf16 a[160:163], a[176:179], v[184:191], v14
s_waitcnt lgkmcnt(3)
lv 188,9,16384
qb 16,196,212,36
ex 31
qb 16,200,216,16
lv 190,9,20480
cv 163,30,31
qb 16,204,220,16
lv 192,213,16384
v_fma_f32 v133, v133, v125, v129
qb 16,208,224,16
lv 194,213,20480
v_fma_f32 v135, v135, v125, v129
qb 20,208,240,40
ex 32
qb 20,204,236,20
ex 33
qb 20,200,232,20
ex 34
qb 20,196,228,20
ex 16
qb 24,196,244,44
ex 35
qb 24,200,248,24

LwX1_1:
s_cbranch_vccnz LwX1_5
ex 17
qb 24,204,252,24
cv 140,16,17
cv 170,32,33
pw 24,208,216
ex 18
qa 28,208,232,48
lk 208,3,36864
cv 171,34,35
pw 28,204,228
s_waitcnt lgkmcnt(1)
global_load_lds_dwordx4 v13, s[98:99] offset:3072 nt
lk 204,2,36864
pw 28,200,224
s_add_u32 m0, s21, 65536
lk 200,1,36864
cv 132,132,133
pw 28,196,220
s_add_u32 s98, s98, 16384
s_addc_u32 s99, s99, 0
lk 196,0,36864
pb 72,176,180
ex 19
pb 72,180,184
cv 141,18,19
cv 133,134,135
pb 104,188,184
ex 20
pb 104,184,180
ex 21
pa 80,192,180
ex 22
pa 80,196,184
ds_write_b64 v120, v[132:133] offset:128
pa 112,204,184
ex 23
pa 112,200,180
lv 184,214,16384
cv 148,20,21
pa 144,208,180
lv 180,10,16384
cv 149,22,23
pa 148,208,188
lv 182,10,20480
v_accvgpr_read_b32 v132, a50
pa 116,200,188
lv 186,214,20480
v_accvgpr_read_b32 v133, a54
pa 116,204,192
ex 24
pa 84,196,192
ex 25
pa 84,192,188
ex 26
pb 108,184,188
cv 156,24,25
v_accvgpr_read_b32 v134, a58
pb 108,188,192
ex 27
pb 76,180,192
lv 192,215,16384
cv 157,26,27
pb 76,176,188
lv 188,11,16384
v_accvgpr_read_b32 v135, a62
v_smfmac_f32_16x16x64_bf16 a[164:167], a[172:175], v[192:199], v14
lv 190,11,20480
v_smfmac_f32_16x16x64_bf16 a[164:167], a[176:179], v[200:207], v14
s_waitcnt lgkmcnt(3)
lv 194,215,20480
qb 16,196,212,36
s_waitcnt vmcnt(20)
ds_write_b32 v254, v255 offset:0
qb 16,200,216,16
ex 28
qb 16,204,220,16
ex 29
qb 16,208,224,16
ex 30
qb 20,208,240,40
ex 31
qb 20,204,236,20
cv 164,28,29
cv 165,30,31
qb 20,200,232,20
v_fma_f32 v132, v132, v126, v130
v_fma_f32 v133, v133, v126, v130
qb 20,196,228,20
ex 16
qb 24,196,244,44
v_fma_f32 v134, v134, v126, v130
v_fma_f32 v135, v135, v126, v130
qb 24,200,248,24
ex 17
qb 24,204,252,24
cv 142,16,17
cv 132,132,133
pw 24,208,216
ex 18
qa 28,208,232,48
cv 133,134,135
v_accvgpr_read_b32 v134, a59
pw 28,204,228
ex 19
pw 28,200,224
ds_write_b64 v120, v[132:133] offset:256
pw 28,196,220
cv 143,18,19
v_accvgpr_read_b32 v132, a51
pb 80,176,180
ds_read_b32 v255, v12 offset:1024
v_accvgpr_read_b32 v133, a55
pb 80,180,184
ex 20
pb 112,188,184
ex 21
pb 112,184,180
cv 150,20,21
v_accvgpr_read_b32 v135, a63
pa 88,192,180
ex 22
pa 88,196,184
v_fma_f32 v132, v132, v127, v131
v_fma_f32 v133, v133, v127, v131
pa 120,204,184
ex 23
pa 120,200,180
s_waitcnt lgkmcnt(0)
v_cmp_gt_u32 vcc, 21, v255
cv 151,22,23
pa 152,208,180
ex 24
pa 156,208,188
s_cbranch_vccnz LsX21
LrX21:
lk 196,0,49152
global_load_lds_dwordx4 v12, s[96:97] offset:0 nt
pa 124,200,188
lk 200,1,49152
v_mov_b32 v255, 22
pa 124,204,192
lk 204,2,49152
v_fma_f32 v134, v134, v127, v131
pa 92,196,192
lk 208,3,49152
v_fma_f32 v135, v135, v127, v131
pa 92,192,188
ex 25
pb 116,184,188
ex 26
pb 116,188,192
ex 27
pb 84,180,192
lv 180,4,32768
cv 158,24,25
pb 84,176,188
lv 182,4,36864
cv 159,26,27
pv 168,172,208
s_waitcnt lgkmcnt(4)
lv 184,172,32768
cv 132,132,133
qb 16,196,212,36
lv 186,172,36864
cv 133,134,135
qb 16,200,216,16
s_waitcnt lgkmcnt(4)
ex 28
qb 16,204,220,16
ex 29
qb 16,208,224,16
ex 30
qb 20,208,240,40
ex 31
qb 20,204,236,20
global_load_lds_dwordx4 v13, s[96:97] offset:1024 nt
cv 166,28,29
qb 20,200,232,20
lv 188,5,32768
cv 167,30,31
qb 20,196,228,20
lv 190,5,36864
qb 24,196,244,44
lv 192,173,32768
qb 24,200,248,24
lv 194,173,36864
qb 24,204,252,24
ex 16
pw 24,208,216
ex 17
qa 28,208,232,48
lk 208,3,53248
cv 180,16,17
pw 28,204,228
lk 204,2,53248
v_xor_b32 v2, 0x2000, v2
pw 28,200,224
lk 200,1,53248
v_xor_b32 v1, 0x2000, v1
pw 28,196,220
s_waitcnt lgkmcnt(5)
lk 196,0,53248
v_xor_b32 v0, 0x2000, v0
pb 56,136,180
global_load_lds_dwordx4 v12, s[96:97] offset:2048 nt
v_xor_b32 v3, 0x2000, v3
pb 56,140,184
ex 18
pb 88,148,184
ex 19
pb 88,144,180
ds_write_b64 v120, v[132:133] offset:384
pa 64,152,180
ds_read_b64_tr_b16 v[132:133], v121 offset:0
cv 181,18,19
pa 64,156,184
ex 20
pa 96,164,184
ex 21
pa 96,160,180
ex 22
pa 128,168,180
ex 23
pa 132,168,188
lv 180,6,32768
cv 188,20,21
pa 100,160,188
s_waitcnt lgkmcnt(3)
lv 182,6,36864
cv 189,22,23
pa 100,164,192
ex 24
pa 68,156,192
ex 25
pa 68,152,188
ex 26
pb 92,144,188
lv 184,174,32768
cv 196,24,25
pb 92,148,192
global_load_lds_dwordx4 v13, s[96:97] offset:3072 nt
lv 186,174,36864
pb 60,140,192
s_add_u32 m0, s21, 114688
ex 27
pb 60,136,188
s_add_u32 s96, s96, 16384
s_addc_u32 s97, s97, 0
lv 188,7,32768
v_smfmac_f32_16x16x64_bf16 a[160:163], a[172:175], v[136:143], v14
lv 190,7,36864
qb 16,196,212,36
lv 192,175,32768
cv 197,26,27
qb 16,200,216,16
ex 28
qb 16,204,220,16
ex 29
qb 16,208,224,16
ex 30
qb 20,208,240,40
ex 31
qb 20,204,236,20
lv 194,175,36864
cv 204,28,29
qb 20,200,232,20
ds_read_b64_tr_b16 v[134:135], v121 offset:32
cv 205,30,31
qb 20,196,228,20
ex 16
qb 24,196,244,44
qb 24,200,248,24
ex 17
qb 24,204,252,24
cv 182,16,17
pw 24,208,216
global_load_lds_dwordx4 v12, s[98:99] offset:0 nt
qa 28,208,232,48
lk 208,3,49152
pw 28,204,228
lk 204,2,49152
pw 28,200,224
lk 200,1,49152
pw 28,196,220
s_waitcnt lgkmcnt(3)
lk 196,0,49152
pb 64,136,180
ex 18
pb 64,140,184
ex 19
pb 96,148,184
buffer_store_dwordx4 v[132:135], v122, s[16:19], s37 offen offset:128 sc0 sc1
cv 183,18,19
ex 20
pb 96,144,180
ex 21
pa 72,152,180
ex 22
pa 72,156,184
ds_read_b64_tr_b16 v[132:133], v121 offset:1024
cv 190,20,21
pa 104,164,184
ex 23
pa 104,160,180
lv 184,212,32768
cv 191,22,23
pa 136,168,180
ex 24
pa 140,168,188
lv 180,8,32768
pa 108,160,188
global_load_lds_dwordx4 v13, s[98:99] offset:1024 nt
lv 182,8,36864
pa 108,164,192
ex 25
pa 76,156,192
ex 26
pa 76,152,188
lv 186,212,36864
cv 198,24,25
pb 100,144,188
ds_read_b64_tr_b16 v[134:135], v121 offset:1056
pb 100,148,192
ex 27
pb 68,140,192
lv 192,213,32768
cv 199,26,27
pb 68,136,188
ex 28
v_smfmac_f32_16x16x64_bf16 a[160:163], a[176:179], v[144:151], v14
s_waitcnt lgkmcnt(3)
lv 188,9,32768
qb 16,196,212,36
ex 29
qb 16,200,216,16
lv 190,9,36864
cv 206,28,29
qb 16,204,220,16
ex 30
qb 16,208,224,16
lv 194,213,36864
qb 20,208,240,40
ex 31
qb 20,204,236,20
s_waitcnt lgkmcnt(3)
buffer_store_dwordx4 v[132:135], v122, s[16:19], s37 offen offset:2176 sc0 sc1
cv 207,30,31
s_add_u32 s37, s26, 12288
s_add_u32 s37, s37, s2
qb 20,200,232,20
qb 20,196,228,20
ex 16
qb 24,196,244,44
ex 17
qb 24,200,248,24
global_load_lds_dwordx4 v12, s[98:99] offset:2048 nt
cv 176,16,17
qb 24,204,252,24
ex 18
pw 24,208,216
qa 28,208,232,48
ex 19
pw 28,204,228
cv 177,18,19
pw 28,200,224
ex 20
pw 28,196,220
qa 32,196,236,52
lk 196,0,53248
pw 32,200,240
lk 200,1,53248
pw 32,204,244
lk 204,2,53248
pw 32,208,248
lk 208,3,53248
pb 72,136,180
ex 21
pb 72,140,184
global_load_lds_dwordx4 v13, s[98:99] offset:3072 nt
cv 184,20,21
pb 104,148,184
s_add_u32 m0, s21, 81920
ex 22
pb 104,144,180
s_add_u32 s98, s98, 16384
s_addc_u32 s99, s99, 0
pa 80,152,180
ex 23
pa 80,156,184
cv 185,22,23
pa 112,164,184
ex 24
pa 112,160,180
ex 25
pa 144,168,180
s_waitcnt lgkmcnt(0)
ex 26
pa 148,168,188
ex 27
pa 116,160,188
lv 180,10,32768
cv 192,24,25
pa 116,164,192
lv 182,10,36864
cv 193,26,27
pa 84,156,192
lv 184,214,32768
pa 84,152,188
lv 186,214,36864
pb 108,144,188
ex 28
pb 108,148,192
ex 29
pb 76,140,192
lv 192,215,32768
cv 200,28,29
pb 76,136,188
lv 188,11,32768
v_smfmac_f32_16x16x64_bf16 a[164:167], a[172:175], v[152:159], v14
lv 190,11,36864
v_smfmac_f32_16x16x64_bf16 a[164:167], a[176:179], v[160:167], v14
lv 194,215,36864
qb 16,196,212,36
s_waitcnt vmcnt(20)
ds_write_b32 v254, v255 offset:0
qb 16,200,216,16
ex 30
qb 16,204,220,16
ex 31
qb 16,208,224,16
cv 201,30,31
qb 20,208,240,40
ex 32
qb 20,204,236,20
ex 33
qb 20,200,232,20
ex 34
qb 20,196,228,20
ex 35
qb 24,196,244,44
cv 208,32,33
cv 209,34,35
qb 24,200,248,24
ex 16
qb 24,204,252,24
ex 17
pw 24,208,216
ex 18
qa 28,208,232,48
ex 19
pw 28,204,228
cv 178,16,17
cv 179,18,19
pw 28,200,224
ex 20
pw 28,196,220
qa 32,196,236,52
ex 21
pw 32,200,240
cv 186,20,21
pw 32,204,244
ex 22
pw 32,208,248
s_waitcnt lgkmcnt(0)
pb 80,136,180
ds_read_b32 v255, v12 offset:1024
pb 80,140,184
ex 23
pb 112,148,184
cv 187,22,23
pb 112,144,180
ex 24
pa 88,152,180
ex 25
pa 88,156,184
cv 194,24,25
pa 120,164,184
ex 26
pa 120,160,180
s_waitcnt lgkmcnt(0)
v_cmp_gt_u32 vcc, 22, v255
pa 152,168,180
ex 27
pa 156,168,188
s_cbranch_vccnz LsX22
LrX22:
lk 196,0,0
global_load_lds_dwordx4 v12, s[96:97] offset:0 nt
pa 124,160,188
lk 200,1,0
cv 195,26,27
pa 124,164,192
lk 204,2,0
v_mov_b32 v255, 23
pa 92,156,192
lk 208,3,0
pa 92,152,188
ex 28
pb 116,144,188
ex 29
pb 116,148,192
ex 30
pb 84,140,192
ex 31
pb 84,136,188
lv 180,4,49152
cv 202,28,29
pv 168,172,168
s_waitcnt lgkmcnt(3)
lv 182,4,53248
cv 203,30,31
qb 16,196,212,36
lv 184,172,49152
qb 16,200,216,16
s_waitcnt lgkmcnt(3)
global_load_lds_dwordx4 v13, s[96:97] offset:1024 nt
lv 186,172,53248
qb 16,204,220,16
ex 32
qb 16,208,224,16
ex 33
qb 20,208,240,40
ex 34
qb 20,204,236,20
ex 35
qb 20,200,232,20
lv 188,5,49152
cv 210,32,33
qb 20,196,228,20
lv 190,5,53248
cv 211,34,35
qb 24,196,244,44
lv 192,173,49152
qb 24,200,248,24
lv 194,173,53248
qb 24,204,252,24
ex 16
pw 24,208,216
ex 17
qa 28,208,232,48
ex 18
pw 28,204,228
ex 19
pw 28,200,224
cv 136,16,17
cv 137,18,19
pw 28,196,220
ex 20
qa 32,196,236,52
global_load_lds_dwordx4 v12, s[96:97] offset:2048 nt
lk 196,0,4096
pw 32,200,240
lk 200,1,4096
v_xor_b32 v0, 0x2000, v0
pw 32,204,244
lk 204,2,4096
v_xor_b32 v1, 0x2000, v1
pw 32,208,248
s_waitcnt lgkmcnt(3)
lk 208,3,4096
v_xor_b32 v2, 0x2000, v2
pb 56,176,180
ex 21
pb 56,180,184
ex 22
pb 88,188,184
ex 23
pb 88,184,180
cv 144,20,21
cv 145,22,23
pa 64,192,180
ex 24
pa 64,196,184
ex 25
pa 96,204,184
ex 26
pa 96,200,180
lv 184,174,49152
cv 152,24,25
pa 128,208,180
ex 27
pa 132,208,188
lv 180,6,49152
cv 153,26,27
pa 100,200,188

LwX1_2:
s_cbranch_vccnz LwX1_6
ex 28
pa 100,204,192
global_load_lds_dwordx4 v13, s[96:97] offset:3072 nt
lv 182,6,53248
pa 68,196,192
s_add_u32 m0, s21, 131072
ex 29
pa 68,192,188
s_add_u32 s96, s96, 16384
s_addc_u32 s97, s97, 0
lv 186,174,53248
pb 92,184,188
ex 30
pb 92,188,192
cv 160,28,29
v_xor_b32 v3, 0x2000, v3
pb 60,180,192
ex 31
pb 60,176,188
lv 188,7,49152
cv 161,30,31
v_smfmac_f32_16x16x64_bf16 a[160:163], a[172:175], v[176:183], v14
s_waitcnt lgkmcnt(3)
lv 190,7,53248
qb 16,196,212,36
ex 32
qb 16,200,216,16
ex 33
qb 16,204,220,16
lv 192,175,49152
cv 168,32,33
qb 16,208,224,16
ex 34
qb 20,208,240,40
lv 194,175,53248
qb 20,204,236,20
ex 35
qb 20,200,232,20
cv 169,34,35
qb 20,196,228,20
global_load_lds_dwordx4 v12, s[98:99] offset:0 nt
qb 24,196,244,44
ex 16
qb 24,200,248,24
ex 17
qb 24,204,252,24
ex 18
pw 24,208,216
cv 138,16,17
qa 28,208,232,48
ex 19
pw 28,204,228
cv 139,18,19
pw 28,200,224
ex 20
pw 28,196,220
qa 32,196,236,52
lk 196,0,0
pw 32,200,240
lk 200,1,0
pw 32,204,244
lk 204,2,0
pw 32,208,248
s_waitcnt lgkmcnt(3)
lk 208,3,0
pb 64,176,180
ex 21
pb 64,180,184
ex 22
pb 96,188,184
global_load_lds_dwordx4 v13, s[98:99] offset:1024 nt
cv 146,20,21
pb 96,184,180
ex 23
pa 72,192,180
cv 147,22,23
pa 72,196,184
ex 24
pa 104,204,184
ex 25
pa 104,200,180
ex 26
pa 136,208,180
ex 27
pa 140,208,188
lv 180,8,49152
cv 154,24,25
pa 108,200,188
lv 182,8,53248
cv 155,26,27
pa 108,204,192
lv 184,212,49152
pa 76,196,192
lv 186,212,53248
pa 76,192,188
ex 28
pb 100,184,188
ex 29
pb 100,188,192
ex 30
pb 68,180,192
ex 31
pb 68,176,188
global_load_lds_dwordx4 v12, s[98:99] offset:2048 nt
cv 162,28,29
v_smfmac_f32_16x16x64_bf16 a[160:163], a[176:179], v[184:191], v14
s_waitcnt lgkmcnt(2)
lv 188,9,49152
qb 16,196,212,36
lv 190,9,53248
cv 163,30,31
qb 16,200,216,16
lv 192,213,49152
qb 16,204,220,16
lv 194,213,53248
qb 16,208,224,16
ex 32
qb 20,208,240,40
ex 33
qb 20,204,236,20
ex 34
qb 20,200,232,20
ex 35
qb 20,196,228,20
ex 16
qb 24,196,244,44
cv 170,32,33
cv 171,34,35
qb 24,200,248,24
ex 17
qb 24,204,252,24
cv 140,16,17
pw 24,208,216
ex 18
qa 28,208,232,48
lk 208,3,4096
pw 28,204,228
global_load_lds_dwordx4 v13, s[98:99] offset:3072 nt
lk 204,2,4096
pw 28,200,224
s_add_u32 m0, s21, 32768
lk 200,1,4096
pw 28,196,220
s_add_u32 s98, s98, 16384
s_addc_u32 s99, s99, 0
lk 196,0,4096
pb 72,176,180
s_waitcnt lgkmcnt(4)
ex 19
pb 72,180,184
cv 141,18,19
pb 104,188,184
ex 20
pb 104,184,180
ex 21
pa 80,192,180
ex 22
pa 80,196,184
cv 148,20,21
pa 112,204,184
ex 23
pa 112,200,180
lv 184,214,49152
cv 149,22,23
pa 144,208,180
lv 180,10,49152
pa 148,208,188
lv 182,10,53248
pa 116,200,188
lv 186,214,53248
pa 116,204,192
ex 24
pa 84,196,192
ex 25
pa 84,192,188
ex 26
pb 108,184,188
cv 156,24,25
pb 108,188,192
ex 27
pb 76,180,192
lv 192,215,49152
cv 157,26,27
pb 76,176,188
lv 188,11,49152
v_smfmac_f32_16x16x64_bf16 a[164:167], a[172:175], v[192:199], v14
lv 190,11,53248
v_smfmac_f32_16x16x64_bf16 a[164:167], a[176:179], v[200:207], v14
s_waitcnt lgkmcnt(3)
lv 194,215,53248
qb 16,196,212,36
s_waitcnt vmcnt(18)
ds_write_b32 v254, v255 offset:0
qb 16,200,216,16
ex 28
qb 16,204,220,16
ex 29
qb 16,208,224,16
ex 30
qb 20,208,240,40
ex 31
qb 20,204,236,20
cv 164,28,29
cv 165,30,31
qb 20,200,232,20
qb 20,196,228,20
ex 16
qb 24,196,244,44
qb 24,200,248,24
ex 17
qb 24,204,252,24
cv 142,16,17
pw 24,208,216
ex 18
qa 28,208,232,48
pw 28,204,228
ex 19
pw 28,200,224
cv 143,18,19
pw 28,196,220
ex 20
pb 80,176,180
ds_read_b32 v255, v12 offset:1024
pb 80,180,184
ex 21
pb 112,188,184
cv 150,20,21
pb 112,184,180
pa 88,192,180
ex 22
pa 88,196,184
pa 120,204,184
ex 23
pa 120,200,180
s_waitcnt lgkmcnt(0)
v_cmp_gt_u32 vcc, 23, v255
cv 151,22,23
pa 152,208,180
ex 24
pa 156,208,188
s_cbranch_vccnz LsX23
LrX23:
lk 196,0,16384
global_load_lds_dwordx4 v12, s[96:97] offset:0 nt
pa 124,200,188
lk 200,1,16384
v_mov_b32 v255, 24
pa 124,204,192
lk 204,2,16384
pa 92,196,192
lk 208,3,16384
pa 92,192,188
ex 25
pb 116,184,188
ex 26
pb 116,188,192
ex 27
pb 84,180,192
lv 180,4,0
cv 158,24,25
pb 84,176,188
lv 182,4,4096
cv 159,26,27
pv 168,172,208
s_waitcnt lgkmcnt(4)
lv 184,172,0
qb 16,196,212,36
lv 186,172,4096
qb 16,200,216,16
s_waitcnt lgkmcnt(4)
ex 28
qb 16,204,220,16
ex 29
qb 16,208,224,16
ex 30
qb 20,208,240,40
ex 31
qb 20,204,236,20
global_load_lds_dwordx4 v13, s[96:97] offset:1024 nt
cv 166,28,29
qb 20,200,232,20
lv 188,5,0
cv 167,30,31
qb 20,196,228,20
lv 190,5,4096
qb 24,196,244,44
lv 192,173,0
qb 24,200,248,24
lv 194,173,4096
qb 24,204,252,24
ex 16
pw 24,208,216
ex 17
qa 28,208,232,48
lk 208,3,20480
cv 180,16,17
pw 28,204,228
lk 204,2,20480
v_xor_b32 v2, 0x2000, v2
pw 28,200,224
lk 200,1,20480
v_xor_b32 v1, 0x2000, v1
pw 28,196,220
s_waitcnt lgkmcnt(5)
lk 196,0,20480
v_xor_b32 v0, 0x2000, v0
pb 56,136,180
global_load_lds_dwordx4 v12, s[96:97] offset:2048 nt
v_xor_b32 v3, 0x2000, v3
pb 56,140,184
ex 18
pb 88,148,184
ex 19
pb 88,144,180
cv 181,18,19
pa 64,152,180
ex 20
pa 64,156,184
ex 21
pa 96,164,184
ex 22
pa 96,160,180
ex 23
pa 128,168,180
lv 180,6,0
cv 188,20,21
pa 132,168,188
lv 182,6,4096
cv 189,22,23
pa 100,160,188
s_waitcnt lgkmcnt(2)
ex 24
pa 100,164,192
ex 25
pa 68,156,192
ex 26
pa 68,152,188
lv 184,174,0
cv 196,24,25
pb 92,144,188
lv 186,174,4096
pb 92,148,192
global_load_lds_dwordx4 v13, s[96:97] offset:3072 nt
s_add_u32 m0, s21, 147456
pb 60,140,192
s_add_u32 s96, s96, 16384
s_addc_u32 s97, s97, 0
lv 192,175,0
pb 60,136,188
ex 27
v_smfmac_f32_16x16x64_bf16 a[160:163], a[172:175], v[136:143], v14
lv 188,7,0
qb 16,196,212,36
lv 190,7,4096
cv 197,26,27
qb 16,200,216,16
ex 28
qb 16,204,220,16
ex 29
qb 16,208,224,16
ex 30
qb 20,208,240,40
ex 31
qb 20,204,236,20
lv 194,175,4096
cv 204,28,29
qb 20,200,232,20
cv 205,30,31
qb 20,196,228,20
ex 16
qb 24,196,244,44
qb 24,200,248,24
ex 17
qb 24,204,252,24
cv 182,16,17
pw 24,208,216
global_load_lds_dwordx4 v12, s[98:99] offset:0 nt
qa 28,208,232,48
lk 208,3,16384
pw 28,204,228
lk 204,2,16384
pw 28,200,224
lk 200,1,16384
pw 28,196,220
s_waitcnt lgkmcnt(3)
lk 196,0,16384
pb 64,136,180
ex 18
pb 64,140,184
ex 19
pb 96,148,184
cv 183,18,19
pb 96,144,180
ex 20
pa 72,152,180
ex 21
pa 72,156,184
ex 22
pa 104,164,184
ex 23
pa 104,160,180
lv 184,212,0
cv 190,20,21
pa 136,168,180
lv 180,8,0
cv 191,22,23
pa 140,168,188
ex 24
pa 108,160,188
global_load_lds_dwordx4 v13, s[98:99] offset:1024 nt
lv 182,8,4096
pa 108,164,192
ex 25
pa 76,156,192
ex 26
pa 76,152,188
lv 186,212,4096
cv 198,24,25
pb 100,144,188
pb 100,148,192
ex 27
pb 68,140,192
lv 192,213,0
cv 199,26,27
pb 68,136,188
ex 28
v_smfmac_f32_16x16x64_bf16 a[160:163], a[176:179], v[144:151], v14
s_waitcnt lgkmcnt(2)
lv 188,9,0
qb 16,196,212,36
ex 29
qb 16,200,216,16
lv 190,9,4096
cv 206,28,29
qb 16,204,220,16
ex 30
qb 16,208,224,16
lv 194,213,4096
qb 20,208,240,40
ex 31
qb 20,204,236,20
cv 207,30,31
s_nop 0
qb 20,200,232,20
global_load_lds_dwordx4 v12, s[98:99] offset:2048 nt
qb 20,196,228,20
ex 16
qb 24,196,244,44
ex 17
qb 24,200,248,24
cv 176,16,17
qb 24,204,252,24
ex 18
pw 24,208,216
qa 28,208,232,48
ex 19
pw 28,204,228
cv 177,18,19
pw 28,200,224
ex 20
pw 28,196,220
qa 32,196,236,52
lk 196,0,20480
pw 32,200,240
lk 200,1,20480
pw 32,204,244
lk 204,2,20480
pw 32,208,248
lk 208,3,20480
pb 72,136,180
s_waitcnt lgkmcnt(4)
ex 21
pb 72,140,184
global_load_lds_dwordx4 v13, s[98:99] offset:3072 nt
cv 184,20,21
pb 104,148,184
s_add_u32 m0, s21, 49152
ex 22
pb 104,144,180
s_add_u32 s98, s98, 16384
s_addc_u32 s99, s99, 0
pa 80,152,180
ex 23
pa 80,156,184
cv 185,22,23
pa 112,164,184
ex 24
pa 112,160,180
ex 25
pa 144,168,180
ex 26
pa 148,168,188
ex 27
pa 116,160,188
lv 180,10,0
cv 192,24,25
pa 116,164,192
lv 182,10,4096
cv 193,26,27
pa 84,156,192
lv 184,214,0
pa 84,152,188
lv 186,214,4096
pb 108,144,188
ex 28
pb 108,148,192
ex 29
pb 76,140,192
lv 192,215,0
cv 200,28,29
pb 76,136,188
lv 188,11,0
v_smfmac_f32_16x16x64_bf16 a[164:167], a[172:175], v[152:159], v14
lv 190,11,4096
v_smfmac_f32_16x16x64_bf16 a[164:167], a[176:179], v[160:167], v14
s_waitcnt lgkmcnt(5)
lv 194,215,4096
qb 16,196,212,36
s_waitcnt vmcnt(16)
ds_write_b32 v254, v255 offset:0
qb 16,200,216,16
ex 30
qb 16,204,220,16
ex 31
qb 16,208,224,16
cv 201,30,31
qb 20,208,240,40
ex 32
qb 20,204,236,20
ex 33
qb 20,200,232,20
ex 34
qb 20,196,228,20
ex 35
qb 24,196,244,44
cv 208,32,33
cv 209,34,35
qb 24,200,248,24
ex 16
qb 24,204,252,24
ex 17
pw 24,208,216
ex 18
qa 28,208,232,48
ex 19
pw 28,204,228
cv 178,16,17
cv 179,18,19
pw 28,200,224
ex 20
pw 28,196,220
qa 32,196,236,52
ex 21
pw 32,200,240
cv 186,20,21
pw 32,204,244
ex 22
pw 32,208,248
pb 80,136,180
s_waitcnt lgkmcnt(0)
ds_read_b32 v255, v12 offset:1024
pb 80,140,184
ex 23
pb 112,148,184
cv 187,22,23
pb 112,144,180
ex 24
pa 88,152,180
ex 25
pa 88,156,184
cv 194,24,25
pa 120,164,184
ex 26
pa 120,160,180
s_waitcnt lgkmcnt(0)
v_cmp_gt_u32 vcc, 24, v255
pa 152,168,180
ex 27
pa 156,168,188
s_cbranch_vccnz LsX24
LrX24:
lk 196,0,32768
global_load_lds_dwordx4 v12, s[96:97] offset:0 nt
pa 124,160,188
lk 200,1,32768
cv 195,26,27
pa 124,164,192
lk 204,2,32768
v_mov_b32 v255, 25
pa 92,156,192

LwX1_3:
s_cbranch_vccnz LwX1_7
lk 208,3,32768
pa 92,152,188
ex 28
pb 116,144,188
ex 29
pb 116,148,192
ex 30
pb 84,140,192
ex 31
pb 84,136,188
lv 180,4,16384
cv 202,28,29
pv 168,172,168
s_waitcnt lgkmcnt(3)
lv 182,4,20480
cv 203,30,31
qb 16,196,212,36
lv 184,172,16384
qb 16,200,216,16
s_waitcnt lgkmcnt(3)
global_load_lds_dwordx4 v13, s[96:97] offset:1024 nt
lv 186,172,20480
qb 16,204,220,16
ex 32
qb 16,208,224,16
ex 33
qb 20,208,240,40
ex 34
qb 20,204,236,20
ex 35
qb 20,200,232,20
lv 188,5,16384
cv 210,32,33
qb 20,196,228,20
lv 190,5,20480
cv 211,34,35
qb 24,196,244,44
lv 192,173,16384
qb 24,200,248,24
lv 194,173,20480
qb 24,204,252,24
ex 16
pw 24,208,216
ex 17
qa 28,208,232,48
ex 18
pw 28,204,228
ex 19
pw 28,200,224
cv 136,16,17
cv 137,18,19
pw 28,196,220
ex 20
qa 32,196,236,52
global_load_lds_dwordx4 v12, s[96:97] offset:2048 nt
lk 196,0,36864
pw 32,200,240
lk 200,1,36864
v_xor_b32 v0, 0x2000, v0
pw 32,204,244
lk 204,2,36864
v_xor_b32 v1, 0x2000, v1
pw 32,208,248
s_waitcnt lgkmcnt(3)
lk 208,3,36864
v_xor_b32 v2, 0x2000, v2
pb 56,176,180
ex 21
pb 56,180,184
ex 22
pb 88,188,184
ex 23
pb 88,184,180
cv 144,20,21
cv 145,22,23
pa 64,192,180
ex 24
pa 64,196,184
ex 25
pa 96,204,184
ex 26
pa 96,200,180
lv 184,174,16384
cv 152,24,25
pa 128,208,180
ex 27
pa 132,208,188
lv 180,6,16384
cv 153,26,27
pa 100,200,188
ex 28
pa 100,204,192
global_load_lds_dwordx4 v13, s[96:97] offset:3072 nt
lv 182,6,20480
pa 68,196,192
s_add_u32 m0, s21, 98304
ex 29
pa 68,192,188
s_add_u32 s96, s96, 16384
s_addc_u32 s97, s97, 0
lv 186,174,20480
pb 92,184,188
ex 30
pb 92,188,192
cv 160,28,29
v_xor_b32 v3, 0x2000, v3
pb 60,180,192
ex 31
pb 60,176,188
lv 188,7,16384
cv 161,30,31
v_smfmac_f32_16x16x64_bf16 a[160:163], a[172:175], v[176:183], v14
s_waitcnt lgkmcnt(3)
lv 190,7,20480
qb 16,196,212,36
ex 32
qb 16,200,216,16
ex 33
qb 16,204,220,16
lv 192,175,16384
cv 168,32,33
qb 16,208,224,16
ex 34
qb 20,208,240,40
lv 194,175,20480
qb 20,204,236,20
ex 35
qb 20,200,232,20
cv 169,34,35
qb 20,196,228,20
global_load_lds_dwordx4 v12, s[98:99] offset:0 nt
qb 24,196,244,44
ex 16
qb 24,200,248,24
ex 17
qb 24,204,252,24
ex 18
pw 24,208,216
cv 138,16,17
qa 28,208,232,48
ex 19
pw 28,204,228
cv 139,18,19
pw 28,200,224
ex 20
pw 28,196,220
qa 32,196,236,52
lk 196,0,32768
pw 32,200,240
lk 200,1,32768
pw 32,204,244
lk 204,2,32768
pw 32,208,248
s_waitcnt lgkmcnt(3)
lk 208,3,32768
pb 64,176,180
ex 21
pb 64,180,184
ex 22
pb 96,188,184
global_load_lds_dwordx4 v13, s[98:99] offset:1024 nt
cv 146,20,21
pb 96,184,180
ex 23
pa 72,192,180
cv 147,22,23
pa 72,196,184
ex 24
pa 104,204,184
ex 25
pa 104,200,180
ex 26
pa 136,208,180
ex 27
pa 140,208,188
lv 180,8,16384
cv 154,24,25
pa 108,200,188
lv 182,8,20480
cv 155,26,27
pa 108,204,192
lv 184,212,16384
pa 76,196,192
lv 186,212,20480
pa 76,192,188
ex 28
pb 100,184,188
ex 29
pb 100,188,192
ex 30
pb 68,180,192
ex 31
pb 68,176,188
global_load_lds_dwordx4 v12, s[98:99] offset:2048 nt
cv 162,28,29
v_smfmac_f32_16x16x64_bf16 a[160:163], a[176:179], v[184:191], v14
s_waitcnt lgkmcnt(2)
lv 188,9,16384
qb 16,196,212,36
lv 190,9,20480
cv 163,30,31
qb 16,200,216,16
lv 192,213,16384
qb 16,204,220,16
lv 194,213,20480
qb 16,208,224,16
ex 32
qb 20,208,240,40
ex 33
qb 20,204,236,20
ex 34
qb 20,200,232,20
ex 35
qb 20,196,228,20
ex 16
qb 24,196,244,44
cv 170,32,33
cv 171,34,35
qb 24,200,248,24
ex 17
qb 24,204,252,24
cv 140,16,17
pw 24,208,216
ex 18
qa 28,208,232,48
lk 208,3,36864
pw 28,204,228
global_load_lds_dwordx4 v13, s[98:99] offset:3072 nt
lk 204,2,36864
pw 28,200,224
s_add_u32 m0, s21, 65536
lk 200,1,36864
pw 28,196,220
s_add_u32 s98, s98, 16384
s_addc_u32 s99, s99, 0
lk 196,0,36864
pb 72,176,180
s_waitcnt lgkmcnt(4)
ex 19
pb 72,180,184
cv 141,18,19
pb 104,188,184
ex 20
pb 104,184,180
ex 21
pa 80,192,180
ex 22
pa 80,196,184
cv 148,20,21
pa 112,204,184
ex 23
pa 112,200,180
lv 184,214,16384
cv 149,22,23
pa 144,208,180
lv 180,10,16384
pa 148,208,188
lv 182,10,20480
pa 116,200,188
lv 186,214,20480
pa 116,204,192
ex 24
pa 84,196,192
ex 25
pa 84,192,188
ex 26
pb 108,184,188
cv 156,24,25
pb 108,188,192
ex 27
pb 76,180,192
lv 192,215,16384
cv 157,26,27
pb 76,176,188
lv 188,11,16384
v_smfmac_f32_16x16x64_bf16 a[164:167], a[172:175], v[192:199], v14
lv 190,11,20480
v_smfmac_f32_16x16x64_bf16 a[164:167], a[176:179], v[200:207], v14
s_waitcnt lgkmcnt(3)
lv 194,215,20480
qb 16,196,212,36
s_waitcnt vmcnt(16)
ds_write_b32 v254, v255 offset:0
qb 16,200,216,16
ex 28
qb 16,204,220,16
ex 29
qb 16,208,224,16
ex 30
qb 20,208,240,40
ex 31
qb 20,204,236,20
cv 164,28,29
cv 165,30,31
qb 20,200,232,20
qb 20,196,228,20
ex 16
qb 24,196,244,44
qb 24,200,248,24
ex 17
qb 24,204,252,24
cv 142,16,17
pw 24,208,216
ex 18
qa 28,208,232,48
pw 28,204,228
ex 19
pw 28,200,224
cv 143,18,19
pw 28,196,220
ex 20
pb 80,176,180
ds_read_b32 v255, v12 offset:1024
pb 80,180,184
ex 21
pb 112,188,184
cv 150,20,21
pb 112,184,180
pa 88,192,180
ex 22
pa 88,196,184
pa 120,204,184
ex 23
pa 120,200,180
s_waitcnt lgkmcnt(0)
v_cmp_gt_u32 vcc, 25, v255
cv 151,22,23
pa 152,208,180
ex 24
pa 156,208,188
s_cbranch_vccnz LsX25
LrX25:
lk 196,0,49152
global_load_lds_dwordx4 v12, s[96:97] offset:0 nt
pa 124,200,188
lk 200,1,49152
v_mov_b32 v255, 26
pa 124,204,192
lk 204,2,49152
pa 92,196,192
lk 208,3,49152
pa 92,192,188
ex 25
pb 116,184,188
ex 26
pb 116,188,192
ex 27
pb 84,180,192
lv 180,4,32768
cv 158,24,25
pb 84,176,188
lv 182,4,36864
cv 159,26,27
pv 168,172,208
s_waitcnt lgkmcnt(4)
lv 184,172,32768
qb 16,196,212,36
lv 186,172,36864
qb 16,200,216,16
s_waitcnt lgkmcnt(4)
ex 28
qb 16,204,220,16
ex 29
qb 16,208,224,16
ex 30
qb 20,208,240,40
ex 31
qb 20,204,236,20
global_load_lds_dwordx4 v13, s[96:97] offset:1024 nt
cv 166,28,29
qb 20,200,232,20
lv 188,5,32768
cv 167,30,31
qb 20,196,228,20
lv 190,5,36864
qb 24,196,244,44
lv 192,173,32768
qb 24,200,248,24
lv 194,173,36864
qb 24,204,252,24
ex 16
pw 24,208,216
ex 17
qa 28,208,232,48
lk 208,3,53248
cv 180,16,17
pw 28,204,228
lk 204,2,53248
v_xor_b32 v2, 0x2000, v2
pw 28,200,224
lk 200,1,53248
v_xor_b32 v1, 0x2000, v1
pw 28,196,220
s_waitcnt lgkmcnt(5)
lk 196,0,53248
v_xor_b32 v0, 0x2000, v0
pb 56,136,180
global_load_lds_dwordx4 v12, s[96:97] offset:2048 nt
v_xor_b32 v3, 0x2000, v3
pb 56,140,184
ex 18
pb 88,148,184
ex 19
pb 88,144,180
cv 181,18,19
pa 64,152,180
ex 20
pa 64,156,184
ex 21
pa 96,164,184
ex 22
pa 96,160,180
ex 23
pa 128,168,180
lv 180,6,32768
cv 188,20,21
pa 132,168,188
lv 182,6,36864
cv 189,22,23
pa 100,160,188
s_waitcnt lgkmcnt(2)
ex 24
pa 100,164,192
ex 25
pa 68,156,192
ex 26
pa 68,152,188
lv 184,174,32768
cv 196,24,25
pb 92,144,188
lv 186,174,36864
pb 92,148,192
global_load_lds_dwordx4 v13, s[96:97] offset:3072 nt
s_add_u32 m0, s21, 114688
pb 60,140,192
s_add_u32 s96, s96, 16384
s_addc_u32 s97, s97, 0
lv 192,175,32768
pb 60,136,188
ex 27
v_smfmac_f32_16x16x64_bf16 a[160:163], a[172:175], v[136:143], v14
lv 188,7,32768
qb 16,196,212,36
lv 190,7,36864
cv 197,26,27
qb 16,200,216,16
ex 28
qb 16,204,220,16
ex 29
qb 16,208,224,16
ex 30
qb 20,208,240,40
ex 31
qb 20,204,236,20
lv 194,175,36864
cv 204,28,29
qb 20,200,232,20
cv 205,30,31
qb 20,196,228,20
ex 16
qb 24,196,244,44
qb 24,200,248,24
ex 17
qb 24,204,252,24
cv 182,16,17
pw 24,208,216
global_load_lds_dwordx4 v12, s[98:99] offset:0 nt
qa 28,208,232,48
lk 208,3,49152
pw 28,204,228
lk 204,2,49152
pw 28,200,224
lk 200,1,49152
pw 28,196,220
s_waitcnt lgkmcnt(3)
lk 196,0,49152
pb 64,136,180
ex 18
pb 64,140,184
ex 19
pb 96,148,184
cv 183,18,19
pb 96,144,180
ex 20
pa 72,152,180
ex 21
pa 72,156,184
ex 22
pa 104,164,184
ex 23
pa 104,160,180
lv 184,212,32768
cv 190,20,21
pa 136,168,180
lv 180,8,32768
cv 191,22,23
pa 140,168,188
ex 24
pa 108,160,188
global_load_lds_dwordx4 v13, s[98:99] offset:1024 nt
lv 182,8,36864
pa 108,164,192
ex 25
pa 76,156,192
ex 26
pa 76,152,188
lv 186,212,36864
cv 198,24,25
pb 100,144,188
pb 100,148,192
ex 27
pb 68,140,192
lv 192,213,32768
cv 199,26,27
pb 68,136,188
ex 28
v_smfmac_f32_16x16x64_bf16 a[160:163], a[176:179], v[144:151], v14
s_waitcnt lgkmcnt(2)
lv 188,9,32768
qb 16,196,212,36
ex 29
qb 16,200,216,16
lv 190,9,36864
cv 206,28,29
qb 16,204,220,16
ex 30
qb 16,208,224,16
lv 194,213,36864
qb 20,208,240,40
ex 31
qb 20,204,236,20
cv 207,30,31
s_nop 0
qb 20,200,232,20
global_load_lds_dwordx4 v12, s[98:99] offset:2048 nt
qb 20,196,228,20
ex 16
qb 24,196,244,44
ex 17
qb 24,200,248,24
cv 176,16,17
qb 24,204,252,24
ex 18
pw 24,208,216
qa 28,208,232,48
ex 19
pw 28,204,228
cv 177,18,19
pw 28,200,224
ex 20
pw 28,196,220
qa 32,196,236,52
lk 196,0,53248
pw 32,200,240
lk 200,1,53248
pw 32,204,244
lk 204,2,53248
pw 32,208,248
lk 208,3,53248
pb 72,136,180
s_waitcnt lgkmcnt(4)
ex 21
pb 72,140,184
global_load_lds_dwordx4 v13, s[98:99] offset:3072 nt
cv 184,20,21
pb 104,148,184
s_add_u32 m0, s21, 81920
ex 22
pb 104,144,180
s_add_u32 s98, s98, 16384
s_addc_u32 s99, s99, 0
pa 80,152,180
ex 23
pa 80,156,184
cv 185,22,23
pa 112,164,184
ex 24
pa 112,160,180
ex 25
pa 144,168,180
ex 26
pa 148,168,188
ex 27
pa 116,160,188
lv 180,10,32768
cv 192,24,25
pa 116,164,192

LwX1_4:
s_cbranch_vccnz LwrX1
lv 182,10,36864
cv 193,26,27
pa 84,156,192
lv 184,214,32768
pa 84,152,188
lv 186,214,36864
pb 108,144,188
ex 28
pb 108,148,192
ex 29
pb 76,140,192
lv 192,215,32768
cv 200,28,29
pb 76,136,188
lv 188,11,32768
v_smfmac_f32_16x16x64_bf16 a[164:167], a[172:175], v[152:159], v14
lv 190,11,36864
v_smfmac_f32_16x16x64_bf16 a[164:167], a[176:179], v[160:167], v14
s_waitcnt lgkmcnt(5)
lv 194,215,36864
qb 16,196,212,36
s_waitcnt vmcnt(16)
ds_write_b32 v254, v255 offset:0
qb 16,200,216,16
ex 30
qb 16,204,220,16
ex 31
qb 16,208,224,16
cv 201,30,31
qb 20,208,240,40
ex 32
qb 20,204,236,20
ex 33
qb 20,200,232,20
ex 34
qb 20,196,228,20
ex 35
qb 24,196,244,44
cv 208,32,33
cv 209,34,35
qb 24,200,248,24
ex 16
qb 24,204,252,24
ex 17
pw 24,208,216
ex 18
qa 28,208,232,48
ex 19
pw 28,204,228
cv 178,16,17
cv 179,18,19
pw 28,200,224
ex 20
pw 28,196,220
qa 32,196,236,52
ex 21
pw 32,200,240
cv 186,20,21
pw 32,204,244
ex 22
pw 32,208,248
pb 80,136,180
s_waitcnt lgkmcnt(0)
ds_read_b32 v255, v12 offset:1024
pb 80,140,184
ex 23
pb 112,148,184
cv 187,22,23
pb 112,144,180
ex 24
pa 88,152,180
ex 25
pa 88,156,184
cv 194,24,25
pa 120,164,184
ex 26
pa 120,160,180
s_waitcnt lgkmcnt(0)
v_cmp_gt_u32 vcc, 26, v255
pa 152,168,180
ex 27
pa 156,168,188
s_cbranch_vccnz LsX26
LrX26:
lk 196,0,0
global_load_lds_dwordx4 v12, s[96:97] offset:0 nt
pa 124,160,188
lk 200,1,0
cv 195,26,27
pa 124,164,192
lk 204,2,0
v_mov_b32 v255, 27
pa 92,156,192
lk 208,3,0
pa 92,152,188
ex 28
pb 116,144,188
ex 29
pb 116,148,192
ex 30
pb 84,140,192
ex 31
pb 84,136,188
lv 180,4,49152
cv 202,28,29
pv 168,172,168
s_waitcnt lgkmcnt(3)
lv 182,4,53248
cv 203,30,31
qb 16,196,212,36
lv 184,172,49152
qb 16,200,216,16
s_waitcnt lgkmcnt(3)
global_load_lds_dwordx4 v13, s[96:97] offset:1024 nt
lv 186,172,53248
qb 16,204,220,16
ex 32
qb 16,208,224,16
ex 33
qb 20,208,240,40
ex 34
qb 20,204,236,20
ex 35
qb 20,200,232,20
lv 188,5,49152
cv 210,32,33
qb 20,196,228,20
lv 190,5,53248
cv 211,34,35
qb 24,196,244,44
lv 192,173,49152
qb 24,200,248,24
lv 194,173,53248
qb 24,204,252,24
ex 16
pw 24,208,216
ex 17
qa 28,208,232,48
ex 18
pw 28,204,228
ex 19
pw 28,200,224
cv 136,16,17
cv 137,18,19
pw 28,196,220
ex 20
qa 32,196,236,52
global_load_lds_dwordx4 v12, s[96:97] offset:2048 nt
lk 196,0,4096
pw 32,200,240
lk 200,1,4096
v_xor_b32 v0, 0x2000, v0
pw 32,204,244
lk 204,2,4096
v_xor_b32 v1, 0x2000, v1
pw 32,208,248
s_waitcnt lgkmcnt(3)
lk 208,3,4096
v_xor_b32 v2, 0x2000, v2
pb 56,176,180
ex 21
pb 56,180,184
ex 22
pb 88,188,184
ex 23
pb 88,184,180
cv 144,20,21
cv 145,22,23
pa 64,192,180
ex 24
pa 64,196,184
ex 25
pa 96,204,184
ex 26
pa 96,200,180
lv 184,174,49152
cv 152,24,25
pa 128,208,180
ex 27
pa 132,208,188
lv 180,6,49152
cv 153,26,27
pa 100,200,188
ex 28
pa 100,204,192
global_load_lds_dwordx4 v13, s[96:97] offset:3072 nt
lv 182,6,53248
pa 68,196,192
s_add_u32 m0, s21, 131072
ex 29
pa 68,192,188
lv 186,174,53248
cv 160,28,29
pb 92,184,188
ex 30
pb 92,188,192
v_xor_b32 v3, 0x2000, v3
pb 60,180,192
ex 31
pb 60,176,188
lv 188,7,49152
cv 161,30,31
v_smfmac_f32_16x16x64_bf16 a[160:163], a[172:175], v[176:183], v14
s_waitcnt lgkmcnt(3)
lv 190,7,53248
qb 16,196,212,36
ex 32
qb 16,200,216,16
ex 33
qb 16,204,220,16
lv 192,175,49152
cv 168,32,33
qb 16,208,224,16
ex 34
qb 20,208,240,40
lv 194,175,53248
qb 20,204,236,20
ex 35
qb 20,200,232,20
cv 169,34,35
qb 20,196,228,20
global_load_lds_dwordx4 v12, s[98:99] offset:0 nt
qb 24,196,244,44
ex 16
qb 24,200,248,24
ex 17
qb 24,204,252,24
ex 18
pw 24,208,216
cv 138,16,17
qa 28,208,232,48
ex 19
pw 28,204,228
cv 139,18,19
pw 28,200,224
ex 20
pw 28,196,220
qa 32,196,236,52
lk 196,0,0
pw 32,200,240
lk 200,1,0
pw 32,204,244
lk 204,2,0
pw 32,208,248
s_waitcnt lgkmcnt(3)
lk 208,3,0
pb 64,176,180
ex 21
pb 64,180,184
ex 22
pb 96,188,184
global_load_lds_dwordx4 v13, s[98:99] offset:1024 nt
cv 146,20,21
pb 96,184,180
ex 23
pa 72,192,180
cv 147,22,23
pa 72,196,184
ex 24
pa 104,204,184
ex 25
pa 104,200,180
ex 26
pa 136,208,180
ex 27
pa 140,208,188
lv 180,8,49152
cv 154,24,25
pa 108,200,188
lv 182,8,53248
cv 155,26,27
pa 108,204,192
lv 184,212,49152
pa 76,196,192
lv 186,212,53248
pa 76,192,188
ex 28
pb 100,184,188
ex 29
pb 100,188,192
ex 30
pb 68,180,192
ex 31
pb 68,176,188
global_load_lds_dwordx4 v12, s[98:99] offset:2048 nt
cv 162,28,29
v_smfmac_f32_16x16x64_bf16 a[160:163], a[176:179], v[184:191], v14
s_waitcnt lgkmcnt(2)
lv 188,9,49152
qb 16,196,212,36
lv 190,9,53248
cv 163,30,31
qb 16,200,216,16
lv 192,213,49152
qb 16,204,220,16
lv 194,213,53248
qb 16,208,224,16
ex 32
qb 20,208,240,40
ex 33
qb 20,204,236,20
ex 34
qb 20,200,232,20
ex 35
qb 20,196,228,20
ex 16
qb 24,196,244,44
cv 170,32,33
cv 171,34,35
qb 24,200,248,24
ex 17
qb 24,204,252,24
cv 140,16,17
pw 24,208,216
ex 18
qa 28,208,232,48
lk 208,3,4096
pw 28,204,228
global_load_lds_dwordx4 v13, s[98:99] offset:3072 nt
lk 204,2,4096
pw 28,200,224
s_add_u32 s98, s98, 16384
s_addc_u32 s99, s99, 0
lk 200,1,4096
pw 28,196,220
s_add_u32 m0, s21, 147456
lk 196,0,4096
pb 72,176,180
s_waitcnt lgkmcnt(4)
ex 19
pb 72,180,184
cv 141,18,19
pb 104,188,184
ex 20
pb 104,184,180
ex 21
pa 80,192,180
ex 22
pa 80,196,184
cv 148,20,21
pa 112,204,184
ex 23
pa 112,200,180
lv 184,214,49152
cv 149,22,23
pa 144,208,180
lv 180,10,49152
pa 148,208,188
lv 182,10,53248
pa 116,200,188
lv 186,214,53248
pa 116,204,192
ex 24
pa 84,196,192
ex 25
pa 84,192,188
ex 26
pb 108,184,188
cv 156,24,25
pb 108,188,192
ex 27
pb 76,180,192
lv 192,215,49152
cv 157,26,27
pb 76,176,188
lv 188,11,49152
v_smfmac_f32_16x16x64_bf16 a[164:167], a[172:175], v[192:199], v14
lv 190,11,53248
v_smfmac_f32_16x16x64_bf16 a[164:167], a[176:179], v[200:207], v14
s_waitcnt lgkmcnt(3)
lv 194,215,53248
qb 16,196,212,36
s_waitcnt vmcnt(16)
ds_write_b32 v254, v255 offset:0
qb 16,200,216,16
ex 28
qb 16,204,220,16
ex 29
qb 16,208,224,16
ex 30
qb 20,208,240,40
ex 31
qb 20,204,236,20
cv 164,28,29
cv 165,30,31
qb 20,200,232,20
qb 20,196,228,20
ex 16
qb 24,196,244,44
qb 24,200,248,24
ex 17
qb 24,204,252,24
cv 142,16,17
pw 24,208,216
ex 18
qa 28,208,232,48
pw 28,204,228
ex 19
pw 28,200,224
cv 143,18,19
pw 28,196,220
ex 20
pb 80,176,180
ds_read_b32 v255, v12 offset:1024
pb 80,180,184
ex 21
pb 112,188,184
cv 150,20,21
pb 112,184,180
pa 88,192,180
ex 22
pa 88,196,184
pa 120,204,184
ex 23
pa 120,200,180
s_waitcnt lgkmcnt(0)
v_cmp_gt_u32 vcc, 27, v255
cv 151,22,23
pa 152,208,180
ex 24
pa 156,208,188
s_cbranch_vccnz LsX27
LrX27:
lk 196,0,16384
global_load_lds_dwordx4 v12, s[98:99] offset:0 nt
pa 124,200,188
lk 200,1,16384
v_mov_b32 v255, 28
pa 124,204,192
lk 204,2,16384
pa 92,196,192
lk 208,3,16384
pa 92,192,188
ex 25
pb 116,184,188
ex 26
pb 116,188,192
ex 27
pb 84,180,192
lv 180,4,0
cv 158,24,25
pb 84,176,188
lv 182,4,4096
cv 159,26,27
pv 168,172,208
s_waitcnt lgkmcnt(3)
lv 184,172,0
qb 16,196,212,36
s_add_u32 s39, s21, 32768
lv 186,172,4096
v_mbcnt_lo_u32_b32 v126, -1, 0
qb 16,200,216,16
s_add_u32 s38, s21, 98304
ex 28
qb 16,204,220,16
s_waitcnt lgkmcnt(4)
ex 29
qb 16,208,224,16
ex 30
qb 20,208,240,40
ex 31
qb 20,204,236,20
global_load_lds_dwordx4 v13, s[98:99] offset:1024 nt
cv 166,28,29
qb 20,200,232,20
lv 188,5,0
cv 167,30,31
qb 20,196,228,20
lv 190,5,4096
v_mbcnt_hi_u32_b32 v126, -1, v126
qb 24,196,244,44
lv 192,173,0
v_and_b32 v127, 15, v126
qb 24,200,248,24
lv 194,173,4096
v_lshl_add_u32 v123, v127, 2, s39
qb 24,204,252,24
ex 16
pw 24,208,216
ex 17
qa 28,208,232,48
lk 208,3,20480
cv 180,16,17
pw 28,204,228
lk 204,2,20480
v_xor_b32 v2, 0x2000, v2
pw 28,200,224
lk 200,1,20480
v_xor_b32 v1, 0x2000, v1
pw 28,196,220
s_waitcnt lgkmcnt(5)
lk 196,0,20480
v_xor_b32 v0, 0x2000, v0
pb 56,136,180
global_load_lds_dwordx4 v12, s[98:99] offset:2048 nt
v_xor_b32 v3, 0x2000, v3
pb 56,140,184
ex 18
pb 88,148,184
ex 19
pb 88,144,180
cv 181,18,19
v_lshl_add_u32 v120, v127, 3, s38
pa 64,152,180
ex 20
pa 64,156,184
ex 21
pa 96,164,184
ex 22
pa 96,160,180
ex 23
pa 128,168,180
lv 180,6,0
cv 188,20,21
pa 132,168,188
lv 182,6,4096
cv 189,22,23
pa 100,160,188
s_waitcnt lgkmcnt(2)
ex 24
pa 100,164,192
ex 25
pa 68,156,192
ex 26
pa 68,152,188
lv 184,174,0
cv 196,24,25
pb 92,144,188
lv 186,174,4096
v_lshrrev_b32 v127, 4, v126
pb 92,148,192
global_load_lds_dwordx4 v13, s[98:99] offset:3072 nt
v_lshl_add_u32 v120, v127, 9, v120
pb 60,140,192
ex 27
pb 60,136,188
lv 188,7,0
cv 197,26,27
v_smfmac_f32_16x16x64_bf16 a[160:163], a[172:175], v[136:143], v14
lv 190,7,4096
qb 16,196,212,36
ex 28
qb 16,200,216,16
ex 29
qb 16,204,220,16
ex 30
qb 16,208,224,16
lv 192,175,0
cv 204,28,29
qb 20,208,240,40
ex 31
qb 20,204,236,20
lv 194,175,4096
cv 205,30,31
qb 20,200,232,20
v_lshl_add_u32 v124, v127, 4, s39
v_lshl_add_u32 v121, v127, 8, s38
qb 20,196,228,20
s_mov_b32 s38, s27
ex 16
qb 24,196,244,44
s_add_u32 s38, s38, s2
v_and_b32 v127, 3, v126
v_lshl_add_u32 v121, v127, 6, v121
qb 24,200,248,24
s_add_u32 s39, s26, 8192
ex 17
qb 24,204,252,24
s_add_u32 s39, s39, s3
cv 182,16,17
v_and_b32 v127, 12, v126
pw 24,208,216
ex 18
qa 28,208,232,48
lk 208,3,16384
v_lshl_add_u32 v121, v127, 1, v121
pw 28,204,228
lk 204,2,16384
v_and_b32 v127, 7, v126
pw 28,200,224
lk 200,1,16384
v_lshlrev_b32 v127, 4, v127
pw 28,196,220
s_waitcnt lgkmcnt(3)
lk 196,0,16384
v_lshrrev_b32 v126, 3, v126
pb 64,136,180
ex 19
pb 64,140,184
cv 183,18,19
v_lshl_add_u32 v122, v126, 8, v127
pb 96,148,184

LwX1_5:
s_cbranch_vccnz LwrX1
ex 20
pb 96,144,180
ex 21
pa 72,152,180
ex 22
pa 72,156,184
cv 190,20,21
pa 104,164,184
ex 23
pa 104,160,180
lv 184,212,0
cv 191,22,23
pa 136,168,180
ex 24
pa 140,168,188
lv 180,8,0
pa 108,160,188
ex 25
pa 108,164,192
lv 182,8,4096
cv 198,24,25
pa 76,156,192
ex 26
pa 76,152,188
lv 186,212,4096
pb 100,144,188
pb 100,148,192
ex 27
pb 68,140,192
lv 192,213,0
cv 199,26,27
pb 68,136,188
ex 28
v_smfmac_f32_16x16x64_bf16 a[160:163], a[176:179], v[144:151], v14
s_waitcnt lgkmcnt(3)
lv 188,9,0
qb 16,196,212,36
ex 29
qb 16,200,216,16
lv 190,9,4096
cv 206,28,29
qb 16,204,220,16
ex 30
qb 16,208,224,16
lv 194,213,4096
qb 20,208,240,40
ex 31
qb 20,204,236,20
cv 207,30,31
s_nop 0
qb 20,200,232,20
qb 20,196,228,20
ex 16
qb 24,196,244,44
ex 17
qb 24,200,248,24
cv 176,16,17
qb 24,204,252,24
ex 18
pw 24,208,216
qa 28,208,232,48
ex 19
pw 28,204,228
cv 177,18,19
pw 28,200,224
ex 20
pw 28,196,220
qa 32,196,236,52
lk 196,0,20480
pw 32,200,240
lk 200,1,20480
pw 32,204,244
lk 204,2,20480
pw 32,208,248
s_waitcnt lgkmcnt(3)
lk 208,3,20480
pb 72,136,180
ex 21
pb 72,140,184
ex 22
pb 104,148,184
ex 23
pb 104,144,180
cv 184,20,21
cv 185,22,23
pa 80,152,180
ex 24
pa 80,156,184
ex 25
pa 112,164,184
ex 26
pa 112,160,180
lv 184,214,0
cv 192,24,25
pa 144,168,180
ex 27
pa 148,168,188
lv 180,10,0
cv 193,26,27
pa 116,160,188
lv 182,10,4096
pa 116,164,192
lv 186,214,4096
pa 84,156,192
ex 28
pa 84,152,188
ex 29
pb 108,144,188
ex 30
pb 108,148,192
cv 200,28,29
pb 76,140,192
lv 192,215,0
pb 76,136,188
lv 188,11,0
v_smfmac_f32_16x16x64_bf16 a[164:167], a[172:175], v[152:159], v14
lv 190,11,4096
v_smfmac_f32_16x16x64_bf16 a[164:167], a[176:179], v[160:167], v14
s_waitcnt lgkmcnt(3)
lv 194,215,4096
qb 16,196,212,36
s_waitcnt vmcnt(12)
ds_write_b32 v254, v255 offset:0
qb 16,200,216,16
ex 31
qb 16,204,220,16
cv 201,30,31
qb 16,208,224,16
ex 32
qb 20,208,240,40
ex 33
qb 20,204,236,20
ex 34
qb 20,200,232,20
ex 35
qb 20,196,228,20
cv 208,32,33
cv 209,34,35
qb 24,196,244,44
ex 16
qb 24,200,248,24
ex 17
qb 24,204,252,24
ex 18
pw 24,208,216
cv 178,16,17
qa 28,208,232,48
ex 19
pw 28,204,228
cv 179,18,19
pw 28,200,224
ex 20
pw 28,196,220
qa 32,196,236,52
ex 21
pw 32,200,240
cv 186,20,21
pw 32,204,244
ex 22
pw 32,208,248
pb 80,136,180
ds_read_b32 v255, v12 offset:1024
pb 80,140,184
ex 23
pb 112,148,184
cv 187,22,23
pb 112,144,180
ex 24
pa 88,152,180
ex 25
pa 88,156,184
cv 194,24,25
pa 120,164,184
ex 26
pa 120,160,180
s_waitcnt lgkmcnt(0)
v_cmp_gt_u32 vcc, 28, v255
pa 152,168,180
ex 27
pa 156,168,188
s_cbranch_vccnz LsX28
LrX28:
lk 196,0,32768
cv 195,26,27
pa 124,160,188
lk 200,1,32768
v_mov_b32 v255, 29
pa 124,164,192
lk 204,2,32768
pa 92,156,192
lk 208,3,32768
pa 92,152,188
ex 28
pb 116,144,188
ex 29
pb 116,148,192
ex 30
pb 84,140,192
ex 31
pb 84,136,188
lv 180,4,16384
cv 202,28,29
pv 168,172,168
s_waitcnt lgkmcnt(3)
lv 182,4,20480
cv 203,30,31
qb 16,196,212,36
lv 184,172,16384
qb 16,200,216,16
s_waitcnt lgkmcnt(3)
lv 186,172,20480
qb 16,204,220,16
ex 32
qb 16,208,224,16
ex 33
qb 20,208,240,40
ex 34
qb 20,204,236,20
ex 35
qb 20,200,232,20
lv 188,5,16384
cv 210,32,33
qb 20,196,228,20
lv 190,5,20480
cv 211,34,35
qb 24,196,244,44
lv 192,173,16384
qb 24,200,248,24
lv 194,173,20480
qb 24,204,252,24
ex 16
pw 24,208,216
ex 17
qa 28,208,232,48
ex 18
pw 28,204,228
ex 19
pw 28,200,224
cv 136,16,17
cv 137,18,19
pw 28,196,220
ex 20
qa 32,196,236,52
lk 196,0,36864
v_xor_b32 v0, 0x2000, v0
pw 32,200,240
lk 200,1,36864
v_xor_b32 v1, 0x2000, v1
pw 32,204,244
lk 204,2,36864
v_xor_b32 v2, 0x2000, v2
pw 32,208,248
s_waitcnt lgkmcnt(3)
lk 208,3,36864
v_xor_b32 v3, 0x2000, v3
pb 56,176,180
ex 21
pb 56,180,184
ex 22
pb 88,188,184
ex 23
pb 88,184,180
cv 144,20,21
cv 145,22,23
pa 64,192,180
ex 24
pa 64,196,184
ex 25
pa 96,204,184
ex 26
pa 96,200,180
lv 184,174,16384
cv 152,24,25
pa 128,208,180
ex 27
pa 132,208,188
lv 180,6,16384
cv 153,26,27
pa 100,200,188
ex 28
pa 100,204,192
lv 182,6,20480
pa 68,196,192
ex 29
pa 68,192,188
lv 186,174,20480
cv 160,28,29
pb 92,184,188
ex 30
pb 92,188,192
pb 60,180,192
ex 31
pb 60,176,188
lv 188,7,16384
cv 161,30,31
v_smfmac_f32_16x16x64_bf16 a[160:163], a[172:175], v[176:183], v14
s_waitcnt lgkmcnt(3)
lv 190,7,20480
qb 16,196,212,36
ex 32
qb 16,200,216,16
ex 33
qb 16,204,220,16
lv 192,175,16384
cv 168,32,33
qb 16,208,224,16
ex 34
qb 20,208,240,40
lv 194,175,20480
qb 20,204,236,20
ex 35
qb 20,200,232,20
cv 169,34,35
qb 20,196,228,20
ex 16
qb 24,196,244,44
ex 17
qb 24,200,248,24
cv 138,16,17
qb 24,204,252,24
ex 18
pw 24,208,216
qa 28,208,232,48
ex 19
pw 28,204,228
cv 139,18,19
pw 28,200,224
ex 20
pw 28,196,220
qa 32,196,236,52
lk 196,0,32768
pw 32,200,240
lk 200,1,32768
pw 32,204,244
lk 204,2,32768
pw 32,208,248
s_waitcnt lgkmcnt(3)
lk 208,3,32768
pb 64,176,180
ex 21
pb 64,180,184
ex 22
pb 96,188,184
ex 23
pb 96,184,180
cv 146,20,21
cv 147,22,23
pa 72,192,180
ex 24
pa 72,196,184
ex 25
pa 104,204,184
ex 26
pa 104,200,180
lv 184,212,16384
cv 154,24,25
pa 136,208,180
ex 27
pa 140,208,188
lv 180,8,16384
cv 155,26,27
pa 108,200,188
lv 182,8,20480
pa 108,204,192
lv 186,212,20480
pa 76,196,192
ex 28
pa 76,192,188
ex 29
pb 100,184,188
ex 30
pb 100,188,192
cv 162,28,29
pb 68,180,192
ex 31
pb 68,176,188
lv 188,9,16384
cv 163,30,31
v_smfmac_f32_16x16x64_bf16 a[160:163], a[176:179], v[184:191], v14
s_waitcnt lgkmcnt(2)
lv 190,9,20480
qb 16,196,212,36
lv 192,213,16384
qb 16,200,216,16
lv 194,213,20480
qb 16,204,220,16
ex 32
qb 16,208,224,16
ex 33
qb 20,208,240,40
ex 34
qb 20,204,236,20
ex 35
qb 20,200,232,20
cv 170,32,33
cv 171,34,35
qb 20,196,228,20
ex 16
qb 24,196,244,44
qb 24,200,248,24
ex 17
qb 24,204,252,24
cv 140,16,17
pw 24,208,216
ex 18
qa 28,208,232,48
lk 208,3,36864
v_xor_b32 v3, 0x2000, v3
pw 28,204,228
lk 204,2,36864
v_xor_b32 v2, 0x2000, v2
pw 28,200,224
lk 200,1,36864
v_xor_b32 v1, 0x2000, v1
pw 28,196,220
lk 196,0,36864
v_xor_b32 v0, 0x2000, v0
pb 72,176,180
s_waitcnt lgkmcnt(4)
ex 19
pb 72,180,184
cv 141,18,19
pb 104,188,184
ex 20
pb 104,184,180
ex 21
pa 80,192,180
ex 22
pa 80,196,184
cv 148,20,21
pa 112,204,184
ex 23
pa 112,200,180
lv 184,214,16384
cv 149,22,23
pa 144,208,180
lv 180,10,16384
pa 148,208,188
lv 182,10,20480
pa 116,200,188
lv 186,214,20480
pa 116,204,192
ex 24
pa 84,196,192
ex 25
pa 84,192,188
ex 26
pb 108,184,188
cv 156,24,25
pb 108,188,192
ex 27
pb 76,180,192
lv 192,215,16384
cv 157,26,27
pb 76,176,188
lv 188,11,16384
v_smfmac_f32_16x16x64_bf16 a[164:167], a[172:175], v[192:199], v14
lv 190,11,20480
v_smfmac_f32_16x16x64_bf16 a[164:167], a[176:179], v[200:207], v14
s_waitcnt lgkmcnt(3)
lv 194,215,20480
qb 16,196,212,36
s_waitcnt vmcnt(0)
ds_write_b32 v254, v255 offset:0
qb 16,200,216,16
ex 28
qb 16,204,220,16
ex 29
qb 16,208,224,16
ex 30
qb 20,208,240,40
ex 31
qb 20,204,236,20
cv 164,28,29
cv 165,30,31
qb 20,200,232,20
qb 20,196,228,20
ex 16
qb 24,196,244,44
qb 24,200,248,24
ex 17
qb 24,204,252,24
cv 142,16,17
pw 24,208,216
ex 18
qa 28,208,232,48
pw 28,204,228
ex 19
pw 28,200,224
cv 143,18,19
pw 28,196,220
ex 20
pb 80,176,180
ds_read_b32 v255, v12 offset:1024
pb 80,180,184
ex 21
pb 112,188,184
cv 150,20,21
pb 112,184,180
pa 88,192,180
ex 22
pa 88,196,184
pa 120,204,184
ex 23
pa 120,200,180
s_waitcnt lgkmcnt(0)
v_cmp_gt_u32 vcc, 29, v255
cv 151,22,23
pa 152,208,180
ex 24
pa 156,208,188
s_cbranch_vccnz LsX29
LrX29:
lk 196,0,49152
v_mov_b32 v255, 30
pa 124,200,188
lk 200,1,49152
pa 124,204,192
lk 204,2,49152
pa 92,196,192
lk 208,3,49152
pa 92,192,188
lv 180,4,32768
pb 116,184,188
lv 182,4,36864
pb 116,188,192
lv 184,172,32768
pb 84,180,192
lv 186,172,36864
pb 84,176,188
lv 188,5,32768
pv 168,172,208
s_waitcnt lgkmcnt(7)
lv 190,5,36864
qa 16,196,236,52
ex 25
pw 16,200,240
s_waitcnt lgkmcnt(6)
ex 26
pw 16,204,244
ex 27
pw 16,208,248
s_waitcnt lgkmcnt(4)
lv 192,173,32768
cv 158,24,25
pb 56,136,180
s_waitcnt lgkmcnt(3)
lv 194,173,36864
cv 159,26,27
pb 56,140,184
ex 28
pb 88,148,184
ex 29
pb 88,144,180
ex 30
pa 64,152,180
ex 31
pa 64,156,184
ds_read_b128 v[176:179], v0 offset:53248
cv 166,28,29
cv 167,30,31
ds_read_b128 v[180:183], v1 offset:53248
ds_read_b128 v[184:187], v2 offset:53248
pa 96,164,184
ds_read_b128 v[188:191], v3 offset:53248
v_xor_b32 v3, 0x2000, v3
pa 96,160,180
lv 184,174,32768
v_xor_b32 v2, 0x2000, v2
pa 128,168,180
s_waitcnt lgkmcnt(5)
lv 180,6,32768
v_xor_b32 v1, 0x2000, v1
pa 132,168,188
lv 182,6,36864
v_xor_b32 v0, 0x2000, v0
pa 100,160,188
lv 186,174,36864
pa 100,164,192
lv 0,4,49152
pa 68,156,192
lv 2,4,53248
pa 68,152,188
lv 8,5,49152
pb 92,144,188
lv 10,5,53248
pb 92,148,192
lv 16,6,49152
pb 60,140,192

LwX1_6:
s_cbranch_vccnz LwrX1
lv 192,175,32768
pb 60,136,188
s_waitcnt lgkmcnt(7)
lv 188,7,32768
v_mfma_f32_16x16x32_bf16 v[20:23], v[176:179], v[236:239], v[52:55]
lv 190,7,36864
v_mfma_f32_16x16x32_bf16 v[20:23], v[180:183], v[240:243], v[20:23]
lv 194,175,36864
v_mfma_f32_16x16x32_bf16 v[20:23], v[184:187], v[244:247], v[20:23]
lv 18,6,53248
v_mbcnt_lo_u32_b32 v244, -1, 0
v_mfma_f32_16x16x32_bf16 v[20:23], v[188:191], v[248:251], v[20:23]
lv 24,7,49152
v_mbcnt_hi_u32_b32 v244, -1, v244
qa 24,208,232,48
lv 26,7,53248
v_mov_b32 v246, v52
pw 24,204,228
ds_read_b128 v[204:207], v3 offset:49152
v_lshlrev_b32 v244, 4, v244
pw 24,200,224
ds_read_b128 v[200:203], v2 offset:49152
v_add_u32 v244, s21, v244
pw 24,196,220
ex 16
v_mfma_f32_16x16x32_bf16 v[28:31], v[188:191], v[232:235], v[48:51]
ex 17
v_mfma_f32_16x16x32_bf16 v[28:31], v[184:187], v[228:231], v[28:31]
ex 18
v_mfma_f32_16x16x32_bf16 v[28:31], v[180:183], v[224:227], v[28:31]
ex 19
v_mfma_f32_16x16x32_bf16 v[28:31], v[176:179], v[220:223], v[28:31]
ex 20
pb 64,136,180
s_waitcnt lgkmcnt(2)
ex 21
pb 64,140,184
ex 22
pb 96,148,184
ex 23
pb 96,144,180
ds_read_b128 v[196:199], v1 offset:49152
cv 208,16,17
pa 72,152,180
ds_read_b128 v[192:195], v0 offset:49152
cv 209,18,19
pa 72,156,184
lk 60,3,53248
cv 210,20,21
pa 104,164,184
lk 56,2,53248
cv 211,22,23
pa 104,160,180
lk 52,1,53248
v_add_u32 v244, 32768, v244
pa 136,168,180
lk 48,0,53248
v_xor_b32 v251, 0x1000, v123
pa 140,168,188
lv 180,8,32768
v_xor_b32 v245, 0x1000, v244
pa 108,160,188
lv 182,8,36864
pa 108,164,192
lv 184,212,32768
pa 76,156,192
lv 186,212,36864
pa 76,152,188
lv 4,172,49152
pb 100,144,188
lv 6,172,53248
pb 100,148,192
lv 12,173,49152
pb 68,140,192
s_waitcnt lgkmcnt(7)
lv 192,213,32768
pb 68,136,188
lv 188,9,32768
pv 168,172,168
lv 190,9,36864
pv 168,172,208
lv 194,213,36864
s_nop 0
pa 128,208,0
lv 14,173,53248
s_nop 0
pa 132,208,8
ex 24
pa 136,208,16
lv 20,174,49152
v_accvgpr_read_b32 v247, a168
pa 140,208,24
ds_write2_b32 v123, v246, v247 offset0:192 offset1:208
v_mfma_f32_16x16x32_bf16 v[32:35], v[204:207], v[232:235], v[48:51]
ds_write_b128 v244, a[128:131] offset:16384
v_mfma_f32_16x16x32_bf16 v[32:35], v[200:203], v[228:231], v[32:35]
s_waitcnt lgkmcnt(5)
ds_write_b128 v244, a[132:135] offset:17408
v_mfma_f32_16x16x32_bf16 v[32:35], v[196:199], v[224:227], v[32:35]
ds_write_b128 v244, a[136:139] offset:18432
v_mfma_f32_16x16x32_bf16 v[32:35], v[192:195], v[220:223], v[32:35]
ds_write_b128 v244, a[140:143] offset:19456
qa 16,60,232,48
ds_write_b32 v254, v255 offset:0
pw 16,56,228
lv 22,174,53248
v_cmp_nge_f32 s[42:43], s29, v247
pw 16,52,224
s_or_b64 s[32:33], s[32:33], s[42:43]
ex 25
pw 16,48,220
ex 26
pb 72,136,180
ex 27
pb 72,140,184
ex 28
pb 104,148,184
ex 29
pb 104,144,180
ex 30
pa 80,152,180
ex 31
pa 80,156,184
ex 32
pa 112,164,184
ex 33
pa 112,160,180
ex 34
pa 144,168,180
ex 35
pa 148,168,188
ex 16
pa 116,160,188
s_waitcnt lgkmcnt(0)
ex 17
pa 116,164,192
ex 18
pa 84,156,192
ex 19
pa 84,152,188
lv 28,175,49152
cv 236,24,25
pb 108,144,188
lv 30,175,53248
cv 237,26,27
pb 108,148,192
lv 180,10,32768
cv 238,28,29
pb 76,140,192
lv 182,10,36864
cv 239,30,31
pb 76,136,188
lv 184,214,32768
cv 240,32,33
v_smfmac_f32_16x16x64_bf16 a[164:167], a[176:179], v[160:167], v14
lv 186,214,36864
cv 241,34,35
cv 242,16,17
cv 243,18,19
lv 188,11,32768
lv 190,11,36864
v_smfmac_f32_16x16x64_bf16 a[164:167], a[176:179], v[236:243], v14
lv 192,215,32768
pa 96,236,0
lv 194,215,36864
s_nop 0
pa 96,240,4
ds_read_b32 v255, v12 offset:1024
s_nop 0
pa 100,240,12
lv 32,8,49152
v_accvgpr_read_b32 v126, a166
v_accvgpr_read_b32 v127, a167
v_add_f32 v126, v126, v127
v_cmp_nge_f32 s[42:43], s29, v126
v_rcp_f32 v126, v126
pa 100,236,8
s_or_b64 s[32:33], s[32:33], s[42:43]
lv 34,8,53248
v_mul_f32_e64 v127, -s41, v126
pa 104,236,16
ds_write2_b32 v123, v126, v127 offset0:96 offset1:112
pa 104,240,20
s_waitcnt lgkmcnt(6)
ds_read_b128 v[128:131], v124 offset:384
v_accvgpr_read_b32 v220, a96
pa 108,240,28
ds_read_b128 v[132:135], v124 offset:448
v_accvgpr_read_b32 v221, a97
v_accvgpr_read_b32 v222, a100
v_accvgpr_read_b32 v223, a101
pa 108,236,24
lv 40,9,49152
v_accvgpr_read_b32 v224, a104
v_accvgpr_read_b32 v225, a105
pb 80,136,180
s_waitcnt lgkmcnt(5)
lv 42,9,53248
v_cmp_gt_u32 vcc, 30, v255
pb 80,140,184
lv 36,212,49152
v_accvgpr_read_b32 v226, a108
v_accvgpr_read_b32 v227, a109
pb 112,148,184
s_cbranch_vccnz LsX30
LrX30:
ds_read2_b32 v[248:249], v251 offset0:192 offset1:208
pb 112,144,180
lv 38,212,53248
pa 88,152,180
s_waitcnt lgkmcnt(5)
lv 44,213,49152
v_fma_f32 v220, v220, v128, v132
v_fma_f32 v221, v221, v129, v133
v_fma_f32 v222, v222, v128, v132
v_fma_f32 v223, v223, v129, v133
cv 220,220,222
v_pk_fma_f32 v[224:225], v[224:225], v[128:129], v[132:133]
v_pk_fma_f32 v[226:227], v[226:227], v[128:129], v[132:133]
cv 222,221,223
cv 221,224,226
cv 223,225,227
pa 88,156,184
ds_write_b64 v120, v[220:221] offset:0
pa 120,164,184
ds_write_b64 v120, v[222:223] offset:128
v_accvgpr_read_b32 v220, a98
v_accvgpr_read_b32 v221, a99
v_accvgpr_read_b32 v222, a102
v_accvgpr_read_b32 v223, a103
v_pk_fma_f32 v[220:221], v[220:221], v[130:131], v[134:135]
v_pk_fma_f32 v[222:223], v[222:223], v[130:131], v[134:135]
v_accvgpr_read_b32 v224, a106
v_accvgpr_read_b32 v225, a107
v_accvgpr_read_b32 v226, a110
v_accvgpr_read_b32 v227, a111
cv 220,220,222
v_pk_fma_f32 v[224:225], v[224:225], v[130:131], v[134:135]
v_pk_fma_f32 v[226:227], v[226:227], v[130:131], v[134:135]
cv 222,221,223
cv 221,224,226
cv 223,225,227
pa 120,160,180
ds_write_b64 v120, v[220:221] offset:256
pa 152,168,180
ds_write_b64 v120, v[222:223] offset:384
pa 156,168,188
s_waitcnt lgkmcnt(2)
ds_read_b64_tr_b16 v[228:229], v121 offset:0
v_min_f32 v250, v246, v248
pa 124,160,188
ds_read_b64_tr_b16 v[230:231], v121 offset:32
v_sub_f32 v246, v250, v246
pa 124,164,192
ds_read_b64_tr_b16 v[232:233], v121 offset:1024
v_sub_f32 v248, v250, v248
pa 92,156,192
ds_read_b64_tr_b16 v[234:235], v121 offset:1056
v_cmp_nge_f32 s[42:43], s29, v249
pa 92,152,188
s_or_b64 s[32:33], s[32:33], s[42:43]
lv 46,213,53248
pb 116,144,188
ex 246
pb 116,148,192
ex 248
pb 84,140,192
lv 180,10,49152
v_mul_f32 v250, v247, v246
pb 84,136,188
s_waitcnt lgkmcnt(4)
buffer_store_dwordx4 v[228:231], v122, s[16:19], s36 offen offset:0 sc0 sc1
v_fma_f32 v250, v249, v248, v250
v_rcp_f32 v250, v250
v_smfmac_f32_16x16x64_bf16 a[160:163], a[172:175], v[136:143], v14
lv 182,10,53248
v_smfmac_f32_16x16x64_bf16 a[160:163], a[176:179], v[144:151], v14
lv 188,11,49152
v_smfmac_f32_16x16x64_bf16 a[164:167], a[172:175], v[152:159], v14
s_waitcnt lgkmcnt(3)
buffer_store_dwordx4 v[232:235], v122, s[16:19], s36 offen offset:2048 sc0 sc1
v_mul_f32 v246, v246, v250
v_mul_f32 v248, v248, v250
v_add_f32 v251, v246, v248
v_mul_f32_e64 v251, -s41, v251
pa 144,208,32
s_add_u32 s36, s26, 8192
ds_write2_b32 v123, v246, v251 offset0:128 offset1:144
pa 148,208,40
s_add_u32 s36, s36, s2
ds_write2_b32 v123, v248, v248 offset0:160 offset1:176
pa 112,236,32
lv 190,11,53248
pa 112,240,36
ds_read_b128 v[152:155], v124 offset:512
pa 116,240,44
ds_read_b128 v[156:159], v124 offset:576
pa 116,236,40
ds_read_b128 v[228:231], v124 offset:640
qb 20,196,244,44
ds_read_b64 v[48:49], v245 offset:16384
qb 20,200,248,20
ds_read_b64 v[50:51], v245 offset:17408
v_accvgpr_read_b32 v136, a112
qb 20,204,252,20
ds_read_b64 v[52:53], v245 offset:18432
v_accvgpr_read_b32 v137, a113
pw 20,208,216
ds_read_b64 v[54:55], v245 offset:19456
v_accvgpr_read_b32 v138, a116
v_mfma_f32_16x16x32_bf16 v[24:27], v[176:179], a[244:247], v[44:47]
lv 184,214,49152
v_accvgpr_read_b32 v139, a117
pb 24,180,248
lv 186,214,53248
v_accvgpr_read_b32 v144, a114
pb 24,184,252
s_waitcnt lgkmcnt(7)
lv 192,215,49152
v_accvgpr_read_b32 v145, a115
v_mfma_f32_16x16x32_bf16 v[24:27], v[188:191], v[216:219], v[24:27]
lv 194,215,53248
v_accvgpr_read_b32 v146, a118
v_accvgpr_read_b32 v147, a119
v_fma_f32 v136, v136, v128, v132
v_fma_f32 v137, v137, v129, v133
v_pk_fma_f32 v[138:139], v[138:139], v[128:129], v[132:133]
cv 136,136,138
cv 138,137,139
pa 152,208,180
v_fma_f32 v144, v144, v130, v134
v_fma_f32 v145, v145, v131, v135
pa 156,208,188
v_fma_f32 v146, v146, v130, v134
v_fma_f32 v147, v147, v131, v135
pa 120,236,180
s_waitcnt lgkmcnt(2)
cv 144,144,146
cv 146,145,147
pa 120,240,184
s_waitcnt lgkmcnt(0)
ex 20
ex 21
ex 22
pa 124,240,192
ex 23
pa 124,236,188
ex 24
v_mfma_f32_16x16x32_bf16 v[28:31], v[192:195], a[244:247], v[44:47]
v_accvgpr_read_b32 v140, a120
v_accvgpr_read_b32 v141, a121
v_accvgpr_read_b32 v148, a122
v_accvgpr_read_b32 v149, a123
v_fma_f32 v140, v140, v128, v132
v_fma_f32 v141, v141, v129, v133
v_accvgpr_read_b32 v142, a124
v_accvgpr_read_b32 v143, a125
v_pk_fma_f32 v[142:143], v[142:143], v[128:129], v[132:133]
cv 137,140,142
cv 139,141,143
pb 28,196,248
ds_write_b64 v120, v[136:137] offset:2048
pb 28,200,252
ds_write_b64 v120, v[138:139] offset:2176
v_accvgpr_read_b32 v136, a144
v_accvgpr_read_b32 v137, a145
v_accvgpr_read_b32 v138, a148
v_accvgpr_read_b32 v139, a149
v_pk_fma_f32 v[136:137], v[136:137], v[152:153], v[156:157]
v_pk_fma_f32 v[138:139], v[138:139], v[152:153], v[156:157]
v_accvgpr_read_b32 v140, a152
v_accvgpr_read_b32 v141, a153
v_accvgpr_read_b32 v142, a156
v_accvgpr_read_b32 v143, a157
v_pk_fma_f32 v[136:137], v[48:49], v[228:229], v[136:137]
v_pk_fma_f32 v[138:139], v[50:51], v[228:229], v[138:139]
v_pk_fma_f32 v[140:141], v[140:141], v[152:153], v[156:157]
v_pk_fma_f32 v[142:143], v[142:143], v[152:153], v[156:157]
ds_read_b64 v[48:49], v245 offset:16392
ds_read_b64 v[50:51], v245 offset:17416
v_pk_fma_f32 v[140:141], v[52:53], v[228:229], v[140:141]
v_pk_fma_f32 v[142:143], v[54:55], v[228:229], v[142:143]
ds_read_b64 v[52:53], v245 offset:18440
ds_read_b64 v[54:55], v245 offset:19464
v_accvgpr_read_b32 v150, a126
v_accvgpr_read_b32 v151, a127
v_pk_fma_f32 v[148:149], v[148:149], v[130:131], v[134:135]
v_pk_fma_f32 v[150:151], v[150:151], v[130:131], v[134:135]
cv 145,148,150
cv 147,149,151
v_mfma_f32_16x16x32_bf16 v[28:31], v[204:207], v[216:219], v[28:31]
ds_write_b64 v120, v[144:145] offset:2304
qb 32,48,244,44
s_waitcnt lgkmcnt(1)
ds_write_b64 v120, v[146:147] offset:2432
v_accvgpr_read_b32 v144, a146
v_accvgpr_read_b32 v145, a147
v_accvgpr_read_b32 v146, a150
v_accvgpr_read_b32 v147, a151
v_pk_fma_f32 v[144:145], v[144:145], v[154:155], v[158:159]
v_pk_fma_f32 v[146:147], v[146:147], v[154:155], v[158:159]
v_accvgpr_read_b32 v148, a154
v_accvgpr_read_b32 v149, a155
v_accvgpr_read_b32 v150, a158
v_accvgpr_read_b32 v151, a159
v_pk_fma_f32 v[144:145], v[48:49], v[230:231], v[144:145]
v_pk_fma_f32 v[146:147], v[50:51], v[230:231], v[146:147]
cv 136,136,138
v_pk_fma_f32 v[148:149], v[148:149], v[154:155], v[158:159]
v_pk_fma_f32 v[150:151], v[150:151], v[154:155], v[158:159]
cv 144,144,146
cv 138,137,139
v_pk_fma_f32 v[148:149], v[52:53], v[230:231], v[148:149]
v_pk_fma_f32 v[150:151], v[54:55], v[230:231], v[150:151]
cv 146,145,147
cv 137,140,142
cv 139,141,143
cv 145,148,150
cv 147,149,151
qb 32,52,248,32
ds_write_b64 v120, v[136:137] offset:16384
qb 32,56,252,32
ds_write_b64 v120, v[138:139] offset:16512
pw 32,60,216
ds_write_b64 v120, v[144:145] offset:16640
qb 16,208,240,40
ds_write_b64 v120, v[146:147] offset:16768
qb 16,204,236,16
ds_read_b64_tr_b16 v[168:169], v121 offset:2048
cv 220,20,21
qb 16,200,232,16
ds_read_b64_tr_b16 v[170:171], v121 offset:2080
cv 221,22,23
qb 16,196,228,16
s_waitcnt lgkmcnt(0)
ds_read_b64_tr_b16 v[172:173], v121 offset:3072
ds_read_b64_tr_b16 v[174:175], v121 offset:3104
ds_read_b64_tr_b16 v[160:161], v121 offset:16384
ds_read_b64_tr_b16 v[162:163], v121 offset:16416
ds_read_b64_tr_b16 v[164:165], v121 offset:17408
ds_read_b64_tr_b16 v[166:167], v121 offset:17440
ex 25
ex 26
ex 27
ex 28
ex 29
ex 30
ex 31
ex 32
ex 33
ex 34
ex 35
cv 222,24,25
cv 223,26,27
cv 224,28,29
cv 225,30,31
cv 226,32,33
cv 227,34,35
buffer_store_dwordx4 v[168:171], v122, s[16:19], s37 offen offset:0 sc0 sc1
ex 16
ex 17
v_smfmac_f32_16x16x64_bf16 a[164:167], a[172:175], v[220:227], v14
cv 208,16,17
pa 64,220,0
ex 18
pa 64,224,4
s_waitcnt lgkmcnt(0)
buffer_store_dwordx4 v[172:175], v122, s[16:19], s37 offen offset:2048 sc0 sc1
ex 19
s_add_u32 s37, s26, 4096
cv 209,18,19
pa 68,224,12
s_add_u32 s37, s37, s3
v_accvgpr_read_b32 v126, a164
v_accvgpr_read_b32 v127, a165
pa 68,220,8
v_add_f32 v126, v126, v127
v_cmp_nge_f32 s[42:43], s29, v126
v_mfma_f32_16x16x32_bf16 v[20:23], v[188:191], a[240:243], v[40:43]
s_or_b64 s[32:33], s[32:33], s[42:43]
v_rcp_f32 v126, v126
pb 20,184,236
buffer_store_dwordx4 v[160:163], v122, s[16:19], s38 offen offset:0 sc0 sc1
v_mul_f32_e64 v127, -s41, v126
v_accvgpr_read_b32 v136, a64
v_accvgpr_read_b32 v137, a65
v_accvgpr_read_b32 v138, a68
pb 20,180,232
ds_write2_b32 v123, v126, v127 offset0:64 offset1:80
pb 20,176,228
ds_read_b128 v[128:131], v124 offset:256
v_accvgpr_read_b32 v139, a69
pa 72,220,16
buffer_store_dwordx4 v[164:167], v122, s[16:19], s38 offen offset:2048 sc0 sc1
ds_read_b128 v[132:135], v124 offset:320
v_accvgpr_read_b32 v144, a66
v_accvgpr_read_b32 v145, a67
v_accvgpr_read_b32 v146, a70
pa 72,224,20
s_add_u32 s38, s26, 4096
v_accvgpr_read_b32 v147, a71
s_add_u32 s38, s38, s2
pa 76,224,28
ex 20
pa 76,220,24
ex 21
v_mfma_f32_16x16x32_bf16 v[24:27], v[204:207], a[240:243], v[40:43]
v_accvgpr_read_b32 v140, a72
v_accvgpr_read_b32 v141, a73
pb 24,200,236
v_accvgpr_read_b32 v148, a74
v_accvgpr_read_b32 v149, a75
pb 24,196,232
v_accvgpr_read_b32 v142, a76
v_accvgpr_read_b32 v143, a77
pb 24,192,228
s_waitcnt lgkmcnt(0)
v_accvgpr_read_b32 v150, a78
v_accvgpr_read_b32 v151, a79
v_fma_f32 v136, v136, v128, v132
v_fma_f32 v137, v137, v129, v133
v_fma_f32 v138, v138, v128, v132
v_fma_f32 v139, v139, v129, v133
v_pk_fma_f32 v[144:145], v[144:145], v[130:131], v[134:135]
v_pk_fma_f32 v[146:147], v[146:147], v[130:131], v[134:135]
cv 136,136,138
cv 144,144,146
pa 80,220,32
cv 138,137,139
cv 146,145,147
v_fma_f32 v140, v140, v128, v132
v_fma_f32 v141, v141, v129, v133
v_fma_f32 v142, v142, v128, v132
v_fma_f32 v143, v143, v129, v133
v_pk_fma_f32 v[148:149], v[148:149], v[130:131], v[134:135]
v_pk_fma_f32 v[150:151], v[150:151], v[130:131], v[134:135]
cv 137,140,142
cv 139,141,143
cv 145,148,150
cv 147,149,151
pa 80,224,36
ds_write_b64 v120, v[136:137] offset:18432
pa 84,224,44
ds_write_b64 v120, v[138:139] offset:18560
pa 84,220,40
ds_write_b64 v120, v[144:145] offset:18688
qb 28,60,240,40
ds_write_b64 v120, v[146:147] offset:18816
qb 28,56,236,28
ds_read_b64_tr_b16 v[168:169], v121 offset:18432
v_accvgpr_read_b32 v136, a80
qb 28,52,232,28
ds_read_b64_tr_b16 v[170:171], v121 offset:18464
v_accvgpr_read_b32 v137, a81
qb 28,48,228,28
ds_read_b64_tr_b16 v[172:173], v121 offset:19456
v_accvgpr_read_b32 v138, a84
pa 88,220,180

LwX1_7:
s_cbranch_vccnz LwrX1
ds_read_b64_tr_b16 v[174:175], v121 offset:19488
v_accvgpr_read_b32 v139, a85
pa 88,224,184
ex 22
pa 92,224,192
ex 23
pa 92,220,188
ex 24
qb 32,196,212,36
ex 25
qb 32,200,216,32
s_waitcnt lgkmcnt(2)
buffer_store_dwordx4 v[168:171], v122, s[16:19], s39 offen offset:0 sc0 sc1
ex 26
ex 27
qb 32,204,220,32
ex 28
ex 29
ex 30
ex 31
v_accvgpr_read_b32 v144, a82
qb 32,208,224,32
s_waitcnt lgkmcnt(0)
buffer_store_dwordx4 v[172:175], v122, s[16:19], s39 offen offset:2048 sc0 sc1
v_accvgpr_read_b32 v145, a83
v_accvgpr_read_b32 v146, a86
v_accvgpr_read_b32 v147, a87
cv 210,20,21
cv 211,22,23
cv 212,24,25
cv 213,26,27
cv 214,28,29
cv 215,30,31
v_pk_fma_f32 v[136:137], v[136:137], v[128:129], v[132:133]
v_pk_fma_f32 v[138:139], v[138:139], v[128:129], v[132:133]
v_pk_fma_f32 v[144:145], v[144:145], v[130:131], v[134:135]
v_pk_fma_f32 v[146:147], v[146:147], v[130:131], v[134:135]
v_accvgpr_read_b32 v140, a88
v_accvgpr_read_b32 v141, a89
v_accvgpr_read_b32 v142, a92
v_accvgpr_read_b32 v143, a93
cv 136,136,138
v_accvgpr_read_b32 v148, a90
v_accvgpr_read_b32 v149, a91
v_accvgpr_read_b32 v150, a94
v_accvgpr_read_b32 v151, a95
cv 144,144,146
v_smfmac_f32_16x16x64_bf16 a[160:163], a[176:179], v[208:215], v14
s_add_u32 s39, s26, 0
cv 138,137,139
cv 146,145,147
v_fma_f32 v140, v140, v128, v132
v_fma_f32 v141, v141, v129, v133
v_pk_fma_f32 v[142:143], v[142:143], v[128:129], v[132:133]
v_pk_fma_f32 v[148:149], v[148:149], v[130:131], v[134:135]
v_pk_fma_f32 v[150:151], v[150:151], v[130:131], v[134:135]
cv 137,140,142
cv 139,141,143
cv 145,148,150
cv 147,149,151
pb 88,208,0
s_add_u32 s39, s39, s3
ds_write_b64 v120, v[136:137] offset:0
pb 88,212,4
ds_write_b64 v120, v[138:139] offset:128
pb 92,212,12
ds_write_b64 v120, v[144:145] offset:256
pb 92,208,8
ds_write_b64 v120, v[146:147] offset:384
v_mfma_f32_16x16x32_bf16 v[16:19], v[176:179], a[212:215], v[36:39]
ds_read_b64_tr_b16 v[160:161], v121 offset:0
v_accvgpr_read_b32 v126, a162
pb 16,180,216
ds_read_b64_tr_b16 v[162:163], v121 offset:32
v_accvgpr_read_b32 v127, a163
pb 16,184,220
ds_read_b64_tr_b16 v[164:165], v121 offset:1024
v_add_f32 v126, v126, v127
pb 16,188,224
ds_read_b64_tr_b16 v[166:167], v121 offset:1056
v_cmp_nge_f32 s[42:43], s29, v126
v_rcp_f32 v126, v126
pb 96,208,16
s_or_b64 s[32:33], s[32:33], s[42:43]
v_mul_f32_e64 v127, -s41, v126
pb 96,212,20
ds_write2_b32 v123, v126, v127 offset0:32 offset1:48
pb 100,212,28
ds_read_b128 v[152:155], v124 offset:128
pb 100,208,24
ds_read_b128 v[156:159], v124 offset:192
v_mfma_f32_16x16x32_bf16 v[20:23], v[192:195], a[212:215], v[36:39]
s_waitcnt lgkmcnt(5)
buffer_store_dwordx4 v[160:163], v122, s[16:19], s36 offen offset:0 sc0 sc1
ex 32
ex 33
pb 20,196,216
ex 34
pb 20,200,220
ex 35
pb 20,204,224
ex 16
pb 104,208,32
s_waitcnt lgkmcnt(0)
buffer_store_dwordx4 v[164:167], v122, s[16:19], s36 offen offset:2048 sc0 sc1
ex 17
ex 18
v_pk_fma_f32 v[88:89], v[88:89], v[152:153], v[156:157]
v_pk_fma_f32 v[92:93], v[92:93], v[152:153], v[156:157]
v_pk_fma_f32 v[96:97], v[96:97], v[152:153], v[156:157]
v_pk_fma_f32 v[100:101], v[100:101], v[152:153], v[156:157]
v_pk_fma_f32 v[90:91], v[90:91], v[154:155], v[158:159]
v_pk_fma_f32 v[94:95], v[94:95], v[154:155], v[158:159]
v_pk_fma_f32 v[98:99], v[98:99], v[154:155], v[158:159]
v_pk_fma_f32 v[102:103], v[102:103], v[154:155], v[158:159]
cv 136,88,92
cv 138,89,93
cv 137,96,100
cv 139,97,101
cv 144,90,94
cv 146,91,95
cv 145,98,102
cv 147,99,103
pb 104,212,36
s_add_u32 s36, s26, 0
ds_write_b64 v120, v[136:137] offset:2048
pb 108,212,44
s_add_u32 s36, s36, s2
ds_write_b64 v120, v[138:139] offset:2176
pb 108,208,40
ds_write_b64 v120, v[144:145] offset:2304
qb 24,48,212,36
ds_write_b64 v120, v[146:147] offset:2432
qb 24,52,216,24
ds_read_b64_tr_b16 v[168:169], v121 offset:2048
cv 236,32,33
qb 24,56,220,24
ds_read_b64_tr_b16 v[170:171], v121 offset:2080
cv 237,34,35
qb 24,60,224,24
ds_read_b64_tr_b16 v[172:173], v121 offset:3072
cv 238,16,17
pb 112,208,180
ds_read_b64_tr_b16 v[174:175], v121 offset:3104
v_fma_f32 v104, v104, v152, v156
pb 112,212,184
v_fma_f32 v105, v105, v153, v157
v_fma_f32 v108, v108, v152, v156
v_fma_f32 v109, v109, v153, v157
cv 136,104,108
cv 138,105,109
v_pk_fma_f32 v[106:107], v[106:107], v[154:155], v[158:159]
v_pk_fma_f32 v[110:111], v[110:111], v[154:155], v[158:159]
cv 144,106,110
v_pk_fma_f32 v[112:113], v[112:113], v[152:153], v[156:157]
v_pk_fma_f32 v[114:115], v[114:115], v[154:155], v[158:159]
cv 146,107,111
ex 19
pb 116,212,192
ex 20
pb 116,208,188
s_waitcnt lgkmcnt(0)
buffer_store_dwordx4 v[168:171], v122, s[16:19], s37 offen offset:0 sc0 sc1
ex 21
ex 22
ex 23
ex 24
ex 25
ex 26
ex 27
v_pk_fma_f32 v[116:117], v[116:117], v[152:153], v[156:157]
v_pk_fma_f32 v[118:119], v[118:119], v[154:155], v[158:159]
cv 137,112,116
cv 139,113,117
cv 145,114,118
cv 147,115,119
ds_write_b64 v120, v[136:137] offset:16384
ds_write_b64 v120, v[138:139] offset:16512
ds_write_b64 v120, v[144:145] offset:16640
ds_write_b64 v120, v[146:147] offset:16768
buffer_store_dwordx4 v[172:175], v122, s[16:19], s37 offen offset:2048 sc0 sc1
cv 239,18,19
cv 240,20,21
cv 241,22,23
cv 242,24,25
cv 243,26,27
ds_read_b64_tr_b16 v[160:161], v121 offset:16384
ds_read_b64_tr_b16 v[162:163], v121 offset:16416
v_smfmac_f32_16x16x64_bf16 a[160:163], a[172:175], v[236:243], v14
ds_read_b64_tr_b16 v[164:165], v121 offset:17408
pb 56,236,0
ds_read_b64_tr_b16 v[166:167], v121 offset:17440
s_nop 0
pb 56,240,4
s_nop 1
pb 60,240,12
v_accvgpr_read_b32 v126, a160
v_accvgpr_read_b32 v127, a161
v_add_f32 v126, v126, v127
v_cmp_nge_f32 s[42:43], s29, v126
v_rcp_f32 v126, v126
pb 60,236,8
s_or_b64 s[32:33], s[32:33], s[42:43]
v_mul_f32_e64 v127, -s41, v126
pb 64,236,16
ds_write2_b32 v123, v126, v127 offset0:0 offset1:16
pb 64,240,20
ds_read_b128 v[128:131], v124 offset:0
pb 68,240,28
ds_read_b128 v[132:135], v124 offset:64
pb 68,236,24
s_waitcnt lgkmcnt(3)
buffer_store_dwordx4 v[160:163], v122, s[16:19], s38 offen offset:0 sc0 sc1
pb 72,236,32
buffer_store_dwordx4 v[164:167], v122, s[16:19], s38 offen offset:2048 sc0 sc1
pb 72,240,36
pb 76,240,44
pb 76,236,40
pb 80,236,180
s_waitcnt lgkmcnt(0)
v_fma_f32 v56, v56, v128, v132
v_fma_f32 v57, v57, v129, v133
v_fma_f32 v60, v60, v128, v132
v_fma_f32 v61, v61, v129, v133
cv 136,56,60
v_pk_fma_f32 v[64:65], v[64:65], v[128:129], v[132:133]
v_pk_fma_f32 v[68:69], v[68:69], v[128:129], v[132:133]
v_pk_fma_f32 v[58:59], v[58:59], v[130:131], v[134:135]
v_pk_fma_f32 v[62:63], v[62:63], v[130:131], v[134:135]
v_pk_fma_f32 v[66:67], v[66:67], v[130:131], v[134:135]
v_pk_fma_f32 v[70:71], v[70:71], v[130:131], v[134:135]
cv 138,57,61
cv 137,64,68
cv 139,65,69
cv 144,58,62
cv 146,59,63
cv 145,66,70
cv 147,67,71
pb 80,240,184
ds_write_b64 v120, v[136:137] offset:18432
pb 84,240,192
ds_write_b64 v120, v[138:139] offset:18560
pb 84,236,188
s_waitcnt lgkmcnt(1)
ds_write_b64 v120, v[144:145] offset:18688
ds_write_b64 v120, v[146:147] offset:18816
v_pk_fma_f32 v[72:73], v[72:73], v[128:129], v[132:133]
v_pk_fma_f32 v[76:77], v[76:77], v[128:129], v[132:133]
v_pk_fma_f32 v[80:81], v[80:81], v[128:129], v[132:133]
v_pk_fma_f32 v[74:75], v[74:75], v[130:131], v[134:135]
v_pk_fma_f32 v[78:79], v[78:79], v[130:131], v[134:135]
v_pk_fma_f32 v[82:83], v[82:83], v[130:131], v[134:135]
v_pk_fma_f32 v[84:85], v[84:85], v[128:129], v[132:133]
v_pk_fma_f32 v[86:87], v[86:87], v[130:131], v[134:135]
cv 136,72,76
cv 138,73,77
cv 137,80,84
cv 139,81,85
cv 144,74,78
cv 146,75,79
cv 145,82,86
cv 147,83,87
ds_write_b64 v120, v[136:137] offset:0
ds_write_b64 v120, v[138:139] offset:128
ds_write_b64 v120, v[144:145] offset:256
ds_write_b64 v120, v[146:147] offset:384
ds_read_b64_tr_b16 v[168:169], v121 offset:18432
ds_read_b64_tr_b16 v[170:171], v121 offset:18464
ds_read_b64_tr_b16 v[172:173], v121 offset:19456
ds_read_b64_tr_b16 v[174:175], v121 offset:19488
ds_read_b64_tr_b16 v[160:161], v121 offset:0
ds_read_b64_tr_b16 v[162:163], v121 offset:32
ds_read_b64_tr_b16 v[164:165], v121 offset:1024
ds_read_b64_tr_b16 v[166:167], v121 offset:1056
s_waitcnt lgkmcnt(6)
buffer_store_dwordx4 v[168:171], v122, s[16:19], s39 offen offset:0 sc0 sc1
s_waitcnt lgkmcnt(4)
buffer_store_dwordx4 v[172:175], v122, s[16:19], s39 offen offset:2048 sc0 sc1
s_waitcnt lgkmcnt(2)
buffer_store_dwordx4 v[160:163], v122, s[16:19], s36 offen offset:0 sc0 sc1
s_waitcnt lgkmcnt(0)
buffer_store_dwordx4 v[164:167], v122, s[16:19], s36 offen offset:2048 sc0 sc1
Lfin0:
s_or_b64 s[36:37], s[30:31], s[32:33]
s_cbranch_scc1 Lslow
s_endpgm
LsX1:
ds_read_b32 v255, v12 offset:1024
s_waitcnt lgkmcnt(0)
v_cmp_gt_u32 vcc, 1, v255
s_nop 0
s_cbranch_vccnz LsX1
s_branch LrX1
LsX2:
ds_read_b32 v255, v12 offset:1024
s_waitcnt lgkmcnt(0)
v_cmp_gt_u32 vcc, 2, v255
s_nop 0
s_cbranch_vccnz LsX2
s_branch LrX2
LsX3:
ds_read_b32 v255, v12 offset:1024
s_waitcnt lgkmcnt(0)
v_cmp_gt_u32 vcc, 3, v255
s_nop 0
s_cbranch_vccnz LsX3
s_branch LrX3
LsX4:
ds_read_b32 v255, v12 offset:1024
s_waitcnt lgkmcnt(0)
v_cmp_gt_u32 vcc, 4, v255
s_nop 0
s_cbranch_vccnz LsX4
s_branch LrX4
LsX5:
ds_read_b32 v255, v12 offset:1024
s_waitcnt lgkmcnt(0)
v_cmp_gt_u32 vcc, 5, v255
s_nop 0
s_cbranch_vccnz LsX5
s_branch LrX5
LsX6:
ds_read_b32 v255, v12 offset:1024
s_waitcnt lgkmcnt(0)
v_cmp_gt_u32 vcc, 6, v255
s_nop 0
s_cbranch_vccnz LsX6
s_branch LrX6
LsX7:
ds_read_b32 v255, v12 offset:1024
s_waitcnt lgkmcnt(0)
v_cmp_gt_u32 vcc, 7, v255
s_nop 0
s_cbranch_vccnz LsX7
s_branch LrX7
LsX8:
ds_read_b32 v255, v12 offset:1024
s_waitcnt lgkmcnt(0)
v_cmp_gt_u32 vcc, 8, v255
s_nop 0
s_cbranch_vccnz LsX8
s_branch LrX8
LsX9:
ds_read_b32 v255, v12 offset:1024
s_waitcnt lgkmcnt(0)
v_cmp_gt_u32 vcc, 9, v255
s_nop 0
s_cbranch_vccnz LsX9
s_branch LrX9
LsX10:
ds_read_b32 v255, v12 offset:1024
s_waitcnt lgkmcnt(0)
v_cmp_gt_u32 vcc, 10, v255
s_nop 0
s_cbranch_vccnz LsX10
s_branch LrX10
LsX11:
ds_read_b32 v255, v12 offset:1024
s_waitcnt lgkmcnt(0)
v_cmp_gt_u32 vcc, 11, v255
s_nop 0
s_cbranch_vccnz LsX11
s_branch LrX11
LsX12:
ds_read_b32 v255, v12 offset:1024
s_waitcnt lgkmcnt(0)
v_cmp_gt_u32 vcc, 12, v255
s_nop 0
s_cbranch_vccnz LsX12
s_branch LrX12
LsX13:
ds_read_b32 v255, v12 offset:1024
s_waitcnt lgkmcnt(0)
v_cmp_gt_u32 vcc, 13, v255
s_nop 0
s_cbranch_vccnz LsX13
s_branch LrX13
LsX14:
ds_read_b32 v255, v12 offset:1024
s_waitcnt lgkmcnt(0)
v_cmp_gt_u32 vcc, 14, v255
s_nop 0
s_cbranch_vccnz LsX14
s_branch LrX14
LsX15:
ds_read_b32 v255, v12 offset:1024
s_waitcnt lgkmcnt(0)
v_cmp_gt_u32 vcc, 15, v255
s_nop 0
s_cbranch_vccnz LsX15
s_branch LrX15
LsX16:
ds_read_b32 v255, v12 offset:1024
s_waitcnt lgkmcnt(0)
v_cmp_gt_u32 vcc, 16, v255
s_nop 0
s_cbranch_vccnz LsX16
s_branch LrX16
LsX17:
ds_read_b32 v255, v12 offset:1024
s_waitcnt lgkmcnt(0)
v_cmp_gt_u32 vcc, 17, v255
s_nop 0
s_cbranch_vccnz LsX17
s_branch LrX17
LsX18:
ds_read_b32 v255, v12 offset:1024
s_waitcnt lgkmcnt(0)
v_cmp_gt_u32 vcc, 18, v255
s_nop 0
s_cbranch_vccnz LsX18
s_branch LrX18
LsX19:
ds_read_b32 v255, v12 offset:1024
s_waitcnt lgkmcnt(0)
v_cmp_gt_u32 vcc, 19, v255
s_nop 0
s_cbranch_vccnz LsX19
s_branch LrX19
LsX20:
ds_read_b32 v255, v12 offset:1024
s_waitcnt lgkmcnt(0)
v_cmp_gt_u32 vcc, 20, v255
s_nop 0
s_cbranch_vccnz LsX20
s_branch LrX20
LsX21:
ds_read_b32 v255, v12 offset:1024
s_waitcnt lgkmcnt(0)
v_cmp_gt_u32 vcc, 21, v255
s_nop 0
s_cbranch_vccnz LsX21
s_branch LrX21
LsX22:
ds_read_b32 v255, v12 offset:1024
s_waitcnt lgkmcnt(0)
v_cmp_gt_u32 vcc, 22, v255
s_nop 0
s_cbranch_vccnz LsX22
s_branch LrX22
LsX23:
ds_read_b32 v255, v12 offset:1024
s_waitcnt lgkmcnt(0)
v_cmp_gt_u32 vcc, 23, v255
s_nop 0
s_cbranch_vccnz LsX23
s_branch LrX23
LsX24:
ds_read_b32 v255, v12 offset:1024
s_waitcnt lgkmcnt(0)
v_cmp_gt_u32 vcc, 24, v255
s_nop 0
s_cbranch_vccnz LsX24
s_branch LrX24
LsX25:
ds_read_b32 v255, v12 offset:1024
s_waitcnt lgkmcnt(0)
v_cmp_gt_u32 vcc, 25, v255
s_nop 0
s_cbranch_vccnz LsX25
s_branch LrX25
LsX26:
ds_read_b32 v255, v12 offset:1024
s_waitcnt lgkmcnt(0)
v_cmp_gt_u32 vcc, 26, v255
s_nop 0
s_cbranch_vccnz LsX26
s_branch LrX26
LsX27:
ds_read_b32 v255, v12 offset:1024
s_waitcnt lgkmcnt(0)
v_cmp_gt_u32 vcc, 27, v255
s_nop 0
s_cbranch_vccnz LsX27
s_branch LrX27
LsX28:
ds_read_b32 v255, v12 offset:1024
s_waitcnt lgkmcnt(0)
v_cmp_gt_u32 vcc, 28, v255
s_nop 0
s_cbranch_vccnz LsX28
s_branch LrX28
LsX29:
ds_read_b32 v255, v12 offset:1024
s_waitcnt lgkmcnt(0)
v_cmp_gt_u32 vcc, 29, v255
s_nop 0
s_cbranch_vccnz LsX29
s_branch LrX29
LsX30:
ds_read_b32 v255, v12 offset:1024
s_waitcnt lgkmcnt(0)
v_cmp_gt_u32 vcc, 30, v255
s_nop 0
s_cbranch_vccnz LsX30
s_branch LrX30
Lslow:
s_waitcnt vmcnt(0) lgkmcnt(0)
s_mov_b32 s42, 0
v_mbcnt_lo_u32_b32 v219, -1, 0
v_mbcnt_hi_u32_b32 v219, -1, v219
v_lshrrev_b32 v216, 2, v219
v_and_b32 v217, 3, v216
v_and_b32 v218, 4, v216
v_lshl_add_u32 v217, v218, 1, v217
v_lshlrev_b32 v217, 4, v217
v_and_b32 v218, 3, v219
v_lshlrev_b32 v218, 3, v218
v_xor_b32 v217, v217, v218
v_lshl_add_u32 v217, v216, 8, v217
v_add_u32 v217, s21, v217
v_add_u32 v4, 98304, v217
v_xor_b32 v5, 32, v4
v_xor_b32 v6, 64, v4
v_xor_b32 v7, 96, v4
v_xor_b32 v8, 128, v4
v_xor_b32 v9, 160, v4
v_xor_b32 v10, 192, v4
v_xor_b32 v11, 224, v4
v_and_b32 v216, 15, v219
v_and_b32 v217, 16, v219
v_lshlrev_b32 v217, 1, v217
v_lshl_add_u32 v216, v216, 8, v217
v_lshrrev_b32 v217, 5, v219
v_lshl_add_u32 v230, v217, 4, v216
v_and_b32 v216, 15, v219
v_and_b32 v217, 16, v219
v_lshlrev_b32 v217, 2, v217
v_lshl_add_u32 v216, v216, 8, v217
v_lshrrev_b32 v217, 5, v219
v_lshl_add_u32 v15, v217, 4, v216
Lsl_pass:
s_cmp_eq_u64 s[30:31], 0
s_cbranch_scc1 Lsl_next
s_mov_b32 s36, s24
s_mov_b32 s37, s25
s_mul_i32 s38, s42, 262144
s_add_u32 s41, s36, 0
buffer_load_dwordx4 v[56:59], v15, s[4:7], s41 offen offset:0
buffer_load_dwordx4 v[60:63], v15, s[4:7], s41 offen offset:32
buffer_load_dwordx4 v[64:67], v15, s[4:7], s41 offen offset:128
buffer_load_dwordx4 v[68:71], v15, s[4:7], s41 offen offset:160
s_add_u32 s41, s36, 4096
buffer_load_dwordx4 v[72:75], v15, s[4:7], s41 offen offset:0
buffer_load_dwordx4 v[76:79], v15, s[4:7], s41 offen offset:32
buffer_load_dwordx4 v[80:83], v15, s[4:7], s41 offen offset:128
buffer_load_dwordx4 v[84:87], v15, s[4:7], s41 offen offset:160
s_add_u32 s41, s36, 8192
buffer_load_dwordx4 v[88:91], v15, s[4:7], s41 offen offset:0
buffer_load_dwordx4 v[92:95], v15, s[4:7], s41 offen offset:32
buffer_load_dwordx4 v[96:99], v15, s[4:7], s41 offen offset:128
buffer_load_dwordx4 v[100:103], v15, s[4:7], s41 offen offset:160
s_add_u32 s41, s36, 12288
buffer_load_dwordx4 v[104:107], v15, s[4:7], s41 offen offset:0
buffer_load_dwordx4 v[108:111], v15, s[4:7], s41 offen offset:32
buffer_load_dwordx4 v[112:115], v15, s[4:7], s41 offen offset:128
buffer_load_dwordx4 v[116:119], v15, s[4:7], s41 offen offset:160
s_mov_b32 s41, s37
buffer_load_dwordx4 v[120:123], v15, s[4:7], s41 offen offset:0
buffer_load_dwordx4 v[124:127], v15, s[4:7], s41 offen offset:32
buffer_load_dwordx4 v[128:131], v15, s[4:7], s41 offen offset:128
buffer_load_dwordx4 v[132:135], v15, s[4:7], s41 offen offset:160
s_waitcnt vmcnt(0) lgkmcnt(0)
v_lshlrev_b32 v216, 16, v56
v_and_b32 v217, s28, v56
v_mul_f32 v216, s22, v216
v_mul_f32 v217, s22, v217
cv 56,216,217
v_lshlrev_b32 v218, 16, v57
v_and_b32 v219, s28, v57
v_mul_f32 v218, s22, v218
v_mul_f32 v219, s22, v219
cv 57,218,219
v_lshlrev_b32 v220, 16, v58
v_and_b32 v221, s28, v58
v_mul_f32 v220, s22, v220
v_mul_f32 v221, s22, v221
cv 58,220,221
v_lshlrev_b32 v222, 16, v59
v_and_b32 v223, s28, v59
v_mul_f32 v222, s22, v222
v_mul_f32 v223, s22, v223
cv 59,222,223
v_lshlrev_b32 v216, 16, v60
v_and_b32 v217, s28, v60
v_mul_f32 v216, s22, v216
v_mul_f32 v217, s22, v217
cv 60,216,217
v_lshlrev_b32 v218, 16, v61
v_and_b32 v219, s28, v61
v_mul_f32 v218, s22, v218
v_mul_f32 v219, s22, v219
cv 61,218,219
v_lshlrev_b32 v220, 16, v62
v_and_b32 v221, s28, v62
v_mul_f32 v220, s22, v220
v_mul_f32 v221, s22, v221
cv 62,220,221
v_lshlrev_b32 v222, 16, v63
v_and_b32 v223, s28, v63
v_mul_f32 v222, s22, v222
v_mul_f32 v223, s22, v223
cv 63,222,223
v_lshlrev_b32 v216, 16, v64
v_and_b32 v217, s28, v64
v_mul_f32 v216, s22, v216
v_mul_f32 v217, s22, v217
cv 64,216,217
v_lshlrev_b32 v218, 16, v65
v_and_b32 v219, s28, v65
v_mul_f32 v218, s22, v218
v_mul_f32 v219, s22, v219
cv 65,218,219
v_lshlrev_b32 v220, 16, v66
v_and_b32 v221, s28, v66
v_mul_f32 v220, s22, v220
v_mul_f32 v221, s22, v221
cv 66,220,221
v_lshlrev_b32 v222, 16, v67
v_and_b32 v223, s28, v67
v_mul_f32 v222, s22, v222
v_mul_f32 v223, s22, v223
cv 67,222,223
v_lshlrev_b32 v216, 16, v68
v_and_b32 v217, s28, v68
v_mul_f32 v216, s22, v216
v_mul_f32 v217, s22, v217
cv 68,216,217
v_lshlrev_b32 v218, 16, v69
v_and_b32 v219, s28, v69
v_mul_f32 v218, s22, v218
v_mul_f32 v219, s22, v219
cv 69,218,219
v_lshlrev_b32 v220, 16, v70
v_and_b32 v221, s28, v70
v_mul_f32 v220, s22, v220
v_mul_f32 v221, s22, v221
cv 70,220,221
v_lshlrev_b32 v222, 16, v71
v_and_b32 v223, s28, v71
v_mul_f32 v222, s22, v222
v_mul_f32 v223, s22, v223
cv 71,222,223
v_lshlrev_b32 v216, 16, v72
v_and_b32 v217, s28, v72
v_mul_f32 v216, s22, v216
v_mul_f32 v217, s22, v217
cv 72,216,217
v_lshlrev_b32 v218, 16, v73
v_and_b32 v219, s28, v73
v_mul_f32 v218, s22, v218
v_mul_f32 v219, s22, v219
cv 73,218,219
v_lshlrev_b32 v220, 16, v74
v_and_b32 v221, s28, v74
v_mul_f32 v220, s22, v220
v_mul_f32 v221, s22, v221
cv 74,220,221
v_lshlrev_b32 v222, 16, v75
v_and_b32 v223, s28, v75
v_mul_f32 v222, s22, v222
v_mul_f32 v223, s22, v223
cv 75,222,223
v_lshlrev_b32 v216, 16, v76
v_and_b32 v217, s28, v76
v_mul_f32 v216, s22, v216
v_mul_f32 v217, s22, v217
cv 76,216,217
v_lshlrev_b32 v218, 16, v77
v_and_b32 v219, s28, v77
v_mul_f32 v218, s22, v218
v_mul_f32 v219, s22, v219
cv 77,218,219
v_lshlrev_b32 v220, 16, v78
v_and_b32 v221, s28, v78
v_mul_f32 v220, s22, v220
v_mul_f32 v221, s22, v221
cv 78,220,221
v_lshlrev_b32 v222, 16, v79
v_and_b32 v223, s28, v79
v_mul_f32 v222, s22, v222
v_mul_f32 v223, s22, v223
cv 79,222,223
v_lshlrev_b32 v216, 16, v80
v_and_b32 v217, s28, v80
v_mul_f32 v216, s22, v216
v_mul_f32 v217, s22, v217
cv 80,216,217
v_lshlrev_b32 v218, 16, v81
v_and_b32 v219, s28, v81
v_mul_f32 v218, s22, v218
v_mul_f32 v219, s22, v219
cv 81,218,219
v_lshlrev_b32 v220, 16, v82
v_and_b32 v221, s28, v82
v_mul_f32 v220, s22, v220
v_mul_f32 v221, s22, v221
cv 82,220,221
v_lshlrev_b32 v222, 16, v83
v_and_b32 v223, s28, v83
v_mul_f32 v222, s22, v222
v_mul_f32 v223, s22, v223
cv 83,222,223
v_lshlrev_b32 v216, 16, v84
v_and_b32 v217, s28, v84
v_mul_f32 v216, s22, v216
v_mul_f32 v217, s22, v217
cv 84,216,217
v_lshlrev_b32 v218, 16, v85
v_and_b32 v219, s28, v85
v_mul_f32 v218, s22, v218
v_mul_f32 v219, s22, v219
cv 85,218,219
v_lshlrev_b32 v220, 16, v86
v_and_b32 v221, s28, v86
v_mul_f32 v220, s22, v220
v_mul_f32 v221, s22, v221
cv 86,220,221
v_lshlrev_b32 v222, 16, v87
v_and_b32 v223, s28, v87
v_mul_f32 v222, s22, v222
v_mul_f32 v223, s22, v223
cv 87,222,223
v_lshlrev_b32 v216, 16, v88
v_and_b32 v217, s28, v88
v_mul_f32 v216, s22, v216
v_mul_f32 v217, s22, v217
cv 88,216,217
v_lshlrev_b32 v218, 16, v89
v_and_b32 v219, s28, v89
v_mul_f32 v218, s22, v218
v_mul_f32 v219, s22, v219
cv 89,218,219
v_lshlrev_b32 v220, 16, v90
v_and_b32 v221, s28, v90
v_mul_f32 v220, s22, v220
v_mul_f32 v221, s22, v221
cv 90,220,221
v_lshlrev_b32 v222, 16, v91
v_and_b32 v223, s28, v91
v_mul_f32 v222, s22, v222
v_mul_f32 v223, s22, v223
cv 91,222,223
v_lshlrev_b32 v216, 16, v92
v_and_b32 v217, s28, v92
v_mul_f32 v216, s22, v216
v_mul_f32 v217, s22, v217
cv 92,216,217
v_lshlrev_b32 v218, 16, v93
v_and_b32 v219, s28, v93
v_mul_f32 v218, s22, v218
v_mul_f32 v219, s22, v219
cv 93,218,219
v_lshlrev_b32 v220, 16, v94
v_and_b32 v221, s28, v94
v_mul_f32 v220, s22, v220
v_mul_f32 v221, s22, v221
cv 94,220,221
v_lshlrev_b32 v222, 16, v95
v_and_b32 v223, s28, v95
v_mul_f32 v222, s22, v222
v_mul_f32 v223, s22, v223
cv 95,222,223
v_lshlrev_b32 v216, 16, v96
v_and_b32 v217, s28, v96
v_mul_f32 v216, s22, v216
v_mul_f32 v217, s22, v217
cv 96,216,217
v_lshlrev_b32 v218, 16, v97
v_and_b32 v219, s28, v97
v_mul_f32 v218, s22, v218
v_mul_f32 v219, s22, v219
cv 97,218,219
v_lshlrev_b32 v220, 16, v98
v_and_b32 v221, s28, v98
v_mul_f32 v220, s22, v220
v_mul_f32 v221, s22, v221
cv 98,220,221
v_lshlrev_b32 v222, 16, v99
v_and_b32 v223, s28, v99
v_mul_f32 v222, s22, v222
v_mul_f32 v223, s22, v223
cv 99,222,223
v_lshlrev_b32 v216, 16, v100
v_and_b32 v217, s28, v100
v_mul_f32 v216, s22, v216
v_mul_f32 v217, s22, v217
cv 100,216,217
v_lshlrev_b32 v218, 16, v101
v_and_b32 v219, s28, v101
v_mul_f32 v218, s22, v218
v_mul_f32 v219, s22, v219
cv 101,218,219
v_lshlrev_b32 v220, 16, v102
v_and_b32 v221, s28, v102
v_mul_f32 v220, s22, v220
v_mul_f32 v221, s22, v221
cv 102,220,221
v_lshlrev_b32 v222, 16, v103
v_and_b32 v223, s28, v103
v_mul_f32 v222, s22, v222
v_mul_f32 v223, s22, v223
cv 103,222,223
v_lshlrev_b32 v216, 16, v104
v_and_b32 v217, s28, v104
v_mul_f32 v216, s22, v216
v_mul_f32 v217, s22, v217
cv 104,216,217
v_lshlrev_b32 v218, 16, v105
v_and_b32 v219, s28, v105
v_mul_f32 v218, s22, v218
v_mul_f32 v219, s22, v219
cv 105,218,219
v_lshlrev_b32 v220, 16, v106
v_and_b32 v221, s28, v106
v_mul_f32 v220, s22, v220
v_mul_f32 v221, s22, v221
cv 106,220,221
v_lshlrev_b32 v222, 16, v107
v_and_b32 v223, s28, v107
v_mul_f32 v222, s22, v222
v_mul_f32 v223, s22, v223
cv 107,222,223
v_lshlrev_b32 v216, 16, v108
v_and_b32 v217, s28, v108
v_mul_f32 v216, s22, v216
v_mul_f32 v217, s22, v217
cv 108,216,217
v_lshlrev_b32 v218, 16, v109
v_and_b32 v219, s28, v109
v_mul_f32 v218, s22, v218
v_mul_f32 v219, s22, v219
cv 109,218,219
v_lshlrev_b32 v220, 16, v110
v_and_b32 v221, s28, v110
v_mul_f32 v220, s22, v220
v_mul_f32 v221, s22, v221
cv 110,220,221
v_lshlrev_b32 v222, 16, v111
v_and_b32 v223, s28, v111
v_mul_f32 v222, s22, v222
v_mul_f32 v223, s22, v223
cv 111,222,223
v_lshlrev_b32 v216, 16, v112
v_and_b32 v217, s28, v112
v_mul_f32 v216, s22, v216
v_mul_f32 v217, s22, v217
cv 112,216,217
v_lshlrev_b32 v218, 16, v113
v_and_b32 v219, s28, v113
v_mul_f32 v218, s22, v218
v_mul_f32 v219, s22, v219
cv 113,218,219
v_lshlrev_b32 v220, 16, v114
v_and_b32 v221, s28, v114
v_mul_f32 v220, s22, v220
v_mul_f32 v221, s22, v221
cv 114,220,221
v_lshlrev_b32 v222, 16, v115
v_and_b32 v223, s28, v115
v_mul_f32 v222, s22, v222
v_mul_f32 v223, s22, v223
cv 115,222,223
v_lshlrev_b32 v216, 16, v116
v_and_b32 v217, s28, v116
v_mul_f32 v216, s22, v216
v_mul_f32 v217, s22, v217
cv 116,216,217
v_lshlrev_b32 v218, 16, v117
v_and_b32 v219, s28, v117
v_mul_f32 v218, s22, v218
v_mul_f32 v219, s22, v219
cv 117,218,219
v_lshlrev_b32 v220, 16, v118
v_and_b32 v221, s28, v118
v_mul_f32 v220, s22, v220
v_mul_f32 v221, s22, v221
cv 118,220,221
v_lshlrev_b32 v222, 16, v119
v_and_b32 v223, s28, v119
v_mul_f32 v222, s22, v222
v_mul_f32 v223, s22, v223
cv 119,222,223
v_lshlrev_b32 v216, 16, v120
v_and_b32 v217, s28, v120
v_mul_f32 v216, s22, v216
v_mul_f32 v217, s22, v217
cv 120,216,217
v_lshlrev_b32 v218, 16, v121
v_and_b32 v219, s28, v121
v_mul_f32 v218, s22, v218
v_mul_f32 v219, s22, v219
cv 121,218,219
v_lshlrev_b32 v220, 16, v122
v_and_b32 v221, s28, v122
v_mul_f32 v220, s22, v220
v_mul_f32 v221, s22, v221
cv 122,220,221
v_lshlrev_b32 v222, 16, v123
v_and_b32 v223, s28, v123
v_mul_f32 v222, s22, v222
v_mul_f32 v223, s22, v223
cv 123,222,223
v_lshlrev_b32 v216, 16, v124
v_and_b32 v217, s28, v124
v_mul_f32 v216, s22, v216
v_mul_f32 v217, s22, v217
cv 124,216,217
v_lshlrev_b32 v218, 16, v125
v_and_b32 v219, s28, v125
v_mul_f32 v218, s22, v218
v_mul_f32 v219, s22, v219
cv 125,218,219
v_lshlrev_b32 v220, 16, v126
v_and_b32 v221, s28, v126
v_mul_f32 v220, s22, v220
v_mul_f32 v221, s22, v221
cv 126,220,221
v_lshlrev_b32 v222, 16, v127
v_and_b32 v223, s28, v127
v_mul_f32 v222, s22, v222
v_mul_f32 v223, s22, v223
cv 127,222,223
v_lshlrev_b32 v216, 16, v128
v_and_b32 v217, s28, v128
v_mul_f32 v216, s22, v216
v_mul_f32 v217, s22, v217
cv 128,216,217
v_lshlrev_b32 v218, 16, v129
v_and_b32 v219, s28, v129
v_mul_f32 v218, s22, v218
v_mul_f32 v219, s22, v219
cv 129,218,219
v_lshlrev_b32 v220, 16, v130
v_and_b32 v221, s28, v130
v_mul_f32 v220, s22, v220
v_mul_f32 v221, s22, v221
cv 130,220,221
v_lshlrev_b32 v222, 16, v131
v_and_b32 v223, s28, v131
v_mul_f32 v222, s22, v222
v_mul_f32 v223, s22, v223
cv 131,222,223
v_lshlrev_b32 v216, 16, v132
v_and_b32 v217, s28, v132
v_mul_f32 v216, s22, v216
v_mul_f32 v217, s22, v217
cv 132,216,217
v_lshlrev_b32 v218, 16, v133
v_and_b32 v219, s28, v133
v_mul_f32 v218, s22, v218
v_mul_f32 v219, s22, v219
cv 133,218,219
v_lshlrev_b32 v220, 16, v134
v_and_b32 v221, s28, v134
v_mul_f32 v220, s22, v220
v_mul_f32 v221, s22, v221
cv 134,220,221
v_lshlrev_b32 v222, 16, v135
v_and_b32 v223, s28, v135
v_mul_f32 v222, s22, v222
v_mul_f32 v223, s22, v223
cv 135,222,223
v_mov_b32 v224, 0xff800000
v_mov_b32 v225, 0xff800000
v_mov_b32 v226, 0xff800000
v_mov_b32 v227, 0xff800000
v_mov_b32 v228, 0xff800000
s_mov_b32 s39, s38
s_mov_b32 s40, 16
Lsl_max:
buffer_load_dwordx4 a[0:3], v15, s[8:11], s39 offen offset:0
buffer_load_dwordx4 a[4:7], v15, s[8:11], s39 offen offset:32
buffer_load_dwordx4 a[8:11], v15, s[8:11], s39 offen offset:128
buffer_load_dwordx4 a[12:15], v15, s[8:11], s39 offen offset:160
s_add_u32 s39, s39, 4096
buffer_load_dwordx4 a[16:19], v15, s[8:11], s39 offen offset:0
buffer_load_dwordx4 a[20:23], v15, s[8:11], s39 offen offset:32
buffer_load_dwordx4 a[24:27], v15, s[8:11], s39 offen offset:128
buffer_load_dwordx4 a[28:31], v15, s[8:11], s39 offen offset:160
s_add_u32 s39, s39, 4096
buffer_load_dwordx4 a[32:35], v15, s[8:11], s39 offen offset:0
buffer_load_dwordx4 a[36:39], v15, s[8:11], s39 offen offset:32
buffer_load_dwordx4 a[40:43], v15, s[8:11], s39 offen offset:128
buffer_load_dwordx4 a[44:47], v15, s[8:11], s39 offen offset:160
s_add_u32 s39, s39, 4096
buffer_load_dwordx4 a[48:51], v15, s[8:11], s39 offen offset:0
buffer_load_dwordx4 a[52:55], v15, s[8:11], s39 offen offset:32
buffer_load_dwordx4 a[56:59], v15, s[8:11], s39 offen offset:128
buffer_load_dwordx4 a[60:63], v15, s[8:11], s39 offen offset:160
s_add_u32 s39, s39, 4096
s_waitcnt vmcnt(0) lgkmcnt(0)
v_mfma_f32_16x16x32_bf16 v[16:19], a[0:3], v[56:59], 0
pw 16,4,60
pw 16,8,64
pw 16,12,68
v_mfma_f32_16x16x32_bf16 v[20:23], a[12:15], v[84:87], 0
pw 20,8,80
pw 20,4,76
pw 20,0,72
v_mfma_f32_16x16x32_bf16 v[24:27], a[0:3], v[88:91], 0
pw 24,4,92
pw 24,8,96
pw 24,12,100
v_mfma_f32_16x16x32_bf16 v[28:31], a[12:15], v[116:119], 0
pw 28,8,112
pw 28,4,108
pw 28,0,104
v_mfma_f32_16x16x32_bf16 v[32:35], a[0:3], v[120:123], 0
pw 32,4,124
pw 32,8,128
pw 32,12,132
v_max3_f32 v224, v224, v16, v17
v_max3_f32 v224, v224, v18, v19
v_max3_f32 v225, v225, v20, v21
v_max3_f32 v225, v225, v22, v23
v_max3_f32 v226, v226, v24, v25
v_max3_f32 v226, v226, v26, v27
v_max3_f32 v227, v227, v28, v29
v_max3_f32 v227, v227, v30, v31
v_max3_f32 v228, v228, v32, v33
v_max3_f32 v228, v228, v34, v35
v_mfma_f32_16x16x32_bf16 v[16:19], a[16:19], v[56:59], 0
pw 16,20,60
pw 16,24,64
pw 16,28,68
v_mfma_f32_16x16x32_bf16 v[20:23], a[28:31], v[84:87], 0
pw 20,24,80
pw 20,20,76
pw 20,16,72
v_mfma_f32_16x16x32_bf16 v[24:27], a[16:19], v[88:91], 0
pw 24,20,92
pw 24,24,96
pw 24,28,100
v_mfma_f32_16x16x32_bf16 v[28:31], a[28:31], v[116:119], 0
pw 28,24,112
pw 28,20,108
pw 28,16,104
v_mfma_f32_16x16x32_bf16 v[32:35], a[16:19], v[120:123], 0
pw 32,20,124
pw 32,24,128
pw 32,28,132
v_max3_f32 v224, v224, v16, v17
v_max3_f32 v224, v224, v18, v19
v_max3_f32 v225, v225, v20, v21
v_max3_f32 v225, v225, v22, v23
v_max3_f32 v226, v226, v24, v25
v_max3_f32 v226, v226, v26, v27
v_max3_f32 v227, v227, v28, v29
v_max3_f32 v227, v227, v30, v31
v_max3_f32 v228, v228, v32, v33
v_max3_f32 v228, v228, v34, v35
v_mfma_f32_16x16x32_bf16 v[16:19], a[32:35], v[56:59], 0
pw 16,36,60
pw 16,40,64
pw 16,44,68
v_mfma_f32_16x16x32_bf16 v[20:23], a[44:47], v[84:87], 0
pw 20,40,80
pw 20,36,76
pw 20,32,72
v_mfma_f32_16x16x32_bf16 v[24:27], a[32:35], v[88:91], 0
pw 24,36,92
pw 24,40,96
pw 24,44,100
v_mfma_f32_16x16x32_bf16 v[28:31], a[44:47], v[116:119], 0
pw 28,40,112
pw 28,36,108
pw 28,32,104
v_mfma_f32_16x16x32_bf16 v[32:35], a[32:35], v[120:123], 0
pw 32,36,124
pw 32,40,128
pw 32,44,132
v_max3_f32 v224, v224, v16, v17
v_max3_f32 v224, v224, v18, v19
v_max3_f32 v225, v225, v20, v21
v_max3_f32 v225, v225, v22, v23
v_max3_f32 v226, v226, v24, v25
v_max3_f32 v226, v226, v26, v27
v_max3_f32 v227, v227, v28, v29
v_max3_f32 v227, v227, v30, v31
v_max3_f32 v228, v228, v32, v33
v_max3_f32 v228, v228, v34, v35
v_mfma_f32_16x16x32_bf16 v[16:19], a[48:51], v[56:59], 0
pw 16,52,60
pw 16,56,64
pw 16,60,68
v_mfma_f32_16x16x32_bf16 v[20:23], a[60:63], v[84:87], 0
pw 20,56,80
pw 20,52,76
pw 20,48,72
v_mfma_f32_16x16x32_bf16 v[24:27], a[48:51], v[88:91], 0
pw 24,52,92
pw 24,56,96
pw 24,60,100
v_mfma_f32_16x16x32_bf16 v[28:31], a[60:63], v[116:119], 0
pw 28,56,112
pw 28,52,108
pw 28,48,104
v_mfma_f32_16x16x32_bf16 v[32:35], a[48:51], v[120:123], 0
pw 32,52,124
pw 32,56,128
pw 32,60,132
v_max3_f32 v224, v224, v16, v17
v_max3_f32 v224, v224, v18, v19
v_max3_f32 v225, v225, v20, v21
v_max3_f32 v225, v225, v22, v23
v_max3_f32 v226, v226, v24, v25
v_max3_f32 v226, v226, v26, v27
v_max3_f32 v227, v227, v28, v29
v_max3_f32 v227, v227, v30, v31
v_max3_f32 v228, v228, v32, v33
v_max3_f32 v228, v228, v34, v35
s_nop 11
s_sub_u32 s40, s40, 1
s_cmp_lg_u32 s40, 0
s_cbranch_scc1 Lsl_max
v_mov_b32 v217, v224
s_nop 1
v_permlane16_swap_b32 v224, v217
v_max_f32 v224, v224, v217
v_mov_b32 v217, v224
s_nop 1
v_permlane32_swap_b32 v224, v217
v_max_f32 v224, v224, v217
v_mov_b32 v217, v225
s_nop 1
v_permlane16_swap_b32 v225, v217
v_max_f32 v225, v225, v217
v_mov_b32 v217, v225
s_nop 1
v_permlane32_swap_b32 v225, v217
v_max_f32 v225, v225, v217
v_mov_b32 v217, v226
s_nop 1
v_permlane16_swap_b32 v226, v217
v_max_f32 v226, v226, v217
v_mov_b32 v217, v226
s_nop 1
v_permlane32_swap_b32 v226, v217
v_max_f32 v226, v226, v217
v_mov_b32 v217, v227
s_nop 1
v_permlane16_swap_b32 v227, v217
v_max_f32 v227, v227, v217
v_mov_b32 v217, v227
s_nop 1
v_permlane32_swap_b32 v227, v217
v_max_f32 v227, v227, v217
v_mov_b32 v217, v228
s_nop 1
v_permlane16_swap_b32 v228, v217
v_max_f32 v228, v228, v217
v_mov_b32 v217, v228
s_nop 1
v_permlane32_swap_b32 v228, v217
v_max_f32 v228, v228, v217
v_accvgpr_write_b32 a0, 0
v_accvgpr_write_b32 a1, 0
v_accvgpr_write_b32 a2, 0
v_accvgpr_write_b32 a3, 0
v_accvgpr_write_b32 a4, 0
v_accvgpr_write_b32 a5, 0
v_accvgpr_write_b32 a6, 0
v_accvgpr_write_b32 a7, 0
v_accvgpr_write_b32 a8, 0
v_accvgpr_write_b32 a9, 0
v_accvgpr_write_b32 a10, 0
v_accvgpr_write_b32 a11, 0
v_accvgpr_write_b32 a12, 0
v_accvgpr_write_b32 a13, 0
v_accvgpr_write_b32 a14, 0
v_accvgpr_write_b32 a15, 0
v_accvgpr_write_b32 a16, 0
v_accvgpr_write_b32 a17, 0
v_accvgpr_write_b32 a18, 0
v_accvgpr_write_b32 a19, 0
v_accvgpr_write_b32 a20, 0
v_accvgpr_write_b32 a21, 0
v_accvgpr_write_b32 a22, 0
v_accvgpr_write_b32 a23, 0
v_accvgpr_write_b32 a24, 0
v_accvgpr_write_b32 a25, 0
v_accvgpr_write_b32 a26, 0
v_accvgpr_write_b32 a27, 0
v_accvgpr_write_b32 a28, 0
v_accvgpr_write_b32 a29, 0
v_accvgpr_write_b32 a30, 0
v_accvgpr_write_b32 a31, 0
v_accvgpr_write_b32 a32, 0
v_accvgpr_write_b32 a33, 0
v_accvgpr_write_b32 a34, 0
v_accvgpr_write_b32 a35, 0
v_accvgpr_write_b32 a36, 0
v_accvgpr_write_b32 a37, 0
v_accvgpr_write_b32 a38, 0
v_accvgpr_write_b32 a39, 0
v_accvgpr_write_b32 a40, 0
v_accvgpr_write_b32 a41, 0
v_accvgpr_write_b32 a42, 0
v_accvgpr_write_b32 a43, 0
v_accvgpr_write_b32 a44, 0
v_accvgpr_write_b32 a45, 0
v_accvgpr_write_b32 a46, 0
v_accvgpr_write_b32 a47, 0
v_accvgpr_write_b32 a48, 0
v_accvgpr_write_b32 a49, 0
v_accvgpr_write_b32 a50, 0
v_accvgpr_write_b32 a51, 0
v_accvgpr_write_b32 a52, 0
v_accvgpr_write_b32 a53, 0
v_accvgpr_write_b32 a54, 0
v_accvgpr_write_b32 a55, 0
v_accvgpr_write_b32 a56, 0
v_accvgpr_write_b32 a57, 0
v_accvgpr_write_b32 a58, 0
v_accvgpr_write_b32 a59, 0
v_accvgpr_write_b32 a60, 0
v_accvgpr_write_b32 a61, 0
v_accvgpr_write_b32 a62, 0
v_accvgpr_write_b32 a63, 0
v_accvgpr_write_b32 a64, 0
v_accvgpr_write_b32 a65, 0
v_accvgpr_write_b32 a66, 0
v_accvgpr_write_b32 a67, 0
v_accvgpr_write_b32 a68, 0
v_accvgpr_write_b32 a69, 0
v_accvgpr_write_b32 a70, 0
v_accvgpr_write_b32 a71, 0
v_accvgpr_write_b32 a72, 0
v_accvgpr_write_b32 a73, 0
v_accvgpr_write_b32 a74, 0
v_accvgpr_write_b32 a75, 0
v_accvgpr_write_b32 a76, 0
v_accvgpr_write_b32 a77, 0
v_accvgpr_write_b32 a78, 0
v_accvgpr_write_b32 a79, 0
v_accvgpr_write_b32 a80, 0
v_accvgpr_write_b32 a81, 0
v_accvgpr_write_b32 a82, 0
v_accvgpr_write_b32 a83, 0
v_accvgpr_write_b32 a84, 0
v_accvgpr_write_b32 a85, 0
v_accvgpr_write_b32 a86, 0
v_accvgpr_write_b32 a87, 0
v_accvgpr_write_b32 a88, 0
v_accvgpr_write_b32 a89, 0
v_accvgpr_write_b32 a90, 0
v_accvgpr_write_b32 a91, 0
v_accvgpr_write_b32 a92, 0
v_accvgpr_write_b32 a93, 0
v_accvgpr_write_b32 a94, 0
v_accvgpr_write_b32 a95, 0
v_accvgpr_write_b32 a96, 0
v_accvgpr_write_b32 a97, 0
v_accvgpr_write_b32 a98, 0
v_accvgpr_write_b32 a99, 0
v_accvgpr_write_b32 a100, 0
v_accvgpr_write_b32 a101, 0
v_accvgpr_write_b32 a102, 0
v_accvgpr_write_b32 a103, 0
v_accvgpr_write_b32 a104, 0
v_accvgpr_write_b32 a105, 0
v_accvgpr_write_b32 a106, 0
v_accvgpr_write_b32 a107, 0
v_accvgpr_write_b32 a108, 0
v_accvgpr_write_b32 a109, 0
v_accvgpr_write_b32 a110, 0
v_accvgpr_write_b32 a111, 0
v_accvgpr_write_b32 a112, 0
v_accvgpr_write_b32 a113, 0
v_accvgpr_write_b32 a114, 0
v_accvgpr_write_b32 a115, 0
v_accvgpr_write_b32 a116, 0
v_accvgpr_write_b32 a117, 0
v_accvgpr_write_b32 a118, 0
v_accvgpr_write_b32 a119, 0
v_accvgpr_write_b32 a120, 0
v_accvgpr_write_b32 a121, 0
v_accvgpr_write_b32 a122, 0
v_accvgpr_write_b32 a123, 0
v_accvgpr_write_b32 a124, 0
v_accvgpr_write_b32 a125, 0
v_accvgpr_write_b32 a126, 0
v_accvgpr_write_b32 a127, 0
v_accvgpr_write_b32 a128, 0
v_accvgpr_write_b32 a129, 0
v_accvgpr_write_b32 a130, 0
v_accvgpr_write_b32 a131, 0
v_accvgpr_write_b32 a132, 0
v_accvgpr_write_b32 a133, 0
v_accvgpr_write_b32 a134, 0
v_accvgpr_write_b32 a135, 0
v_accvgpr_write_b32 a136, 0
v_accvgpr_write_b32 a137, 0
v_accvgpr_write_b32 a138, 0
v_accvgpr_write_b32 a139, 0
v_accvgpr_write_b32 a140, 0
v_accvgpr_write_b32 a141, 0
v_accvgpr_write_b32 a142, 0
v_accvgpr_write_b32 a143, 0
v_accvgpr_write_b32 a144, 0
v_accvgpr_write_b32 a145, 0
v_accvgpr_write_b32 a146, 0
v_accvgpr_write_b32 a147, 0
v_accvgpr_write_b32 a148, 0
v_accvgpr_write_b32 a149, 0
v_accvgpr_write_b32 a150, 0
v_accvgpr_write_b32 a151, 0
v_accvgpr_write_b32 a152, 0
v_accvgpr_write_b32 a153, 0
v_accvgpr_write_b32 a154, 0
v_accvgpr_write_b32 a155, 0
v_accvgpr_write_b32 a156, 0
v_accvgpr_write_b32 a157, 0
v_accvgpr_write_b32 a158, 0
v_accvgpr_write_b32 a159, 0
v_accvgpr_write_b32 a212, 0
v_accvgpr_write_b32 a213, 0
v_accvgpr_write_b32 a214, 0
v_accvgpr_write_b32 a215, 0
v_accvgpr_write_b32 a216, 0
v_accvgpr_write_b32 a217, 0
v_accvgpr_write_b32 a218, 0
v_accvgpr_write_b32 a219, 0
v_accvgpr_write_b32 a220, 0
v_accvgpr_write_b32 a221, 0
v_accvgpr_write_b32 a222, 0
v_accvgpr_write_b32 a223, 0
v_accvgpr_write_b32 a224, 0
v_accvgpr_write_b32 a225, 0
v_accvgpr_write_b32 a226, 0
v_accvgpr_write_b32 a227, 0
v_accvgpr_write_b32 a228, 0
v_accvgpr_write_b32 a229, 0
v_accvgpr_write_b32 a230, 0
v_accvgpr_write_b32 a231, 0
s_mov_b32 s39, s38
s_mov_b32 s40, 32
Lsl_pv:
buffer_load_dwordx4 a[180:183], v15, s[8:11], s39 offen offset:0
buffer_load_dwordx4 a[184:187], v15, s[8:11], s39 offen offset:32
buffer_load_dwordx4 a[188:191], v15, s[8:11], s39 offen offset:128
buffer_load_dwordx4 a[192:195], v15, s[8:11], s39 offen offset:160
s_add_u32 m0, s21, 98304
s_nop 0
buffer_load_dwordx4 v12, s[12:15], s39 offen offset:0 lds
buffer_load_dwordx4 v13, s[12:15], s39 offen offset:1024 lds
buffer_load_dwordx4 v12, s[12:15], s39 offen offset:2048 lds
buffer_load_dwordx4 v13, s[12:15], s39 offen offset:3072 lds
s_add_u32 s39, s39, 4096
buffer_load_dwordx4 a[196:199], v15, s[8:11], s39 offen offset:0
buffer_load_dwordx4 a[200:203], v15, s[8:11], s39 offen offset:32
buffer_load_dwordx4 a[204:207], v15, s[8:11], s39 offen offset:128
buffer_load_dwordx4 a[208:211], v15, s[8:11], s39 offen offset:160
s_add_u32 m0, s21, 114688
s_nop 0
buffer_load_dwordx4 v12, s[12:15], s39 offen offset:0 lds
buffer_load_dwordx4 v13, s[12:15], s39 offen offset:1024 lds
buffer_load_dwordx4 v12, s[12:15], s39 offen offset:2048 lds
buffer_load_dwordx4 v13, s[12:15], s39 offen offset:3072 lds
s_add_u32 s39, s39, 4096
s_waitcnt vmcnt(0) lgkmcnt(0)
ds_read_b64_tr_b16 v[176:177], v4 offset:0
ds_read_b64_tr_b16 v[178:179], v4 offset:16384
ds_read_b64_tr_b16 v[180:181], v5 offset:0
ds_read_b64_tr_b16 v[182:183], v5 offset:16384
ds_read_b64_tr_b16 v[184:185], v6 offset:0
ds_read_b64_tr_b16 v[186:187], v6 offset:16384
ds_read_b64_tr_b16 v[188:189], v7 offset:0
ds_read_b64_tr_b16 v[190:191], v7 offset:16384
s_waitcnt vmcnt(0) lgkmcnt(0)
ds_read_b64_tr_b16 v[192:193], v8 offset:0
ds_read_b64_tr_b16 v[194:195], v8 offset:16384
ds_read_b64_tr_b16 v[196:197], v9 offset:0
ds_read_b64_tr_b16 v[198:199], v9 offset:16384
ds_read_b64_tr_b16 v[200:201], v10 offset:0
ds_read_b64_tr_b16 v[202:203], v10 offset:16384
ds_read_b64_tr_b16 v[204:205], v11 offset:0
ds_read_b64_tr_b16 v[206:207], v11 offset:16384
v_mfma_f32_16x16x32_bf16 v[16:19], a[180:183], v[56:59], 0
pw 16,184,60
pw 16,188,64
pw 16,192,68
v_mfma_f32_16x16x32_bf16 v[20:23], a[192:195], v[84:87], 0
pw 20,188,80
pw 20,184,76
pw 20,180,72
v_mfma_f32_16x16x32_bf16 v[24:27], a[180:183], v[88:91], 0
pw 24,184,92
pw 24,188,96
pw 24,192,100
v_mfma_f32_16x16x32_bf16 v[28:31], a[192:195], v[116:119], 0
pw 28,188,112
pw 28,184,108
pw 28,180,104
v_mfma_f32_16x16x32_bf16 v[32:35], a[180:183], v[120:123], 0
pw 32,184,124
pw 32,188,128
pw 32,192,132
v_sub_f32 v16, v16, v224
v_sub_f32 v17, v17, v224
v_sub_f32 v18, v18, v224
v_sub_f32 v19, v19, v224
ex 16
ex 17
s_nop 0
cv 136,16,17
ex 18
ex 19
s_nop 0
cv 137,18,19
v_sub_f32 v20, v20, v225
v_sub_f32 v21, v21, v225
v_sub_f32 v22, v22, v225
v_sub_f32 v23, v23, v225
ex 20
ex 21
s_nop 0
cv 144,20,21
ex 22
ex 23
s_nop 0
cv 145,22,23
v_sub_f32 v24, v24, v226
v_sub_f32 v25, v25, v226
v_sub_f32 v26, v26, v226
v_sub_f32 v27, v27, v226
ex 24
ex 25
s_nop 0
cv 152,24,25
ex 26
ex 27
s_nop 0
cv 153,26,27
v_sub_f32 v28, v28, v227
v_sub_f32 v29, v29, v227
v_sub_f32 v30, v30, v227
v_sub_f32 v31, v31, v227
ex 28
ex 29
s_nop 0
cv 160,28,29
ex 30
ex 31
s_nop 0
cv 161,30,31
v_sub_f32 v32, v32, v228
v_sub_f32 v33, v33, v228
v_sub_f32 v34, v34, v228
v_sub_f32 v35, v35, v228
ex 32
ex 33
s_nop 0
cv 168,32,33
ex 34
ex 35
s_nop 0
cv 169,34,35
v_mfma_f32_16x16x32_bf16 v[16:19], a[196:199], v[56:59], 0
pw 16,200,60
pw 16,204,64
pw 16,208,68
v_mfma_f32_16x16x32_bf16 v[20:23], a[208:211], v[84:87], 0
pw 20,204,80
pw 20,200,76
pw 20,196,72
v_mfma_f32_16x16x32_bf16 v[24:27], a[196:199], v[88:91], 0
pw 24,200,92
pw 24,204,96
pw 24,208,100
v_mfma_f32_16x16x32_bf16 v[28:31], a[208:211], v[116:119], 0
pw 28,204,112
pw 28,200,108
pw 28,196,104
v_mfma_f32_16x16x32_bf16 v[32:35], a[196:199], v[120:123], 0
pw 32,200,124
pw 32,204,128
pw 32,208,132
v_sub_f32 v16, v16, v224
v_sub_f32 v17, v17, v224
v_sub_f32 v18, v18, v224
v_sub_f32 v19, v19, v224
ex 16
ex 17
s_nop 0
cv 138,16,17
ex 18
ex 19
s_nop 0
cv 139,18,19
v_sub_f32 v20, v20, v225
v_sub_f32 v21, v21, v225
v_sub_f32 v22, v22, v225
v_sub_f32 v23, v23, v225
ex 20
ex 21
s_nop 0
cv 146,20,21
ex 22
ex 23
s_nop 0
cv 147,22,23
v_sub_f32 v24, v24, v226
v_sub_f32 v25, v25, v226
v_sub_f32 v26, v26, v226
v_sub_f32 v27, v27, v226
ex 24
ex 25
s_nop 0
cv 154,24,25
ex 26
ex 27
s_nop 0
cv 155,26,27
v_sub_f32 v28, v28, v227
v_sub_f32 v29, v29, v227
v_sub_f32 v30, v30, v227
v_sub_f32 v31, v31, v227
ex 28
ex 29
s_nop 0
cv 162,28,29
ex 30
ex 31
s_nop 0
cv 163,30,31
v_sub_f32 v32, v32, v228
v_sub_f32 v33, v33, v228
v_sub_f32 v34, v34, v228
v_sub_f32 v35, v35, v228
ex 32
ex 33
s_nop 0
cv 170,32,33
ex 34
ex 35
s_nop 0
cv 171,34,35
s_waitcnt vmcnt(0) lgkmcnt(0)
pv 212,172,136
v_mfma_f32_16x16x32_bf16 a[0:3], v[176:179], v[136:139], a[0:3]
v_mfma_f32_16x16x32_bf16 a[4:7], v[180:183], v[136:139], a[4:7]
v_mfma_f32_16x16x32_bf16 a[8:11], v[184:187], v[136:139], a[8:11]
v_mfma_f32_16x16x32_bf16 a[12:15], v[188:191], v[136:139], a[12:15]
v_mfma_f32_16x16x32_bf16 a[16:19], v[192:195], v[136:139], a[16:19]
v_mfma_f32_16x16x32_bf16 a[20:23], v[196:199], v[136:139], a[20:23]
v_mfma_f32_16x16x32_bf16 a[24:27], v[200:203], v[136:139], a[24:27]
v_mfma_f32_16x16x32_bf16 a[28:31], v[204:207], v[136:139], a[28:31]
pv 216,172,144
v_mfma_f32_16x16x32_bf16 a[32:35], v[176:179], v[144:147], a[32:35]
v_mfma_f32_16x16x32_bf16 a[36:39], v[180:183], v[144:147], a[36:39]
v_mfma_f32_16x16x32_bf16 a[40:43], v[184:187], v[144:147], a[40:43]
v_mfma_f32_16x16x32_bf16 a[44:47], v[188:191], v[144:147], a[44:47]
v_mfma_f32_16x16x32_bf16 a[48:51], v[192:195], v[144:147], a[48:51]
v_mfma_f32_16x16x32_bf16 a[52:55], v[196:199], v[144:147], a[52:55]
v_mfma_f32_16x16x32_bf16 a[56:59], v[200:203], v[144:147], a[56:59]
v_mfma_f32_16x16x32_bf16 a[60:63], v[204:207], v[144:147], a[60:63]
pv 220,172,152
v_mfma_f32_16x16x32_bf16 a[64:67], v[176:179], v[152:155], a[64:67]
v_mfma_f32_16x16x32_bf16 a[68:71], v[180:183], v[152:155], a[68:71]
v_mfma_f32_16x16x32_bf16 a[72:75], v[184:187], v[152:155], a[72:75]
v_mfma_f32_16x16x32_bf16 a[76:79], v[188:191], v[152:155], a[76:79]
v_mfma_f32_16x16x32_bf16 a[80:83], v[192:195], v[152:155], a[80:83]
v_mfma_f32_16x16x32_bf16 a[84:87], v[196:199], v[152:155], a[84:87]
v_mfma_f32_16x16x32_bf16 a[88:91], v[200:203], v[152:155], a[88:91]
v_mfma_f32_16x16x32_bf16 a[92:95], v[204:207], v[152:155], a[92:95]
pv 224,172,160
v_mfma_f32_16x16x32_bf16 a[96:99], v[176:179], v[160:163], a[96:99]
v_mfma_f32_16x16x32_bf16 a[100:103], v[180:183], v[160:163], a[100:103]
v_mfma_f32_16x16x32_bf16 a[104:107], v[184:187], v[160:163], a[104:107]
v_mfma_f32_16x16x32_bf16 a[108:111], v[188:191], v[160:163], a[108:111]
v_mfma_f32_16x16x32_bf16 a[112:115], v[192:195], v[160:163], a[112:115]
v_mfma_f32_16x16x32_bf16 a[116:119], v[196:199], v[160:163], a[116:119]
v_mfma_f32_16x16x32_bf16 a[120:123], v[200:203], v[160:163], a[120:123]
v_mfma_f32_16x16x32_bf16 a[124:127], v[204:207], v[160:163], a[124:127]
pv 228,172,168
v_mfma_f32_16x16x32_bf16 a[128:131], v[176:179], v[168:171], a[128:131]
v_mfma_f32_16x16x32_bf16 a[132:135], v[180:183], v[168:171], a[132:135]
v_mfma_f32_16x16x32_bf16 a[136:139], v[184:187], v[168:171], a[136:139]
v_mfma_f32_16x16x32_bf16 a[140:143], v[188:191], v[168:171], a[140:143]
v_mfma_f32_16x16x32_bf16 a[144:147], v[192:195], v[168:171], a[144:147]
v_mfma_f32_16x16x32_bf16 a[148:151], v[196:199], v[168:171], a[148:151]
v_mfma_f32_16x16x32_bf16 a[152:155], v[200:203], v[168:171], a[152:155]
v_mfma_f32_16x16x32_bf16 a[156:159], v[204:207], v[168:171], a[156:159]
s_nop 11
s_sub_u32 s40, s40, 1
s_cmp_lg_u32 s40, 0
s_cbranch_scc1 Lsl_pv
v_accvgpr_read_b32 v216, a212
v_rcp_f32 v216, v216
s_add_u32 s41, s36, 0
v_accvgpr_read_b32 v232, a0
v_accvgpr_read_b32 v233, a1
v_accvgpr_read_b32 v234, a2
v_accvgpr_read_b32 v235, a3
v_accvgpr_read_b32 v236, a4
v_accvgpr_read_b32 v237, a5
v_accvgpr_read_b32 v238, a6
v_accvgpr_read_b32 v239, a7
v_mul_f32 v232, v232, v216
v_mul_f32 v233, v233, v216
v_mul_f32 v234, v234, v216
v_mul_f32 v235, v235, v216
v_mul_f32 v236, v236, v216
v_mul_f32 v237, v237, v216
v_mul_f32 v238, v238, v216
v_mul_f32 v239, v239, v216
cv 240,232,233
cv 241,234,235
cv 242,236,237
cv 243,238,239
s_nop 0
v_permlane16_swap_b32 v240, v242
v_permlane16_swap_b32 v241, v243
buffer_store_dwordx4 v[240:243], v230, s[16:19], s41 offen offset:0 sc0 sc1
v_accvgpr_read_b32 v232, a8
v_accvgpr_read_b32 v233, a9
v_accvgpr_read_b32 v234, a10
v_accvgpr_read_b32 v235, a11
v_accvgpr_read_b32 v236, a12
v_accvgpr_read_b32 v237, a13
v_accvgpr_read_b32 v238, a14
v_accvgpr_read_b32 v239, a15
v_mul_f32 v232, v232, v216
v_mul_f32 v233, v233, v216
v_mul_f32 v234, v234, v216
v_mul_f32 v235, v235, v216
v_mul_f32 v236, v236, v216
v_mul_f32 v237, v237, v216
v_mul_f32 v238, v238, v216
v_mul_f32 v239, v239, v216
cv 244,232,233
cv 245,234,235
cv 246,236,237
cv 247,238,239
s_nop 0
v_permlane16_swap_b32 v244, v246
v_permlane16_swap_b32 v245, v247
buffer_store_dwordx4 v[244:247], v230, s[16:19], s41 offen offset:64 sc0 sc1
v_accvgpr_read_b32 v232, a16
v_accvgpr_read_b32 v233, a17
v_accvgpr_read_b32 v234, a18
v_accvgpr_read_b32 v235, a19
v_accvgpr_read_b32 v236, a20
v_accvgpr_read_b32 v237, a21
v_accvgpr_read_b32 v238, a22
v_accvgpr_read_b32 v239, a23
v_mul_f32 v232, v232, v216
v_mul_f32 v233, v233, v216
v_mul_f32 v234, v234, v216
v_mul_f32 v235, v235, v216
v_mul_f32 v236, v236, v216
v_mul_f32 v237, v237, v216
v_mul_f32 v238, v238, v216
v_mul_f32 v239, v239, v216
cv 240,232,233
cv 241,234,235
cv 242,236,237
cv 243,238,239
s_nop 0
v_permlane16_swap_b32 v240, v242
v_permlane16_swap_b32 v241, v243
buffer_store_dwordx4 v[240:243], v230, s[16:19], s41 offen offset:128 sc0 sc1
v_accvgpr_read_b32 v232, a24
v_accvgpr_read_b32 v233, a25
v_accvgpr_read_b32 v234, a26
v_accvgpr_read_b32 v235, a27
v_accvgpr_read_b32 v236, a28
v_accvgpr_read_b32 v237, a29
v_accvgpr_read_b32 v238, a30
v_accvgpr_read_b32 v239, a31
v_mul_f32 v232, v232, v216
v_mul_f32 v233, v233, v216
v_mul_f32 v234, v234, v216
v_mul_f32 v235, v235, v216
v_mul_f32 v236, v236, v216
v_mul_f32 v237, v237, v216
v_mul_f32 v238, v238, v216
v_mul_f32 v239, v239, v216
cv 244,232,233
cv 245,234,235
cv 246,236,237
cv 247,238,239
s_nop 0
v_permlane16_swap_b32 v244, v246
v_permlane16_swap_b32 v245, v247
buffer_store_dwordx4 v[244:247], v230, s[16:19], s41 offen offset:192 sc0 sc1
v_accvgpr_read_b32 v216, a216
v_rcp_f32 v216, v216
s_add_u32 s41, s36, 4096
v_accvgpr_read_b32 v232, a32
v_accvgpr_read_b32 v233, a33
v_accvgpr_read_b32 v234, a34
v_accvgpr_read_b32 v235, a35
v_accvgpr_read_b32 v236, a36
v_accvgpr_read_b32 v237, a37
v_accvgpr_read_b32 v238, a38
v_accvgpr_read_b32 v239, a39
v_mul_f32 v232, v232, v216
v_mul_f32 v233, v233, v216
v_mul_f32 v234, v234, v216
v_mul_f32 v235, v235, v216
v_mul_f32 v236, v236, v216
v_mul_f32 v237, v237, v216
v_mul_f32 v238, v238, v216
v_mul_f32 v239, v239, v216
cv 240,232,233
cv 241,234,235
cv 242,236,237
cv 243,238,239
s_nop 0
v_permlane16_swap_b32 v240, v242
v_permlane16_swap_b32 v241, v243
buffer_store_dwordx4 v[240:243], v230, s[16:19], s41 offen offset:0 sc0 sc1
v_accvgpr_read_b32 v232, a40
v_accvgpr_read_b32 v233, a41
v_accvgpr_read_b32 v234, a42
v_accvgpr_read_b32 v235, a43
v_accvgpr_read_b32 v236, a44
v_accvgpr_read_b32 v237, a45
v_accvgpr_read_b32 v238, a46
v_accvgpr_read_b32 v239, a47
v_mul_f32 v232, v232, v216
v_mul_f32 v233, v233, v216
v_mul_f32 v234, v234, v216
v_mul_f32 v235, v235, v216
v_mul_f32 v236, v236, v216
v_mul_f32 v237, v237, v216
v_mul_f32 v238, v238, v216
v_mul_f32 v239, v239, v216
cv 244,232,233
cv 245,234,235
cv 246,236,237
cv 247,238,239
s_nop 0
v_permlane16_swap_b32 v244, v246
v_permlane16_swap_b32 v245, v247
buffer_store_dwordx4 v[244:247], v230, s[16:19], s41 offen offset:64 sc0 sc1
v_accvgpr_read_b32 v232, a48
v_accvgpr_read_b32 v233, a49
v_accvgpr_read_b32 v234, a50
v_accvgpr_read_b32 v235, a51
v_accvgpr_read_b32 v236, a52
v_accvgpr_read_b32 v237, a53
v_accvgpr_read_b32 v238, a54
v_accvgpr_read_b32 v239, a55
v_mul_f32 v232, v232, v216
v_mul_f32 v233, v233, v216
v_mul_f32 v234, v234, v216
v_mul_f32 v235, v235, v216
v_mul_f32 v236, v236, v216
v_mul_f32 v237, v237, v216
v_mul_f32 v238, v238, v216
v_mul_f32 v239, v239, v216
cv 240,232,233
cv 241,234,235
cv 242,236,237
cv 243,238,239
s_nop 0
v_permlane16_swap_b32 v240, v242
v_permlane16_swap_b32 v241, v243
buffer_store_dwordx4 v[240:243], v230, s[16:19], s41 offen offset:128 sc0 sc1
v_accvgpr_read_b32 v232, a56
v_accvgpr_read_b32 v233, a57
v_accvgpr_read_b32 v234, a58
v_accvgpr_read_b32 v235, a59
v_accvgpr_read_b32 v236, a60
v_accvgpr_read_b32 v237, a61
v_accvgpr_read_b32 v238, a62
v_accvgpr_read_b32 v239, a63
v_mul_f32 v232, v232, v216
v_mul_f32 v233, v233, v216
v_mul_f32 v234, v234, v216
v_mul_f32 v235, v235, v216
v_mul_f32 v236, v236, v216
v_mul_f32 v237, v237, v216
v_mul_f32 v238, v238, v216
v_mul_f32 v239, v239, v216
cv 244,232,233
cv 245,234,235
cv 246,236,237
cv 247,238,239
s_nop 0
v_permlane16_swap_b32 v244, v246
v_permlane16_swap_b32 v245, v247
buffer_store_dwordx4 v[244:247], v230, s[16:19], s41 offen offset:192 sc0 sc1
v_accvgpr_read_b32 v216, a220
v_rcp_f32 v216, v216
s_add_u32 s41, s36, 8192
v_accvgpr_read_b32 v232, a64
v_accvgpr_read_b32 v233, a65
v_accvgpr_read_b32 v234, a66
v_accvgpr_read_b32 v235, a67
v_accvgpr_read_b32 v236, a68
v_accvgpr_read_b32 v237, a69
v_accvgpr_read_b32 v238, a70
v_accvgpr_read_b32 v239, a71
v_mul_f32 v232, v232, v216
v_mul_f32 v233, v233, v216
v_mul_f32 v234, v234, v216
v_mul_f32 v235, v235, v216
v_mul_f32 v236, v236, v216
v_mul_f32 v237, v237, v216
v_mul_f32 v238, v238, v216
v_mul_f32 v239, v239, v216
cv 240,232,233
cv 241,234,235
cv 242,236,237
cv 243,238,239
s_nop 0
v_permlane16_swap_b32 v240, v242
v_permlane16_swap_b32 v241, v243
buffer_store_dwordx4 v[240:243], v230, s[16:19], s41 offen offset:0 sc0 sc1
v_accvgpr_read_b32 v232, a72
v_accvgpr_read_b32 v233, a73
v_accvgpr_read_b32 v234, a74
v_accvgpr_read_b32 v235, a75
v_accvgpr_read_b32 v236, a76
v_accvgpr_read_b32 v237, a77
v_accvgpr_read_b32 v238, a78
v_accvgpr_read_b32 v239, a79
v_mul_f32 v232, v232, v216
v_mul_f32 v233, v233, v216
v_mul_f32 v234, v234, v216
v_mul_f32 v235, v235, v216
v_mul_f32 v236, v236, v216
v_mul_f32 v237, v237, v216
v_mul_f32 v238, v238, v216
v_mul_f32 v239, v239, v216
cv 244,232,233
cv 245,234,235
cv 246,236,237
cv 247,238,239
s_nop 0
v_permlane16_swap_b32 v244, v246
v_permlane16_swap_b32 v245, v247
buffer_store_dwordx4 v[244:247], v230, s[16:19], s41 offen offset:64 sc0 sc1
v_accvgpr_read_b32 v232, a80
v_accvgpr_read_b32 v233, a81
v_accvgpr_read_b32 v234, a82
v_accvgpr_read_b32 v235, a83
v_accvgpr_read_b32 v236, a84
v_accvgpr_read_b32 v237, a85
v_accvgpr_read_b32 v238, a86
v_accvgpr_read_b32 v239, a87
v_mul_f32 v232, v232, v216
v_mul_f32 v233, v233, v216
v_mul_f32 v234, v234, v216
v_mul_f32 v235, v235, v216
v_mul_f32 v236, v236, v216
v_mul_f32 v237, v237, v216
v_mul_f32 v238, v238, v216
v_mul_f32 v239, v239, v216
cv 240,232,233
cv 241,234,235
cv 242,236,237
cv 243,238,239
s_nop 0
v_permlane16_swap_b32 v240, v242
v_permlane16_swap_b32 v241, v243
buffer_store_dwordx4 v[240:243], v230, s[16:19], s41 offen offset:128 sc0 sc1
v_accvgpr_read_b32 v232, a88
v_accvgpr_read_b32 v233, a89
v_accvgpr_read_b32 v234, a90
v_accvgpr_read_b32 v235, a91
v_accvgpr_read_b32 v236, a92
v_accvgpr_read_b32 v237, a93
v_accvgpr_read_b32 v238, a94
v_accvgpr_read_b32 v239, a95
v_mul_f32 v232, v232, v216
v_mul_f32 v233, v233, v216
v_mul_f32 v234, v234, v216
v_mul_f32 v235, v235, v216
v_mul_f32 v236, v236, v216
v_mul_f32 v237, v237, v216
v_mul_f32 v238, v238, v216
v_mul_f32 v239, v239, v216
cv 244,232,233
cv 245,234,235
cv 246,236,237
cv 247,238,239
s_nop 0
v_permlane16_swap_b32 v244, v246
v_permlane16_swap_b32 v245, v247
buffer_store_dwordx4 v[244:247], v230, s[16:19], s41 offen offset:192 sc0 sc1
v_accvgpr_read_b32 v216, a224
v_rcp_f32 v216, v216
s_add_u32 s41, s36, 12288
v_accvgpr_read_b32 v232, a96
v_accvgpr_read_b32 v233, a97
v_accvgpr_read_b32 v234, a98
v_accvgpr_read_b32 v235, a99
v_accvgpr_read_b32 v236, a100
v_accvgpr_read_b32 v237, a101
v_accvgpr_read_b32 v238, a102
v_accvgpr_read_b32 v239, a103
v_mul_f32 v232, v232, v216
v_mul_f32 v233, v233, v216
v_mul_f32 v234, v234, v216
v_mul_f32 v235, v235, v216
v_mul_f32 v236, v236, v216
v_mul_f32 v237, v237, v216
v_mul_f32 v238, v238, v216
v_mul_f32 v239, v239, v216
cv 240,232,233
cv 241,234,235
cv 242,236,237
cv 243,238,239
s_nop 0
v_permlane16_swap_b32 v240, v242
v_permlane16_swap_b32 v241, v243
buffer_store_dwordx4 v[240:243], v230, s[16:19], s41 offen offset:0 sc0 sc1
v_accvgpr_read_b32 v232, a104
v_accvgpr_read_b32 v233, a105
v_accvgpr_read_b32 v234, a106
v_accvgpr_read_b32 v235, a107
v_accvgpr_read_b32 v236, a108
v_accvgpr_read_b32 v237, a109
v_accvgpr_read_b32 v238, a110
v_accvgpr_read_b32 v239, a111
v_mul_f32 v232, v232, v216
v_mul_f32 v233, v233, v216
v_mul_f32 v234, v234, v216
v_mul_f32 v235, v235, v216
v_mul_f32 v236, v236, v216
v_mul_f32 v237, v237, v216
v_mul_f32 v238, v238, v216
v_mul_f32 v239, v239, v216
cv 244,232,233
cv 245,234,235
cv 246,236,237
cv 247,238,239
s_nop 0
v_permlane16_swap_b32 v244, v246
v_permlane16_swap_b32 v245, v247
buffer_store_dwordx4 v[244:247], v230, s[16:19], s41 offen offset:64 sc0 sc1
v_accvgpr_read_b32 v232, a112
v_accvgpr_read_b32 v233, a113
v_accvgpr_read_b32 v234, a114
v_accvgpr_read_b32 v235, a115
v_accvgpr_read_b32 v236, a116
v_accvgpr_read_b32 v237, a117
v_accvgpr_read_b32 v238, a118
v_accvgpr_read_b32 v239, a119
v_mul_f32 v232, v232, v216
v_mul_f32 v233, v233, v216
v_mul_f32 v234, v234, v216
v_mul_f32 v235, v235, v216
v_mul_f32 v236, v236, v216
v_mul_f32 v237, v237, v216
v_mul_f32 v238, v238, v216
v_mul_f32 v239, v239, v216
cv 240,232,233
cv 241,234,235
cv 242,236,237
cv 243,238,239
s_nop 0
v_permlane16_swap_b32 v240, v242
v_permlane16_swap_b32 v241, v243
buffer_store_dwordx4 v[240:243], v230, s[16:19], s41 offen offset:128 sc0 sc1
v_accvgpr_read_b32 v232, a120
v_accvgpr_read_b32 v233, a121
v_accvgpr_read_b32 v234, a122
v_accvgpr_read_b32 v235, a123
v_accvgpr_read_b32 v236, a124
v_accvgpr_read_b32 v237, a125
v_accvgpr_read_b32 v238, a126
v_accvgpr_read_b32 v239, a127
v_mul_f32 v232, v232, v216
v_mul_f32 v233, v233, v216
v_mul_f32 v234, v234, v216
v_mul_f32 v235, v235, v216
v_mul_f32 v236, v236, v216
v_mul_f32 v237, v237, v216
v_mul_f32 v238, v238, v216
v_mul_f32 v239, v239, v216
cv 244,232,233
cv 245,234,235
cv 246,236,237
cv 247,238,239
s_nop 0
v_permlane16_swap_b32 v244, v246
v_permlane16_swap_b32 v245, v247
buffer_store_dwordx4 v[244:247], v230, s[16:19], s41 offen offset:192 sc0 sc1
v_accvgpr_read_b32 v216, a228
v_rcp_f32 v216, v216
s_mov_b32 s41, s37
v_accvgpr_read_b32 v232, a128
v_accvgpr_read_b32 v233, a129
v_accvgpr_read_b32 v234, a130
v_accvgpr_read_b32 v235, a131
v_accvgpr_read_b32 v236, a132
v_accvgpr_read_b32 v237, a133
v_accvgpr_read_b32 v238, a134
v_accvgpr_read_b32 v239, a135
v_mul_f32 v232, v232, v216
v_mul_f32 v233, v233, v216
v_mul_f32 v234, v234, v216
v_mul_f32 v235, v235, v216
v_mul_f32 v236, v236, v216
v_mul_f32 v237, v237, v216
v_mul_f32 v238, v238, v216
v_mul_f32 v239, v239, v216
cv 240,232,233
cv 241,234,235
cv 242,236,237
cv 243,238,239
s_nop 0
v_permlane16_swap_b32 v240, v242
v_permlane16_swap_b32 v241, v243
buffer_store_dwordx4 v[240:243], v230, s[16:19], s41 offen offset:0 sc0 sc1
v_accvgpr_read_b32 v232, a136
v_accvgpr_read_b32 v233, a137
v_accvgpr_read_b32 v234, a138
v_accvgpr_read_b32 v235, a139
v_accvgpr_read_b32 v236, a140
v_accvgpr_read_b32 v237, a141
v_accvgpr_read_b32 v238, a142
v_accvgpr_read_b32 v239, a143
v_mul_f32 v232, v232, v216
v_mul_f32 v233, v233, v216
v_mul_f32 v234, v234, v216
v_mul_f32 v235, v235, v216
v_mul_f32 v236, v236, v216
v_mul_f32 v237, v237, v216
v_mul_f32 v238, v238, v216
v_mul_f32 v239, v239, v216
cv 244,232,233
cv 245,234,235
cv 246,236,237
cv 247,238,239
s_nop 0
v_permlane16_swap_b32 v244, v246
v_permlane16_swap_b32 v245, v247
buffer_store_dwordx4 v[244:247], v230, s[16:19], s41 offen offset:64 sc0 sc1
v_accvgpr_read_b32 v232, a144
v_accvgpr_read_b32 v233, a145
v_accvgpr_read_b32 v234, a146
v_accvgpr_read_b32 v235, a147
v_accvgpr_read_b32 v236, a148
v_accvgpr_read_b32 v237, a149
v_accvgpr_read_b32 v238, a150
v_accvgpr_read_b32 v239, a151
v_mul_f32 v232, v232, v216
v_mul_f32 v233, v233, v216
v_mul_f32 v234, v234, v216
v_mul_f32 v235, v235, v216
v_mul_f32 v236, v236, v216
v_mul_f32 v237, v237, v216
v_mul_f32 v238, v238, v216
v_mul_f32 v239, v239, v216
cv 240,232,233
cv 241,234,235
cv 242,236,237
cv 243,238,239
s_nop 0
v_permlane16_swap_b32 v240, v242
v_permlane16_swap_b32 v241, v243
buffer_store_dwordx4 v[240:243], v230, s[16:19], s41 offen offset:128 sc0 sc1
v_accvgpr_read_b32 v232, a152
v_accvgpr_read_b32 v233, a153
v_accvgpr_read_b32 v234, a154
v_accvgpr_read_b32 v235, a155
v_accvgpr_read_b32 v236, a156
v_accvgpr_read_b32 v237, a157
v_accvgpr_read_b32 v238, a158
v_accvgpr_read_b32 v239, a159
v_mul_f32 v232, v232, v216
v_mul_f32 v233, v233, v216
v_mul_f32 v234, v234, v216
v_mul_f32 v235, v235, v216
v_mul_f32 v236, v236, v216
v_mul_f32 v237, v237, v216
v_mul_f32 v238, v238, v216
v_mul_f32 v239, v239, v216
cv 244,232,233
cv 245,234,235
cv 246,236,237
cv 247,238,239
s_nop 0
v_permlane16_swap_b32 v244, v246
v_permlane16_swap_b32 v245, v247
buffer_store_dwordx4 v[244:247], v230, s[16:19], s41 offen offset:192 sc0 sc1
s_waitcnt vmcnt(0) lgkmcnt(0)
Lsl_next:
s_nop 11
s_mov_b64 s[30:31], s[32:33]
s_mov_b32 s24, s26
s_mov_b32 s25, s27
s_add_u32 s42, s42, 1
s_cmp_lt_u32 s42, 2
s_cbranch_scc1 Lsl_pass
s_endpgm
.p2align 12
LroleY:
s_mov_b64 vcc, -1
s_cmp_eq_u32 s21, 0
s_cbranch_scc1 LwY0_0
s_cmp_eq_u32 s21, 4096
s_cbranch_scc1 LwY0_1
s_cmp_eq_u32 s21, 8192
s_cbranch_scc1 LwY0_2
s_branch LwY0_3
LwrY0:
s_mov_b64 vcc, 0
s_xor_b32 s2, s3, 128
v_xor_b32 v0, s34, v0
v_xor_b32 v1, s34, v1
v_xor_b32 v2, s34, v2
v_xor_b32 v3, s34, v3
v_xor_b32 v4, s35, v4
v_xor_b32 v5, s35, v5
v_xor_b32 v6, s35, v6
v_xor_b32 v7, s35, v7
v_xor_b32 v8, s35, v8
v_xor_b32 v9, s35, v9
v_xor_b32 v10, s35, v10
v_xor_b32 v11, s35, v11
v_xor_b32 v172, 0x2000, v4
v_xor_b32 v173, 0x2000, v5
v_xor_b32 v174, 0x2000, v6
v_xor_b32 v175, 0x2000, v7
v_xor_b32 v212, 0x2000, v8
v_xor_b32 v213, 0x2000, v9
v_xor_b32 v214, 0x2000, v10
v_xor_b32 v215, 0x2000, v11
s_waitcnt vmcnt(8) lgkmcnt(0)
s_add_u32 s37, s24, 8192
s_add_u32 m0, s21, 131072
s_add_u32 s38, s24, 12288
buffer_load_dwordx4 v12, s[4:7], s37 offen offset:0 nt lds
buffer_load_dwordx4 v13, s[4:7], s37 offen offset:1024 nt lds
buffer_load_dwordx4 v12, s[4:7], s37 offen offset:2048 nt lds
buffer_load_dwordx4 v13, s[4:7], s37 offen offset:3072 nt lds
s_barrier
lk 96,0,0
lk 100,1,0
lk 104,2,0
lk 108,3,0
lk 112,0,4096
lk 116,1,4096
lk 120,2,4096
lk 124,3,4096
v_xor_b32 v0, 0x2000, v0
v_xor_b32 v1, 0x2000, v1
v_xor_b32 v2, 0x2000, v2
v_xor_b32 v3, 0x2000, v3
lk 128,0,0
lk 132,1,0
lk 136,2,0
lk 140,3,0
lk 144,0,4096
lk 148,1,4096
lk 152,2,4096
s_waitcnt lgkmcnt(12)
lk 156,3,4096
s_add_u32 m0, s21, 81920
s_mov_b32 s39, s25
s_add_u32 s20, s20, 16384
lk 244,0,16384
ds_read_b128 v[220:223], v0 offset:20480
v_xor_b32 v0, 0x2000, v0
s_waitcnt lgkmcnt(10)
lk 248,1,16384
ds_read_b128 v[224:227], v1 offset:20480
lk 212,0,16384
v_xor_b32 v1, 0x2000, v1
lk 252,2,16384
ds_read_b128 v[228:231], v2 offset:20480
s_waitcnt lgkmcnt(11)
lk 216,1,16384
v_xor_b32 v2, 0x2000, v2
ds_read_b128 v[216:219], v3 offset:16384
s_waitcnt vmcnt(8)
ds_read_b128 v[56:59], v236 offset:49152
ds_read_b128 v[60:63], v237 offset:49152
s_waitcnt lgkmcnt(11)
ds_read_b128 v[64:67], v238 offset:49152
ds_read_b128 v[68:71], v239 offset:49152
buffer_load_dwordx4 v12, s[4:7], s38 offen offset:0 nt lds
buffer_load_dwordx4 v13, s[4:7], s38 offen offset:1024 nt lds
buffer_load_dwordx4 v12, s[4:7], s38 offen offset:2048 nt lds
buffer_load_dwordx4 v13, s[4:7], s38 offen offset:3072 nt lds
s_add_u32 m0, s21, 16384
ds_read_b128 v[232:235], v3 offset:20480
lk 220,2,16384
v_xor_b32 v3, 0x2000, v3
s_waitcnt lgkmcnt(8)
lk 224,3,16384
lk 228,0,20480
lk 232,1,20480
s_waitcnt lgkmcnt(8)
v_lshlrev_b32 v244, 16, v56
v_and_b32 v245, s28, v56
v_lshlrev_b32 v246, 16, v57
v_and_b32 v247, s28, v57
v_lshlrev_b32 v248, 16, v58
v_and_b32 v249, s28, v58
v_lshlrev_b32 v250, 16, v59
v_and_b32 v251, s28, v59
v_pk_mul_f32 v[244:245], v[244:245], s[22:23]
v_pk_mul_f32 v[246:247], v[246:247], s[22:23]
v_pk_mul_f32 v[248:249], v[248:249], s[22:23]
v_pk_mul_f32 v[250:251], v[250:251], s[22:23]
cv 56,244,245
cv 57,246,247
cv 58,248,249
cv 59,250,251
s_waitcnt lgkmcnt(5)
v_lshlrev_b32 v244, 16, v60
v_and_b32 v245, s28, v60
v_lshlrev_b32 v246, 16, v61
v_and_b32 v247, s28, v61
v_lshlrev_b32 v248, 16, v62
v_and_b32 v249, s28, v62
v_lshlrev_b32 v250, 16, v63
v_and_b32 v251, s28, v63
v_pk_mul_f32 v[244:245], v[244:245], s[22:23]
v_pk_mul_f32 v[246:247], v[246:247], s[22:23]
v_pk_mul_f32 v[248:249], v[248:249], s[22:23]
v_pk_mul_f32 v[250:251], v[250:251], s[22:23]
cv 60,244,245
cv 61,246,247
cv 62,248,249
cv 63,250,251
v_lshlrev_b32 v244, 16, v64
v_and_b32 v245, s28, v64
v_lshlrev_b32 v246, 16, v65
v_and_b32 v247, s28, v65
v_lshlrev_b32 v248, 16, v66
v_and_b32 v249, s28, v66
v_lshlrev_b32 v250, 16, v67
v_and_b32 v251, s28, v67
v_mfma_f32_16x16x32_bf16 v[16:19], a[96:99], v[56:59], 0
s_add_u32 s36, s26, 0
lk 236,2,20480
v_mul_f32 v244, s22, v244
v_mul_f32 v245, s22, v245
cv 64,244,245
v_lshlrev_b32 v244, 16, v68
v_pk_mul_f32 v[246:247], v[246:247], s[22:23]
v_pk_mul_f32 v[248:249], v[248:249], s[22:23]
v_pk_mul_f32 v[250:251], v[250:251], s[22:23]
cv 65,246,247
cv 66,248,249
cv 67,250,251
pw 16,100,60
s_add_u32 s37, s26, 0
lk 240,3,20480
v_and_b32 v245, s28, v68
v_lshlrev_b32 v246, 16, v69
v_and_b32 v247, s28, v69
v_lshlrev_b32 v248, 16, v70
v_and_b32 v249, s28, v70
v_lshlrev_b32 v250, 16, v71
v_and_b32 v251, s28, v71
v_pk_mul_f32 v[244:245], v[244:245], s[22:23]
v_pk_mul_f32 v[246:247], v[246:247], s[22:23]
v_pk_mul_f32 v[248:249], v[248:249], s[22:23]
v_pk_mul_f32 v[250:251], v[250:251], s[22:23]
cv 68,244,245
cv 69,246,247
pw 16,104,64
s_add_u32 s38, s26, 0
cv 70,248,249
cv 71,250,251
v_mov_b32 v255, 1
s_nop 0
pw 16,108,68
s_nop 7
v_max3_f32 v252, v16, v17, v18
v_max_f32 v252, v252, v19
v_add_f32 v252, 0x41200000, v252
v_mov_b32 v253, v252
s_nop 1
v_permlane16_swap_b32 v252, v253
v_max_f32 v252, v252, v253
v_mov_b32 v253, v252
s_nop 1
v_permlane32_swap_b32 v252, v253
v_min_f32 v36, -v252, -v253
v_min_f32 v37, -v252, -v253
v_min_f32 v38, -v252, -v253
v_min_f32 v39, -v252, -v253
v_add_f32 v16, v16, v36
v_add_f32 v17, v17, v36
qa 20,112,56,36
v_add_f32 v18, v18, v36
v_add_f32 v19, v19, v36
pw 20,116,60
ex 16
pw 20,120,64
ex 17
pw 20,124,68
ex 18
qa 24,128,56,36
ex 19
pw 24,132,60
cv 136,16,17
cv 137,18,19
pw 24,136,64
pw 24,140,68
ex 20
qa 28,144,56,36
ex 21
pw 28,148,60
ex 22
pw 28,152,64
ex 23
pw 28,156,68
cv 138,20,21
cv 139,22,23
qa 32,212,56,36
ex 24
pw 32,216,60
s_waitcnt lgkmcnt(0)
ex 25
pw 32,220,64
ex 26
pw 32,224,68
ex 27
qa 16,228,56,36
cv 140,24,25
cv 141,26,27
pw 16,232,60
ex 28
pw 16,236,64
ex 29
pw 16,240,68
ex 30
qa 20,244,56,36
ex 31
pw 20,248,60
cv 142,28,29
cv 143,30,31
pw 20,252,64
ex 32
v_mfma_f32_16x16x32_bf16 v[20:23], v[216:219], v[68:71], v[20:23]
ex 33
v_mfma_f32_16x16x32_bf16 v[24:27], v[220:223], v[56:59], v[36:39]
ex 34
v_mfma_f32_16x16x32_bf16 v[24:27], v[224:227], v[60:63], v[24:27]
ex 35
v_mfma_f32_16x16x32_bf16 v[24:27], v[228:231], v[64:67], v[24:27]
cv 176,32,33
cv 177,34,35
v_mfma_f32_16x16x32_bf16 v[24:27], v[232:235], v[68:71], v[24:27]
ex 16
ex 17
ex 18
ex 19
s_waitcnt vmcnt(8)
ds_read_b128 v[72:75], v240 offset:32768
ds_read_b128 v[76:79], v241 offset:32768
ds_read_b128 v[80:83], v242 offset:32768
ds_read_b128 v[84:87], v243 offset:32768
buffer_load_dwordx4 v12, s[4:7], s39 offen offset:0 nt lds
buffer_load_dwordx4 v13, s[4:7], s39 offen offset:1024 nt lds
buffer_load_dwordx4 v12, s[4:7], s39 offen offset:2048 nt lds
buffer_load_dwordx4 v13, s[4:7], s39 offen offset:3072 nt lds
s_add_u32 m0, s21, 98304
cv 178,16,17
cv 179,18,19
ex 20
ex 21
ex 22
ex 23
s_waitcnt lgkmcnt(3)
v_lshlrev_b32 v244, 16, v72
v_and_b32 v245, s28, v72
v_lshlrev_b32 v246, 16, v73
v_and_b32 v247, s28, v73
v_lshlrev_b32 v248, 16, v74
v_and_b32 v249, s28, v74
v_lshlrev_b32 v250, 16, v75
v_and_b32 v251, s28, v75
v_pk_mul_f32 v[244:245], v[244:245], s[22:23]
v_pk_mul_f32 v[246:247], v[246:247], s[22:23]
v_pk_mul_f32 v[248:249], v[248:249], s[22:23]
v_pk_mul_f32 v[250:251], v[250:251], s[22:23]
cv 72,244,245
cv 73,246,247
cv 74,248,249
cv 75,250,251
s_waitcnt lgkmcnt(0)
v_lshlrev_b32 v244, 16, v76
v_and_b32 v245, s28, v76
v_lshlrev_b32 v246, 16, v77
v_and_b32 v247, s28, v77
v_lshlrev_b32 v248, 16, v78
v_and_b32 v249, s28, v78
v_lshlrev_b32 v250, 16, v79
v_and_b32 v251, s28, v79
v_pk_mul_f32 v[244:245], v[244:245], s[22:23]
v_pk_mul_f32 v[246:247], v[246:247], s[22:23]
v_pk_mul_f32 v[248:249], v[248:249], s[22:23]
v_pk_mul_f32 v[250:251], v[250:251], s[22:23]
cv 76,244,245
cv 77,246,247
cv 78,248,249
cv 79,250,251
v_lshlrev_b32 v244, 16, v80
v_and_b32 v245, s28, v80
v_lshlrev_b32 v246, 16, v81
v_and_b32 v247, s28, v81
v_lshlrev_b32 v248, 16, v82
v_and_b32 v249, s28, v82
v_lshlrev_b32 v250, 16, v83
v_and_b32 v251, s28, v83
v_pk_mul_f32 v[244:245], v[244:245], s[22:23]
v_pk_mul_f32 v[246:247], v[246:247], s[22:23]
v_pk_mul_f32 v[248:249], v[248:249], s[22:23]
v_pk_mul_f32 v[250:251], v[250:251], s[22:23]
cv 80,244,245
cv 81,246,247
cv 82,248,249
cv 83,250,251
v_lshlrev_b32 v244, 16, v84
v_and_b32 v245, s28, v84
v_lshlrev_b32 v246, 16, v85
v_and_b32 v247, s28, v85
v_lshlrev_b32 v248, 16, v86
v_and_b32 v249, s28, v86
v_lshlrev_b32 v250, 16, v87
v_and_b32 v251, s28, v87
v_pk_mul_f32 v[244:245], v[244:245], s[22:23]
v_pk_mul_f32 v[246:247], v[246:247], s[22:23]
v_pk_mul_f32 v[248:249], v[248:249], s[22:23]
v_pk_mul_f32 v[250:251], v[250:251], s[22:23]
cv 84,244,245
cv 85,246,247
cv 86,248,249
cv 87,250,251
cv 180,20,21
cv 181,22,23
v_mfma_f32_16x16x32_bf16 v[28:31], a[108:111], v[84:87], 0
s_add_u32 s39, s26, 0
ex 24
pw 28,104,80
ex 25
pw 28,100,76
ex 26
pw 28,96,72
ex 27
cv 182,24,25
cv 183,26,27
s_nop 4
v_max3_f32 v252, v28, v29, v30
v_max_f32 v252, v252, v31
v_add_f32 v252, 0x41200000, v252
v_mov_b32 v253, v252
s_nop 1
v_permlane16_swap_b32 v252, v253
v_max_f32 v252, v252, v253
v_mov_b32 v253, v252
s_nop 1
v_permlane32_swap_b32 v252, v253
v_min_f32 v40, -v252, -v253
v_min_f32 v41, -v252, -v253
v_min_f32 v42, -v252, -v253
v_min_f32 v43, -v252, -v253
v_add_f32 v28, v28, v40
v_add_f32 v29, v29, v40
qa 32,124,84,40
v_add_f32 v30, v30, v40
v_add_f32 v31, v31, v40
pw 32,120,80
ex 28
pw 32,116,76
ex 29
pw 32,112,72
ex 30
qa 16,140,84,40
ex 31
pw 16,136,80
cv 144,28,29
cv 145,30,31
pw 16,132,76
pw 16,128,72
ex 32
qa 20,156,84,40
ex 33
pw 20,152,80
ex 34
pw 20,148,76
ex 35
pw 20,144,72
cv 146,32,33
cv 147,34,35
qa 24,224,84,40
ex 16
pw 24,220,80
ex 17
pw 24,216,76
ex 18
pw 24,212,72
ex 19
qa 28,240,84,40
cv 148,16,17
cv 149,18,19
pw 28,236,80
ex 20
pw 28,232,76
ex 21
pw 28,228,72
ex 22
v_mfma_f32_16x16x32_bf16 v[32:35], v[216:219], v[84:87], v[40:43]
ex 23
pw 32,252,80
cv 150,20,21
cv 151,22,23
pw 32,248,76
ex 24
pw 32,244,72
ex 25
v_mfma_f32_16x16x32_bf16 v[16:19], v[232:235], v[84:87], v[40:43]
ex 26
v_mfma_f32_16x16x32_bf16 v[16:19], v[228:231], v[80:83], v[16:19]
ex 27
v_mfma_f32_16x16x32_bf16 v[16:19], v[224:227], v[76:79], v[16:19]
cv 184,24,25
cv 185,26,27
v_mfma_f32_16x16x32_bf16 v[16:19], v[220:223], v[72:75], v[16:19]
ex 28
ex 29
ex 30
ex 31
s_waitcnt vmcnt(8)
ds_read_b128 v[88:91], v240 offset:49152
ds_read_b128 v[92:95], v241 offset:49152
ds_read_b128 v[96:99], v242 offset:49152
ds_read_b128 v[100:103], v243 offset:49152
buffer_load_dwordx4 v12, s[12:15], s43 offen offset:0 nt lds
buffer_load_dwordx4 v13, s[12:15], s43 offen offset:1024 nt lds
buffer_load_dwordx4 v12, s[12:15], s43 offen offset:2048 nt lds
buffer_load_dwordx4 v13, s[12:15], s43 offen offset:3072 nt lds
s_add_u32 m0, s21, 65536
s_add_u32 s43, s43, 16384
cv 186,28,29
cv 187,30,31
ex 32
ex 33
ex 34
ex 35
s_waitcnt lgkmcnt(3)
v_lshlrev_b32 v244, 16, v88
v_and_b32 v245, s28, v88
v_lshlrev_b32 v246, 16, v89
v_and_b32 v247, s28, v89
v_lshlrev_b32 v248, 16, v90
v_and_b32 v249, s28, v90
v_lshlrev_b32 v250, 16, v91
v_and_b32 v251, s28, v91
v_pk_mul_f32 v[244:245], v[244:245], s[22:23]
v_pk_mul_f32 v[246:247], v[246:247], s[22:23]
v_pk_mul_f32 v[248:249], v[248:249], s[22:23]
v_pk_mul_f32 v[250:251], v[250:251], s[22:23]
cv 88,244,245
cv 89,246,247
cv 90,248,249
cv 91,250,251
s_waitcnt lgkmcnt(0)
v_lshlrev_b32 v244, 16, v92
v_and_b32 v245, s28, v92
v_lshlrev_b32 v246, 16, v93
v_and_b32 v247, s28, v93
v_lshlrev_b32 v248, 16, v94
v_and_b32 v249, s28, v94
v_lshlrev_b32 v250, 16, v95
v_and_b32 v251, s28, v95
v_pk_mul_f32 v[244:245], v[244:245], s[22:23]
v_pk_mul_f32 v[246:247], v[246:247], s[22:23]
v_pk_mul_f32 v[248:249], v[248:249], s[22:23]
v_pk_mul_f32 v[250:251], v[250:251], s[22:23]
cv 92,244,245
cv 93,246,247
cv 94,248,249
cv 95,250,251
v_lshlrev_b32 v244, 16, v96
v_and_b32 v245, s28, v96
v_lshlrev_b32 v246, 16, v97
v_and_b32 v247, s28, v97
v_lshlrev_b32 v248, 16, v98
v_and_b32 v249, s28, v98
v_lshlrev_b32 v250, 16, v99
v_and_b32 v251, s28, v99
v_mfma_f32_16x16x32_bf16 v[20:23], a[96:99], v[88:91], 0
v_mul_f32 v244, s22, v244
v_mul_f32 v245, s22, v245
cv 96,244,245
v_lshlrev_b32 v244, 16, v100
v_and_b32 v245, s28, v100
v_pk_mul_f32 v[246:247], v[246:247], s[22:23]
v_pk_mul_f32 v[248:249], v[248:249], s[22:23]
v_pk_mul_f32 v[250:251], v[250:251], s[22:23]
cv 97,246,247
cv 98,248,249
cv 99,250,251
pw 20,100,92
v_lshlrev_b32 v246, 16, v101
v_and_b32 v247, s28, v101
v_lshlrev_b32 v248, 16, v102
v_and_b32 v249, s28, v102
v_lshlrev_b32 v250, 16, v103
v_and_b32 v251, s28, v103
v_pk_mul_f32 v[244:245], v[244:245], s[22:23]
v_pk_mul_f32 v[246:247], v[246:247], s[22:23]
v_pk_mul_f32 v[248:249], v[248:249], s[22:23]
v_pk_mul_f32 v[250:251], v[250:251], s[22:23]
cv 100,244,245
cv 101,246,247
pw 20,104,96
cv 102,248,249
cv 103,250,251
cv 188,32,33
cv 189,34,35
pw 20,108,100
ex 16
ex 17
ex 18
ex 19
cv 190,16,17
cv 191,18,19
s_nop 1
v_max3_f32 v252, v20, v21, v22
v_max_f32 v252, v252, v23
v_add_f32 v252, 0x41200000, v252
v_mov_b32 v253, v252
s_nop 1
v_permlane16_swap_b32 v252, v253
v_max_f32 v252, v252, v253
v_mov_b32 v253, v252
s_nop 1
v_permlane32_swap_b32 v252, v253
v_min_f32 v44, -v252, -v253
v_min_f32 v45, -v252, -v253
v_min_f32 v46, -v252, -v253
v_min_f32 v47, -v252, -v253
v_add_f32 v20, v20, v44
v_add_f32 v21, v21, v44
qa 24,112,88,44
v_add_f32 v22, v22, v44
v_add_f32 v23, v23, v44
pw 24,116,92
ex 20
pw 24,120,96
ex 21
pw 24,124,100
ex 22
qa 28,128,88,44
ex 23
pw 28,132,92
cv 152,20,21
cv 153,22,23
pw 28,136,96
pw 28,140,100
ex 24
qa 32,144,88,44
ex 25
pw 32,148,92
ex 26
pw 32,152,96
ex 27
pw 32,156,100
cv 154,24,25
cv 155,26,27
qa 16,212,88,44
ex 28
pw 16,216,92
ex 29
pw 16,220,96
ex 30
pw 16,224,100
ex 31
qa 20,228,88,44
cv 156,28,29
cv 157,30,31
pw 20,232,92
ex 32
pw 20,236,96
ex 33
pw 20,240,100
ex 34
qa 24,244,88,44
ex 35
pw 24,248,92
cv 158,32,33
cv 159,34,35
pw 24,252,96
ex 16
v_mfma_f32_16x16x32_bf16 v[24:27], v[216:219], v[100:103], v[24:27]
ex 17
v_mfma_f32_16x16x32_bf16 v[28:31], v[220:223], v[88:91], v[44:47]
ex 18
v_mfma_f32_16x16x32_bf16 v[28:31], v[224:227], v[92:95], v[28:31]
ex 19
v_mfma_f32_16x16x32_bf16 v[28:31], v[228:231], v[96:99], v[28:31]
cv 192,16,17
cv 193,18,19
v_mfma_f32_16x16x32_bf16 v[28:31], v[232:235], v[100:103], v[28:31]
ex 20
ex 21
ex 22
ex 23
s_waitcnt vmcnt(8)
ds_read_b128 v[104:107], v240 offset:0
ds_read_b128 v[108:111], v241 offset:0
ds_read_b128 v[112:115], v242 offset:0
ds_read_b128 v[116:119], v243 offset:0
buffer_load_dwordx4 v12, s[8:11], s20 offen offset:0 nt lds
buffer_load_dwordx4 v13, s[8:11], s20 offen offset:1024 nt lds
buffer_load_dwordx4 v12, s[8:11], s20 offen offset:2048 nt lds
buffer_load_dwordx4 v13, s[8:11], s20 offen offset:3072 nt lds
s_add_u32 m0, s21, 114688
cv 194,20,21
cv 195,22,23
ex 24
ex 25
ex 26
ex 27
s_waitcnt lgkmcnt(3)
v_lshlrev_b32 v244, 16, v104
v_and_b32 v245, s28, v104
v_lshlrev_b32 v246, 16, v105
v_and_b32 v247, s28, v105
v_lshlrev_b32 v248, 16, v106
v_and_b32 v249, s28, v106
v_lshlrev_b32 v250, 16, v107
v_and_b32 v251, s28, v107
v_pk_mul_f32 v[244:245], v[244:245], s[22:23]
v_pk_mul_f32 v[246:247], v[246:247], s[22:23]
v_pk_mul_f32 v[248:249], v[248:249], s[22:23]
v_pk_mul_f32 v[250:251], v[250:251], s[22:23]
cv 104,244,245
cv 105,246,247
cv 106,248,249
cv 107,250,251
s_waitcnt lgkmcnt(0)
v_lshlrev_b32 v244, 16, v108
v_and_b32 v245, s28, v108
v_lshlrev_b32 v246, 16, v109
v_and_b32 v247, s28, v109
v_lshlrev_b32 v248, 16, v110
v_and_b32 v249, s28, v110
v_lshlrev_b32 v250, 16, v111
v_and_b32 v251, s28, v111
v_pk_mul_f32 v[244:245], v[244:245], s[22:23]
v_pk_mul_f32 v[246:247], v[246:247], s[22:23]
v_pk_mul_f32 v[248:249], v[248:249], s[22:23]
v_pk_mul_f32 v[250:251], v[250:251], s[22:23]
cv 108,244,245
cv 109,246,247
cv 110,248,249
cv 111,250,251
v_lshlrev_b32 v244, 16, v112
v_and_b32 v245, s28, v112
v_lshlrev_b32 v246, 16, v113
v_and_b32 v247, s28, v113
v_lshlrev_b32 v248, 16, v114
v_and_b32 v249, s28, v114
v_lshlrev_b32 v250, 16, v115
v_and_b32 v251, s28, v115
v_pk_mul_f32 v[244:245], v[244:245], s[22:23]
v_pk_mul_f32 v[246:247], v[246:247], s[22:23]

LwY0_0:
s_cbranch_vccnz LwY0_4
v_pk_mul_f32 v[248:249], v[248:249], s[22:23]
v_pk_mul_f32 v[250:251], v[250:251], s[22:23]
cv 112,244,245
cv 113,246,247
cv 114,248,249
cv 115,250,251
v_lshlrev_b32 v244, 16, v116
v_and_b32 v245, s28, v116
v_lshlrev_b32 v246, 16, v117
v_and_b32 v247, s28, v117
v_lshlrev_b32 v248, 16, v118
v_and_b32 v249, s28, v118
v_lshlrev_b32 v250, 16, v119
v_and_b32 v251, s28, v119
v_pk_mul_f32 v[244:245], v[244:245], s[22:23]
v_pk_mul_f32 v[246:247], v[246:247], s[22:23]
v_pk_mul_f32 v[248:249], v[248:249], s[22:23]
v_pk_mul_f32 v[250:251], v[250:251], s[22:23]
cv 116,244,245
cv 117,246,247
cv 118,248,249
cv 119,250,251
cv 196,24,25
cv 197,26,27
v_mfma_f32_16x16x32_bf16 v[32:35], a[108:111], v[116:119], 0
s_add_u32 s20, s20, 16384
ex 28
pw 32,104,112
s_add_u32 s96, s8, s20
s_addc_u32 s97, s9, 0
pw 32,100,108
s_add_u32 s96, s96, 16384
s_addc_u32 s97, s97, 0
pw 32,96,104
ex 29
ex 30
ex 31
cv 198,28,29
cv 199,30,31
s_nop 2
v_max3_f32 v252, v32, v33, v34
v_max_f32 v252, v252, v35
v_add_f32 v252, 0x41200000, v252
v_mov_b32 v253, v252
s_nop 1
v_permlane16_swap_b32 v252, v253
v_max_f32 v252, v252, v253
v_mov_b32 v253, v252
s_nop 1
v_permlane32_swap_b32 v252, v253
v_min_f32 v48, -v252, -v253
v_min_f32 v49, -v252, -v253
v_min_f32 v50, -v252, -v253
v_min_f32 v51, -v252, -v253
v_add_f32 v32, v32, v48
v_add_f32 v33, v33, v48
qa 16,124,116,48
v_add_f32 v34, v34, v48
v_add_f32 v35, v35, v48
pw 16,120,112
ex 32
pw 16,116,108
ex 33
pw 16,112,104
ex 34
qa 20,140,116,48
ex 35
pw 20,136,112
cv 160,32,33
cv 161,34,35
pw 20,132,108
pw 20,128,104
ex 16
qa 24,156,116,48
ex 17
pw 24,152,112
ex 18
pw 24,148,108
ex 19
pw 24,144,104
cv 162,16,17
cv 163,18,19
qa 28,224,116,48
ex 20
pw 28,220,112
ex 21
pw 28,216,108
ex 22
pw 28,212,104
ex 23
qa 32,240,116,48
cv 164,20,21
cv 165,22,23
pw 32,236,112
ex 24
pw 32,232,108
ex 25
pw 32,228,104
ex 26
v_mfma_f32_16x16x32_bf16 v[16:19], v[216:219], v[116:119], v[48:51]
ex 27
pw 16,252,112
cv 166,24,25
cv 167,26,27
pw 16,248,108
ex 28
pw 16,244,104
ex 29
v_mfma_f32_16x16x32_bf16 v[20:23], v[232:235], v[116:119], v[48:51]
ex 30
v_mfma_f32_16x16x32_bf16 v[20:23], v[228:231], v[112:115], v[20:23]
ex 31
v_mfma_f32_16x16x32_bf16 v[20:23], v[224:227], v[108:111], v[20:23]
cv 200,28,29
cv 201,30,31
v_mfma_f32_16x16x32_bf16 v[20:23], v[220:223], v[104:107], v[20:23]
ex 32
ex 33
ex 34
ex 35
s_waitcnt vmcnt(8)
ds_read_b128 v[120:123], v236 offset:0
ds_read_b128 v[124:127], v237 offset:0
ds_read_b128 v[128:131], v238 offset:0
ds_read_b128 v[132:135], v239 offset:0
buffer_load_dwordx4 v12, s[12:15], s43 offen offset:0 nt lds
buffer_load_dwordx4 v13, s[12:15], s43 offen offset:1024 nt lds
buffer_load_dwordx4 v12, s[12:15], s43 offen offset:2048 nt lds
buffer_load_dwordx4 v13, s[12:15], s43 offen offset:3072 nt lds
cv 202,32,33
cv 203,34,35
ex 16
ex 17
ex 18
ex 19
cv 204,16,17
s_waitcnt lgkmcnt(3)
v_lshlrev_b32 v244, 16, v120
v_and_b32 v245, s28, v120
v_lshlrev_b32 v246, 16, v121
v_and_b32 v247, s28, v121
v_lshlrev_b32 v248, 16, v122
v_and_b32 v249, s28, v122
v_lshlrev_b32 v250, 16, v123
v_and_b32 v251, s28, v123
v_pk_mul_f32 v[244:245], v[244:245], s[22:23]
v_pk_mul_f32 v[246:247], v[246:247], s[22:23]
v_pk_mul_f32 v[248:249], v[248:249], s[22:23]
v_pk_mul_f32 v[250:251], v[250:251], s[22:23]
cv 120,244,245
cv 121,246,247
cv 122,248,249
cv 123,250,251
s_waitcnt lgkmcnt(0)
v_lshlrev_b32 v244, 16, v124
v_and_b32 v245, s28, v124
v_lshlrev_b32 v246, 16, v125
v_and_b32 v247, s28, v125
v_lshlrev_b32 v248, 16, v126
v_and_b32 v249, s28, v126
v_lshlrev_b32 v250, 16, v127
v_and_b32 v251, s28, v127
v_pk_mul_f32 v[244:245], v[244:245], s[22:23]
v_pk_mul_f32 v[246:247], v[246:247], s[22:23]
v_pk_mul_f32 v[248:249], v[248:249], s[22:23]
v_pk_mul_f32 v[250:251], v[250:251], s[22:23]
cv 124,244,245
cv 125,246,247
cv 126,248,249
cv 127,250,251
v_lshlrev_b32 v244, 16, v128
v_and_b32 v245, s28, v128
v_lshlrev_b32 v246, 16, v129
v_and_b32 v247, s28, v129
v_lshlrev_b32 v248, 16, v130
v_and_b32 v249, s28, v130
v_lshlrev_b32 v250, 16, v131
v_and_b32 v251, s28, v131
v_mfma_f32_16x16x32_bf16 v[24:27], a[96:99], v[120:123], 0
s_add_u32 m0, s21, 81920
v_mul_f32 v244, s22, v244
v_mul_f32 v245, s22, v245
cv 128,244,245
v_lshlrev_b32 v244, 16, v132
v_and_b32 v245, s28, v132
v_pk_mul_f32 v[246:247], v[246:247], s[22:23]
v_pk_mul_f32 v[248:249], v[248:249], s[22:23]
v_pk_mul_f32 v[250:251], v[250:251], s[22:23]
cv 129,246,247
cv 130,248,249
cv 131,250,251
pw 24,100,124
s_add_u32 s43, s43, 16384
v_lshlrev_b32 v246, 16, v133
v_and_b32 v247, s28, v133
v_lshlrev_b32 v248, 16, v134
v_and_b32 v249, s28, v134
v_lshlrev_b32 v250, 16, v135
v_and_b32 v251, s28, v135
v_pk_mul_f32 v[244:245], v[244:245], s[22:23]
v_pk_mul_f32 v[246:247], v[246:247], s[22:23]
v_pk_mul_f32 v[248:249], v[248:249], s[22:23]
v_pk_mul_f32 v[250:251], v[250:251], s[22:23]
cv 132,244,245
cv 133,246,247
pw 24,104,128
cv 134,248,249
cv 135,250,251
cv 205,18,19
ex 20
pw 24,108,132
ex 21
ex 22
ex 23
cv 206,20,21
s_waitcnt vmcnt(8)
s_barrier
lv 196,4,0
lv 198,4,4096
v_max3_f32 v252, v24, v25, v26
v_max_f32 v252, v252, v27
v_add_f32 v252, 0x41200000, v252
v_mov_b32 v253, v252
lv 200,172,0
lv 202,172,4096
v_permlane16_swap_b32 v252, v253
v_max_f32 v252, v252, v253
v_mov_b32 v253, v252
lv 204,5,0
lv 206,5,4096
v_permlane32_swap_b32 v252, v253
v_min_f32 v52, -v252, -v253
v_min_f32 v53, -v252, -v253
v_min_f32 v54, -v252, -v253
v_min_f32 v55, -v252, -v253
lv 208,173,0
lv 210,173,4096
qa 28,112,120,52
lv 180,6,0
v_add_f32 v24, v24, v52
pw 28,116,124
lv 182,6,4096
v_add_f32 v25, v25, v52
pw 28,120,128
lv 184,174,0
v_add_f32 v26, v26, v52
pw 28,124,132
lv 186,174,4096
v_add_f32 v27, v27, v52
qa 32,212,120,52
buffer_load_dwordx4 v12, s[8:11], s20 offen offset:0 nt lds
pw 32,216,124
lv 188,7,0
v_accvgpr_write_b32 a212, s40
pw 32,220,128
lv 190,7,4096
v_accvgpr_write_b32 a213, s40
pw 32,224,132
lv 192,175,0
v_accvgpr_write_b32 a214, s40
qa 16,228,120,52
s_waitcnt lgkmcnt(6)
lv 194,175,4096
v_accvgpr_write_b32 a215, s40
pw 16,232,124
ex 24
pw 16,236,128
ex 25
pw 16,240,132
ex 26
v_mfma_f32_16x16x32_bf16 a[0:3], v[136:139], a[196:199], a[212:215]
ex 27
pa 0,140,200
ex 28
v_mfma_f32_16x16x32_bf16 a[32:35], v[148:151], a[200:203], a[212:215]
ex 29
pa 32,144,196
ex 30
v_mfma_f32_16x16x32_bf16 a[64:67], v[152:155], a[196:199], a[212:215]
ex 31
pa 64,156,200
buffer_load_dwordx4 v13, s[8:11], s20 offen offset:1024 nt lds
v_mfma_f32_16x16x32_bf16 a[96:99], v[164:167], a[200:203], a[212:215]
lv 200,212,0
cv 168,24,25
pa 96,160,196
lv 202,212,4096
cv 169,26,27
cv 170,28,29
cv 171,30,31
ex 16
ex 17
v_mfma_f32_16x16x32_bf16 a[128:131], v[168:171], a[196:199], a[212:215]
lv 196,8,0
cv 210,16,17
v_mfma_f32_16x16x32_bf16 a[132:135], v[168:171], a[204:207], a[212:215]
lv 198,8,4096
cv 207,22,23
v_mfma_f32_16x16x32_bf16 a[100:103], v[160:163], a[204:207], a[212:215]
ex 18
pa 100,164,208
ex 19
v_mfma_f32_16x16x32_bf16 a[68:71], v[156:159], a[208:211], a[212:215]
cv 211,18,19
pa 68,152,204
ex 32
v_mfma_f32_16x16x32_bf16 a[36:39], v[144:147], a[204:207], a[212:215]
ex 33
pa 36,148,208
ex 34
v_mfma_f32_16x16x32_bf16 a[4:7], v[140:143], a[208:211], a[212:215]
buffer_load_dwordx4 v12, s[8:11], s20 offen offset:2048 nt lds
pa 4,136,204
lv 204,9,0
cv 208,32,33
v_smfmac_f32_16x16x64_bf16 a[160:163], a[172:175], v[136:143], v14
s_waitcnt lgkmcnt(1)
lv 206,9,4096
v_mfma_f32_16x16x32_bf16 a[8:11], v[136:139], a[180:183], a[212:215]
lv 208,213,0
pa 8,140,184
lv 210,213,4096
v_mfma_f32_16x16x32_bf16 a[40:43], v[148:151], a[184:187], a[212:215]
ex 35
pa 40,144,180
cv 209,34,35
v_mfma_f32_16x16x32_bf16 a[72:75], v[152:155], a[180:183], a[212:215]
pa 72,156,184
v_mfma_f32_16x16x32_bf16 a[104:107], v[164:167], a[184:187], a[212:215]
lv 184,214,0
pa 104,160,180
lv 186,214,4096
v_mfma_f32_16x16x32_bf16 a[136:139], v[168:171], a[180:183], a[212:215]
lv 180,10,0
v_mfma_f32_16x16x32_bf16 a[140:143], v[168:171], a[188:191], a[212:215]
buffer_load_dwordx4 v13, s[8:11], s20 offen offset:3072 nt lds
v_mfma_f32_16x16x32_bf16 a[108:111], v[160:163], a[188:191], a[212:215]
s_add_u32 m0, s21, 131072
lv 182,10,4096
pa 108,164,192
v_mfma_f32_16x16x32_bf16 a[76:79], v[156:159], a[192:195], a[212:215]
pa 76,152,188
v_mfma_f32_16x16x32_bf16 a[44:47], v[144:147], a[188:191], a[212:215]
pa 44,148,192
v_mfma_f32_16x16x32_bf16 a[12:15], v[140:143], a[192:195], a[212:215]
lv 192,215,0
pa 12,136,188
lv 188,11,0
v_smfmac_f32_16x16x64_bf16 a[160:163], a[176:179], v[144:151], v14
lv 190,11,4096
v_mfma_f32_16x16x32_bf16 a[16:19], v[136:139], a[196:199], a[212:215]
lv 194,215,4096
pa 16,140,200
v_mfma_f32_16x16x32_bf16 a[48:51], v[148:151], a[200:203], a[212:215]
buffer_load_dwordx4 v12, s[12:15], s43 offen offset:0 nt lds
pa 48,144,196
v_mfma_f32_16x16x32_bf16 a[80:83], v[152:155], a[196:199], a[212:215]
pa 80,156,200
v_mfma_f32_16x16x32_bf16 a[112:115], v[164:167], a[200:203], a[212:215]
pa 112,160,196
v_mfma_f32_16x16x32_bf16 a[144:147], v[168:171], a[196:199], a[212:215]
s_waitcnt lgkmcnt(0)
v_mfma_f32_16x16x32_bf16 a[148:151], v[168:171], a[204:207], a[212:215]
v_mfma_f32_16x16x32_bf16 a[116:119], v[160:163], a[204:207], a[212:215]
pa 116,164,208
v_mfma_f32_16x16x32_bf16 a[84:87], v[156:159], a[208:211], a[212:215]
pa 84,152,204
v_mfma_f32_16x16x32_bf16 a[52:55], v[144:147], a[204:207], a[212:215]
buffer_load_dwordx4 v13, s[12:15], s43 offen offset:1024 nt lds
pa 52,148,208
v_mfma_f32_16x16x32_bf16 a[20:23], v[140:143], a[208:211], a[212:215]
pa 20,136,204
v_smfmac_f32_16x16x64_bf16 a[164:167], a[172:175], v[152:159], v14
v_smfmac_f32_16x16x64_bf16 a[164:167], a[176:179], v[160:167], v14
v_mfma_f32_16x16x32_bf16 a[24:27], v[136:139], a[180:183], a[212:215]
s_waitcnt vmcnt(6)
s_barrier
pa 24,140,184
lk 196,0,32768
v_mfma_f32_16x16x32_bf16 a[56:59], v[148:151], a[184:187], a[212:215]
lk 200,1,32768
pa 56,144,180
lk 204,2,32768
v_mfma_f32_16x16x32_bf16 a[88:91], v[152:155], a[180:183], a[212:215]
lk 208,3,32768
pa 88,156,184
v_mfma_f32_16x16x32_bf16 a[120:123], v[164:167], a[184:187], a[212:215]
buffer_load_dwordx4 v12, s[12:15], s43 offen offset:2048 nt lds
pa 120,160,180
lv 184,172,16384
v_mfma_f32_16x16x32_bf16 a[152:155], v[168:171], a[180:183], a[212:215]
lv 180,4,16384
v_mfma_f32_16x16x32_bf16 a[156:159], v[168:171], a[188:191], a[212:215]
lv 182,4,20480
v_mfma_f32_16x16x32_bf16 a[124:127], v[160:163], a[188:191], a[212:215]
lv 186,172,20480
pa 124,164,192
v_mfma_f32_16x16x32_bf16 a[92:95], v[156:159], a[192:195], a[212:215]
pa 92,152,188
v_mfma_f32_16x16x32_bf16 a[60:63], v[144:147], a[188:191], a[212:215]
pa 60,148,192
v_mfma_f32_16x16x32_bf16 a[28:31], v[140:143], a[192:195], a[212:215]
lv 192,173,16384
pa 28,136,188
lv 188,5,16384
pv 168,172,168
s_waitcnt lgkmcnt(2)
buffer_load_dwordx4 v13, s[12:15], s43 offen offset:3072 nt lds
qa 16,196,56,36
s_add_u32 m0, s21, 32768
lv 190,5,20480
s_add_u32 s43, s43, 16384
pw 16,200,60
s_add_u32 s98, s12, s43
s_addc_u32 s99, s13, 0
lv 194,173,20480
pw 16,204,64
s_add_u32 s98, s98, 16384
s_addc_u32 s99, s99, 0
pw 16,208,68
qa 20,208,84,40
pw 20,204,80
s_nop 2
pw 20,200,76
s_nop 0
pw 20,196,72
ex 16
qa 24,196,88,44
ex 17
pw 24,200,92
cv 136,16,17
pw 24,204,96
ex 18
pw 24,208,100
global_load_lds_dwordx4 v12, s[96:97] offset:0 nt
qa 28,208,116,48
ex 19
pw 28,204,112
cv 137,18,19
pw 28,200,108
ex 20
pw 28,196,104
qa 32,196,120,52
lk 196,0,36864
v_xor_b32 v0, 0x2000, v0
pw 32,200,124
lk 200,1,36864
v_xor_b32 v1, 0x2000, v1
pw 32,204,128
lk 204,2,36864
v_xor_b32 v2, 0x2000, v2
pw 32,208,132
lk 208,3,36864
v_xor_b32 v3, 0x2000, v3
pa 0,176,180
ex 21
pa 0,180,184
ex 22
pa 32,188,184
ex 23
pa 32,184,180
global_load_lds_dwordx4 v13, s[96:97] offset:1024 nt
cv 144,20,21
pa 64,192,180
cv 145,22,23
pa 64,196,184
ex 24
pa 96,204,184
ex 25
pa 96,200,180
ex 26
pa 128,208,180
s_waitcnt lgkmcnt(0)
ex 27
pa 132,208,188
lv 180,6,16384
cv 152,24,25
pa 100,200,188
lv 182,6,20480
cv 153,26,27
pa 100,204,192
ex 28
pa 68,196,192
ex 29
pa 68,192,188
lv 184,174,16384
cv 160,28,29
pa 36,184,188
ex 30
pa 36,188,192
global_load_lds_dwordx4 v12, s[96:97] offset:2048 nt
lv 186,174,20480
pa 4,180,192
ex 31
pa 4,176,188
lv 188,7,16384
cv 161,30,31
v_smfmac_f32_16x16x64_bf16 a[160:163], a[172:175], v[176:183], v14
lv 190,7,20480
qa 16,196,56,36
ex 32
pw 16,200,60
ex 33
pw 16,204,64
lv 192,175,16384
cv 168,32,33
pw 16,208,68
ex 34
qa 20,208,84,40
lv 194,175,20480
pw 20,204,80
ex 35
pw 20,200,76
cv 169,34,35
pw 20,196,72
ex 16
qa 24,196,88,44
global_load_lds_dwordx4 v13, s[96:97] offset:3072 nt
s_add_u32 m0, s21, 147456
pw 24,200,92
s_add_u32 s96, s96, 16384
s_addc_u32 s97, s97, 0
pw 24,204,96
ex 17
pw 24,208,100
ex 18
qa 28,208,116,48
ex 19
pw 28,204,112
cv 138,16,17
cv 139,18,19
pw 28,200,108
ex 20
pw 28,196,104
qa 32,196,120,52
lk 196,0,32768
pw 32,200,124
lk 200,1,32768
pw 32,204,128
lk 204,2,32768
pw 32,208,132
s_waitcnt lgkmcnt(3)
lk 208,3,32768
pa 8,176,180
buffer_load_dwordx4 v12, s[12:15], s43 offen offset:0 nt lds
pa 8,180,184
ex 21
pa 40,188,184
ex 22
pa 40,184,180
ex 23
pa 72,192,180
cv 146,20,21
cv 147,22,23
pa 72,196,184
ex 24
pa 104,204,184
ex 25
pa 104,200,180
ex 26
pa 136,208,180
ex 27
pa 140,208,188
lv 180,8,16384
cv 154,24,25
pa 108,200,188
lv 182,8,20480
cv 155,26,27
pa 108,204,192
lv 184,212,16384
pa 76,196,192
buffer_load_dwordx4 v13, s[12:15], s43 offen offset:1024 nt lds
pa 76,192,188
lv 186,212,20480
pa 44,184,188
ex 28
pa 44,188,192
ex 29
pa 12,180,192
ex 30
pa 12,176,188
ex 31
v_smfmac_f32_16x16x64_bf16 a[160:163], a[176:179], v[184:191], v14
s_waitcnt lgkmcnt(2)
lv 188,9,16384
qa 16,196,56,36
lv 190,9,20480
cv 162,28,29
pw 16,200,60
lv 192,213,16384
cv 163,30,31
pw 16,204,64
lv 194,213,20480
pw 16,208,68

LwY0_1:
s_cbranch_vccnz LwY0_5
ex 32
qa 20,208,84,40
ex 33
pw 20,204,80
buffer_load_dwordx4 v12, s[12:15], s43 offen offset:2048 nt lds
pw 20,200,76
ex 34
pw 20,196,72
ex 16
qa 24,196,88,44
ex 35
pw 24,200,92
ex 17
pw 24,204,96
cv 140,16,17
cv 170,32,33
pw 24,208,100
ex 18
qa 28,208,116,48
lk 208,3,36864
cv 171,34,35
pw 28,204,112
lk 204,2,36864
pw 28,200,108
lk 200,1,36864
pw 28,196,104
lk 196,0,36864
pa 16,176,180
s_waitcnt lgkmcnt(4)
ex 19
pa 16,180,184
buffer_load_dwordx4 v13, s[12:15], s43 offen offset:3072 nt lds
pa 48,188,184
s_add_u32 m0, s21, 49152
cv 141,18,19
pa 48,184,180
ex 20
pa 80,192,180
ex 21
pa 80,196,184
ex 22
pa 112,204,184
ex 23
pa 112,200,180
lv 184,214,16384
cv 148,20,21
pa 144,208,180
lv 180,10,16384
cv 149,22,23
pa 148,208,188
lv 182,10,20480
pa 116,200,188
lv 186,214,20480
pa 116,204,192
ex 24
pa 84,196,192
ex 25
pa 84,192,188
global_load_lds_dwordx4 v12, s[96:97] offset:0 nt
cv 156,24,25
pa 52,184,188
ex 26
pa 52,188,192
ex 27
pa 20,180,192
lv 192,215,16384
cv 157,26,27
pa 20,176,188
lv 188,11,16384
v_smfmac_f32_16x16x64_bf16 a[164:167], a[172:175], v[192:199], v14
lv 190,11,20480
v_smfmac_f32_16x16x64_bf16 a[164:167], a[176:179], v[200:207], v14
s_waitcnt lgkmcnt(3)
lv 194,215,20480
qa 16,196,56,36
s_waitcnt vmcnt(9)
ds_write_b32 v254, v255 offset:0
pw 16,200,60
ex 28
pw 16,204,64
ex 29
pw 16,208,68
ex 30
qa 20,208,84,40
ex 31
pw 20,204,80
global_load_lds_dwordx4 v13, s[96:97] offset:1024 nt
cv 164,28,29
pw 20,200,76
cv 165,30,31
pw 20,196,72
ex 16
qa 24,196,88,44
pw 24,200,92
ex 17
pw 24,204,96
cv 142,16,17
pw 24,208,100
ex 18
qa 28,208,116,48
pw 28,204,112
ex 19
pw 28,200,108
cv 143,18,19
pw 28,196,104
ex 20
pa 24,176,180
ds_read_b32 v255, v12 offset:1024
pa 24,180,184
global_load_lds_dwordx4 v12, s[96:97] offset:2048 nt
pa 56,188,184
ex 21
pa 56,184,180
cv 150,20,21
pa 88,192,180
ex 22
pa 88,196,184
pa 120,204,184
ex 23
pa 120,200,180
s_waitcnt lgkmcnt(0)
v_cmp_gt_u32 vcc, 1, v255
cv 151,22,23
pa 152,208,180
ex 24
pa 156,208,188
s_cbranch_vccnz LsY1
LrY1:
lk 196,0,49152
v_mov_b32 v255, 2
pa 124,200,188
lk 200,1,49152
pa 124,204,192
lk 204,2,49152
pa 92,196,192
lk 208,3,49152
pa 92,192,188
global_load_lds_dwordx4 v13, s[96:97] offset:3072 nt
lv 180,4,32768
pa 60,184,188
s_add_u32 m0, s21, 98304
ex 25
pa 60,188,192
s_add_u32 s96, s96, 16384
s_addc_u32 s97, s97, 0
cv 158,24,25
pa 28,180,192
ex 26
pa 28,176,188
ex 27
pv 168,172,208
s_waitcnt lgkmcnt(3)
lv 182,4,36864
cv 159,26,27
qa 16,196,56,36
lv 184,172,32768
pw 16,200,60
s_waitcnt lgkmcnt(3)
lv 186,172,36864
pw 16,204,64
ex 28
pw 16,208,68
ex 29
qa 20,208,84,40
ex 30
pw 20,204,80
ex 31
pw 20,200,76
global_load_lds_dwordx4 v12, s[98:99] offset:0 nt
cv 166,28,29
pw 20,196,72
lv 188,5,32768
cv 167,30,31
qa 24,196,88,44
lv 190,5,36864
pw 24,200,92
lv 192,173,32768
pw 24,204,96
lv 194,173,36864
pw 24,208,100
ex 16
qa 28,208,116,48
lk 208,3,53248
v_xor_b32 v3, 0x2000, v3
pw 28,204,112
lk 204,2,53248
v_xor_b32 v2, 0x2000, v2
pw 28,200,108
lk 200,1,53248
v_xor_b32 v1, 0x2000, v1
pw 28,196,104
s_waitcnt lgkmcnt(6)
lk 196,0,53248
v_xor_b32 v0, 0x2000, v0
pa 0,136,180
ex 17
pa 0,140,184
ex 18
pa 32,148,184
global_load_lds_dwordx4 v13, s[98:99] offset:1024 nt
cv 180,16,17
pa 32,144,180
ex 19
pa 64,152,180
cv 181,18,19
pa 64,156,184
ex 20
pa 96,164,184
ex 21
pa 96,160,180
ex 22
pa 128,168,180
s_waitcnt lgkmcnt(0)
ex 23
pa 132,168,188
lv 180,6,32768
cv 188,20,21
pa 100,160,188
lv 182,6,36864
cv 189,22,23
pa 100,164,192
ex 24
pa 68,156,192
ex 25
pa 68,152,188
ex 26
pa 36,144,188
global_load_lds_dwordx4 v12, s[98:99] offset:2048 nt
cv 196,24,25
pa 36,148,192
ex 27
pa 4,140,192
lv 184,174,32768
cv 197,26,27
pa 4,136,188
lv 186,174,36864
v_smfmac_f32_16x16x64_bf16 a[160:163], a[172:175], v[136:143], v14
lv 188,7,32768
qa 16,196,56,36
ex 28
pw 16,200,60
ex 29
pw 16,204,64
ex 30
pw 16,208,68
lv 190,7,36864
cv 204,28,29
qa 20,208,84,40
ex 31
pw 20,204,80
lv 192,175,32768
cv 205,30,31
pw 20,200,76
lv 194,175,36864
pw 20,196,72
global_load_lds_dwordx4 v13, s[98:99] offset:3072 nt
s_add_u32 m0, s21, 65536
qa 24,196,88,44
s_add_u32 s98, s98, 16384
s_addc_u32 s99, s99, 0
pw 24,200,92
ex 16
pw 24,204,96
ex 17
pw 24,208,100
ex 18
qa 28,208,116,48
lk 208,3,49152
cv 182,16,17
pw 28,204,112
lk 204,2,49152
pw 28,200,108
lk 200,1,49152
pw 28,196,104
s_waitcnt lgkmcnt(3)
lk 196,0,49152
pa 8,136,180
ex 19
pa 8,140,184
buffer_load_dwordx4 v[220:223], v15, s[4:7], s36 offen offset:0 nt
pa 40,148,184
s_add_u32 s36, s26, 4096
cv 183,18,19
pa 40,144,180
ex 20
pa 72,152,180
ex 21
pa 72,156,184
ex 22
pa 104,164,184
ex 23
pa 104,160,180
lv 184,212,32768
cv 190,20,21
pa 136,168,180
lv 180,8,32768
cv 191,22,23
pa 140,168,188
ex 24
pa 108,160,188
ex 25
pa 108,164,192
lv 182,8,36864
cv 198,24,25
pa 76,156,192
ex 26
pa 76,152,188
lv 186,212,36864
pa 44,144,188
pa 44,148,192
ex 27
pa 12,140,192
lv 192,213,32768
cv 199,26,27
pa 12,136,188
global_load_lds_dwordx4 v12, s[96:97] offset:0 nt
lv 188,9,32768
v_smfmac_f32_16x16x64_bf16 a[160:163], a[176:179], v[144:151], v14
s_waitcnt lgkmcnt(4)
lv 190,9,36864
qa 16,196,56,36
ex 28
pw 16,200,60
ex 29
pw 16,204,64
global_load_lds_dwordx4 v13, s[96:97] offset:1024 nt
cv 206,28,29
pw 16,208,68
ex 30
qa 20,208,84,40
ex 31
pw 20,204,80
lv 194,213,36864
cv 207,30,31
pw 20,200,76
buffer_load_dwordx4 v[224:227], v15, s[4:7], s37 offen offset:32 nt
pw 20,196,72
s_add_u32 s37, s26, 4096
ex 16
qa 24,196,88,44
ex 17
pw 24,200,92
cv 176,16,17
pw 24,204,96
ex 18
pw 24,208,100
qa 28,208,116,48
ex 19
pw 28,204,112
cv 177,18,19
pw 28,200,108
ex 20
pw 28,196,104
qa 32,196,120,52
lk 196,0,53248
pw 32,200,124
lk 200,1,53248
pw 32,204,128
lk 204,2,53248
pw 32,208,132
s_waitcnt lgkmcnt(3)
lk 208,3,53248
pa 16,136,180
ex 21
pa 16,140,184
ex 22
pa 48,148,184
global_load_lds_dwordx4 v12, s[96:97] offset:2048 nt
cv 184,20,21
pa 48,144,180
ex 23
pa 80,152,180
cv 185,22,23
pa 80,156,184
ex 24
pa 112,164,184
global_load_lds_dwordx4 v13, s[96:97] offset:3072 nt
s_add_u32 m0, s21, 114688
pa 112,160,180
s_add_u32 s96, s96, 16384
s_addc_u32 s97, s97, 0
lv 184,214,32768
pa 144,168,180
ex 25
pa 148,168,188
ex 26
pa 116,160,188
ex 27
pa 116,164,192
lv 180,10,32768
cv 192,24,25
pa 84,156,192
global_load_lds_dwordx4 v12, s[98:99] offset:0 nt
cv 193,26,27
pa 84,152,188
lv 182,10,36864
pa 52,144,188
lv 186,214,36864
pa 52,148,192
ex 28
pa 20,140,192
lv 192,215,32768
pa 20,136,188
lv 188,11,32768
v_smfmac_f32_16x16x64_bf16 a[164:167], a[172:175], v[152:159], v14
lv 190,11,36864
v_smfmac_f32_16x16x64_bf16 a[164:167], a[176:179], v[160:167], v14
s_waitcnt lgkmcnt(5)
lv 194,215,36864
qa 16,196,56,36
s_waitcnt vmcnt(15)
ds_write_b32 v254, v255 offset:0
pw 16,200,60
ex 29
pw 16,204,64
ex 30
pw 16,208,68
ex 31
qa 20,208,84,40
global_load_lds_dwordx4 v13, s[98:99] offset:1024 nt
cv 200,28,29
pw 20,204,80
cv 201,30,31
pw 20,200,76
ex 32
pw 20,196,72
ex 33
qa 24,196,88,44
ex 34
pw 24,200,92
ex 35
pw 24,204,96
cv 208,32,33
cv 209,34,35
pw 24,208,100
ex 16
qa 28,208,116,48
ex 17
pw 28,204,112
ex 18
pw 28,200,108
ex 19
pw 28,196,104
cv 178,16,17
cv 179,18,19
qa 32,196,120,52
global_load_lds_dwordx4 v12, s[98:99] offset:2048 nt
pw 32,200,124
ex 20
pw 32,204,128
ex 21
pw 32,208,132
s_waitcnt lgkmcnt(0)
ex 22
pa 24,136,180
ds_read_b32 v255, v12 offset:1024
cv 186,20,21
pa 24,140,184
ex 23
pa 56,148,184
cv 187,22,23
pa 56,144,180
ex 24
pa 88,152,180
ex 25
pa 88,156,184
cv 194,24,25
pa 120,164,184
ex 26
pa 120,160,180
s_waitcnt lgkmcnt(0)
v_cmp_gt_u32 vcc, 2, v255
pa 152,168,180
global_load_lds_dwordx4 v13, s[98:99] offset:3072 nt
s_add_u32 m0, s21, 81920
pa 156,168,188
s_cbranch_vccnz LsY2
LrY2:
lk 196,0,0
v_mov_b32 v255, 3
pa 124,160,188
s_add_u32 s98, s98, 16384
s_addc_u32 s99, s99, 0
lk 200,1,0
pa 124,164,192
lk 204,2,0
pa 92,156,192
lk 208,3,0
pa 92,152,188
ex 27
pa 60,144,188
lv 180,4,49152
cv 195,26,27
pa 60,148,192
ex 28
pa 28,140,192
ex 29
pa 28,136,188
ex 30
pv 168,172,168
s_waitcnt lgkmcnt(3)
ex 31
qa 16,196,56,36
lv 182,4,53248
cv 202,28,29
pw 16,200,60
s_waitcnt lgkmcnt(2)
lv 184,172,49152
cv 203,30,31
pw 16,204,64
lv 186,172,53248
pw 16,208,68
ex 32
qa 20,208,84,40
ex 33
pw 20,204,80
ex 34
pw 20,200,76
ex 35
pw 20,196,72
lv 188,5,49152
cv 210,32,33
qa 24,196,88,44
lv 190,5,53248
cv 211,34,35
pw 24,200,92
lv 192,173,49152
pw 24,204,96
lv 194,173,53248
pw 24,208,100
ex 16
qa 28,208,116,48
ex 17
pw 28,204,112
ex 18
pw 28,200,108
ex 19
pw 28,196,104
cv 136,16,17
cv 137,18,19
qa 32,196,120,52
lk 196,0,4096
v_xor_b32 v0, 0x2000, v0
pw 32,200,124
lk 200,1,4096
v_xor_b32 v1, 0x2000, v1
pw 32,204,128
lk 204,2,4096
v_xor_b32 v2, 0x2000, v2
pw 32,208,132
s_waitcnt lgkmcnt(3)
lk 208,3,4096
v_xor_b32 v3, 0x2000, v3
pa 0,176,180
ex 20
pa 0,180,184
ex 21
pa 32,188,184
ex 22
pa 32,184,180
ex 23
pa 64,192,180
cv 144,20,21
cv 145,22,23
pa 64,196,184
ex 24
pa 96,204,184
ex 25
pa 96,200,180
global_load_lds_dwordx4 v12, s[96:97] offset:0 nt
cv 152,24,25
pa 128,208,180
ex 26
pa 132,208,188
ex 27
pa 100,200,188
lv 180,6,49152
cv 153,26,27
pa 100,204,192
ex 28
pa 68,196,192
ex 29
pa 68,192,188
lv 182,6,53248
cv 160,28,29
pa 36,184,188
ex 30
pa 36,188,192
lv 184,174,49152
pa 4,180,192

LwY0_2:
s_cbranch_vccnz LwY0_6
ex 31
pa 4,176,188
lv 186,174,53248
cv 161,30,31
v_smfmac_f32_16x16x64_bf16 a[160:163], a[172:175], v[176:183], v14
s_waitcnt lgkmcnt(3)
lv 188,7,49152
qa 16,196,56,36
ex 32
pw 16,200,60
ex 33
pw 16,204,64
lv 190,7,53248
cv 168,32,33
pw 16,208,68
global_load_lds_dwordx4 v13, s[96:97] offset:1024 nt
lv 192,175,49152
qa 20,208,84,40
ex 34
pw 20,204,80
ex 35
pw 20,200,76
lv 194,175,53248
cv 169,34,35
pw 20,196,72
ex 16
qa 24,196,88,44
ex 17
pw 24,200,92
buffer_load_dwordx4 v[228:231], v15, s[4:7], s38 offen offset:128 nt
pw 24,204,96
s_add_u32 s38, s26, 4096
ex 18
pw 24,208,100
cv 138,16,17
qa 28,208,116,48
ex 19
pw 28,204,112
cv 139,18,19
pw 28,200,108
ex 20
pw 28,196,104
qa 32,196,120,52
lk 196,0,0
pw 32,200,124
lk 200,1,0
pw 32,204,128
lk 204,2,0
pw 32,208,132
s_waitcnt lgkmcnt(3)
lk 208,3,0
pa 8,176,180
ex 21
pa 8,180,184
ex 22
pa 40,188,184
ex 23
pa 40,184,180
cv 146,20,21
cv 147,22,23
pa 72,192,180
ex 24
pa 72,196,184
global_load_lds_dwordx4 v12, s[96:97] offset:2048 nt
pa 104,204,184
ex 25
pa 104,200,180
ex 26
pa 136,208,180
ex 27
pa 140,208,188
lv 180,8,49152
cv 154,24,25
pa 108,200,188
lv 182,8,53248
cv 155,26,27
pa 108,204,192
lv 184,212,49152
pa 76,196,192
lv 186,212,53248
pa 76,192,188
global_load_lds_dwordx4 v13, s[96:97] offset:3072 nt
s_add_u32 m0, s21, 131072
pa 44,184,188
s_add_u32 s96, s96, 16384
s_addc_u32 s97, s97, 0
pa 44,188,192
ex 28
pa 12,180,192
ex 29
pa 12,176,188
ex 30
v_smfmac_f32_16x16x64_bf16 a[160:163], a[176:179], v[184:191], v14
s_waitcnt lgkmcnt(2)
cv 162,28,29
qa 16,196,56,36
ex 31
pw 16,200,60
lv 188,9,49152
cv 163,30,31
pw 16,204,64
lv 190,9,53248
pw 16,208,68
lv 192,213,49152
qa 20,208,84,40
lv 194,213,53248
pw 20,204,80
ex 32
pw 20,200,76
ex 33
pw 20,196,72
ex 16
qa 24,196,88,44
ex 34
pw 24,200,92
global_load_lds_dwordx4 v12, s[98:99] offset:0 nt
cv 170,32,33
pw 24,204,96
ex 17
pw 24,208,100
ex 18
qa 28,208,116,48
lk 208,3,4096
cv 140,16,17
pw 28,204,112
lk 204,2,4096
pw 28,200,108
lk 200,1,4096
pw 28,196,104
lk 196,0,4096
pa 16,176,180
s_waitcnt lgkmcnt(4)
ex 19
pa 16,180,184
buffer_load_dwordx4 v[232:235], v15, s[4:7], s39 offen offset:160 nt
pa 48,188,184
s_add_u32 s39, s26, 4096
cv 141,18,19
pa 48,184,180
ex 20
pa 80,192,180
ex 21
pa 80,196,184
ex 22
pa 112,204,184
ex 23
pa 112,200,180
lv 184,214,49152
cv 148,20,21
pa 144,208,180
lv 180,10,49152
cv 149,22,23
pa 148,208,188
lv 182,10,53248
pa 116,200,188
lv 186,214,53248
pa 116,204,192
ex 24
pa 84,196,192
ex 25
pa 84,192,188
ex 26
pa 52,184,188
cv 156,24,25
pa 52,188,192
ex 27
pa 20,180,192
lv 192,215,49152
cv 157,26,27
pa 20,176,188
global_load_lds_dwordx4 v13, s[98:99] offset:1024 nt
lv 188,11,49152
v_smfmac_f32_16x16x64_bf16 a[164:167], a[172:175], v[192:199], v14
lv 190,11,53248
v_smfmac_f32_16x16x64_bf16 a[164:167], a[176:179], v[200:207], v14
s_waitcnt lgkmcnt(3)
lv 194,215,53248
qa 16,196,56,36
s_waitcnt vmcnt(18)
ds_write_b32 v254, v255 offset:0
pw 16,200,60
ex 28
pw 16,204,64
ex 29
pw 16,208,68
ex 30
qa 20,208,84,40
ex 31
pw 20,204,80
global_load_lds_dwordx4 v12, s[98:99] offset:2048 nt
cv 164,28,29
pw 20,200,76
cv 165,30,31
pw 20,196,72
ex 16
qa 24,196,88,44
ex 35
pw 24,200,92
ex 17
pw 24,204,96
cv 142,16,17
cv 171,34,35
pw 24,208,100
ex 18
qa 28,208,116,48
s_waitcnt vmcnt(18)
v_lshlrev_b32 v252, 16, v220
v_and_b32 v253, s28, v220
pw 28,204,112
ex 19
pw 28,200,108
cv 143,18,19
v_mul_f32 v252, s22, v252
pw 28,196,104
ex 20
pa 24,176,180
ds_read_b32 v255, v12 offset:1024
v_mul_f32 v253, s22, v253
pa 24,180,184
ex 21
pa 56,188,184
global_load_lds_dwordx4 v13, s[98:99] offset:3072 nt
cv 150,20,21
pa 56,184,180
s_add_u32 m0, s21, 32768
s_add_u32 s98, s98, 16384
s_addc_u32 s99, s99, 0
pa 88,192,180
ex 22
pa 88,196,184
cv 252,252,253
v_accvgpr_write_b32 a212, v252
pa 120,204,184
ex 23
pa 120,200,180
s_waitcnt lgkmcnt(0)
v_cmp_gt_u32 vcc, 3, v255
cv 151,22,23
pa 152,208,180
ex 24
pa 156,208,188
s_cbranch_vccnz LsY3
LrY3:
lk 196,0,16384
v_mov_b32 v255, 4
pa 124,200,188
lk 200,1,16384
v_lshlrev_b32 v252, 16, v221
pa 124,204,192
lk 204,2,16384
v_and_b32 v253, s28, v221
pa 92,196,192
lk 208,3,16384
v_mul_f32 v252, s22, v252
pa 92,192,188
ex 25
pa 60,184,188
ex 26
pa 60,188,192
ex 27
pa 28,180,192
lv 180,4,0
cv 158,24,25
pa 28,176,188
lv 182,4,4096
cv 159,26,27
pv 168,172,208
s_waitcnt lgkmcnt(4)
lv 184,172,0
v_mul_f32 v253, s22, v253
qa 16,196,56,36
lv 186,172,4096
cv 252,252,253
pw 16,200,60
s_waitcnt lgkmcnt(4)
ex 28
pw 16,204,64
ex 29
pw 16,208,68
ex 30
qa 20,208,84,40
ex 31
pw 20,204,80
lv 188,5,0
cv 166,28,29
pw 20,200,76
lv 190,5,4096
cv 167,30,31
pw 20,196,72
lv 192,173,0
v_accvgpr_write_b32 a213, v252
qa 24,196,88,44
lv 194,173,4096
v_lshlrev_b32 v252, 16, v222
pw 24,200,92
ex 16
pw 24,204,96
ex 17
pw 24,208,100
ex 18
qa 28,208,116,48
lk 208,3,20480
cv 180,16,17
pw 28,204,112
lk 204,2,20480
v_xor_b32 v2, 0x2000, v2
pw 28,200,108
lk 200,1,20480
v_xor_b32 v1, 0x2000, v1
pw 28,196,104
s_waitcnt lgkmcnt(4)
lk 196,0,20480
v_xor_b32 v0, 0x2000, v0
pa 0,136,180
ex 19
pa 0,140,184
buffer_load_dwordx4 v[236:239], v15, s[4:7], s36 offen offset:0 nt
pa 32,148,184
s_add_u32 s36, s26, 8192
cv 181,18,19
v_xor_b32 v3, 0x2000, v3
pa 32,144,180
ex 20
pa 64,152,180
ex 21
pa 64,156,184
ex 22
pa 96,164,184
ex 23
pa 96,160,180
lv 184,174,0
cv 188,20,21
pa 128,168,180
lv 180,6,0
cv 189,22,23
pa 132,168,188
ex 24
pa 100,160,188
s_waitcnt lgkmcnt(2)
ex 25
pa 100,164,192
lv 182,6,4096
cv 196,24,25
pa 68,156,192
ex 26
pa 68,152,188
lv 186,174,4096
v_and_b32 v253, s28, v222
pa 36,144,188
v_mul_f32 v252, s22, v252
v_mul_f32 v253, s22, v253
pa 36,148,192
ex 27
pa 4,140,192
lv 192,175,0
cv 197,26,27
pa 4,136,188
ex 28
v_smfmac_f32_16x16x64_bf16 a[160:163], a[172:175], v[136:143], v14
lv 188,7,0
qa 16,196,56,36
ex 29
pw 16,200,60
lv 190,7,4096
cv 204,28,29
pw 16,204,64
ex 30
pw 16,208,68
lv 194,175,4096
cv 252,252,253
qa 20,208,84,40
ex 31
pw 20,204,80
buffer_load_dwordx4 v[240:243], v15, s[4:7], s37 offen offset:32 nt
pw 20,200,76
s_add_u32 s37, s26, 8192
cv 205,30,31
v_accvgpr_write_b32 a214, v252
pw 20,196,72
ex 16
qa 24,196,88,44
v_lshlrev_b32 v252, 16, v223
v_and_b32 v253, s28, v223
pw 24,200,92
ex 17
pw 24,204,96
cv 182,16,17
v_mul_f32 v252, s22, v252
pw 24,208,100
ex 18
qa 28,208,116,48
lk 208,3,16384
v_mul_f32 v253, s22, v253
pw 28,204,112
lk 204,2,16384
cv 252,252,253
pw 28,200,108
lk 200,1,16384
v_accvgpr_write_b32 a215, v252
pw 28,196,104
s_waitcnt vmcnt(18) lgkmcnt(3)
lk 196,0,16384
v_lshlrev_b32 v252, 16, v224
pa 8,136,180
ex 19
pa 8,140,184
cv 183,18,19
v_and_b32 v253, s28, v224
pa 40,148,184
ex 20
pa 40,144,180
ex 21
pa 72,152,180
ex 22
pa 72,156,184
global_load_lds_dwordx4 v12, s[96:97] offset:0 nt
cv 190,20,21
pa 104,164,184
ex 23
pa 104,160,180
lv 184,212,0
cv 191,22,23
pa 136,168,180
ex 24
pa 140,168,188
global_load_lds_dwordx4 v13, s[96:97] offset:1024 nt
lv 180,8,0
pa 108,160,188
ex 25
pa 108,164,192
lv 182,8,4096
cv 198,24,25
pa 76,156,192
ex 26
pa 76,152,188
lv 186,212,4096
v_mul_f32 v252, s22, v252
pa 44,144,188
v_mul_f32 v253, s22, v253
cv 252,252,253
pa 44,148,192
ex 27
pa 12,140,192
lv 192,213,0
cv 199,26,27
pa 12,136,188
ex 28
v_smfmac_f32_16x16x64_bf16 a[160:163], a[176:179], v[144:151], v14
s_waitcnt lgkmcnt(3)
lv 188,9,0
qa 16,196,56,36
ex 29
pw 16,200,60
global_load_lds_dwordx4 v12, s[96:97] offset:2048 nt
cv 206,28,29
pw 16,204,64
ex 30
pw 16,208,68
lv 190,9,4096
v_accvgpr_write_b32 a216, v252
qa 20,208,84,40
ex 31
pw 20,204,80
lv 194,213,4096
cv 207,30,31
pw 20,200,76
v_lshlrev_b32 v252, 16, v225
v_and_b32 v253, s28, v225
pw 20,196,72
ex 16
qa 24,196,88,44
ex 17
pw 24,200,92
cv 176,16,17
v_mul_f32 v252, s22, v252
pw 24,204,96
ex 18
pw 24,208,100
v_mul_f32 v253, s22, v253
cv 252,252,253
qa 28,208,116,48
ex 19
pw 28,204,112
cv 177,18,19
v_accvgpr_write_b32 a217, v252
pw 28,200,108
ex 20
pw 28,196,104
v_lshlrev_b32 v252, 16, v226
v_and_b32 v253, s28, v226
qa 32,196,120,52
global_load_lds_dwordx4 v13, s[96:97] offset:3072 nt
lk 196,0,20480
pw 32,200,124
s_add_u32 m0, s21, 147456
lk 200,1,20480
v_mul_f32 v252, s22, v252
pw 32,204,128
s_add_u32 s96, s96, 16384
s_addc_u32 s97, s97, 0
lk 204,2,20480
pw 32,208,132
s_waitcnt lgkmcnt(3)
lk 208,3,20480
v_mul_f32 v253, s22, v253
pa 16,136,180
ex 21
pa 16,140,184
ex 22
pa 48,148,184
ex 23
pa 48,144,180
cv 184,20,21
cv 185,22,23
pa 80,152,180
ex 24
pa 80,156,184
ex 25
pa 112,164,184
ex 26
pa 112,160,180
lv 184,214,0
cv 192,24,25
pa 144,168,180
ex 27
pa 148,168,188
lv 180,10,0
cv 193,26,27
pa 116,160,188
lv 182,10,4096
cv 252,252,253
pa 116,164,192
global_load_lds_dwordx4 v12, s[98:99] offset:0 nt
lv 186,214,4096
pa 84,156,192
ex 28
pa 84,152,188
ex 29
pa 52,144,188
ex 30
pa 52,148,192
cv 200,28,29
v_accvgpr_write_b32 a218, v252
pa 20,140,192
lv 192,215,0
v_lshlrev_b32 v252, 16, v227
pa 20,136,188
lv 188,11,0
v_and_b32 v253, s28, v227
v_smfmac_f32_16x16x64_bf16 a[164:167], a[172:175], v[152:159], v14
lv 190,11,4096
v_smfmac_f32_16x16x64_bf16 a[164:167], a[176:179], v[160:167], v14
s_waitcnt lgkmcnt(3)
lv 194,215,4096
qa 16,196,56,36
s_waitcnt vmcnt(17)
ds_write_b32 v254, v255 offset:0
pw 16,200,60
ex 31
pw 16,204,64
cv 201,30,31
v_mul_f32 v252, s22, v252
pw 16,208,68
ex 32
qa 20,208,84,40
ex 33
pw 20,204,80
ex 34
pw 20,200,76
ex 35
pw 20,196,72
global_load_lds_dwordx4 v13, s[98:99] offset:1024 nt
cv 208,32,33
qa 24,196,88,44
cv 209,34,35
v_mul_f32 v253, s22, v253
pw 24,200,92
ex 16
pw 24,204,96
ex 17
pw 24,208,100
ex 18
qa 28,208,116,48
ex 19
pw 28,204,112
cv 178,16,17
cv 179,18,19
pw 28,200,108
ex 20
pw 28,196,104
cv 252,252,253
v_accvgpr_write_b32 a219, v252
qa 32,196,120,52
ex 21
pw 32,200,124
s_waitcnt vmcnt(15)
cv 186,20,21
v_lshlrev_b32 v252, 16, v228
pw 32,204,128

LwY0_3:
s_cbranch_vccnz LwY0_7
ex 22
pw 32,208,132
v_and_b32 v253, s28, v228
v_mul_f32 v252, s22, v252
pa 24,136,180
ds_read_b32 v255, v12 offset:1024
v_mul_f32 v253, s22, v253
pa 24,140,184
global_load_lds_dwordx4 v12, s[98:99] offset:2048 nt
cv 252,252,253
pa 56,148,184
ex 23
pa 56,144,180
cv 187,22,23
v_accvgpr_write_b32 a220, v252
pa 88,152,180
ex 24
pa 88,156,184
ex 25
pa 120,164,184
ex 26
pa 120,160,180
s_waitcnt lgkmcnt(0)
v_cmp_gt_u32 vcc, 4, v255
cv 194,24,25
pa 152,168,180
ex 27
pa 156,168,188
s_cbranch_vccnz LsY4
LrY4:
lk 196,0,32768
cv 195,26,27
pa 124,160,188
lk 200,1,32768
v_mov_b32 v255, 5
pa 124,164,192
lk 204,2,32768
v_lshlrev_b32 v252, 16, v229
pa 92,156,192
lk 208,3,32768
v_and_b32 v253, s28, v229
pa 92,152,188
ex 28
pa 60,144,188
ex 29
pa 60,148,192
ex 30
pa 28,140,192
s_waitcnt lgkmcnt(3)
global_load_lds_dwordx4 v13, s[98:99] offset:3072 nt
cv 202,28,29
pa 28,136,188
s_add_u32 m0, s21, 49152
ex 31
pv 168,172,168
s_add_u32 s98, s98, 16384
s_addc_u32 s99, s99, 0
lv 180,4,16384
qa 16,196,56,36
s_waitcnt lgkmcnt(2)
lv 182,4,20480
cv 203,30,31
pw 16,200,60
lv 184,172,16384
v_mul_f32 v252, s22, v252
pw 16,204,64
s_waitcnt lgkmcnt(3)
lv 186,172,20480
v_mul_f32 v253, s22, v253
pw 16,208,68
ex 32
qa 20,208,84,40
ex 33
pw 20,204,80
ex 34
pw 20,200,76
ex 35
pw 20,196,72
lv 188,5,16384
cv 210,32,33
qa 24,196,88,44
lv 190,5,20480
cv 211,34,35
pw 24,200,92
lv 192,173,16384
cv 252,252,253
pw 24,204,96
lv 194,173,20480
v_accvgpr_write_b32 a221, v252
pw 24,208,100
ex 16
qa 28,208,116,48
ex 17
pw 28,204,112
ex 18
pw 28,200,108
ex 19
pw 28,196,104
buffer_load_dwordx4 v[244:247], v15, s[4:7], s38 offen offset:128 nt
qa 32,196,120,52
s_add_u32 s38, s26, 8192
lk 196,0,36864
cv 136,16,17
pw 32,200,124
lk 200,1,36864
cv 137,18,19
pw 32,204,128
lk 204,2,36864
v_xor_b32 v0, 0x2000, v0
pw 32,208,132
s_waitcnt lgkmcnt(3)
lk 208,3,36864
v_xor_b32 v1, 0x2000, v1
pa 0,176,180
ex 20
pa 0,180,184
ex 21
pa 32,188,184
ex 22
pa 32,184,180
ex 23
pa 64,192,180
cv 144,20,21
cv 145,22,23
pa 64,196,184
ex 24
pa 96,204,184
ex 25
pa 96,200,180
ex 26
pa 128,208,180
ex 27
pa 132,208,188
lv 180,6,16384
cv 152,24,25
pa 100,200,188
lv 182,6,20480
cv 153,26,27
pa 100,204,192
ex 28
pa 68,196,192
ex 29
pa 68,192,188
lv 184,174,16384
cv 160,28,29
pa 36,184,188
ex 30
pa 36,188,192
lv 186,174,20480
v_xor_b32 v2, 0x2000, v2
pa 4,180,192
ex 31
pa 4,176,188
lv 188,7,16384
cv 161,30,31
v_smfmac_f32_16x16x64_bf16 a[160:163], a[172:175], v[176:183], v14
s_waitcnt lgkmcnt(3)
lv 190,7,20480
qa 16,196,56,36
ex 32
pw 16,200,60
ex 33
pw 16,204,64
lv 192,175,16384
cv 168,32,33
pw 16,208,68
ex 34
qa 20,208,84,40
lv 194,175,20480
v_xor_b32 v3, 0x2000, v3
pw 20,204,80
ex 35
pw 20,200,76
buffer_load_dwordx4 v[248:251], v15, s[4:7], s39 offen offset:160 nt
pw 20,196,72
s_add_u32 s39, s26, 8192
cv 169,34,35
v_lshlrev_b32 v252, 16, v230
qa 24,196,88,44
ex 16
pw 24,200,92
ex 17
pw 24,204,96
ex 18
pw 24,208,100
cv 138,16,17
v_and_b32 v253, s28, v230
qa 28,208,116,48
ex 19
pw 28,204,112
cv 139,18,19
v_mul_f32 v252, s22, v252
pw 28,200,108
ex 20
pw 28,196,104
v_mul_f32 v253, s22, v253
cv 252,252,253
qa 32,196,120,52
lk 196,0,32768
v_accvgpr_write_b32 a222, v252
pw 32,200,124
lk 200,1,32768
v_lshlrev_b32 v252, 16, v231
pw 32,204,128
lk 204,2,32768
v_and_b32 v253, s28, v231
pw 32,208,132
lk 208,3,32768
v_mul_f32 v252, s22, v252
pa 8,176,180
s_waitcnt lgkmcnt(4)
ex 21
pa 8,180,184
ex 22
pa 40,188,184
global_load_lds_dwordx4 v12, s[96:97] offset:0 nt
cv 146,20,21
pa 40,184,180
ex 23
pa 72,192,180
cv 147,22,23
v_mul_f32 v253, s22, v253
pa 72,196,184
ex 24
pa 104,204,184
ex 25
pa 104,200,180
ex 26
pa 136,208,180
ex 27
pa 140,208,188
lv 180,8,16384
cv 154,24,25
pa 108,200,188
global_load_lds_dwordx4 v13, s[96:97] offset:1024 nt
cv 155,26,27
pa 108,204,192
lv 182,8,20480
cv 252,252,253
pa 76,196,192
lv 184,212,16384
v_accvgpr_write_b32 a223, v252
pa 76,192,188
s_waitcnt vmcnt(17)
lv 186,212,20480
v_lshlrev_b32 v252, 16, v232
pa 44,184,188
ex 28
pa 44,188,192
ex 29
pa 12,180,192
ex 30
pa 12,176,188
ex 31
v_smfmac_f32_16x16x64_bf16 a[160:163], a[176:179], v[184:191], v14
s_waitcnt lgkmcnt(3)
lv 188,9,16384
qa 16,196,56,36
lv 190,9,20480
cv 162,28,29
pw 16,200,60
lv 192,213,16384
cv 163,30,31
pw 16,204,64
lv 194,213,20480
v_and_b32 v253, s28, v232
pw 16,208,68
ex 32
qa 20,208,84,40
ex 33
pw 20,204,80
ex 34
pw 20,200,76
global_load_lds_dwordx4 v12, s[96:97] offset:2048 nt
cv 170,32,33
pw 20,196,72
ex 16
qa 24,196,88,44
ex 35
pw 24,200,92
ex 17
pw 24,204,96
cv 140,16,17
cv 171,34,35
pw 24,208,100
ex 18
qa 28,208,116,48
lk 208,3,36864
v_mul_f32 v252, s22, v252
pw 28,204,112
lk 204,2,36864
v_mul_f32 v253, s22, v253
pw 28,200,108
lk 200,1,36864
cv 252,252,253
pw 28,196,104
s_waitcnt lgkmcnt(3)
lk 196,0,36864
v_accvgpr_write_b32 a224, v252
pa 16,176,180
ex 19
pa 16,180,184
cv 141,18,19
v_lshlrev_b32 v252, 16, v233
pa 48,188,184
ex 20
pa 48,184,180
ex 21
pa 80,192,180
ex 22
pa 80,196,184
global_load_lds_dwordx4 v13, s[96:97] offset:3072 nt
cv 148,20,21
pa 112,204,184
s_add_u32 m0, s21, 98304
ex 23
pa 112,200,180
s_add_u32 s96, s96, 16384
s_addc_u32 s97, s97, 0
lv 184,214,16384
pa 144,208,180
lv 180,10,16384
cv 149,22,23
pa 148,208,188
lv 182,10,20480
v_and_b32 v253, s28, v233
pa 116,200,188
lv 186,214,20480
v_mul_f32 v252, s22, v252
pa 116,204,192
ex 24
pa 84,196,192
ex 25
pa 84,192,188
ex 26
pa 52,184,188
cv 156,24,25
v_mul_f32 v253, s22, v253
pa 52,188,192
ex 27
pa 20,180,192
lv 192,215,16384
cv 157,26,27
pa 20,176,188
lv 188,11,16384
cv 252,252,253
v_smfmac_f32_16x16x64_bf16 a[164:167], a[172:175], v[192:199], v14
lv 190,11,20480
v_smfmac_f32_16x16x64_bf16 a[164:167], a[176:179], v[200:207], v14
s_waitcnt lgkmcnt(3)
lv 194,215,20480
qa 16,196,56,36
s_waitcnt vmcnt(16)
ds_write_b32 v254, v255 offset:0
pw 16,200,60
global_load_lds_dwordx4 v12, s[98:99] offset:0 nt
v_accvgpr_write_b32 a225, v252
pw 16,204,64
ex 28
pw 16,208,68
ex 29
qa 20,208,84,40
ex 30
pw 20,204,80
ex 31
pw 20,200,76
cv 164,28,29
cv 165,30,31
pw 20,196,72
ex 16
qa 24,196,88,44
v_lshlrev_b32 v252, 16, v234
v_and_b32 v253, s28, v234
pw 24,200,92
ex 17
pw 24,204,96
cv 142,16,17
v_mul_f32 v252, s22, v252
pw 24,208,100
ex 18
qa 28,208,116,48
v_mul_f32 v253, s22, v253
cv 252,252,253
pw 28,204,112
ex 19
pw 28,200,108
cv 143,18,19
v_accvgpr_write_b32 a226, v252
pw 28,196,104
global_load_lds_dwordx4 v13, s[98:99] offset:1024 nt
v_lshlrev_b32 v252, 16, v235
pa 24,176,180
ds_read_b32 v255, v12 offset:1024
v_and_b32 v253, s28, v235
pa 24,180,184
ex 20
pa 56,188,184
ex 21
pa 56,184,180
cv 150,20,21
v_mul_f32 v252, s22, v252
pa 88,192,180
ex 22
pa 88,196,184
v_mul_f32 v253, s22, v253
cv 252,252,253
pa 120,204,184
ex 23
pa 120,200,180
s_waitcnt lgkmcnt(0)
v_cmp_gt_u32 vcc, 5, v255
cv 151,22,23
pa 152,208,180
ex 24
pa 156,208,188
s_cbranch_vccnz LsY5
LrY5:
lk 196,0,49152
v_mov_b32 v255, 6
pa 124,200,188
lk 200,1,49152
v_accvgpr_write_b32 a227, v252
pa 124,204,192
s_waitcnt vmcnt(17)
lk 204,2,49152
v_lshlrev_b32 v252, 16, v236
pa 92,196,192
lk 208,3,49152
v_and_b32 v253, s28, v236
pa 92,192,188
ex 25
pa 60,184,188
global_load_lds_dwordx4 v12, s[98:99] offset:2048 nt
cv 158,24,25
pa 60,188,192
ex 26
pa 28,180,192
ex 27
pa 28,176,188
lv 180,4,32768
cv 159,26,27
pv 168,172,208
s_waitcnt lgkmcnt(3)
lv 182,4,36864
v_mul_f32 v252, s22, v252
qa 16,196,56,36
lv 184,172,32768
v_mul_f32 v253, s22, v253
pw 16,200,60
s_waitcnt lgkmcnt(3)
lv 186,172,36864
cv 252,252,253
pw 16,204,64
ex 28
pw 16,208,68
ex 29
qa 20,208,84,40
ex 30
pw 20,204,80
ex 31
pw 20,200,76
lv 188,5,32768
cv 166,28,29
pw 20,196,72
lv 190,5,36864
cv 167,30,31
qa 24,196,88,44
lv 192,173,32768
v_accvgpr_write_b32 a228, v252
pw 24,200,92
lv 194,173,36864
v_lshlrev_b32 v252, 16, v237
pw 24,204,96
global_load_lds_dwordx4 v13, s[98:99] offset:3072 nt
s_add_u32 m0, s21, 65536
pw 24,208,100
s_add_u32 s98, s98, 16384
s_addc_u32 s99, s99, 0
v_and_b32 v253, s28, v237
qa 28,208,116,48
lk 208,3,53248
v_xor_b32 v3, 0x2000, v3
pw 28,204,112
lk 204,2,53248
v_xor_b32 v2, 0x2000, v2
pw 28,200,108
lk 200,1,53248
v_xor_b32 v1, 0x2000, v1
pw 28,196,104
s_waitcnt lgkmcnt(5)
lk 196,0,53248
v_xor_b32 v0, 0x2000, v0
pa 0,136,180
ex 16
pa 0,140,184
ex 17
pa 32,148,184
ex 18
pa 32,144,180
ex 19
pa 64,152,180
buffer_load_dwordx4 a[244:247], v15, s[4:7], s36 offen offset:0 nt
pa 64,156,184
s_add_u32 s36, s26, 12288
cv 180,16,17
cv 181,18,19
pa 96,164,184
ex 20
pa 96,160,180
ex 21
pa 128,168,180
ex 22
pa 132,168,188
ex 23
pa 100,160,188
s_waitcnt lgkmcnt(0)
lv 180,6,32768
cv 188,20,21
pa 100,164,192
lv 182,6,36864
cv 189,22,23
pa 68,156,192
ex 24
pa 68,152,188
ex 25
pa 36,144,188
ex 26
pa 36,148,192
ex 27
pa 4,140,192
lv 184,174,32768
cv 196,24,25
pa 4,136,188
lv 186,174,36864
cv 197,26,27
v_smfmac_f32_16x16x64_bf16 a[160:163], a[172:175], v[136:143], v14
lv 188,7,32768
qa 16,196,56,36
ex 28
pw 16,200,60
ex 29
pw 16,204,64
ex 30
pw 16,208,68
lv 190,7,36864
cv 204,28,29
qa 20,208,84,40
ex 31
pw 20,204,80
lv 192,175,32768
cv 205,30,31
pw 20,200,76
lv 194,175,36864
v_mul_f32 v252, s22, v252
pw 20,196,72
ex 16
qa 24,196,88,44
buffer_load_dwordx4 a[248:251], v15, s[4:7], s37 offen offset:32 nt
pw 24,200,92
s_add_u32 s37, s26, 12288
ex 17
pw 24,204,96
cv 182,16,17
v_mul_f32 v253, s22, v253
pw 24,208,100
ex 18
qa 28,208,116,48
lk 208,3,49152
cv 252,252,253
pw 28,204,112
lk 204,2,49152
v_accvgpr_write_b32 a229, v252
pw 28,200,108
lk 200,1,49152
v_lshlrev_b32 v252, 16, v238
pw 28,196,104
s_waitcnt lgkmcnt(3)
lk 196,0,49152
v_and_b32 v253, s28, v238
pa 8,136,180
ex 19
pa 8,140,184
cv 183,18,19
v_mul_f32 v252, s22, v252
pa 40,148,184
ex 20
pa 40,144,180
ex 21
pa 72,152,180
ex 22
pa 72,156,184
cv 190,20,21
v_mul_f32 v253, s22, v253
pa 104,164,184
ex 23
pa 104,160,180
lv 184,212,32768
cv 191,22,23
pa 136,168,180
ex 24
pa 140,168,188
lv 180,8,32768
cv 252,252,253
pa 108,160,188

LwY0_4:
s_cbranch_vccnz LwY0_8
ex 25
pa 108,164,192
lv 182,8,36864
cv 198,24,25
pa 76,156,192
ex 26
pa 76,152,188
lv 186,212,36864
v_accvgpr_write_b32 a230, v252
pa 44,144,188
v_lshlrev_b32 v252, 16, v239
v_and_b32 v253, s28, v239
pa 44,148,192
ex 27
pa 12,140,192
lv 192,213,32768
cv 199,26,27
pa 12,136,188
global_load_lds_dwordx4 v12, s[96:97] offset:0 nt
lv 188,9,32768
v_smfmac_f32_16x16x64_bf16 a[160:163], a[176:179], v[144:151], v14
s_waitcnt lgkmcnt(4)
lv 190,9,36864
qa 16,196,56,36
ex 28
pw 16,200,60
ex 29
pw 16,204,64
ex 30
pw 16,208,68
lv 194,213,36864
cv 206,28,29
qa 20,208,84,40
ex 31
pw 20,204,80
cv 207,30,31
v_mul_f32 v252, s22, v252
pw 20,200,76
v_mul_f32 v253, s22, v253
cv 252,252,253
pw 20,196,72
ex 16
qa 24,196,88,44
ex 17
pw 24,200,92
cv 176,16,17
v_accvgpr_write_b32 a231, v252
pw 24,204,96
ex 18
pw 24,208,100
s_waitcnt vmcnt(21)
v_lshlrev_b32 v252, 16, v240
v_and_b32 v253, s28, v240
qa 28,208,116,48
ex 19
pw 28,204,112
global_load_lds_dwordx4 v13, s[96:97] offset:1024 nt
cv 177,18,19
pw 28,200,108
ex 20
pw 28,196,104
v_mul_f32 v252, s22, v252
v_mul_f32 v253, s22, v253
qa 32,196,120,52
lk 196,0,53248
cv 252,252,253
pw 32,200,124
lk 200,1,53248
v_accvgpr_write_b32 a232, v252
pw 32,204,128
lk 204,2,53248
v_lshlrev_b32 v252, 16, v241
pw 32,208,132
s_waitcnt lgkmcnt(3)
lk 208,3,53248
v_and_b32 v253, s28, v241
pa 16,136,180
ex 21
pa 16,140,184
ex 22
pa 48,148,184
ex 23
pa 48,144,180
cv 184,20,21
cv 185,22,23
pa 80,152,180
ex 24
pa 80,156,184
ex 25
pa 112,164,184
ex 26
pa 112,160,180
lv 184,214,32768
cv 192,24,25
pa 144,168,180
global_load_lds_dwordx4 v12, s[96:97] offset:2048 nt
lv 180,10,32768
pa 148,168,188
ex 27
pa 116,160,188
lv 182,10,36864
cv 193,26,27
pa 116,164,192
lv 186,214,36864
v_mul_f32 v252, s22, v252
pa 84,156,192
ex 28
pa 84,152,188
ex 29
pa 52,144,188
ex 30
pa 52,148,192
cv 200,28,29
v_mul_f32 v253, s22, v253
pa 20,140,192
lv 192,215,32768
cv 252,252,253
pa 20,136,188
lv 188,11,32768
v_accvgpr_write_b32 a233, v252
v_smfmac_f32_16x16x64_bf16 a[164:167], a[172:175], v[152:159], v14
lv 190,11,36864
v_smfmac_f32_16x16x64_bf16 a[164:167], a[176:179], v[160:167], v14
s_waitcnt lgkmcnt(3)
lv 194,215,36864
qa 16,196,56,36
s_waitcnt vmcnt(15)
ds_write_b32 v254, v255 offset:0
pw 16,200,60
ex 31
pw 16,204,64
cv 201,30,31
v_lshlrev_b32 v252, 16, v242
pw 16,208,68
global_load_lds_dwordx4 v13, s[96:97] offset:3072 nt
s_add_u32 m0, s21, 114688
qa 20,208,84,40
s_add_u32 s96, s96, 16384
s_addc_u32 s97, s97, 0
v_and_b32 v253, s28, v242
pw 20,204,80
ex 32
pw 20,200,76
ex 33
pw 20,196,72
ex 34
qa 24,196,88,44
ex 35
pw 24,200,92
cv 208,32,33
cv 209,34,35
pw 24,204,96
ex 16
pw 24,208,100
ex 17
qa 28,208,116,48
ex 18
pw 28,204,112
ex 19
pw 28,200,108
cv 178,16,17
cv 179,18,19
pw 28,196,104
ex 20
qa 32,196,120,52
ex 21
pw 32,200,124
cv 186,20,21
v_mul_f32 v252, s22, v252
pw 32,204,128
global_load_lds_dwordx4 v12, s[98:99] offset:0 nt
v_mul_f32 v253, s22, v253
pw 32,208,132
ex 22
pa 24,136,180
ds_read_b32 v255, v12 offset:1024
cv 252,252,253
pa 24,140,184
ex 23
pa 56,148,184
cv 187,22,23
v_accvgpr_write_b32 a234, v252
pa 56,144,180
ex 24
pa 88,152,180
ex 25
pa 88,156,184
cv 194,24,25
v_lshlrev_b32 v252, 16, v243
pa 120,164,184
ex 26
pa 120,160,180
s_waitcnt lgkmcnt(0)
v_cmp_gt_u32 vcc, 6, v255
v_and_b32 v253, s28, v243
pa 152,168,180
ex 27
pa 156,168,188
s_cbranch_vccnz LsY6
LrY6:
lk 196,0,0
cv 195,26,27
pa 124,160,188
lk 200,1,0
v_mov_b32 v255, 7
pa 124,164,192
lk 204,2,0
v_mul_f32 v252, s22, v252
pa 92,156,192
lk 208,3,0
v_mul_f32 v253, s22, v253
pa 92,152,188
global_load_lds_dwordx4 v13, s[98:99] offset:1024 nt
lv 180,4,49152
pa 60,144,188
ex 28
pa 60,148,192
ex 29
pa 28,140,192
ex 30
pa 28,136,188
ex 31
pv 168,172,168
s_waitcnt lgkmcnt(3)
lv 182,4,53248
cv 202,28,29
qa 16,196,56,36
lv 184,172,49152
cv 203,30,31
pw 16,200,60
s_waitcnt lgkmcnt(3)
lv 186,172,53248
cv 252,252,253
pw 16,204,64
ex 32
pw 16,208,68
ex 33
qa 20,208,84,40
ex 34
pw 20,204,80
ex 35
pw 20,200,76
lv 188,5,49152
cv 210,32,33
pw 20,196,72
lv 190,5,53248
cv 211,34,35
qa 24,196,88,44
lv 192,173,49152
v_accvgpr_write_b32 a235, v252
pw 24,200,92
global_load_lds_dwordx4 v12, s[98:99] offset:2048 nt
lv 194,173,53248
pw 24,204,96
ex 16
pw 24,208,100
ex 17
qa 28,208,116,48
ex 18
pw 28,204,112
ex 19
pw 28,200,108
buffer_load_dwordx4 a[252:255], v15, s[4:7], s38 offen offset:128 nt
pw 28,196,104
s_add_u32 s38, s26, 12288
cv 136,16,17
cv 137,18,19
qa 32,196,120,52
lk 196,0,4096
v_xor_b32 v0, 0x2000, v0
pw 32,200,124
lk 200,1,4096
v_xor_b32 v1, 0x2000, v1
pw 32,204,128
lk 204,2,4096
v_xor_b32 v2, 0x2000, v2
pw 32,208,132
s_waitcnt lgkmcnt(3)
lk 208,3,4096
v_xor_b32 v3, 0x2000, v3
pa 0,176,180
ex 20
pa 0,180,184
ex 21
pa 32,188,184
ex 22
pa 32,184,180
ex 23
pa 64,192,180
cv 144,20,21
cv 145,22,23
pa 64,196,184
ex 24
pa 96,204,184
ex 25
pa 96,200,180
ex 26
pa 128,208,180
ex 27
pa 132,208,188
lv 180,6,49152
cv 152,24,25
pa 100,200,188
global_load_lds_dwordx4 v13, s[98:99] offset:3072 nt
cv 153,26,27
pa 100,204,192
s_add_u32 m0, s21, 81920
ex 28
pa 68,196,192
s_add_u32 s98, s98, 16384
s_addc_u32 s99, s99, 0
lv 182,6,53248
pa 68,192,188
ex 29
pa 36,184,188
ex 30
pa 36,188,192
lv 184,174,49152
cv 160,28,29
pa 4,180,192
ex 31
pa 4,176,188
lv 186,174,53248
cv 161,30,31
v_smfmac_f32_16x16x64_bf16 a[160:163], a[172:175], v[176:183], v14
s_waitcnt lgkmcnt(3)
lv 188,7,49152
qa 16,196,56,36
ex 32
pw 16,200,60
ex 33
pw 16,204,64
lv 190,7,53248
cv 168,32,33
pw 16,208,68
ex 34
qa 20,208,84,40
s_waitcnt vmcnt(20)
lv 192,175,49152
v_lshlrev_b32 v252, 16, v244
pw 20,204,80
ex 35
pw 20,200,76
lv 194,175,53248
cv 169,34,35
pw 20,196,72
ex 16
qa 24,196,88,44
ex 17
pw 24,200,92
buffer_load_dwordx4 v[216:219], v15, s[4:7], s39 offen offset:160 nt
pw 24,204,96
s_add_u32 s39, s26, 12288
ex 18
pw 24,208,100
cv 138,16,17
v_and_b32 v253, s28, v244
qa 28,208,116,48
ex 19
pw 28,204,112
cv 139,18,19
v_mul_f32 v252, s22, v252
pw 28,200,108
ex 20
pw 28,196,104
v_mul_f32 v253, s22, v253
cv 252,252,253
qa 32,196,120,52
lk 196,0,0
v_accvgpr_write_b32 a236, v252
pw 32,200,124
lk 200,1,0
v_lshlrev_b32 v252, 16, v245
pw 32,204,128
lk 204,2,0
v_and_b32 v253, s28, v245
pw 32,208,132
s_waitcnt lgkmcnt(3)
lk 208,3,0
v_mul_f32 v252, s22, v252
pa 8,176,180
ex 21
pa 8,180,184
ex 22
pa 40,188,184
ex 23
pa 40,184,180
cv 146,20,21
cv 147,22,23
pa 72,192,180
ex 24
pa 72,196,184
ex 25
pa 104,204,184
ex 26
pa 104,200,180
lv 184,212,49152
cv 154,24,25
pa 136,208,180
ex 27
pa 140,208,188
lv 180,8,49152
cv 155,26,27
pa 108,200,188
lv 182,8,53248
v_mul_f32 v253, s22, v253
pa 108,204,192
lv 186,212,53248
cv 252,252,253
pa 76,196,192
ex 28
pa 76,192,188
ex 29
pa 44,184,188
ex 30
pa 44,188,192
buffer_load_dwordx4 v[220:223], v15, s[4:7], s36 offen offset:0 nt
pa 12,180,192
s_mov_b32 s36, s27
ex 31
pa 12,176,188
lv 188,9,49152
cv 162,28,29
v_smfmac_f32_16x16x64_bf16 a[160:163], a[176:179], v[184:191], v14
s_waitcnt lgkmcnt(2)
lv 190,9,53248
qa 16,196,56,36
lv 192,213,49152
cv 163,30,31
pw 16,200,60
lv 194,213,53248
v_accvgpr_write_b32 a237, v252
pw 16,204,64
ex 32
pw 16,208,68
ex 33
qa 20,208,84,40
ex 34
pw 20,204,80
ex 35
pw 20,200,76
cv 170,32,33
cv 171,34,35
pw 20,196,72
ex 16
qa 24,196,88,44
v_lshlrev_b32 v252, 16, v246
v_and_b32 v253, s28, v246
pw 24,200,92
ex 17
pw 24,204,96
cv 140,16,17
v_mul_f32 v252, s22, v252
pw 24,208,100
ex 18
qa 28,208,116,48
global_load_lds_dwordx4 v12, s[96:97] offset:0 nt
lk 208,3,4096
pw 28,204,112
lk 204,2,4096
v_mul_f32 v253, s22, v253
pw 28,200,108
lk 200,1,4096
cv 252,252,253
pw 28,196,104
lk 196,0,4096
v_accvgpr_write_b32 a238, v252
pa 16,176,180
s_waitcnt lgkmcnt(4)
ex 19
pa 16,180,184
buffer_load_dwordx4 v[224:227], v15, s[4:7], s37 offen offset:32 nt
pa 48,188,184
s_mov_b32 s37, s27
cv 141,18,19
v_lshlrev_b32 v252, 16, v247
pa 48,184,180
ex 20
pa 80,192,180
ex 21
pa 80,196,184
ex 22
pa 112,204,184
ex 23
pa 112,200,180
lv 184,214,49152
cv 148,20,21
pa 144,208,180
lv 180,10,49152
cv 149,22,23
pa 148,208,188
lv 182,10,53248
v_and_b32 v253, s28, v247
pa 116,200,188
lv 186,214,53248
v_mul_f32 v252, s22, v252
pa 116,204,192
ex 24
pa 84,196,192
ex 25
pa 84,192,188
ex 26
pa 52,184,188
cv 156,24,25
v_mul_f32 v253, s22, v253
pa 52,188,192
ex 27
pa 20,180,192
lv 192,215,49152
cv 157,26,27
pa 20,176,188
global_load_lds_dwordx4 v13, s[96:97] offset:1024 nt
lv 188,11,49152
v_smfmac_f32_16x16x64_bf16 a[164:167], a[172:175], v[192:199], v14
lv 190,11,53248
v_smfmac_f32_16x16x64_bf16 a[164:167], a[176:179], v[200:207], v14
s_waitcnt lgkmcnt(3)
lv 194,215,53248
qa 16,196,56,36
s_waitcnt vmcnt(16)
ds_write_b32 v254, v255 offset:0
pw 16,200,60
global_load_lds_dwordx4 v12, s[96:97] offset:2048 nt
cv 252,252,253
pw 16,204,64
ex 28
pw 16,208,68
ex 29
qa 20,208,84,40
ex 30
pw 20,204,80
ex 31
pw 20,200,76
buffer_load_dwordx4 v[228:231], v15, s[4:7], s38 offen offset:128 nt
pw 20,196,72
s_mov_b32 s38, s27
cv 164,28,29
cv 165,30,31
qa 24,196,88,44
ex 16
pw 24,200,92
ex 17
pw 24,204,96
cv 142,16,17
v_accvgpr_write_b32 a239, v252
pw 24,208,100
ex 18
qa 28,208,116,48
v_lshlrev_b32 v252, 16, v248
v_and_b32 v253, s28, v248
pw 28,204,112
ex 19
pw 28,200,108
cv 143,18,19
v_mul_f32 v252, s22, v252
pw 28,196,104
ex 20
pa 24,176,180
ds_read_b32 v255, v12 offset:1024
v_mul_f32 v253, s22, v253
pa 24,180,184
ex 21
pa 56,188,184
cv 150,20,21
cv 252,252,253
pa 56,184,180
v_accvgpr_write_b32 a240, v252
v_lshlrev_b32 v252, 16, v249
pa 88,192,180
ex 22
pa 88,196,184
v_and_b32 v253, s28, v249
v_mul_f32 v252, s22, v252
pa 120,204,184
global_load_lds_dwordx4 v13, s[96:97] offset:3072 nt
s_add_u32 m0, s21, 131072
pa 120,200,180
s_add_u32 s96, s96, 16384
s_addc_u32 s97, s97, 0
s_waitcnt lgkmcnt(0)
v_cmp_gt_u32 vcc, 7, v255
pa 152,208,180
ex 23
pa 156,208,188
s_cbranch_vccnz LsY7
LrY7:
lk 196,0,16384
cv 151,22,23
pa 124,200,188
lk 200,1,16384
v_mov_b32 v255, 8
pa 124,204,192
lk 204,2,16384
v_mul_f32 v253, s22, v253
pa 92,196,192
lk 208,3,16384
global_load_lds_dwordx4 v12, s[98:99] offset:0 nt
pa 92,192,188
ex 24
pa 60,184,188
ex 25
pa 60,188,192
ex 26
pa 28,180,192
ex 27
pa 28,176,188
lv 180,4,0
cv 158,24,25
pv 168,172,208
s_waitcnt lgkmcnt(3)
lv 182,4,4096
cv 159,26,27

LwY0_5:
s_cbranch_vccnz LwY0_9
qa 16,196,56,36
lv 184,172,0
cv 252,252,253
pw 16,200,60
s_waitcnt lgkmcnt(3)
lv 186,172,4096
v_accvgpr_write_b32 a241, v252
pw 16,204,64
ex 28
pw 16,208,68
ex 29
qa 20,208,84,40
ex 30
pw 20,204,80
ex 31
pw 20,200,76
lv 188,5,0
cv 166,28,29
pw 20,196,72
lv 190,5,4096
cv 167,30,31
qa 24,196,88,44
global_load_lds_dwordx4 v13, s[98:99] offset:1024 nt
lv 192,173,0
pw 24,200,92
lv 194,173,4096
v_lshlrev_b32 v252, 16, v250
pw 24,204,96
ex 16
pw 24,208,100
ex 17
qa 28,208,116,48
lk 208,3,20480
cv 180,16,17
pw 28,204,112
lk 204,2,20480
v_xor_b32 v2, 0x2000, v2
pw 28,200,108
lk 200,1,20480
v_xor_b32 v1, 0x2000, v1
pw 28,196,104
s_waitcnt lgkmcnt(5)
lk 196,0,20480
v_xor_b32 v0, 0x2000, v0
pa 0,136,180
ex 18
pa 0,140,184
ex 19
pa 32,148,184
buffer_load_dwordx4 v[232:235], v15, s[4:7], s39 offen offset:160 nt
pa 32,144,180
s_mov_b32 s39, s27
cv 181,18,19
v_xor_b32 v3, 0x2000, v3
pa 64,152,180
ex 20
pa 64,156,184
ex 21
pa 96,164,184
ex 22
pa 96,160,180
ex 23
pa 128,168,180
lv 180,6,0
cv 188,20,21
pa 132,168,188
lv 182,6,4096
cv 189,22,23
pa 100,160,188
s_waitcnt lgkmcnt(2)
ex 24
pa 100,164,192
ex 25
pa 68,156,192
ex 26
pa 68,152,188
lv 184,174,0
cv 196,24,25
pa 36,144,188
lv 186,174,4096
v_and_b32 v253, s28, v250
pa 36,148,192
ex 27
pa 4,140,192
lv 192,175,0
cv 197,26,27
pa 4,136,188
ex 28
v_smfmac_f32_16x16x64_bf16 a[160:163], a[172:175], v[136:143], v14
global_load_lds_dwordx4 v12, s[98:99] offset:2048 nt
qa 16,196,56,36
ex 29
pw 16,200,60
lv 188,7,0
cv 204,28,29
pw 16,204,64
ex 30
pw 16,208,68
lv 190,7,4096
global_load_lds_dwordx4 v13, s[98:99] offset:3072 nt
qa 20,208,84,40
s_add_u32 m0, s21, 32768
ex 31
pw 20,204,80
s_add_u32 s98, s98, 16384
s_addc_u32 s99, s99, 0
lv 194,175,4096
pw 20,200,76
cv 205,30,31
v_mul_f32 v252, s22, v252
pw 20,196,72
ex 16
qa 24,196,88,44
buffer_load_dwordx4 v[236:239], v15, s[4:7], s36 offen offset:0 nt
pw 24,200,92
s_add_u32 s36, s21, 2048
ex 17
pw 24,204,96
cv 182,16,17
v_mul_f32 v253, s22, v253
pw 24,208,100
ex 18
qa 28,208,116,48
lk 208,3,16384
cv 252,252,253
pw 28,204,112
lk 204,2,16384
v_accvgpr_write_b32 a242, v252
pw 28,200,108
lk 200,1,16384
v_lshlrev_b32 v252, 16, v251
pw 28,196,104
s_waitcnt lgkmcnt(3)
lk 196,0,16384
v_and_b32 v253, s28, v251
pa 8,136,180
ex 19
pa 8,140,184
cv 183,18,19
v_mul_f32 v252, s22, v252
pa 40,148,184
ex 20
pa 40,144,180
ex 21
pa 72,152,180
ex 22
pa 72,156,184
cv 190,20,21
v_mul_f32 v253, s22, v253
pa 104,164,184
ex 23
pa 104,160,180
lv 184,212,0
cv 191,22,23
pa 136,168,180
ex 24
pa 140,168,188
lv 180,8,0
cv 252,252,253
pa 108,160,188
ex 25
pa 108,164,192
lv 182,8,4096
cv 198,24,25
pa 76,156,192
ex 26
pa 76,152,188
lv 186,212,4096
v_accvgpr_write_b32 a243, v252
pa 44,144,188
buffer_load_dwordx4 v[240:243], v15, s[4:7], s37 offen offset:32 nt
pa 44,148,192
s_add_u32 s37, s21, 0
ex 27
pa 12,140,192
lv 192,213,0
cv 199,26,27
pa 12,136,188
ex 28
v_smfmac_f32_16x16x64_bf16 a[160:163], a[176:179], v[144:151], v14
s_waitcnt lgkmcnt(3)
lv 188,9,0
qa 16,196,56,36
ex 29
pw 16,200,60
lv 190,9,4096
cv 206,28,29
pw 16,204,64
ex 30
pw 16,208,68
s_waitcnt vmcnt(25)
lv 194,213,4096
v_accvgpr_read_b32 v253, a244
qa 20,208,84,40
ex 31
pw 20,204,80
cv 207,30,31
v_lshlrev_b32 v252, 16, v253
pw 20,200,76
v_and_b32 v253, s28, v253
v_mul_f32 v252, s22, v252
pw 20,196,72
ex 16
qa 24,196,88,44
ex 17
pw 24,200,92
cv 176,16,17
v_mul_f32 v253, s22, v253
pw 24,204,96
ex 18
pw 24,208,100
buffer_load_dwordx4 v[244:247], v15, s[4:7], s38 offen offset:128 nt
qa 28,208,116,48
s_add_u32 s38, s24, 8192
ex 19
pw 28,204,112
s_add_u32 s38, s38, s3
cv 177,18,19
cv 252,252,253
pw 28,200,108
ex 20
pw 28,196,104
v_accvgpr_write_b32 a244, v252
v_accvgpr_read_b32 v253, a245
qa 32,196,120,52
lk 196,0,20480
v_lshlrev_b32 v252, 16, v253
pw 32,200,124
lk 200,1,20480
v_and_b32 v253, s28, v253
pw 32,204,128
lk 204,2,20480
v_mul_f32 v252, s22, v252
pw 32,208,132
s_waitcnt lgkmcnt(3)
lk 208,3,20480
v_mul_f32 v253, s22, v253
pa 16,136,180
ex 21
pa 16,140,184
ex 22
pa 48,148,184
ex 23
pa 48,144,180
cv 184,20,21
cv 185,22,23
pa 80,152,180
ex 24
pa 80,156,184
ex 25
pa 112,164,184
ex 26
pa 112,160,180
global_load_lds_dwordx4 v12, s[96:97] offset:0 nt
cv 192,24,25
pa 144,168,180
ex 27
pa 148,168,188
lv 180,10,0
cv 193,26,27
pa 116,160,188
lv 182,10,4096
cv 252,252,253
pa 116,164,192
lv 184,214,0
v_accvgpr_write_b32 a245, v252
pa 84,156,192
lv 186,214,4096
v_accvgpr_read_b32 v253, a246
pa 84,152,188
ex 28
pa 52,144,188
ex 29
pa 52,148,192
ex 30
pa 20,140,192
lv 192,215,0
cv 200,28,29
pa 20,136,188
lv 188,11,0
v_lshlrev_b32 v252, 16, v253
v_smfmac_f32_16x16x64_bf16 a[164:167], a[172:175], v[152:159], v14
lv 190,11,4096
v_smfmac_f32_16x16x64_bf16 a[164:167], a[176:179], v[160:167], v14
s_waitcnt lgkmcnt(4)
lv 194,215,4096
qa 16,196,56,36
s_waitcnt vmcnt(17)
global_load_lds_dwordx4 v13, s[96:97] offset:1024 nt
v_and_b32 v253, s28, v253
pw 16,200,60
ds_write_b32 v254, v255 offset:0
pw 16,204,64
ex 31
pw 16,208,68
cv 201,30,31
v_mul_f32 v252, s22, v252
qa 20,208,84,40
ex 32
pw 20,204,80
ex 33
pw 20,200,76
ex 34
pw 20,196,72
ex 35
qa 24,196,88,44
buffer_load_dwordx4 v[248:251], v15, s[4:7], s39 offen offset:160 nt
pw 24,200,92
s_add_u32 s39, s24, 12288
cv 208,32,33
cv 209,34,35
pw 24,204,96
s_add_u32 s39, s39, s3
ex 16
pw 24,208,100
ex 17
qa 28,208,116,48
ex 18
pw 28,204,112
ex 19
pw 28,200,108
cv 178,16,17
cv 179,18,19
pw 28,196,104
ex 20
qa 32,196,120,52
ex 21
pw 32,200,124
cv 186,20,21
v_mul_f32 v253, s22, v253
pw 32,204,128
ex 22
pw 32,208,132
cv 252,252,253
v_accvgpr_write_b32 a246, v252
pa 24,136,180
s_waitcnt lgkmcnt(0)
ds_read_b32 v255, v12 offset:1024
v_accvgpr_read_b32 v253, a247
pa 24,140,184
ex 23
pa 56,148,184
cv 187,22,23
v_lshlrev_b32 v252, 16, v253
pa 56,144,180
ex 24
pa 88,152,180
global_load_lds_dwordx4 v12, s[96:97] offset:2048 nt
v_and_b32 v253, s28, v253
pa 88,156,184
ex 25
pa 120,164,184
ex 26
pa 120,160,180
s_waitcnt lgkmcnt(0)
v_cmp_gt_u32 vcc, 8, v255
cv 194,24,25
pa 152,168,180
ex 27
pa 156,168,188
s_cbranch_vccnz LsY8
LrY8:
lk 196,0,32768
cv 195,26,27
pa 124,160,188
lk 200,1,32768
global_load_lds_dwordx4 v13, s[96:97] offset:3072 nt
pa 124,164,192
s_add_u32 m0, s21, 147456
lk 204,2,32768
v_mov_b32 v255, 9
pa 92,156,192
s_add_u32 s96, s96, 16384
s_addc_u32 s97, s97, 0
lk 208,3,32768
pa 92,152,188
ex 28
pa 60,144,188
ex 29
pa 60,148,192
ex 30
pa 28,140,192
ex 31
pa 28,136,188
lv 180,4,16384
cv 202,28,29
pv 168,172,168
s_waitcnt lgkmcnt(3)
lv 182,4,20480
cv 203,30,31
qa 16,196,56,36
lv 184,172,16384
v_mul_f32 v252, s22, v252
pw 16,200,60
s_waitcnt lgkmcnt(3)
lv 186,172,20480
v_mul_f32 v253, s22, v253
pw 16,204,64
ex 32
pw 16,208,68
ex 33
qa 20,208,84,40
ex 34
pw 20,204,80
ex 35
pw 20,200,76
global_load_lds_dwordx4 v12, s[98:99] offset:0 nt
cv 210,32,33
pw 20,196,72
lv 188,5,16384
cv 211,34,35
qa 24,196,88,44
lv 190,5,20480
cv 252,252,253
pw 24,200,92
lv 192,173,16384
v_accvgpr_write_b32 a247, v252
pw 24,204,96
lv 194,173,20480
v_accvgpr_read_b32 v253, a248
pw 24,208,100
ex 16
qa 28,208,116,48
ex 17
pw 28,204,112
ex 18
pw 28,200,108
ex 19
pw 28,196,104
cv 136,16,17
cv 137,18,19
qa 32,196,120,52
lk 196,0,36864
v_xor_b32 v0, 0x2000, v0
pw 32,200,124
lk 200,1,36864
v_xor_b32 v1, 0x2000, v1
pw 32,204,128
lk 204,2,36864
v_xor_b32 v2, 0x2000, v2
pw 32,208,132
s_waitcnt lgkmcnt(3)
lk 208,3,36864
v_xor_b32 v3, 0x2000, v3
pa 0,176,180
ex 20
pa 0,180,184
global_load_lds_dwordx4 v13, s[98:99] offset:1024 nt
v_lshlrev_b32 v252, 16, v253
pa 32,188,184
ex 21
pa 32,184,180
ex 22
pa 64,192,180
ex 23
pa 64,196,184
cv 144,20,21
cv 145,22,23
pa 96,204,184
ex 24
pa 96,200,180
ex 25
pa 128,208,180
ex 26
pa 132,208,188
ex 27
pa 100,200,188
lv 180,6,16384
cv 152,24,25
pa 100,204,192
lv 182,6,20480
cv 153,26,27
pa 68,196,192
ex 28
pa 68,192,188
ex 29
pa 36,184,188
ex 30
pa 36,188,192
lv 184,174,16384
cv 160,28,29
pa 4,180,192
global_load_lds_dwordx4 v12, s[98:99] offset:2048 nt
lv 186,174,20480
pa 4,176,188
ex 31
v_smfmac_f32_16x16x64_bf16 a[160:163], a[172:175], v[176:183], v14
s_waitcnt lgkmcnt(3)
lv 188,7,16384
qa 16,196,56,36
lv 190,7,20480
cv 161,30,31
pw 16,200,60
ex 32
pw 16,204,64
ex 33
pw 16,208,68
ex 34
qa 20,208,84,40
lv 192,175,16384
cv 168,32,33
pw 20,204,80
ex 35
pw 20,200,76
lv 194,175,20480
cv 169,34,35
pw 20,196,72
ex 16
qa 24,196,88,44
ex 17
pw 24,200,92
cv 138,16,17
v_and_b32 v253, s28, v253
pw 24,204,96
ex 18
pw 24,208,100
v_mul_f32 v252, s22, v252
v_mul_f32 v253, s22, v253
qa 28,208,116,48
global_load_lds_dwordx4 v13, s[98:99] offset:3072 nt
s_add_u32 m0, s21, 49152
pw 28,204,112
s_add_u32 s98, s98, 16384
s_addc_u32 s99, s99, 0
cv 252,252,253
pw 28,200,108
ex 19
pw 28,196,104
cv 139,18,19
v_accvgpr_write_b32 a248, v252
qa 32,196,120,52
lk 196,0,32768
v_accvgpr_read_b32 v253, a249
pw 32,200,124
lk 200,1,32768
v_lshlrev_b32 v252, 16, v253
pw 32,204,128
lk 204,2,32768
v_and_b32 v253, s28, v253
pw 32,208,132
s_waitcnt lgkmcnt(3)
lk 208,3,32768
v_mul_f32 v252, s22, v252
pa 8,176,180
ex 20
pa 8,180,184
ex 21
pa 40,188,184
ex 22
pa 40,184,180
ex 23
pa 72,192,180
cv 146,20,21
cv 147,22,23
pa 72,196,184
ex 24
pa 104,204,184
ex 25
pa 104,200,180
ex 26
pa 136,208,180
ex 27
pa 140,208,188
lv 180,8,16384
cv 154,24,25
pa 108,200,188
lv 182,8,20480
cv 155,26,27
pa 108,204,192
lv 184,212,16384
v_mul_f32 v253, s22, v253
pa 76,196,192
lv 186,212,20480
cv 252,252,253
pa 76,192,188
ex 28
pa 44,184,188
ex 29
pa 44,188,192
ex 30
pa 12,180,192
ex 31
pa 12,176,188
lv 188,9,16384
cv 162,28,29
v_smfmac_f32_16x16x64_bf16 a[160:163], a[176:179], v[184:191], v14
s_waitcnt lgkmcnt(3)
lv 190,9,20480
qa 16,196,56,36
lv 192,213,16384
cv 163,30,31
pw 16,200,60
lv 194,213,20480
v_accvgpr_write_b32 a249, v252
pw 16,204,64

LwY0_6:
s_cbranch_vccnz LwY0_10
ex 32
pw 16,208,68
ex 33
qa 20,208,84,40
ex 34
pw 20,204,80
ex 35
pw 20,200,76
cv 170,32,33
cv 171,34,35
pw 20,196,72
ex 16
qa 24,196,88,44
v_accvgpr_read_b32 v253, a250
v_lshlrev_b32 v252, 16, v253
pw 24,200,92
ex 17
pw 24,204,96
cv 140,16,17
v_and_b32 v253, s28, v253
pw 24,208,100
ex 18
qa 28,208,116,48
lk 208,3,36864
v_mul_f32 v252, s22, v252
pw 28,204,112
lk 204,2,36864
v_mul_f32 v253, s22, v253
pw 28,200,108
lk 200,1,36864
cv 252,252,253
pw 28,196,104
lk 196,0,36864
v_accvgpr_write_b32 a250, v252
pa 16,176,180
s_waitcnt lgkmcnt(4)
ex 19
pa 16,180,184
cv 141,18,19
v_accvgpr_read_b32 v253, a251
pa 48,188,184
ex 20
pa 48,184,180
ex 21
pa 80,192,180
ex 22
pa 80,196,184
cv 148,20,21
v_lshlrev_b32 v252, 16, v253
pa 112,204,184
ex 23
pa 112,200,180
lv 184,214,16384
cv 149,22,23
pa 144,208,180
lv 180,10,16384
v_and_b32 v253, s28, v253
pa 148,208,188
lv 182,10,20480
v_mul_f32 v252, s22, v252
pa 116,200,188
lv 186,214,20480
v_mul_f32 v253, s22, v253
pa 116,204,192
ex 24
pa 84,196,192
ex 25
pa 84,192,188
ex 26
pa 52,184,188
cv 156,24,25
cv 252,252,253
pa 52,188,192
global_load_lds_dwordx4 v12, s[96:97] offset:0 nt
v_accvgpr_write_b32 a251, v252
pa 20,180,192
lv 192,215,16384
v_accvgpr_read_b32 v253, a252
pa 20,176,188
lv 188,11,16384
v_lshlrev_b32 v252, 16, v253
v_smfmac_f32_16x16x64_bf16 a[164:167], a[172:175], v[192:199], v14
lv 190,11,20480
v_smfmac_f32_16x16x64_bf16 a[164:167], a[176:179], v[200:207], v14
s_waitcnt lgkmcnt(3)
lv 194,215,20480
qa 16,196,56,36
s_waitcnt vmcnt(13)
ds_write_b32 v254, v255 offset:0
pw 16,200,60
ex 27
pw 16,204,64
cv 157,26,27
v_and_b32 v253, s28, v253
pw 16,208,68
ex 28
qa 20,208,84,40
ex 29
pw 20,204,80
ex 30
pw 20,200,76
ex 31
pw 20,196,72
cv 164,28,29
cv 165,30,31
qa 24,196,88,44
ex 16
pw 24,200,92
ex 17
pw 24,204,96
global_load_lds_dwordx4 v13, s[96:97] offset:1024 nt
cv 142,16,17
pw 24,208,100
ex 18
qa 28,208,116,48
v_mul_f32 v252, s22, v252
v_mul_f32 v253, s22, v253
pw 28,204,112
ex 19
pw 28,200,108
cv 143,18,19
cv 252,252,253
pw 28,196,104
ex 20
pa 24,176,180
ds_read_b32 v255, v12 offset:1024
v_accvgpr_write_b32 a252, v252
pa 24,180,184
ex 21
pa 56,188,184
cv 150,20,21
v_accvgpr_read_b32 v253, a253
pa 56,184,180
v_lshlrev_b32 v252, 16, v253
v_and_b32 v253, s28, v253
pa 88,192,180
ex 22
pa 88,196,184
v_mul_f32 v252, s22, v252
v_mul_f32 v253, s22, v253
pa 120,204,184
ex 23
pa 120,200,180
s_waitcnt lgkmcnt(0)
v_cmp_gt_u32 vcc, 9, v255
cv 151,22,23
pa 152,208,180
ex 24
pa 156,208,188
s_cbranch_vccnz LsY9
LrY9:
lk 196,0,49152
global_load_lds_dwordx4 v12, s[96:97] offset:2048 nt
pa 124,200,188
lk 200,1,49152
v_mov_b32 v255, 10
pa 124,204,192
lk 204,2,49152
cv 252,252,253
pa 92,196,192
lk 208,3,49152
v_accvgpr_write_b32 a253, v252
pa 92,192,188
ex 25
pa 60,184,188
ex 26
pa 60,188,192
ex 27
pa 28,180,192
lv 180,4,32768
cv 158,24,25
pa 28,176,188
lv 182,4,36864
cv 159,26,27
pv 168,172,208
s_waitcnt lgkmcnt(4)
lv 184,172,32768
v_accvgpr_read_b32 v253, a254
qa 16,196,56,36
lv 186,172,36864
v_lshlrev_b32 v252, 16, v253
pw 16,200,60
s_waitcnt lgkmcnt(4)
ex 28
pw 16,204,64
ex 29
pw 16,208,68
ex 30
qa 20,208,84,40
ex 31
pw 20,204,80
global_load_lds_dwordx4 v13, s[96:97] offset:3072 nt
cv 166,28,29
pw 20,200,76
s_add_u32 m0, s21, 98304
lv 188,5,32768
cv 167,30,31
pw 20,196,72
s_add_u32 s96, s96, 16384
s_addc_u32 s97, s97, 0
lv 190,5,36864
qa 24,196,88,44
lv 192,173,32768
v_and_b32 v253, s28, v253
pw 24,200,92
lv 194,173,36864
v_mul_f32 v252, s22, v252
pw 24,204,96
ex 16
pw 24,208,100
ex 17
qa 28,208,116,48
lk 208,3,53248
cv 180,16,17
pw 28,204,112
lk 204,2,53248
v_xor_b32 v2, 0x2000, v2
pw 28,200,108
lk 200,1,53248
v_xor_b32 v1, 0x2000, v1
pw 28,196,104
s_waitcnt lgkmcnt(5)
lk 196,0,53248
v_xor_b32 v0, 0x2000, v0
pa 0,136,180
ex 18
pa 0,140,184
ex 19
pa 32,148,184
cv 181,18,19
v_xor_b32 v3, 0x2000, v3
pa 32,144,180
ex 20
pa 64,152,180
global_load_lds_dwordx4 v12, s[98:99] offset:0 nt
v_mul_f32 v253, s22, v253
pa 64,156,184
ex 21
pa 96,164,184
ex 22
pa 96,160,180
ex 23
pa 128,168,180
lv 180,6,32768
cv 188,20,21
pa 132,168,188
lv 182,6,36864
cv 189,22,23
pa 100,160,188
s_waitcnt lgkmcnt(2)
ex 24
pa 100,164,192
ex 25
pa 68,156,192
ex 26
pa 68,152,188
lv 184,174,32768
cv 196,24,25
pa 36,144,188
lv 186,174,36864
cv 252,252,253
pa 36,148,192
ex 27
pa 4,140,192
lv 192,175,32768
cv 197,26,27
pa 4,136,188
ex 28
v_smfmac_f32_16x16x64_bf16 a[160:163], a[172:175], v[136:143], v14
lv 188,7,32768
qa 16,196,56,36
global_load_lds_dwordx4 v13, s[98:99] offset:1024 nt
lv 190,7,36864
pw 16,200,60
ex 29
pw 16,204,64
ex 30
pw 16,208,68
lv 194,175,36864
cv 204,28,29
qa 20,208,84,40
ex 31
pw 20,204,80
cv 205,30,31
v_accvgpr_write_b32 a254, v252
pw 20,200,76
v_accvgpr_read_b32 v253, a255
v_lshlrev_b32 v252, 16, v253
pw 20,196,72
ex 16
qa 24,196,88,44
v_and_b32 v253, s28, v253
v_mul_f32 v252, s22, v252
pw 24,200,92
ex 17
pw 24,204,96
cv 182,16,17
v_mul_f32 v253, s22, v253
pw 24,208,100
ex 18
qa 28,208,116,48
lk 208,3,49152
cv 252,252,253
pw 28,204,112
lk 204,2,49152
v_accvgpr_write_b32 a255, v252
pw 28,200,108
lk 200,1,49152
v_lshlrev_b32 v252, 16, v216
pw 28,196,104
s_waitcnt lgkmcnt(3)
global_load_lds_dwordx4 v12, s[98:99] offset:2048 nt
lk 196,0,49152
pa 8,136,180
ex 19
pa 8,140,184
cv 183,18,19
v_and_b32 v253, s28, v216
pa 40,148,184
ex 20
pa 40,144,180
ex 21
pa 72,152,180
ex 22
pa 72,156,184
cv 190,20,21
v_mul_f32 v252, s22, v252
pa 104,164,184
ex 23
pa 104,160,180
lv 184,212,32768
cv 191,22,23
pa 136,168,180
ex 24
pa 140,168,188
lv 180,8,32768
v_mul_f32 v253, s22, v253
pa 108,160,188
ex 25
pa 108,164,192
lv 182,8,36864
cv 198,24,25
pa 76,156,192
ex 26
pa 76,152,188
lv 186,212,36864
cv 216,252,253
pa 44,144,188
global_load_lds_dwordx4 v13, s[98:99] offset:3072 nt
s_add_u32 m0, s21, 65536
pa 44,148,192
s_add_u32 s98, s98, 16384
s_addc_u32 s99, s99, 0
v_lshlrev_b32 v252, 16, v217
pa 12,140,192
ex 27
pa 12,136,188
lv 188,9,32768
cv 199,26,27
v_smfmac_f32_16x16x64_bf16 a[160:163], a[176:179], v[144:151], v14
s_waitcnt lgkmcnt(3)
lv 190,9,36864
qa 16,196,56,36
ex 28
pw 16,200,60
ex 29
pw 16,204,64
ex 30
pw 16,208,68
lv 192,213,32768
cv 206,28,29
qa 20,208,84,40
ex 31
pw 20,204,80
lv 194,213,36864
cv 207,30,31
pw 20,200,76
v_and_b32 v253, s28, v217
v_mul_f32 v252, s22, v252
pw 20,196,72
ex 16
qa 24,196,88,44
ex 17
pw 24,200,92
cv 176,16,17
v_mul_f32 v253, s22, v253
pw 24,204,96
ex 18
pw 24,208,100
cv 217,252,253
v_lshlrev_b32 v252, 16, v218
qa 28,208,116,48
ex 19
pw 28,204,112
cv 177,18,19
v_and_b32 v253, s28, v218
pw 28,200,108
ex 20
pw 28,196,104
v_mul_f32 v252, s22, v252
v_mul_f32 v253, s22, v253
qa 32,196,120,52
lk 196,0,53248
cv 218,252,253
pw 32,200,124
lk 200,1,53248
v_lshlrev_b32 v252, 16, v219
pw 32,204,128
lk 204,2,53248
v_and_b32 v253, s28, v219
pw 32,208,132
s_waitcnt lgkmcnt(3)
lk 208,3,53248
v_mul_f32 v252, s22, v252
pa 16,136,180
ex 21
pa 16,140,184
ex 22
pa 48,148,184
ex 23
pa 48,144,180
cv 184,20,21
cv 185,22,23
pa 80,152,180
ex 24
pa 80,156,184
ex 25
pa 112,164,184
ex 26
pa 112,160,180
lv 184,214,32768
cv 192,24,25
pa 144,168,180
ex 27
pa 148,168,188
lv 180,10,32768
cv 193,26,27
pa 116,160,188
lv 182,10,36864
v_mul_f32 v253, s22, v253
pa 116,164,192
lv 186,214,36864
cv 219,252,253
pa 84,156,192
ex 28
pa 84,152,188
ex 29
pa 52,144,188
ex 30
pa 52,148,192
cv 200,28,29
v_lshlrev_b32 v252, 16, v220
pa 20,140,192
lv 192,215,32768
v_and_b32 v253, s28, v220
pa 20,136,188
lv 188,11,32768
v_mul_f32 v252, s22, v252
v_smfmac_f32_16x16x64_bf16 a[164:167], a[172:175], v[152:159], v14
lv 190,11,36864
v_smfmac_f32_16x16x64_bf16 a[164:167], a[176:179], v[160:167], v14
s_waitcnt lgkmcnt(3)
lv 194,215,36864
qa 16,196,56,36
s_waitcnt vmcnt(8)
ds_write_b32 v254, v255 offset:0
pw 16,200,60
ex 31
pw 16,204,64
cv 201,30,31
v_mul_f32 v253, s22, v253
pw 16,208,68
ex 32
qa 20,208,84,40
ex 33
pw 20,204,80
ex 34
pw 20,200,76
ex 35
pw 20,196,72
cv 208,32,33
cv 209,34,35
qa 24,196,88,44
ex 16
pw 24,200,92
ex 17
pw 24,204,96
ex 18
pw 24,208,100
cv 178,16,17
cv 220,252,253
qa 28,208,116,48
global_load_lds_dwordx4 v12, s[96:97] offset:0 nt
v_lshlrev_b32 v252, 16, v221
pw 28,204,112
ex 19
pw 28,200,108
cv 179,18,19
v_and_b32 v253, s28, v221
pw 28,196,104
ex 20
qa 32,196,120,52
ex 21
pw 32,200,124
cv 186,20,21
v_mul_f32 v252, s22, v252
pw 32,204,128
ex 22
pw 32,208,132
v_mul_f32 v253, s22, v253
cv 221,252,253
pa 24,136,180
ds_read_b32 v255, v12 offset:1024
v_lshlrev_b32 v252, 16, v222
pa 24,140,184
ex 23
pa 56,148,184
cv 187,22,23
v_and_b32 v253, s28, v222
pa 56,144,180
ex 24
pa 88,152,180
ex 25
pa 88,156,184
cv 194,24,25
v_mul_f32 v252, s22, v252
pa 120,164,184
ex 26
pa 120,160,180
s_waitcnt lgkmcnt(0)
global_load_lds_dwordx4 v13, s[96:97] offset:1024 nt
v_cmp_gt_u32 vcc, 10, v255
pa 152,168,180
ex 27
pa 156,168,188
s_cbranch_vccnz LsY10
LrY10:
lk 196,0,0
cv 195,26,27
pa 124,160,188
lk 200,1,0
v_mov_b32 v255, 11
pa 124,164,192
lk 204,2,0
v_mul_f32 v253, s22, v253
pa 92,156,192
lk 208,3,0
cv 222,252,253
pa 92,152,188
ex 28
pa 60,144,188
ex 29
pa 60,148,192
ex 30
pa 28,140,192
ex 31
pa 28,136,188
lv 180,4,49152
cv 202,28,29
pv 168,172,168
s_waitcnt lgkmcnt(3)
lv 182,4,53248
cv 203,30,31
qa 16,196,56,36
lv 184,172,49152
v_lshlrev_b32 v252, 16, v223
pw 16,200,60
s_waitcnt lgkmcnt(3)
lv 186,172,53248
v_and_b32 v253, s28, v223
pw 16,204,64
ex 32
pw 16,208,68
global_load_lds_dwordx4 v12, s[96:97] offset:2048 nt
lv 188,5,49152
qa 20,208,84,40
ex 33
pw 20,204,80
ex 34
pw 20,200,76
ex 35
pw 20,196,72
lv 190,5,53248
cv 210,32,33
qa 24,196,88,44
lv 192,173,49152
cv 211,34,35
pw 24,200,92
lv 194,173,53248
v_mul_f32 v252, s22, v252
pw 24,204,96
ex 16
pw 24,208,100
ex 17
qa 28,208,116,48
ex 18
pw 28,204,112
ex 19
pw 28,200,108
cv 136,16,17
cv 137,18,19
pw 28,196,104
ex 20
qa 32,196,120,52
lk 196,0,4096
v_xor_b32 v0, 0x2000, v0
pw 32,200,124
lk 200,1,4096
v_xor_b32 v1, 0x2000, v1
pw 32,204,128
s_waitcnt lgkmcnt(2)
global_load_lds_dwordx4 v13, s[96:97] offset:3072 nt
lk 204,2,4096

LwY0_7:
s_cbranch_vccnz LwY0_11
pw 32,208,132
s_add_u32 m0, s21, 114688
lk 208,3,4096
v_xor_b32 v2, 0x2000, v2
pa 0,176,180
s_add_u32 s96, s96, 16384
s_addc_u32 s97, s97, 0
v_xor_b32 v3, 0x2000, v3
pa 0,180,184
ex 21
pa 32,188,184
ex 22
pa 32,184,180
ex 23
pa 64,192,180
cv 144,20,21
cv 145,22,23
pa 64,196,184
ex 24
pa 96,204,184
ex 25
pa 96,200,180
ex 26
pa 128,208,180
ex 27
pa 132,208,188
lv 180,6,49152
cv 152,24,25
pa 100,200,188
lv 182,6,53248
cv 153,26,27
pa 100,204,192
ex 28
pa 68,196,192
ex 29
pa 68,192,188
global_load_lds_dwordx4 v12, s[98:99] offset:0 nt
cv 160,28,29
pa 36,184,188
ex 30
pa 36,188,192
lv 184,174,49152
v_mul_f32 v253, s22, v253
pa 4,180,192
ex 31
pa 4,176,188
lv 186,174,53248
cv 161,30,31
v_smfmac_f32_16x16x64_bf16 a[160:163], a[172:175], v[176:183], v14
s_waitcnt lgkmcnt(2)
lv 188,7,49152
qa 16,196,56,36
ex 32
pw 16,200,60
ex 33
pw 16,204,64
lv 190,7,53248
cv 168,32,33
pw 16,208,68
ex 34
qa 20,208,84,40
lv 192,175,49152
cv 223,252,253
pw 20,204,80
ex 35
pw 20,200,76
lv 194,175,53248
cv 169,34,35
pw 20,196,72
ex 16
qa 24,196,88,44
ex 17
pw 24,200,92
global_load_lds_dwordx4 v13, s[98:99] offset:1024 nt
cv 138,16,17
pw 24,204,96
ex 18
pw 24,208,100
v_lshlrev_b32 v252, 16, v224
v_and_b32 v253, s28, v224
qa 28,208,116,48
ex 19
pw 28,204,112
cv 139,18,19
v_mul_f32 v252, s22, v252
pw 28,200,108
ex 20
pw 28,196,104
v_mul_f32 v253, s22, v253
cv 224,252,253
qa 32,196,120,52
lk 196,0,0
v_lshlrev_b32 v252, 16, v225
pw 32,200,124
lk 200,1,0
v_and_b32 v253, s28, v225
pw 32,204,128
lk 204,2,0
v_mul_f32 v252, s22, v252
pw 32,208,132
lk 208,3,0
v_mul_f32 v253, s22, v253
pa 8,176,180
s_waitcnt lgkmcnt(4)
ex 21
pa 8,180,184
ex 22
pa 40,188,184
ex 23
pa 40,184,180
cv 146,20,21
cv 147,22,23
pa 72,192,180
global_load_lds_dwordx4 v12, s[98:99] offset:2048 nt
cv 225,252,253
pa 72,196,184
ex 24
pa 104,204,184
ex 25
pa 104,200,180
ex 26
pa 136,208,180
ex 27
pa 140,208,188
lv 180,8,49152
cv 154,24,25
pa 108,200,188
lv 182,8,53248
cv 155,26,27
pa 108,204,192
lv 184,212,49152
v_lshlrev_b32 v252, 16, v226
pa 76,196,192
lv 186,212,53248
v_and_b32 v253, s28, v226
pa 76,192,188
ex 28
pa 44,184,188
ex 29
pa 44,188,192
ex 30
pa 12,180,192
ex 31
pa 12,176,188
lv 188,9,49152
cv 162,28,29
v_smfmac_f32_16x16x64_bf16 a[160:163], a[176:179], v[184:191], v14
s_waitcnt lgkmcnt(3)
lv 190,9,53248
qa 16,196,56,36
global_load_lds_dwordx4 v13, s[98:99] offset:3072 nt
cv 163,30,31
pw 16,200,60
s_add_u32 m0, s21, 81920
lv 192,213,49152
v_mul_f32 v252, s22, v252
pw 16,204,64
s_add_u32 s98, s98, 16384
s_addc_u32 s99, s99, 0
lv 194,213,53248
pw 16,208,68
ex 32
qa 20,208,84,40
ex 33
pw 20,204,80
ex 34
pw 20,200,76
ex 35
pw 20,196,72
ex 16
qa 24,196,88,44
cv 170,32,33
cv 171,34,35
pw 24,200,92
ex 17
pw 24,204,96
cv 140,16,17
v_mul_f32 v253, s22, v253
pw 24,208,100
ex 18
qa 28,208,116,48
lk 208,3,4096
cv 226,252,253
pw 28,204,112
lk 204,2,4096
v_lshlrev_b32 v252, 16, v227
pw 28,200,108
lk 200,1,4096
v_and_b32 v253, s28, v227
pw 28,196,104
lk 196,0,4096
v_mul_f32 v252, s22, v252
pa 16,176,180
s_waitcnt lgkmcnt(4)
ex 19
pa 16,180,184
cv 141,18,19
v_mul_f32 v253, s22, v253
pa 48,188,184
ex 20
pa 48,184,180
ex 21
pa 80,192,180
ex 22
pa 80,196,184
cv 148,20,21
cv 227,252,253
pa 112,204,184
ex 23
pa 112,200,180
lv 184,214,49152
cv 149,22,23
pa 144,208,180
lv 180,10,49152
v_lshlrev_b32 v252, 16, v228
pa 148,208,188
lv 182,10,53248
v_and_b32 v253, s28, v228
pa 116,200,188
lv 186,214,53248
v_mul_f32 v252, s22, v252
pa 116,204,192
ex 24
pa 84,196,192
ex 25
pa 84,192,188
ex 26
pa 52,184,188
cv 156,24,25
v_mul_f32 v253, s22, v253
pa 52,188,192
ex 27
pa 20,180,192
lv 192,215,49152
cv 157,26,27
pa 20,176,188
lv 188,11,49152
cv 228,252,253
v_smfmac_f32_16x16x64_bf16 a[164:167], a[172:175], v[192:199], v14
lv 190,11,53248
v_smfmac_f32_16x16x64_bf16 a[164:167], a[176:179], v[200:207], v14
s_waitcnt lgkmcnt(3)
lv 194,215,53248
qa 16,196,56,36
s_waitcnt vmcnt(8)
ds_write_b32 v254, v255 offset:0
pw 16,200,60
ex 28
pw 16,204,64
ex 29
pw 16,208,68
ex 30
qa 20,208,84,40
ex 31
pw 20,204,80
cv 164,28,29
cv 165,30,31
pw 20,200,76
v_lshlrev_b32 v252, 16, v229
v_and_b32 v253, s28, v229
pw 20,196,72
ex 16
qa 24,196,88,44
v_mul_f32 v252, s22, v252
v_mul_f32 v253, s22, v253
pw 24,200,92
ex 17
pw 24,204,96
cv 142,16,17
cv 229,252,253
pw 24,208,100
ex 18
qa 28,208,116,48
v_lshlrev_b32 v252, 16, v230
v_and_b32 v253, s28, v230
pw 28,204,112
ex 19
pw 28,200,108
cv 143,18,19
v_mul_f32 v252, s22, v252
pw 28,196,104
ex 20
pa 24,176,180
ds_read_b32 v255, v12 offset:1024
v_mul_f32 v253, s22, v253
pa 24,180,184
ex 21
pa 56,188,184
cv 150,20,21
cv 230,252,253
pa 56,184,180
v_lshlrev_b32 v252, 16, v231
v_and_b32 v253, s28, v231
pa 88,192,180
ex 22
pa 88,196,184
v_mul_f32 v252, s22, v252
v_mul_f32 v253, s22, v253
pa 120,204,184
global_load_lds_dwordx4 v12, s[96:97] offset:0 nt
cv 231,252,253
pa 120,200,180
s_waitcnt lgkmcnt(0)
v_cmp_gt_u32 vcc, 11, v255
v_lshlrev_b32 v252, 16, v232
pa 152,208,180
ex 23
pa 156,208,188
s_cbranch_vccnz LsY11
LrY11:
lk 196,0,16384
cv 151,22,23
pa 124,200,188
lk 200,1,16384
v_mov_b32 v255, 12
pa 124,204,192
lk 204,2,16384
v_and_b32 v253, s28, v232
pa 92,196,192
lk 208,3,16384
v_mul_f32 v252, s22, v252
pa 92,192,188
ex 24
pa 60,184,188
ex 25
pa 60,188,192
ex 26
pa 28,180,192
ex 27
pa 28,176,188
lv 180,4,0
cv 158,24,25
pv 168,172,208
s_waitcnt lgkmcnt(3)
lv 182,4,4096
cv 159,26,27
qa 16,196,56,36
lv 184,172,0
v_mul_f32 v253, s22, v253
pw 16,200,60
s_waitcnt lgkmcnt(3)
lv 186,172,4096
cv 232,252,253
pw 16,204,64
ex 28
pw 16,208,68
ex 29
qa 20,208,84,40
ex 30
pw 20,204,80
ex 31
pw 20,200,76
global_load_lds_dwordx4 v13, s[96:97] offset:1024 nt
cv 166,28,29
pw 20,196,72
lv 188,5,0
cv 167,30,31
qa 24,196,88,44
lv 190,5,4096
v_lshlrev_b32 v252, 16, v233
pw 24,200,92
lv 192,173,0
v_and_b32 v253, s28, v233
pw 24,204,96
lv 194,173,4096
v_mul_f32 v252, s22, v252
pw 24,208,100
ex 16
qa 28,208,116,48
lk 208,3,20480
v_xor_b32 v3, 0x2000, v3
pw 28,204,112
lk 204,2,20480
v_xor_b32 v2, 0x2000, v2
pw 28,200,108
lk 200,1,20480
v_xor_b32 v1, 0x2000, v1
pw 28,196,104
s_waitcnt lgkmcnt(6)
lk 196,0,20480
v_xor_b32 v0, 0x2000, v0
pa 0,136,180
ex 17
pa 0,140,184
global_load_lds_dwordx4 v12, s[96:97] offset:2048 nt
cv 180,16,17
pa 32,148,184
ex 18
pa 32,144,180
ex 19
pa 64,152,180
cv 181,18,19
v_mul_f32 v253, s22, v253
pa 64,156,184
ex 20
pa 96,164,184
ex 21
pa 96,160,180
ex 22
pa 128,168,180
s_waitcnt lgkmcnt(0)
ex 23
pa 132,168,188
lv 180,6,0
cv 188,20,21
pa 100,160,188
lv 182,6,4096
cv 189,22,23
pa 100,164,192
ex 24
pa 68,156,192
ex 25
pa 68,152,188
ex 26
pa 36,144,188
lv 184,174,0
cv 196,24,25
pa 36,148,192
ex 27
pa 4,140,192
global_load_lds_dwordx4 v13, s[96:97] offset:3072 nt
cv 197,26,27
pa 4,136,188
s_add_u32 m0, s21, 131072
lv 186,174,4096
cv 233,252,253
v_smfmac_f32_16x16x64_bf16 a[160:163], a[172:175], v[136:143], v14
s_add_u32 s96, s96, 16384
s_addc_u32 s97, s97, 0
qa 16,196,56,36
ex 28
pw 16,200,60
ex 29
pw 16,204,64
ex 30
pw 16,208,68
lv 188,7,0
cv 204,28,29
qa 20,208,84,40
ex 31
pw 20,204,80
lv 190,7,4096
cv 205,30,31
pw 20,200,76
lv 192,175,0
v_lshlrev_b32 v252, 16, v234
pw 20,196,72
lv 194,175,4096
v_and_b32 v253, s28, v234
qa 24,196,88,44
ex 16
pw 24,200,92
ex 17
pw 24,204,96
cv 182,16,17
v_mul_f32 v252, s22, v252
pw 24,208,100
ex 18
qa 28,208,116,48
global_load_lds_dwordx4 v12, s[98:99] offset:0 nt
lk 208,3,16384
pw 28,204,112
lk 204,2,16384
v_mul_f32 v253, s22, v253
pw 28,200,108
lk 200,1,16384
cv 234,252,253
pw 28,196,104
s_waitcnt lgkmcnt(3)
lk 196,0,16384
v_lshlrev_b32 v252, 16, v235
pa 8,136,180
ex 19
pa 8,140,184
cv 183,18,19
v_and_b32 v253, s28, v235
pa 40,148,184
ex 20
pa 40,144,180
ex 21
pa 72,152,180
ex 22
pa 72,156,184
cv 190,20,21
v_mul_f32 v252, s22, v252
pa 104,164,184
ex 23
pa 104,160,180
lv 184,212,0
cv 191,22,23
pa 136,168,180
ex 24
pa 140,168,188
lv 180,8,0
v_mul_f32 v253, s22, v253
pa 108,160,188
ex 25
pa 108,164,192
global_load_lds_dwordx4 v13, s[98:99] offset:1024 nt
cv 198,24,25
pa 76,156,192
ex 26
pa 76,152,188
lv 182,8,4096
cv 235,252,253
pa 44,144,188
lv 186,212,4096
v_lshlrev_b32 v252, 16, v236
pa 44,148,192
ex 27
pa 12,140,192
lv 192,213,0
cv 199,26,27
pa 12,136,188
ex 28
v_smfmac_f32_16x16x64_bf16 a[160:163], a[176:179], v[144:151], v14
s_waitcnt lgkmcnt(3)
lv 188,9,0
qa 16,196,56,36
ex 29
pw 16,200,60
lv 190,9,4096
cv 206,28,29
pw 16,204,64
ex 30
pw 16,208,68
lv 194,213,4096
v_and_b32 v253, s28, v236
qa 20,208,84,40
ex 31
pw 20,204,80
cv 207,30,31
v_mul_f32 v252, s22, v252
pw 20,200,76
v_mul_f32 v253, s22, v253
cv 236,252,253
pw 20,196,72
global_load_lds_dwordx4 v12, s[98:99] offset:2048 nt
v_lshlrev_b32 v252, 16, v237
qa 24,196,88,44
ex 16
pw 24,200,92
ex 17
pw 24,204,96
ex 18
pw 24,208,100
cv 176,16,17
v_and_b32 v253, s28, v237
qa 28,208,116,48
ex 19
pw 28,204,112
cv 177,18,19
v_mul_f32 v252, s22, v252
pw 28,200,108
ex 20
pw 28,196,104
v_mul_f32 v253, s22, v253
cv 237,252,253
qa 32,196,120,52
lk 196,0,20480
v_lshlrev_b32 v252, 16, v238
pw 32,200,124
lk 200,1,20480
v_and_b32 v253, s28, v238
pw 32,204,128
lk 204,2,20480
v_mul_f32 v252, s22, v252
pw 32,208,132
s_waitcnt lgkmcnt(3)
lk 208,3,20480
v_mul_f32 v253, s22, v253
pa 16,136,180
ex 21
pa 16,140,184
ex 22
pa 48,148,184
global_load_lds_dwordx4 v13, s[98:99] offset:3072 nt
cv 184,20,21
pa 48,144,180
s_add_u32 m0, s21, 32768
ex 23
pa 80,152,180
s_add_u32 s98, s98, 16384
s_addc_u32 s99, s99, 0
cv 185,22,23
pa 80,156,184
ex 24
pa 112,164,184
ex 25
pa 112,160,180
ex 26
pa 144,168,180
ex 27
pa 148,168,188
lv 180,10,0
cv 192,24,25
pa 116,160,188
lv 182,10,4096
cv 193,26,27
pa 116,164,192
lv 184,214,0
cv 238,252,253
pa 84,156,192
lv 186,214,4096
v_lshlrev_b32 v252, 16, v239
pa 84,152,188

LwY0_8:
s_cbranch_vccnz LwY0_12
ex 28
pa 52,144,188
ex 29
pa 52,148,192
ex 30
pa 20,140,192
lv 192,215,0
cv 200,28,29
pa 20,136,188
lv 188,11,0
v_and_b32 v253, s28, v239
v_smfmac_f32_16x16x64_bf16 a[164:167], a[172:175], v[152:159], v14
lv 190,11,4096
v_smfmac_f32_16x16x64_bf16 a[164:167], a[176:179], v[160:167], v14
s_waitcnt lgkmcnt(4)
lv 194,215,4096
qa 16,196,56,36
s_waitcnt vmcnt(8)
ds_write_b32 v254, v255 offset:0
pw 16,200,60
ex 31
pw 16,204,64
cv 201,30,31
v_mul_f32 v252, s22, v252
pw 16,208,68
ex 32
qa 20,208,84,40
ex 33
pw 20,204,80
ex 34
pw 20,200,76
ex 35
pw 20,196,72
cv 208,32,33
cv 209,34,35
qa 24,196,88,44
ex 16
pw 24,200,92
ex 17
pw 24,204,96
ex 18
pw 24,208,100
cv 178,16,17
v_mul_f32 v253, s22, v253
qa 28,208,116,48
ex 19
pw 28,204,112
cv 179,18,19
cv 239,252,253
pw 28,200,108
ex 20
pw 28,196,104
v_lshlrev_b32 v252, 16, v240
v_and_b32 v253, s28, v240
qa 32,196,120,52
ex 21
pw 32,200,124
cv 186,20,21
v_mul_f32 v252, s22, v252
pw 32,204,128
ex 22
pw 32,208,132
v_mul_f32 v253, s22, v253
cv 240,252,253
pa 24,136,180
s_waitcnt lgkmcnt(0)
ds_read_b32 v255, v12 offset:1024
v_lshlrev_b32 v252, 16, v241
pa 24,140,184
ex 23
pa 56,148,184
cv 187,22,23
v_and_b32 v253, s28, v241
pa 56,144,180
ex 24
pa 88,152,180
ex 25
pa 88,156,184
cv 194,24,25
v_mul_f32 v252, s22, v252
pa 120,164,184
ex 26
pa 120,160,180
s_waitcnt lgkmcnt(0)
v_cmp_gt_u32 vcc, 12, v255
v_mul_f32 v253, s22, v253
pa 152,168,180
ex 27
pa 156,168,188
s_cbranch_vccnz LsY12
LrY12:
lk 196,0,32768
cv 195,26,27
pa 124,160,188
lk 200,1,32768
v_mov_b32 v255, 13
pa 124,164,192
lk 204,2,32768
cv 241,252,253
pa 92,156,192
lk 208,3,32768
v_lshlrev_b32 v252, 16, v242
pa 92,152,188
ex 28
pa 60,144,188
ex 29
pa 60,148,192
ex 30
pa 28,140,192
ex 31
pa 28,136,188
lv 180,4,16384
cv 202,28,29
pv 168,172,168
s_waitcnt lgkmcnt(3)
lv 182,4,20480
cv 203,30,31
qa 16,196,56,36
lv 184,172,16384
v_and_b32 v253, s28, v242
pw 16,200,60
s_waitcnt lgkmcnt(3)
global_load_lds_dwordx4 v12, s[96:97] offset:0 nt
lv 186,172,20480
pw 16,204,64
ex 32
pw 16,208,68
ex 33
qa 20,208,84,40
ex 34
pw 20,204,80
ex 35
pw 20,200,76
lv 188,5,16384
cv 210,32,33
pw 20,196,72
lv 190,5,20480
cv 211,34,35
qa 24,196,88,44
lv 192,173,16384
v_mul_f32 v252, s22, v252
pw 24,200,92
lv 194,173,20480
v_mul_f32 v253, s22, v253
pw 24,204,96
ex 16
pw 24,208,100
ex 17
qa 28,208,116,48
ex 18
pw 28,204,112
ex 19
pw 28,200,108
cv 136,16,17
cv 137,18,19
pw 28,196,104
ex 20
qa 32,196,120,52
global_load_lds_dwordx4 v13, s[96:97] offset:1024 nt
lk 196,0,36864
pw 32,200,124
lk 200,1,36864
v_xor_b32 v0, 0x2000, v0
pw 32,204,128
lk 204,2,36864
v_xor_b32 v1, 0x2000, v1
pw 32,208,132
s_waitcnt lgkmcnt(3)
lk 208,3,36864
v_xor_b32 v2, 0x2000, v2
pa 0,176,180
ex 21
pa 0,180,184
ex 22
pa 32,188,184
ex 23
pa 32,184,180
cv 144,20,21
cv 145,22,23
pa 64,192,180
ex 24
pa 64,196,184
ex 25
pa 96,204,184
ex 26
pa 96,200,180
lv 184,174,16384
cv 152,24,25
pa 128,208,180
ex 27
pa 132,208,188
lv 180,6,16384
cv 153,26,27
pa 100,200,188
ex 28
pa 100,204,192
global_load_lds_dwordx4 v12, s[96:97] offset:2048 nt
lv 182,6,20480
pa 68,196,192
ex 29
pa 68,192,188
lv 186,174,20480
cv 160,28,29
pa 36,184,188
ex 30
pa 36,188,192
v_xor_b32 v3, 0x2000, v3
cv 242,252,253
pa 4,180,192
ex 31
pa 4,176,188
lv 188,7,16384
cv 161,30,31
v_smfmac_f32_16x16x64_bf16 a[160:163], a[172:175], v[176:183], v14
s_waitcnt lgkmcnt(3)
lv 190,7,20480
qa 16,196,56,36
ex 32
pw 16,200,60
ex 33
pw 16,204,64
lv 192,175,16384
cv 168,32,33
pw 16,208,68
ex 34
qa 20,208,84,40
lv 194,175,20480
v_lshlrev_b32 v252, 16, v243
pw 20,204,80
ex 35
pw 20,200,76
cv 169,34,35
v_and_b32 v253, s28, v243
pw 20,196,72
global_load_lds_dwordx4 v13, s[96:97] offset:3072 nt
s_add_u32 m0, s21, 147456
qa 24,196,88,44
s_add_u32 s96, s96, 16384
s_addc_u32 s97, s97, 0
v_mul_f32 v252, s22, v252
pw 24,200,92
ex 16
pw 24,204,96
ex 17
pw 24,208,100
ex 18
qa 28,208,116,48
ex 19
pw 28,204,112
cv 138,16,17
cv 139,18,19
pw 28,200,108
ex 20
pw 28,196,104
v_mul_f32 v253, s22, v253
cv 243,252,253
qa 32,196,120,52
lk 196,0,32768
v_lshlrev_b32 v252, 16, v244
pw 32,200,124
lk 200,1,32768
v_and_b32 v253, s28, v244
pw 32,204,128
lk 204,2,32768
v_mul_f32 v252, s22, v252
pw 32,208,132
s_waitcnt lgkmcnt(3)
lk 208,3,32768
v_mul_f32 v253, s22, v253
pa 8,176,180
ex 21
pa 8,180,184
ex 22
pa 40,188,184
global_load_lds_dwordx4 v12, s[98:99] offset:0 nt
cv 146,20,21
pa 40,184,180
ex 23
pa 72,192,180
cv 147,22,23
cv 244,252,253
pa 72,196,184
ex 24
pa 104,204,184
ex 25
pa 104,200,180
ex 26
pa 136,208,180
ex 27
pa 140,208,188
lv 180,8,16384
cv 154,24,25
pa 108,200,188
lv 182,8,20480
cv 155,26,27
pa 108,204,192
lv 184,212,16384
v_lshlrev_b32 v252, 16, v245
pa 76,196,192
lv 186,212,20480
v_and_b32 v253, s28, v245
pa 76,192,188
ex 28
pa 44,184,188
ex 29
pa 44,188,192
ex 30
pa 12,180,192
ex 31
pa 12,176,188
global_load_lds_dwordx4 v13, s[98:99] offset:1024 nt
cv 162,28,29
v_smfmac_f32_16x16x64_bf16 a[160:163], a[176:179], v[184:191], v14
s_waitcnt lgkmcnt(2)
lv 188,9,16384
qa 16,196,56,36
lv 190,9,20480
cv 163,30,31
pw 16,200,60
lv 192,213,16384
v_mul_f32 v252, s22, v252
pw 16,204,64
lv 194,213,20480
v_mul_f32 v253, s22, v253
pw 16,208,68
ex 32
qa 20,208,84,40
ex 33
pw 20,204,80
ex 34
pw 20,200,76
ex 35
pw 20,196,72
ex 16
qa 24,196,88,44
cv 170,32,33
cv 171,34,35
pw 24,200,92
ex 17
pw 24,204,96
cv 140,16,17
cv 245,252,253
pw 24,208,100
ex 18
qa 28,208,116,48
lk 208,3,36864
v_lshlrev_b32 v252, 16, v246
pw 28,204,112
global_load_lds_dwordx4 v12, s[98:99] offset:2048 nt
lk 204,2,36864
pw 28,200,108
lk 200,1,36864
v_and_b32 v253, s28, v246
pw 28,196,104
lk 196,0,36864
v_mul_f32 v252, s22, v252
pa 16,176,180
s_waitcnt lgkmcnt(4)
ex 19
pa 16,180,184
cv 141,18,19
v_mul_f32 v253, s22, v253
pa 48,188,184
ex 20
pa 48,184,180
ex 21
pa 80,192,180
ex 22
pa 80,196,184
cv 148,20,21
cv 246,252,253
pa 112,204,184
ex 23
pa 112,200,180
lv 184,214,16384
cv 149,22,23
pa 144,208,180
lv 180,10,16384
v_lshlrev_b32 v252, 16, v247
pa 148,208,188
lv 182,10,20480
v_and_b32 v253, s28, v247
pa 116,200,188
lv 186,214,20480
v_mul_f32 v252, s22, v252
pa 116,204,192
ex 24
pa 84,196,192
global_load_lds_dwordx4 v13, s[98:99] offset:3072 nt
s_add_u32 m0, s21, 49152
pa 84,192,188
s_add_u32 s98, s98, 16384
s_addc_u32 s99, s99, 0
v_mul_f32 v253, s22, v253
pa 52,184,188
ex 25
pa 52,188,192
ex 26
pa 20,180,192
lv 192,215,16384
cv 156,24,25
pa 20,176,188
lv 188,11,16384
cv 247,252,253
v_smfmac_f32_16x16x64_bf16 a[164:167], a[172:175], v[192:199], v14
lv 190,11,20480
v_smfmac_f32_16x16x64_bf16 a[164:167], a[176:179], v[200:207], v14
s_waitcnt lgkmcnt(3)
lv 194,215,20480
qa 16,196,56,36
s_waitcnt vmcnt(8)
ds_write_b32 v254, v255 offset:0
pw 16,200,60
ex 27
pw 16,204,64
cv 157,26,27
v_lshlrev_b32 v252, 16, v248
pw 16,208,68
ex 28
qa 20,208,84,40
ex 29
pw 20,204,80
ex 30
pw 20,200,76
ex 31
pw 20,196,72
cv 164,28,29
cv 165,30,31
qa 24,196,88,44
ex 16
pw 24,200,92
ex 17
pw 24,204,96
cv 142,16,17
v_and_b32 v253, s28, v248
pw 24,208,100
ex 18
qa 28,208,116,48
v_mul_f32 v252, s22, v252
v_mul_f32 v253, s22, v253
pw 28,204,112
ex 19
pw 28,200,108
cv 143,18,19
cv 248,252,253
pw 28,196,104
ex 20
pa 24,176,180
ds_read_b32 v255, v12 offset:1024
v_lshlrev_b32 v252, 16, v249
pa 24,180,184
ex 21
pa 56,188,184
cv 150,20,21
v_and_b32 v253, s28, v249
pa 56,184,180
v_mul_f32 v252, s22, v252
v_mul_f32 v253, s22, v253
pa 88,192,180
ex 22
pa 88,196,184
cv 249,252,253
v_lshlrev_b32 v252, 16, v250
pa 120,204,184
ex 23
pa 120,200,180
s_waitcnt lgkmcnt(0)
v_cmp_gt_u32 vcc, 13, v255
cv 151,22,23
pa 152,208,180
ex 24
pa 156,208,188
s_cbranch_vccnz LsY13
LrY13:
lk 196,0,49152
v_mov_b32 v255, 14
pa 124,200,188
lk 200,1,49152
v_and_b32 v253, s28, v250
pa 124,204,192
lk 204,2,49152
v_mul_f32 v252, s22, v252
pa 92,196,192
lk 208,3,49152
v_mul_f32 v253, s22, v253
pa 92,192,188
ex 25
pa 60,184,188
ex 26
pa 60,188,192
ex 27
pa 28,180,192
lv 180,4,32768
cv 158,24,25
pa 28,176,188
lv 182,4,36864
cv 159,26,27
pv 168,172,208
s_waitcnt lgkmcnt(4)
lv 184,172,32768
cv 250,252,253
qa 16,196,56,36
lv 186,172,36864
v_lshlrev_b32 v252, 16, v251
pw 16,200,60
s_waitcnt lgkmcnt(4)
ex 28
pw 16,204,64
ex 29
pw 16,208,68
ex 30
qa 20,208,84,40
ex 31
pw 20,204,80
lv 188,5,32768
cv 166,28,29
pw 20,200,76
lv 190,5,36864
cv 167,30,31
pw 20,196,72
lv 192,173,32768
v_and_b32 v253, s28, v251
qa 24,196,88,44
lv 194,173,36864
v_mul_f32 v252, s22, v252
pw 24,200,92
ex 16
pw 24,204,96
ex 17
pw 24,208,100
ex 18
qa 28,208,116,48
lk 208,3,53248
cv 180,16,17
pw 28,204,112
lk 204,2,53248
v_xor_b32 v2, 0x2000, v2
pw 28,200,108
global_load_lds_dwordx4 v12, s[96:97] offset:0 nt
lk 200,1,53248
pw 28,196,104
s_waitcnt lgkmcnt(4)
lk 196,0,53248
v_xor_b32 v0, 0x2000, v0
pa 0,136,180
ex 19
pa 0,140,184
cv 181,18,19
v_xor_b32 v1, 0x2000, v1
pa 32,148,184
ex 20
pa 32,144,180
ex 21
pa 64,152,180
ex 22
pa 64,156,184
cv 188,20,21
v_xor_b32 v3, 0x2000, v3
pa 96,164,184
ex 23
pa 96,160,180
lv 184,174,32768
cv 189,22,23
pa 128,168,180
ex 24
pa 132,168,188
lv 180,6,32768
v_mul_f32 v253, s22, v253
pa 100,160,188
s_waitcnt lgkmcnt(2)
ex 25
pa 100,164,192
lv 182,6,36864
cv 196,24,25
pa 68,156,192
ex 26
pa 68,152,188
global_load_lds_dwordx4 v13, s[96:97] offset:1024 nt
lv 186,174,36864
pa 36,144,188
cv 251,252,253
pa 36,148,192
ex 27
pa 4,140,192
lv 192,175,32768
cv 197,26,27
pa 4,136,188
ex 28
v_smfmac_f32_16x16x64_bf16 a[160:163], a[172:175], v[136:143], v14
lv 188,7,32768
qa 16,196,56,36
ex 29
pw 16,200,60
lv 190,7,36864
cv 204,28,29
pw 16,204,64
ex 30
pw 16,208,68
lv 194,175,36864
qa 20,208,84,40
ex 31
pw 20,204,80
cv 205,30,31
s_nop 0
pw 20,200,76
pw 20,196,72
ex 16
qa 24,196,88,44
pw 24,200,92
global_load_lds_dwordx4 v12, s[96:97] offset:2048 nt
pw 24,204,96

LwY0_9:
s_cbranch_vccnz LwY0_13
ex 17
pw 24,208,100
ex 18
qa 28,208,116,48
lk 208,3,49152
cv 182,16,17
pw 28,204,112
lk 204,2,49152
pw 28,200,108
lk 200,1,49152
pw 28,196,104
s_waitcnt lgkmcnt(3)
lk 196,0,49152
pa 8,136,180
ex 19
pa 8,140,184
cv 183,18,19
pa 40,148,184
ex 20
pa 40,144,180
ex 21
pa 72,152,180
ex 22
pa 72,156,184
cv 190,20,21
pa 104,164,184
ex 23
pa 104,160,180
lv 184,212,32768
cv 191,22,23
pa 136,168,180
global_load_lds_dwordx4 v13, s[96:97] offset:3072 nt
lv 180,8,32768
pa 140,168,188
s_add_u32 m0, s21, 98304
ex 24
pa 108,160,188
s_add_u32 s96, s96, 16384
s_addc_u32 s97, s97, 0
lv 182,8,36864
pa 108,164,192
ex 25
pa 76,156,192
ex 26
pa 76,152,188
lv 186,212,36864
cv 198,24,25
pa 44,144,188
pa 44,148,192
ex 27
pa 12,140,192
lv 192,213,32768
cv 199,26,27
pa 12,136,188
ex 28
v_smfmac_f32_16x16x64_bf16 a[160:163], a[176:179], v[144:151], v14
s_waitcnt lgkmcnt(2)
lv 188,9,32768
qa 16,196,56,36
ex 29
pw 16,200,60
lv 190,9,36864
cv 206,28,29
pw 16,204,64
ex 30
pw 16,208,68
lv 194,213,36864
qa 20,208,84,40
ex 31
pw 20,204,80
global_load_lds_dwordx4 v12, s[98:99] offset:0 nt
cv 207,30,31
pw 20,200,76
pw 20,196,72
ex 16
qa 24,196,88,44
ex 17
pw 24,200,92
cv 176,16,17
pw 24,204,96
ex 18
pw 24,208,100
qa 28,208,116,48
ex 19
pw 28,204,112
cv 177,18,19
pw 28,200,108
ex 20
pw 28,196,104
qa 32,196,120,52
lk 196,0,53248
v_xor_b32 v0, s34, v0
pw 32,200,124
lk 200,1,53248
v_xor_b32 v1, s34, v1
pw 32,204,128
lk 204,2,53248
v_xor_b32 v2, s34, v2
pw 32,208,132
global_load_lds_dwordx4 v13, s[98:99] offset:1024 nt
lk 208,3,53248
pa 16,136,180
s_waitcnt lgkmcnt(4)
ex 21
pa 16,140,184
ex 22
pa 48,148,184
ex 23
pa 48,144,180
cv 184,20,21
cv 185,22,23
pa 80,152,180
ex 24
pa 80,156,184
ex 25
pa 112,164,184
ex 26
pa 112,160,180
lv 184,214,32768
cv 192,24,25
pa 144,168,180
ex 27
pa 148,168,188
lv 180,10,32768
cv 193,26,27
pa 116,160,188
lv 182,10,36864
v_xor_b32 v3, s34, v3
pa 116,164,192
lv 186,214,36864
pa 84,156,192
ex 28
pa 84,152,188
ex 29
pa 52,144,188
global_load_lds_dwordx4 v12, s[98:99] offset:2048 nt
cv 200,28,29
pa 52,148,192
ex 30
pa 20,140,192
lv 192,215,32768
pa 20,136,188
lv 188,11,32768
v_smfmac_f32_16x16x64_bf16 a[164:167], a[172:175], v[152:159], v14
lv 190,11,36864
v_smfmac_f32_16x16x64_bf16 a[164:167], a[176:179], v[160:167], v14
s_waitcnt lgkmcnt(3)
lv 194,215,36864
qa 16,196,56,36
s_waitcnt vmcnt(7)
ds_write_b32 v254, v255 offset:0
pw 16,200,60
ex 31
pw 16,204,64
cv 201,30,31
v_mbcnt_lo_u32_b32 v58, -1, 0
pw 16,208,68
ex 32
qa 20,208,84,40
ex 33
pw 20,204,80
ex 34
pw 20,200,76
ex 35
pw 20,196,72
cv 208,32,33
cv 209,34,35
qa 24,196,88,44
ex 16
pw 24,200,92
global_load_lds_dwordx4 v13, s[98:99] offset:3072 nt
s_add_u32 m0, s21, 65536
pw 24,204,96
s_add_u32 s98, s98, 16384
s_addc_u32 s99, s99, 0
v_mbcnt_hi_u32_b32 v58, -1, v58
pw 24,208,100
ex 17
qa 28,208,116,48
ex 18
pw 28,204,112
ex 19
pw 28,200,108
cv 178,16,17
cv 179,18,19
pw 28,196,104
ex 20
qa 32,196,120,52
ex 21
pw 32,200,124
cv 186,20,21
v_mov_b32 v114, v52
pw 32,204,128
ex 22
pw 32,208,132
v_and_b32 v59, 15, v58
v_lshl_add_u32 v80, v59, 2, s37
pa 24,136,180
ds_read_b32 v255, v12 offset:1024
v_lshl_add_u32 v120, v59, 3, s36
pa 24,140,184
ex 23
pa 56,148,184
cv 187,22,23
v_lshrrev_b32 v59, 4, v58
pa 56,144,180
ex 24
pa 88,152,180
ex 25
pa 88,156,184
cv 194,24,25
v_lshl_add_u32 v123, v59, 4, s37
pa 120,164,184
s_add_u32 s37, s24, 12288
ex 26
pa 120,160,180
s_add_u32 s37, s37, s2
s_waitcnt lgkmcnt(0)
v_cmp_gt_u32 vcc, 14, v255
v_lshl_add_u32 v120, v59, 9, v120
pa 152,168,180
ex 27
pa 156,168,188
s_cbranch_vccnz LsY14
LrY14:
lk 196,0,0
cv 195,26,27
pa 124,160,188
lk 200,1,0
v_lshl_add_u32 v121, v59, 8, s36
pa 124,164,192
s_add_u32 s36, s24, 8192
lk 204,2,0
v_and_b32 v59, 3, v58
pa 92,156,192
s_add_u32 s36, s36, s2
lk 208,3,0
v_lshl_add_u32 v121, v59, 6, v121
pa 92,152,188
ex 28
pa 60,144,188
ex 29
pa 60,148,192
ex 30
pa 28,140,192
ex 31
pa 28,136,188
lv 180,4,49152
cv 202,28,29
pv 168,172,168
s_waitcnt lgkmcnt(3)
lv 182,4,53248
cv 203,30,31
v_mfma_f32_16x16x32_bf16 v[16:19], a[196:199], a[212:215], 0
ex 32
qb 16,200,216,16
s_waitcnt lgkmcnt(2)
ex 33
qb 16,204,220,16
lv 184,172,49152
cv 210,32,33
qb 16,208,224,16
ex 34
v_mfma_f32_16x16x32_bf16 v[20:23], a[208:211], a[240:243], 0
lv 186,172,53248
v_and_b32 v59, 12, v58
qb 20,204,236,20
ex 35
qb 20,200,232,20
lv 188,5,49152
cv 211,34,35
qb 20,196,228,20
lv 190,5,53248
v_max3_f32 v56, v16, v17, v18
v_mfma_f32_16x16x32_bf16 v[24:27], a[196:199], a[244:247], 0
lv 192,173,49152
v_max_f32 v56, v56, v19
qb 24,200,248,24
lv 194,173,53248
v_add_f32 v56, 0x41200000, v56
qb 24,204,252,24
v_mov_b32 v57, v56
v_lshl_add_u32 v121, v59, 1, v121
pw 24,208,216
v_permlane16_swap_b32 v56, v57
v_mfma_f32_16x16x32_bf16 v[28:31], a[208:211], v[232:235], 0
v_max_f32 v56, v56, v57
v_mov_b32 v57, v56
pw 28,204,228
v_and_b32 v59, 7, v58
v_lshlrev_b32 v59, 4, v59
pw 28,200,224
global_load_lds_dwordx4 v12, s[96:97] offset:0 nt
v_lshrrev_b32 v58, 3, v58
pw 28,196,220
v_permlane32_swap_b32 v56, v57
v_mfma_f32_16x16x32_bf16 v[32:35], a[196:199], v[236:239], 0
lk 196,0,4096
v_min_f32 v36, -v56, -v57
pw 32,200,240
lk 200,1,4096
v_min_f32 v37, -v56, -v57
pw 32,204,244
lk 204,2,4096
v_min_f32 v38, -v56, -v57
pw 32,208,248
lk 208,3,4096
v_min_f32 v39, -v56, -v57
v_smfmac_f32_16x16x64_bf16 a[160:163], a[172:175], v[176:183], v14
v_max3_f32 v56, v20, v21, v22
v_smfmac_f32_16x16x64_bf16 a[160:163], a[176:179], v[184:191], v14
v_max_f32 v56, v56, v23
v_smfmac_f32_16x16x64_bf16 a[164:167], a[172:175], v[192:199], v14
v_add_f32 v56, 0x41200000, v56
v_smfmac_f32_16x16x64_bf16 a[164:167], a[176:179], v[200:207], v14
v_mov_b32 v57, v56
pv 168,172,208
s_waitcnt lgkmcnt(3)
v_add_f32 v16, v16, v36
v_add_f32 v17, v17, v36
pa 0,176,180
v_permlane16_swap_b32 v56, v57
pa 0,180,184
v_max_f32 v56, v56, v57
v_mov_b32 v57, v56
pa 32,188,184
v_add_f32 v18, v18, v36
v_add_f32 v19, v19, v36
pa 32,184,180
v_permlane32_swap_b32 v56, v57
pa 64,192,180
global_load_lds_dwordx4 v13, s[96:97] offset:1024 nt
v_min_f32 v40, -v56, -v57
pa 64,196,184
v_min_f32 v41, -v56, -v57
v_min_f32 v42, -v56, -v57
pa 96,204,184
lv 184,174,49152
v_min_f32 v43, -v56, -v57
pa 96,200,180
lv 186,174,53248
v_max3_f32 v56, v24, v25, v26
pa 128,208,180
lv 180,6,49152
v_max_f32 v56, v56, v27
pa 132,208,188
ex 16
pa 100,200,188
ex 17
pa 100,204,192
ex 18
pa 68,196,192
ex 19
pa 68,192,188
lv 182,6,53248
v_add_f32 v56, 0x41200000, v56
pa 36,184,188
v_mov_b32 v57, v56
cv 136,16,17
pa 36,188,192
cv 137,18,19
v_add_f32 v20, v20, v40
pa 4,180,192
v_permlane16_swap_b32 v56, v57
pa 4,176,188
lv 188,7,49152
v_max_f32 v56, v56, v57
qb 16,196,212,36
s_waitcnt lgkmcnt(2)
lv 190,7,53248
v_mov_b32 v57, v56
qb 16,200,216,16
global_load_lds_dwordx4 v12, s[96:97] offset:2048 nt
v_add_f32 v21, v21, v40
v_permlane32_swap_b32 v56, v57
v_add_f32 v22, v22, v40
v_add_f32 v23, v23, v40
qb 16,204,220,16
ex 20
ex 21
ex 22
ex 23
v_min_f32 v44, -v56, -v57
v_min_f32 v45, -v56, -v57
v_min_f32 v46, -v56, -v57
v_min_f32 v47, -v56, -v57
v_max3_f32 v56, v28, v29, v30
qb 16,208,224,16
lv 192,175,49152
cv 144,20,21
cv 145,22,23
v_max_f32 v56, v56, v31
v_add_f32 v56, 0x41200000, v56
qb 20,208,240,40
lv 194,175,53248
v_mov_b32 v57, v56
qb 20,204,236,20
v_add_f32 v24, v24, v44
v_add_f32 v25, v25, v44
v_permlane16_swap_b32 v56, v57
v_add_f32 v26, v26, v44
v_add_f32 v27, v27, v44
v_max_f32 v56, v56, v57
qb 20,200,232,20
ex 24
ex 25
ex 26
ex 27
v_mov_b32 v57, v56
qb 20,196,228,20
cv 152,24,25
cv 153,26,27
v_permlane32_swap_b32 v56, v57
v_min_f32 v48, -v56, -v57
v_min_f32 v49, -v56, -v57
v_min_f32 v50, -v56, -v57
v_min_f32 v51, -v56, -v57
qb 24,196,244,44
v_max3_f32 v56, v32, v33, v34
v_max_f32 v56, v56, v35
qb 24,200,248,24
v_add_f32 v56, 0x41200000, v56
v_add_f32 v28, v28, v48
v_add_f32 v29, v29, v48
v_add_f32 v30, v30, v48
v_add_f32 v31, v31, v48
v_mov_b32 v57, v56
qb 24,204,252,24
ex 28
ex 29
ex 30
ex 31
v_permlane16_swap_b32 v56, v57
pw 24,208,216
cv 160,28,29
cv 161,30,31
v_max_f32 v56, v56, v57
v_mov_b32 v57, v56
qa 28,208,232,48
ex 16
v_permlane32_swap_b32 v56, v57
pw 28,204,228
v_min_f32 v52, -v56, -v57
v_add_f32 v32, v32, v52
v_add_f32 v33, v33, v52
v_add_f32 v34, v34, v52
v_add_f32 v35, v35, v52
pw 28,200,224
ex 32
ex 33
ex 34
ex 35
pw 28,196,220
v_min_f32 v53, -v56, -v57
v_min_f32 v54, -v56, -v57
v_min_f32 v55, -v56, -v57
cv 168,32,33
cv 169,34,35
qa 32,196,236,52
global_load_lds_dwordx4 v13, s[96:97] offset:3072 nt
lk 196,0,8192
pw 32,200,240
s_add_u32 m0, s21, 114688
lk 200,1,8192
v_accvgpr_read_b32 v60, a164
pw 32,204,244
s_add_u32 s96, s96, 16384
s_addc_u32 s97, s97, 0
lk 204,2,8192
pw 32,208,248
s_waitcnt lgkmcnt(3)
lk 208,3,8192
v_accvgpr_read_b32 v61, a165
pa 8,176,180
ex 17
pa 8,180,184
ex 18
pa 40,188,184
ex 19
pa 40,184,180
cv 138,16,17
cv 139,18,19
pa 72,192,180
ex 20
pa 72,196,184
ex 21
pa 104,204,184
ex 22
pa 104,200,180
ex 23
pa 136,208,180
lv 180,8,49152
cv 146,20,21
pa 140,208,188
lv 182,8,53248
cv 147,22,23
pa 108,200,188
ex 24
pa 108,204,192
global_load_lds_dwordx4 v12, s[98:99] offset:0 nt
v_add_f32 v60, v60, v61
pa 76,196,192
ex 25
pa 76,192,188
ex 26
pa 44,184,188
ex 27
pa 44,188,192
lv 184,212,49152
v_cmp_nge_f32 s[42:43], s29, v60
pa 12,180,192
s_or_b64 s[30:31], s[30:31], s[42:43]
lv 186,212,53248
cv 154,24,25
pa 12,176,188
s_waitcnt lgkmcnt(2)
lv 188,9,49152
cv 155,26,27
qb 16,196,212,36
v_rcp_f32 v60, v60
qb 16,200,216,16
lv 190,9,53248
v_mul_f32_e64 v61, -s40, v60
qb 16,204,220,16
ds_write2_b32 v80, v60, v61 offset0:64 offset1:80
qb 16,208,224,16
ex 28
qb 20,208,240,40
ex 29
qb 20,204,236,20
ex 30
qb 20,200,232,20
ex 31
qb 20,196,228,20
ds_read_b128 v[124:127], v123 offset:256
cv 162,28,29
qb 24,196,244,44
ds_read_b128 v[128:131], v123 offset:320
cv 163,30,31
qb 24,200,248,24
ex 32
qb 24,204,252,24
ex 33
pw 24,208,216
ex 34
qa 28,208,232,48
ex 35
pw 28,204,228
global_load_lds_dwordx4 v13, s[98:99] offset:1024 nt
cv 170,32,33
pw 28,200,224
lv 192,213,49152
cv 171,34,35
pw 28,196,220
lv 194,213,53248
v_accvgpr_read_b32 v72, a64
qa 32,196,236,52
lk 196,0,12288
v_accvgpr_read_b32 v73, a65
pw 32,200,240
lk 200,1,12288
v_accvgpr_read_b32 v74, a68
v_accvgpr_read_b32 v75, a69
pw 32,204,244
s_waitcnt lgkmcnt(4)
lk 204,2,12288
v_accvgpr_read_b32 v76, a72
v_accvgpr_read_b32 v77, a73
v_accvgpr_read_b32 v78, a76
v_accvgpr_read_b32 v79, a77
v_pk_fma_f32 v[72:73], v[72:73], v[124:125], v[128:129]
v_pk_fma_f32 v[74:75], v[74:75], v[124:125], v[128:129]
cv 72,72,74
v_pk_fma_f32 v[76:77], v[76:77], v[124:125], v[128:129]
v_pk_fma_f32 v[78:79], v[78:79], v[124:125], v[128:129]
cv 74,73,75
cv 73,76,78
pw 32,208,248
ds_write_b64 v120, v[72:73] offset:0
cv 75,77,79
pa 16,176,180
ds_write_b64 v120, v[74:75] offset:128
pa 16,180,184
lk 208,3,12288
v_accvgpr_read_b32 v72, a66
v_accvgpr_read_b32 v73, a67
v_accvgpr_read_b32 v74, a70
v_accvgpr_read_b32 v75, a71
pa 48,188,184
v_accvgpr_read_b32 v76, a74
v_accvgpr_read_b32 v77, a75
v_accvgpr_read_b32 v78, a78
v_accvgpr_read_b32 v79, a79
v_fma_f32 v72, v72, v126, v130
v_fma_f32 v73, v73, v127, v131
v_pk_fma_f32 v[74:75], v[74:75], v[126:127], v[130:131]
cv 72,72,74
v_pk_fma_f32 v[76:77], v[76:77], v[126:127], v[130:131]
v_pk_fma_f32 v[78:79], v[78:79], v[126:127], v[130:131]
cv 74,73,75
cv 73,76,78
pa 48,184,180

LwY0_10:
s_cbranch_vccnz LwrY0
ds_write_b64 v120, v[72:73] offset:256
cv 75,77,79
pa 80,192,180
ds_write_b64 v120, v[74:75] offset:384
pa 80,196,184
ds_read_b64_tr_b16 v[64:65], v121 offset:0
global_load_lds_dwordx4 v12, s[98:99] offset:2048 nt
pa 112,204,184
ds_read_b64_tr_b16 v[66:67], v121 offset:32
v_lshl_add_u32 v122, v58, 8, v59
pa 112,200,180
ds_read_b64_tr_b16 v[68:69], v121 offset:1024
v_mbcnt_lo_u32_b32 v112, -1, 0
pa 144,208,180
ds_read_b64_tr_b16 v[70:71], v121 offset:1056
v_mbcnt_hi_u32_b32 v112, -1, v112
pa 148,208,188
lv 180,10,49152
v_accvgpr_read_b32 v115, a168
pa 116,200,188
s_waitcnt lgkmcnt(6)
ds_write2_b32 v80, v114, v115 offset0:192 offset1:208
pa 116,204,192
lv 182,10,53248
v_lshlrev_b32 v112, 4, v112
pa 84,196,192
lv 184,214,49152
v_add_u32 v112, s21, v112
pa 84,192,188
s_waitcnt lgkmcnt(6)
buffer_store_dwordx4 v[64:67], v122, s[16:19], s38 offen offset:0 sc0 sc1
v_add_u32 v112, 0, v112
v_accvgpr_read_b32 v60, a166
v_accvgpr_read_b32 v61, a167
v_add_f32 v60, v60, v61
pa 52,184,188
ex 16
pa 52,188,192
ds_write_b128 v112, a[128:131] offset:16384
pa 20,180,192
s_waitcnt lgkmcnt(3)
buffer_store_dwordx4 v[68:71], v122, s[16:19], s38 offen offset:2048 sc0 sc1
ex 17
ex 18
ex 19
pa 20,176,188
s_mov_b32 s38, s25
ds_write_b128 v112, a[132:135] offset:17408
v_cmp_nge_f32 s[42:43], s29, v60
cv 140,16,17
cv 141,18,19
v_rcp_f32 v60, v60
qb 16,196,212,36
s_waitcnt vmcnt(9)
v_mul_f32_e64 v61, -s40, v60
v_mov_b32 v255, 15
qb 16,200,216,16
s_or_b64 s[30:31], s[30:31], s[42:43]
ds_write2_b32 v80, v60, v61 offset0:96 offset1:112
qb 16,204,220,16
s_add_u32 s38, s38, s2
ds_read_b128 v[124:127], v123 offset:384
global_load_lds_dwordx4 v13, s[98:99] offset:3072 nt
ex 20
ex 21
ex 22
ex 23
qb 16,208,224,16
s_add_u32 m0, s21, 81920
ds_read_b128 v[128:131], v123 offset:448
cv 148,20,21
cv 149,22,23
qb 20,208,240,40
s_add_u32 s98, s98, 16384
s_addc_u32 s99, s99, 0
ds_write_b128 v112, a[136:139] offset:18432
qb 20,204,236,20
ex 24
qb 20,200,232,20
ds_write_b128 v112, a[140:143] offset:19456
ex 25
ex 26
ex 27
qb 20,196,228,20
lv 186,214,53248
cv 156,24,25
cv 157,26,27
qb 24,196,244,44
lv 188,11,49152
v_accvgpr_read_b32 v72, a96
qb 24,200,248,24
lv 190,11,53248
v_accvgpr_read_b32 v73, a97
qb 24,204,252,24
lv 192,215,49152
v_accvgpr_read_b32 v74, a100
pw 24,208,216
s_waitcnt lgkmcnt(4)
lv 194,215,53248
v_accvgpr_read_b32 v75, a101
ds_write_b32 v254, v255 offset:0
v_pk_fma_f32 v[72:73], v[72:73], v[124:125], v[128:129]
v_pk_fma_f32 v[74:75], v[74:75], v[124:125], v[128:129]
ex 28
ex 29
ex 30
ex 31
v_accvgpr_read_b32 v76, a104
v_accvgpr_read_b32 v77, a105
v_accvgpr_read_b32 v78, a108
v_accvgpr_read_b32 v79, a109
cv 72,72,74
v_pk_fma_f32 v[76:77], v[76:77], v[124:125], v[128:129]
v_pk_fma_f32 v[78:79], v[78:79], v[124:125], v[128:129]
cv 74,73,75
cv 164,28,29
cv 165,30,31
cv 73,76,78
cv 75,77,79
qa 28,208,232,48
ds_write_b64 v120, v[72:73] offset:0
pw 28,204,228
ds_write_b64 v120, v[74:75] offset:128
v_accvgpr_read_b32 v72, a98
v_accvgpr_read_b32 v73, a99
v_accvgpr_read_b32 v74, a102
v_accvgpr_read_b32 v75, a103
pw 28,200,224
ex 32
ex 33
ex 34
v_pk_fma_f32 v[72:73], v[72:73], v[126:127], v[130:131]
v_pk_fma_f32 v[74:75], v[74:75], v[126:127], v[130:131]
ex 35
v_accvgpr_read_b32 v76, a106
v_accvgpr_read_b32 v77, a107
v_accvgpr_read_b32 v78, a110
v_accvgpr_read_b32 v79, a111
cv 72,72,74
pw 28,196,220
cv 74,73,75
cv 172,32,33
cv 173,34,35
v_fma_f32 v76, v76, v126, v130
v_fma_f32 v77, v77, v127, v131
v_pk_fma_f32 v[78:79], v[78:79], v[126:127], v[130:131]
cv 73,76,78
cv 75,77,79
qa 32,196,236,52
ds_write_b64 v120, v[72:73] offset:256
pw 32,200,240
ds_write_b64 v120, v[74:75] offset:384
pw 32,204,244
ds_read_b64_tr_b16 v[64:65], v121 offset:0
v_xor_b32 v4, s35, v4
pw 32,208,248
ds_read_b64_tr_b16 v[66:67], v121 offset:32
v_mov_b32 v84, s41
pa 24,176,180
s_waitcnt lgkmcnt(4)
ds_read_b64_tr_b16 v[68:69], v121 offset:1024
v_mov_b32 v85, s41
pa 24,180,184
ds_read_b64_tr_b16 v[70:71], v121 offset:1056
v_mov_b32 v86, s41
pa 56,188,184
ds_read_b32 v255, v12 offset:1024
v_mov_b32 v87, s41
pa 56,184,180
global_load_lds_dwordx4 v12, s[96:97] offset:0 nt
ds_read_b128 v[124:127], v123 offset:256
pa 88,192,180
ex 16
pa 88,196,184
ex 17
pa 120,204,184
ex 18
pa 120,200,180
s_waitcnt lgkmcnt(4)
buffer_store_dwordx4 v[64:67], v122, s[16:19], s39 offen offset:0 sc0 sc1
ex 19
cv 142,16,17
cv 143,18,19
pa 152,208,180
s_waitcnt lgkmcnt(1)
ex 20
v_cmp_gt_u32 vcc, 15, v255
pa 156,208,188
s_cbranch_vccnz LsY15
LrY15:
lk 196,0,16384
v_xor_b32 v5, s35, v5
pa 124,200,188
buffer_store_dwordx4 v[68:71], v122, s[16:19], s39 offen offset:2048 sc0 sc1
lk 200,1,16384
lk 204,2,16384
v_accvgpr_read_b32 v72, a80
pa 124,204,192
s_add_u32 s39, s24, 0
lk 208,3,16384
v_accvgpr_read_b32 v73, a81
pa 92,196,192
s_add_u32 s39, s39, s3
ex 21
pa 92,192,188
ex 22
pa 60,184,188
ex 23
pa 60,188,192
lv 180,4,0
cv 150,20,21
pa 28,180,192
lv 182,4,4096
cv 151,22,23
pa 28,176,188
s_waitcnt lgkmcnt(4)
ex 24
qb 16,196,212,36
ex 25
qb 16,200,216,16
s_waitcnt lgkmcnt(2)
ex 26
qb 16,204,220,16
ex 27
qb 16,208,224,16
global_load_lds_dwordx4 v13, s[96:97] offset:1024 nt
cv 158,24,25
qb 20,208,240,40
lv 184,4,8192
cv 159,26,27
qb 20,204,236,20
ex 28
qb 20,200,232,20
ex 29
qb 20,196,228,20
ex 30
qb 24,196,244,44
ex 31
qb 24,200,248,24
lv 186,4,12288
cv 166,28,29
qb 24,204,252,24
ds_read_b128 v[128:131], v123 offset:320
cv 167,30,31
pw 24,208,216
ex 32
qa 28,208,232,48
ex 33
pw 28,204,228
ex 34
pw 28,200,224
ex 35
pw 28,196,220
lv 192,5,8192
cv 174,32,33
cv 175,34,35
qa 32,196,236,52
lv 194,5,12288
v_accvgpr_read_b32 v74, a84
pw 32,200,240
lv 188,5,0
v_accvgpr_read_b32 v75, a85
pw 32,204,244
s_waitcnt lgkmcnt(3)
lv 190,5,4096
v_fma_f32 v72, v72, v124, v128
pw 32,208,248
global_load_lds_dwordx4 v12, s[96:97] offset:2048 nt
v_fma_f32 v73, v73, v125, v129
v_mfma_f32_16x16x32_bf16 v[56:59], v[136:139], a[180:183], v[84:87]
lk 196,0,20480
v_fma_f32 v74, v74, v124, v128
pb 56,140,184
lk 200,1,20480
v_fma_f32 v75, v75, v125, v129
v_mfma_f32_16x16x32_bf16 v[88:91], v[148:151], a[184:187], v[84:87]
lk 204,2,20480
v_accvgpr_read_b32 v76, a88
v_accvgpr_read_b32 v77, a89
v_accvgpr_read_b32 v78, a92
v_accvgpr_read_b32 v79, a93
cv 72,72,74
pb 88,144,180
lk 208,3,20480
v_accvgpr_write_b32 a76, s41
v_accvgpr_write_b32 a77, s41
v_accvgpr_write_b32 a78, s41
v_accvgpr_write_b32 a79, s41
v_pk_fma_f32 v[76:77], v[76:77], v[124:125], v[128:129]
v_pk_fma_f32 v[78:79], v[78:79], v[124:125], v[128:129]
cv 74,73,75
cv 73,76,78
cv 75,77,79
v_mfma_f32_16x16x32_bf16 a[64:67], v[152:155], a[180:183], a[76:79]
ds_write_b64 v120, v[72:73] offset:0
pa 64,156,184
ds_write_b64 v120, v[74:75] offset:128
v_accvgpr_read_b32 v72, a82
v_accvgpr_read_b32 v73, a83
v_accvgpr_read_b32 v74, a86
v_accvgpr_read_b32 v75, a87
v_mfma_f32_16x16x32_bf16 a[96:99], v[164:167], a[184:187], a[76:79]
v_accvgpr_read_b32 v76, a90
v_accvgpr_read_b32 v77, a91
v_accvgpr_read_b32 v78, a94
v_accvgpr_read_b32 v79, a95
v_accvgpr_read_b32 v60, a160
v_pk_fma_f32 v[72:73], v[72:73], v[126:127], v[130:131]
v_pk_fma_f32 v[74:75], v[74:75], v[126:127], v[130:131]
cv 72,72,74
v_pk_fma_f32 v[76:77], v[76:77], v[126:127], v[130:131]
v_pk_fma_f32 v[78:79], v[78:79], v[126:127], v[130:131]
cv 74,73,75
cv 73,76,78
pa 96,160,180
ds_write_b64 v120, v[72:73] offset:256
cv 75,77,79
v_mfma_f32_16x16x32_bf16 a[128:131], v[168:171], a[180:183], a[76:79]
ds_write_b64 v120, v[74:75] offset:384
v_accvgpr_read_b32 v61, a161
pa 128,172,184
s_waitcnt lgkmcnt(2)
ds_read_b64_tr_b16 v[132:133], v121 offset:0
v_add_f32 v60, v60, v61
v_cmp_nge_f32 s[42:43], s29, v60
v_mfma_f32_16x16x32_bf16 a[132:135], v[172:175], a[192:195], a[76:79]
s_or_b64 s[30:31], s[30:31], s[42:43]
ds_read_b64_tr_b16 v[134:135], v121 offset:32
v_accvgpr_write_b32 a160, 0
v_rcp_f32 v60, v60
pa 132,168,188
ds_read_b64_tr_b16 v[108:109], v121 offset:1024
v_mul_f32_e64 v61, -s40, v60
v_mfma_f32_16x16x32_bf16 a[100:103], v[160:163], a[188:191], a[76:79]
ds_read_b64_tr_b16 v[110:111], v121 offset:1056
v_accvgpr_write_b32 a161, 0
pa 100,164,192
ds_write2_b32 v80, v60, v61 offset0:0 offset1:16
v_accvgpr_read_b32 v60, a162
v_accvgpr_read_b32 v61, a163
v_add_f32 v60, v60, v61
v_mfma_f32_16x16x32_bf16 a[68:71], v[156:159], a[192:195], a[76:79]
global_load_lds_dwordx4 v13, s[96:97] offset:3072 nt
v_cmp_nge_f32 s[42:43], s29, v60
v_rcp_f32 v60, v60
pa 68,152,188
s_add_u32 m0, s21, 131072
ds_read_b128 v[124:127], v123 offset:384
v_mul_f32_e64 v61, -s40, v60
v_mfma_f32_16x16x32_bf16 v[92:95], v[144:147], a[188:191], v[84:87]
s_or_b64 s[30:31], s[30:31], s[42:43]
ds_write2_b32 v80, v60, v61 offset0:32 offset1:48
pb 92,148,192
s_add_u32 s96, s96, 16384
s_addc_u32 s97, s97, 0
s_waitcnt lgkmcnt(4)
buffer_store_dwordx4 v[132:135], v122, s[16:19], s36 offen offset:0 sc0 sc1
v_accvgpr_write_b32 a162, 0
v_accvgpr_write_b32 a163, 0
ex 16
v_mfma_f32_16x16x32_bf16 v[60:63], v[140:143], a[192:195], v[84:87]
ex 17
pb 60,136,188
ex 18
ex 19
v_smfmac_f32_16x16x64_bf16 a[160:163], a[172:175], v[136:143], v14
s_waitcnt lgkmcnt(2)
buffer_store_dwordx4 v[108:111], v122, s[16:19], s36 offen offset:2048 sc0 sc1
cv 176,16,17
cv 177,18,19
ex 20
qb 16,196,212,36
s_add_u32 s36, s24, 0
ex 21
qb 16,200,216,16
s_add_u32 s36, s36, s2
ex 22
qb 16,204,220,16
ds_read_b128 v[128:131], v123 offset:448
cv 184,20,21
ex 23
qb 16,208,224,16
cv 185,22,23
v_accvgpr_read_b32 v72, a112
qb 20,208,240,40
ex 24
qb 20,204,236,20
ex 25
qb 20,200,232,20
ex 26
ex 27
qb 20,196,228,20
global_load_lds_dwordx4 v12, s[98:99] offset:0 nt
cv 192,24,25
cv 193,26,27
qb 24,196,244,44
ex 28
qb 24,200,248,24
ex 29
qb 24,204,252,24
ex 30
ex 31
v_accvgpr_read_b32 v73, a113
v_accvgpr_read_b32 v74, a116
v_accvgpr_read_b32 v75, a117
pw 24,208,216
s_waitcnt lgkmcnt(0)
cv 200,28,29
cv 201,30,31
v_accvgpr_read_b32 v76, a120
v_accvgpr_read_b32 v77, a121
v_accvgpr_read_b32 v78, a124
v_pk_fma_f32 v[72:73], v[72:73], v[124:125], v[128:129]
v_pk_fma_f32 v[74:75], v[74:75], v[124:125], v[128:129]
v_accvgpr_read_b32 v79, a125
cv 72,72,74
v_xor_b32 v6, s35, v6
qa 28,208,232,48
lv 180,6,0
cv 74,73,75
v_xor_b32 v119, 0x1000, v80
ex 32
v_pk_fma_f32 v[76:77], v[76:77], v[124:125], v[128:129]
v_pk_fma_f32 v[78:79], v[78:79], v[124:125], v[128:129]
lv 182,6,4096
cv 73,76,78
cv 75,77,79
pw 28,204,228
ds_write_b64 v120, v[72:73] offset:0
pw 28,200,224
ds_write_b64 v120, v[74:75] offset:128
pw 28,196,220
lv 184,6,8192
v_accvgpr_read_b32 v72, a114
lv 186,6,12288
ex 33
ex 34
ex 35
ds_read2_b32 v[116:117], v119 offset0:192 offset1:208
v_accvgpr_read_b32 v73, a115
v_accvgpr_read_b32 v74, a118
v_accvgpr_read_b32 v75, a119
v_pk_fma_f32 v[72:73], v[72:73], v[126:127], v[130:131]
v_pk_fma_f32 v[74:75], v[74:75], v[126:127], v[130:131]
cv 208,32,33
cv 209,34,35
v_accvgpr_read_b32 v76, a122
v_accvgpr_read_b32 v77, a123
v_accvgpr_read_b32 v78, a126
v_accvgpr_read_b32 v79, a127
cv 72,72,74
qa 32,196,236,52
lk 196,0,24576
cv 74,73,75
v_xor_b32 v7, s35, v7
v_fma_f32 v76, v76, v126, v130
v_fma_f32 v77, v77, v127, v131
v_pk_fma_f32 v[78:79], v[78:79], v[126:127], v[130:131]
cv 73,76,78
cv 75,77,79
pw 32,200,240
ds_write_b64 v120, v[72:73] offset:256
pw 32,204,244
ds_write_b64 v120, v[74:75] offset:384
pw 32,208,248
s_waitcnt lgkmcnt(3)
ds_read_b64_tr_b16 v[132:133], v121 offset:0
v_min_f32 v118, v114, v116
v_mfma_f32_16x16x32_bf16 v[64:67], v[136:139], a[180:183], v[84:87]
ds_read_b64_tr_b16 v[134:135], v121 offset:32
v_sub_f32 v114, v118, v114
pb 64,140,184
ds_read_b64_tr_b16 v[108:109], v121 offset:1024
v_sub_f32 v116, v118, v116
v_mfma_f32_16x16x32_bf16 v[96:99], v[148:151], a[184:187], v[84:87]
ds_read_b64_tr_b16 v[110:111], v121 offset:1056
global_load_lds_dwordx4 v13, s[98:99] offset:1024 nt
pb 96,144,180
lv 192,7,8192
v_xor_b32 v113, 0x1000, v112
v_mfma_f32_16x16x32_bf16 a[72:75], v[152:155], a[180:183], a[76:79]
lv 194,7,12288
v_accvgpr_read_b32 v72, a144
ex 114
pa 72,156,184
lv 188,7,0
v_mul_f32 v118, v115, v114
v_mfma_f32_16x16x32_bf16 a[104:107], v[164:167], a[184:187], a[76:79]
lv 190,7,4096
v_accvgpr_read_b32 v73, a145
ex 116
pa 104,160,180
s_waitcnt lgkmcnt(6)
buffer_store_dwordx4 v[132:135], v122, s[16:19], s37 offen offset:0 sc0 sc1
v_fma_f32 v118, v117, v116, v118
v_rcp_f32 v118, v118
v_accvgpr_read_b32 v74, a148
v_mul_f32 v114, v114, v118
v_mul_f32 v116, v116, v118
v_add_f32 v119, v114, v116
v_mul_f32_e64 v119, -s40, v119
v_mfma_f32_16x16x32_bf16 a[136:139], v[168:171], a[180:183], a[76:79]
ds_write2_b32 v80, v114, v119 offset0:128 offset1:144
pa 136,172,184
s_waitcnt lgkmcnt(3)
buffer_store_dwordx4 v[108:111], v122, s[16:19], s37 offen offset:2048 sc0 sc1
ds_write2_b32 v80, v116, v116 offset0:160 offset1:176
ds_read_b128 v[124:127], v123 offset:512
v_mfma_f32_16x16x32_bf16 a[140:143], v[172:175], a[192:195], a[76:79]
s_add_u32 s37, s24, 4096
ds_read_b128 v[128:131], v123 offset:576
v_accvgpr_read_b32 v75, a149
s_waitcnt lgkmcnt(4)
pa 140,168,188
s_add_u32 s37, s37, s3
ds_read_b128 v[132:135], v123 offset:640
v_accvgpr_read_b32 v76, a152
v_mfma_f32_16x16x32_bf16 a[108:111], v[160:163], a[188:191], a[76:79]
ds_read_b64 v[104:105], v113 offset:16384
v_accvgpr_read_b32 v77, a153
pa 108,164,192
ds_read_b64 v[106:107], v113 offset:17408
v_accvgpr_read_b32 v78, a156
pa 76,156,192
ds_read_b64 v[108:109], v113 offset:18432
v_accvgpr_read_b32 v79, a157
pa 76,152,188
ds_read_b64 v[110:111], v113 offset:19456
global_load_lds_dwordx4 v12, s[98:99] offset:2048 nt
v_mfma_f32_16x16x32_bf16 v[100:103], v[144:147], a[188:191], v[84:87]
lk 200,1,24576
v_cmp_nge_f32 s[42:43], s29, v115
pb 100,148,192
s_or_b64 s[30:31], s[30:31], s[42:43]
lk 204,2,24576
s_waitcnt lgkmcnt(7)
v_fma_f32 v72, v72, v124, v128
v_mfma_f32_16x16x32_bf16 v[68:71], v[140:143], a[192:195], v[84:87]
s_waitcnt lgkmcnt(2)
lk 208,3,24576
v_fma_f32 v73, v73, v125, v129
ex 16
ex 17
v_pk_fma_f32 v[74:75], v[74:75], v[124:125], v[128:129]
v_pk_fma_f32 v[72:73], v[104:105], v[132:133], v[72:73]
v_pk_fma_f32 v[74:75], v[106:107], v[132:133], v[74:75]
v_pk_fma_f32 v[76:77], v[76:77], v[124:125], v[128:129]
v_pk_fma_f32 v[78:79], v[78:79], v[124:125], v[128:129]
ds_read_b64 v[104:105], v113 offset:16392
ds_read_b64 v[106:107], v113 offset:17416
v_pk_fma_f32 v[76:77], v[108:109], v[132:133], v[76:77]
v_pk_fma_f32 v[78:79], v[110:111], v[132:133], v[78:79]
ds_read_b64 v[108:109], v113 offset:18440
ds_read_b64 v[110:111], v113 offset:19464
pb 68,136,188
ex 18
ex 19
v_smfmac_f32_16x16x64_bf16 a[160:163], a[176:179], v[144:151], v14
cv 178,16,17
cv 179,18,19
qb 16,196,212,36
s_waitcnt lgkmcnt(4)
cv 72,72,74
cv 74,73,75
qb 16,200,216,16
cv 73,76,78
cv 75,77,79
qb 16,204,220,16
ds_write_b64 v120, v[72:73] offset:0
qb 16,208,224,16
ds_write_b64 v120, v[74:75] offset:128
ex 20
ex 21
ex 22
ex 23
v_accvgpr_read_b32 v72, a146
v_accvgpr_read_b32 v73, a147
v_accvgpr_read_b32 v74, a150
v_accvgpr_read_b32 v75, a151
cv 186,20,21
cv 187,22,23
v_pk_fma_f32 v[72:73], v[72:73], v[126:127], v[130:131]
v_pk_fma_f32 v[74:75], v[74:75], v[126:127], v[130:131]

LwY0_11:
s_cbranch_vccnz LwrY0
v_accvgpr_read_b32 v76, a154
v_accvgpr_read_b32 v77, a155
qb 20,208,240,40
s_waitcnt lgkmcnt(2)
v_accvgpr_read_b32 v78, a158
v_accvgpr_read_b32 v79, a159
ex 24
ex 25
v_pk_fma_f32 v[72:73], v[104:105], v[134:135], v[72:73]
v_pk_fma_f32 v[74:75], v[106:107], v[134:135], v[74:75]
v_pk_fma_f32 v[76:77], v[76:77], v[126:127], v[130:131]
v_pk_fma_f32 v[78:79], v[78:79], v[126:127], v[130:131]
cv 72,72,74
v_pk_fma_f32 v[76:77], v[108:109], v[134:135], v[76:77]
v_pk_fma_f32 v[78:79], v[110:111], v[134:135], v[78:79]
cv 74,73,75
cv 73,76,78
qb 20,204,236,20
ds_write_b64 v120, v[72:73] offset:256
cv 75,77,79
qb 20,200,232,20
ds_write_b64 v120, v[74:75] offset:384
ex 26
ex 27
qb 20,196,228,20
ds_read_b64_tr_b16 v[132:133], v121 offset:0
cv 194,24,25
cv 195,26,27
v_cmp_nge_f32 s[42:43], s29, v117
qb 24,196,244,44
s_or_b64 s[30:31], s[30:31], s[42:43]
ds_read_b64_tr_b16 v[134:135], v121 offset:32
v_xor_b32 v8, s35, v8
qb 24,200,248,24
ds_read_b64_tr_b16 v[116:117], v121 offset:1024
global_load_lds_dwordx4 v13, s[98:99] offset:3072 nt
qb 24,204,252,24
s_add_u32 m0, s21, 32768
ds_read_b64_tr_b16 v[118:119], v121 offset:1056
v_xor_b32 v9, s35, v9
ex 28
ex 29
ex 30
ex 31
pw 24,208,216
s_add_u32 s98, s98, 16384
s_addc_u32 s99, s99, 0
lv 180,8,0
cv 202,28,29
cv 203,30,31
qa 28,208,232,48
lv 182,8,4096
v_accvgpr_write_b32 a92, s41
pw 28,204,228
lv 184,8,8192
v_accvgpr_write_b32 a93, s41
pw 28,200,224
lv 186,8,12288
v_accvgpr_write_b32 a94, s41
ex 32
ex 33
ex 34
ex 35
pw 28,196,220
s_waitcnt lgkmcnt(4)
buffer_store_dwordx4 v[132:135], v122, s[16:19], s38 offen offset:0 sc0 sc1
cv 210,32,33
cv 211,34,35
v_accvgpr_write_b32 a95, s41
v_accvgpr_write_b32 a164, 0
qa 32,196,236,52
lv 192,9,8192
v_accvgpr_write_b32 a165, 0
pw 32,200,240
lv 194,9,12288
v_accvgpr_write_b32 a166, 0
pw 32,204,244
lv 188,9,0
v_accvgpr_write_b32 a167, 0
pw 32,208,248
s_waitcnt lgkmcnt(3)
buffer_store_dwordx4 v[116:119], v122, s[16:19], s38 offen offset:2048 sc0 sc1
lv 190,9,4096
lk 196,0,28672
v_xor_b32 v10, s35, v10
v_mfma_f32_16x16x32_bf16 v[72:75], v[136:139], a[180:183], v[84:87]
s_add_u32 s38, s24, 4096
lk 200,1,28672
v_xor_b32 v11, s35, v11
pb 72,140,184
s_add_u32 s38, s38, s2
lk 204,2,28672
v_mov_b32 v255, 16
v_mfma_f32_16x16x32_bf16 v[104:107], v[148:151], a[184:187], v[84:87]
lk 208,3,28672
v_accvgpr_write_b32 a168, 0
pb 104,144,180
ex 16
v_mfma_f32_16x16x32_bf16 a[80:83], v[152:155], a[180:183], a[92:95]
ex 17
pa 80,156,184
ex 18
v_mfma_f32_16x16x32_bf16 a[112:115], v[164:167], a[184:187], a[92:95]
ex 19
pa 112,160,180
ds_read_b128 v[124:127], v123 offset:0
cv 180,16,17
v_mfma_f32_16x16x32_bf16 a[144:147], v[168:171], a[180:183], a[92:95]
lv 180,10,0
cv 181,18,19
pa 144,172,184
s_waitcnt lgkmcnt(3)
ex 20
v_mfma_f32_16x16x32_bf16 a[148:151], v[172:175], a[192:195], a[92:95]
ex 21
pa 148,168,188
ex 22
v_mfma_f32_16x16x32_bf16 a[116:119], v[160:163], a[188:191], a[92:95]
ex 23
pa 116,164,192
lv 182,10,4096
cv 188,20,21
v_mfma_f32_16x16x32_bf16 a[84:87], v[156:159], a[192:195], a[92:95]
lv 184,10,8192
cv 189,22,23
pa 84,152,188
ex 24
v_mfma_f32_16x16x32_bf16 v[108:111], v[144:147], a[188:191], v[84:87]
ex 25
pb 108,148,192
ex 26
v_mfma_f32_16x16x32_bf16 v[76:79], v[140:143], a[192:195], v[84:87]
ex 27
pb 76,136,188
lv 186,10,12288
cv 196,24,25
v_smfmac_f32_16x16x64_bf16 a[164:167], a[172:175], v[152:159], v14
lv 192,11,8192
v_smfmac_f32_16x16x64_bf16 a[164:167], a[176:179], v[160:167], v14
lv 194,11,12288
qb 16,196,212,36
s_waitcnt vmcnt(16)
lv 188,11,0
cv 197,26,27
qb 16,200,216,16
lv 190,11,4096
v_accvgpr_write_b32 a169, 0
qb 16,204,220,16
s_waitcnt lgkmcnt(5)
ds_write_b32 v254, v255 offset:0
qb 16,208,224,16
ex 28
qb 20,208,240,40
ex 29
qb 20,204,236,20
ex 30
qb 20,200,232,20
ex 31
qb 20,196,228,20
ds_read_b128 v[128:131], v123 offset:64
cv 204,28,29
qb 24,196,244,44
cv 205,30,31
v_accvgpr_read_b32 v132, a0
qb 24,200,248,24
ex 32
qb 24,204,252,24
ex 33
pw 24,208,216
ex 34
qa 28,208,232,48
ex 35
pw 28,204,228
global_load_lds_dwordx4 v12, s[96:97] offset:0 nt
cv 212,32,33
pw 28,200,224
cv 213,34,35
v_accvgpr_read_b32 v133, a4
pw 28,196,220
ex 16
qa 32,196,236,52
ex 17
pw 32,200,240
ex 18
pw 32,204,244
ex 19
pw 32,208,248
cv 182,16,17
cv 183,18,19
v_mfma_f32_16x16x32_bf16 v[80:83], v[136:139], a[180:183], v[84:87]
s_waitcnt lgkmcnt(0)
ds_read_b32 v255, v12 offset:1024
v_accvgpr_read_b32 v134, a8
pb 80,140,184
ex 20
v_mfma_f32_16x16x32_bf16 v[112:115], v[148:151], a[184:187], v[84:87]
ex 21
pb 112,144,180
ex 22
v_mfma_f32_16x16x32_bf16 a[88:91], v[152:155], a[180:183], a[92:95]
global_load_lds_dwordx4 v13, s[96:97] offset:1024 nt
cv 190,20,21
pa 88,156,184
ex 23
v_mfma_f32_16x16x32_bf16 a[120:123], v[164:167], a[184:187], a[92:95]
cv 191,22,23
v_accvgpr_read_b32 v135, a12
pa 120,160,180
s_waitcnt lgkmcnt(0)
v_cmp_gt_u32 vcc, 16, v255
v_fma_f32 v132, v132, v124, v128
v_mfma_f32_16x16x32_bf16 a[152:155], v[168:171], a[180:183], a[92:95]
ex 24
pa 152,172,184
s_cbranch_vccnz LsY16
LrY16:
lk 196,0,32768
v_mov_b32 v255, 17
v_mfma_f32_16x16x32_bf16 a[156:159], v[172:175], a[192:195], a[92:95]
lk 200,1,32768
v_fma_f32 v133, v133, v124, v128
pa 156,168,188
lk 204,2,32768
v_fma_f32 v134, v134, v124, v128
v_mfma_f32_16x16x32_bf16 a[124:127], v[160:163], a[188:191], a[92:95]
lk 208,3,32768
v_fma_f32 v135, v135, v124, v128
pa 124,164,192
ex 25
pa 92,156,192
ex 26
pa 92,152,188
ex 27
v_mfma_f32_16x16x32_bf16 v[116:119], v[144:147], a[188:191], v[84:87]
lv 180,4,16384
cv 198,24,25
pb 116,148,192
lv 182,4,20480
cv 199,26,27
pb 84,140,192
ex 28
pb 84,136,188
global_load_lds_dwordx4 v12, s[96:97] offset:2048 nt
lv 184,4,24576
v_smfmac_f32_16x16x64_bf16 a[168:171], a[172:175], v[168:175], v14
s_waitcnt lgkmcnt(3)
lv 186,4,28672
qb 16,196,212,36
ex 29
qb 16,200,216,16
ex 30
qb 16,204,220,16
ex 31
qb 16,208,224,16
lv 192,5,24576
cv 206,28,29
qb 20,208,240,40
lv 194,5,28672
cv 207,30,31
qb 20,204,236,20
ex 32
qb 20,200,232,20
ex 33
qb 20,196,228,20
ex 34
qb 24,196,244,44
ex 35
qb 24,200,248,24
lv 188,5,16384
cv 214,32,33
qb 24,204,252,24
lv 190,5,20480
cv 215,34,35
pw 24,208,216
ex 16
qa 28,208,232,48
ex 17
pw 28,204,228
global_load_lds_dwordx4 v13, s[96:97] offset:3072 nt
s_add_u32 m0, s21, 147456
pw 28,200,224
s_add_u32 s96, s96, 16384
s_addc_u32 s97, s97, 0
cv 136,16,17
pw 28,196,220
ex 18
qa 32,196,236,52
lk 196,0,36864
cv 132,132,133
pw 32,200,240
lk 200,1,36864
cv 133,134,135
pw 32,204,244
lk 204,2,36864
v_accvgpr_read_b32 v134, a9
pw 32,208,248
s_waitcnt lgkmcnt(3)
lk 208,3,36864
v_accvgpr_read_b32 v135, a13
pb 56,176,180
ex 19
pb 56,180,184
ds_write_b64 v120, v[132:133] offset:0
pb 88,188,184
cv 137,18,19
v_accvgpr_read_b32 v132, a1
pb 88,184,180
ex 20
pa 64,192,180
ex 21
pa 64,196,184
ex 22
pa 96,204,184
ex 23
pa 96,200,180
cv 144,20,21
cv 145,22,23
pa 128,208,180
global_load_lds_dwordx4 v12, s[98:99] offset:0 nt
lv 180,6,16384
pa 128,212,184
ex 24
pa 132,212,192
ex 25
pa 132,208,188
ex 26
pa 100,200,188
ex 27
pa 100,204,192
lv 182,6,20480
cv 152,24,25
pa 68,196,192
lv 184,6,24576
cv 153,26,27
pa 68,192,188
ex 28
pb 92,184,188
ex 29
pb 92,188,192
ex 30
pb 60,180,192
ex 31
pb 60,176,188
lv 186,6,28672
cv 160,28,29
v_smfmac_f32_16x16x64_bf16 a[160:163], a[172:175], v[176:183], v14
s_waitcnt lgkmcnt(3)
lv 192,7,24576
qb 16,196,212,36
lv 194,7,28672
cv 161,30,31
qb 16,200,216,16
ex 32
qb 16,204,220,16
global_load_lds_dwordx4 v13, s[98:99] offset:1024 nt
lv 188,7,16384
qb 16,208,224,16
ex 33
qb 20,208,240,40
ex 34
qb 20,204,236,20
ex 35
qb 20,200,232,20
lv 190,7,20480
cv 168,32,33
qb 20,196,228,20
cv 169,34,35
v_accvgpr_read_b32 v133, a5
qb 24,196,244,44
ex 16
qb 24,200,248,24
ex 17
qb 24,204,252,24
cv 138,16,17
v_fma_f32 v132, v132, v125, v129
pw 24,208,216
ex 18
qa 28,208,232,48
v_fma_f32 v133, v133, v125, v129
v_fma_f32 v134, v134, v125, v129
pw 28,204,228
ex 19
pw 28,200,224
cv 139,18,19
v_fma_f32 v135, v135, v125, v129
pw 28,196,220
ex 20
qa 32,196,236,52
lk 196,0,40960
cv 132,132,133
pw 32,200,240
global_load_lds_dwordx4 v12, s[98:99] offset:2048 nt
lk 200,1,40960
pw 32,204,244
lk 204,2,40960
cv 133,134,135
pw 32,208,248
s_waitcnt lgkmcnt(3)
lk 208,3,40960
v_accvgpr_read_b32 v134, a10
pb 64,176,180
ex 21
pb 64,180,184
ex 22
pb 96,188,184
ex 23
pb 96,184,180
ds_write_b64 v120, v[132:133] offset:128
pa 72,192,180
cv 146,20,21
cv 147,22,23
pa 72,196,184
ex 24
pa 104,204,184
ex 25
pa 104,200,180
ex 26
pa 136,208,180
lv 180,8,16384
cv 154,24,25
pa 136,212,184
ex 27
pa 140,212,192
lv 182,8,20480
cv 155,26,27
pa 140,208,188
ex 28
pa 108,200,188
global_load_lds_dwordx4 v13, s[98:99] offset:3072 nt
lv 184,8,24576
pa 108,204,192
s_add_u32 m0, s21, 49152
ex 29
pa 76,196,192
s_add_u32 s98, s98, 16384
s_addc_u32 s99, s99, 0
lv 186,8,28672
pa 76,192,188
ex 30
pb 100,184,188
cv 162,28,29
v_accvgpr_read_b32 v132, a2
pb 100,188,192
ex 31
pb 68,180,192
lv 192,9,24576
cv 163,30,31
pb 68,176,188
ex 32
v_smfmac_f32_16x16x64_bf16 a[160:163], a[176:179], v[184:191], v14
s_waitcnt lgkmcnt(2)
lv 194,9,28672
qb 16,196,212,36
ex 33
qb 16,200,216,16
lv 188,9,16384
cv 170,32,33
qb 16,204,220,16
ex 34
qb 16,208,224,16
lv 190,9,20480
v_accvgpr_read_b32 v133, a6
qb 20,208,240,40
ex 35
qb 20,204,236,20
cv 171,34,35
v_accvgpr_read_b32 v135, a14
qb 20,200,232,20
v_fma_f32 v132, v132, v126, v130
v_fma_f32 v133, v133, v126, v130
qb 20,196,228,20
ex 16
qb 24,196,244,44
v_fma_f32 v134, v134, v126, v130
v_fma_f32 v135, v135, v126, v130
qb 24,200,248,24
ex 17
qb 24,204,252,24
cv 140,16,17
cv 132,132,133
pw 24,208,216
ex 18
qa 28,208,232,48
cv 133,134,135
v_accvgpr_read_b32 v134, a11
pw 28,204,228
ex 19
pw 28,200,224
ds_write_b64 v120, v[132:133] offset:256
pw 28,196,220
cv 141,18,19
v_accvgpr_read_b32 v132, a3
qa 32,196,236,52
lk 196,0,45056
v_accvgpr_read_b32 v133, a7
pw 32,200,240
lk 200,1,45056
v_accvgpr_read_b32 v135, a15
pw 32,204,244
lk 204,2,45056
v_fma_f32 v132, v132, v127, v131
pw 32,208,248
lk 208,3,45056
v_fma_f32 v133, v133, v127, v131
pb 72,176,180
s_waitcnt lgkmcnt(5)
ex 20
pb 72,180,184
ex 21
pb 104,188,184
ex 22
pb 104,184,180
ex 23
pa 80,192,180
cv 148,20,21
cv 149,22,23
pa 80,196,184
ex 24
pa 112,204,184
ex 25
pa 112,200,180
ex 26
pa 144,208,180
lv 180,10,16384
cv 156,24,25
pa 144,212,184
ex 27
pa 148,212,192
lv 182,10,20480
cv 157,26,27
pa 148,208,188
lv 184,10,24576
v_fma_f32 v134, v134, v127, v131
pa 116,200,188
lv 186,10,28672
v_fma_f32 v135, v135, v127, v131
pa 116,204,192
ex 28
pa 84,196,192
ex 29
pa 84,192,188
ex 30
pb 108,184,188
cv 164,28,29
cv 132,132,133
pb 108,188,192
ex 31
pb 76,180,192
lv 192,11,24576
cv 165,30,31
pb 76,176,188
lv 194,11,28672
cv 133,134,135
v_smfmac_f32_16x16x64_bf16 a[164:167], a[172:175], v[192:199], v14
lv 188,11,16384
v_smfmac_f32_16x16x64_bf16 a[164:167], a[176:179], v[200:207], v14
s_waitcnt lgkmcnt(3)
lv 190,11,20480
qb 16,196,212,36
s_waitcnt vmcnt(10)
ds_write_b32 v254, v255 offset:0
qb 16,200,216,16
ex 32
qb 16,204,220,16
ex 33
qb 16,208,224,16
ex 34
qb 20,208,240,40
ex 35
qb 20,204,236,20
ds_write_b64 v120, v[132:133] offset:384
qb 20,200,232,20
ds_read_b64_tr_b16 v[132:133], v121 offset:0
cv 172,32,33
qb 20,196,228,20
ds_read_b64_tr_b16 v[134:135], v121 offset:32
cv 173,34,35
qb 24,196,244,44

LwY0_12:
s_cbranch_vccnz LwrY0
ex 16
qb 24,200,248,24
ex 17
qb 24,204,252,24
cv 142,16,17
pw 24,208,216
ex 18
qa 28,208,232,48
pw 28,204,228
ex 19
pw 28,200,224
s_waitcnt lgkmcnt(0)
buffer_store_dwordx4 v[132:135], v122, s[16:19], s39 offen offset:0 sc0 sc1
cv 143,18,19
pw 28,196,220
ex 20
qa 32,196,236,52
ds_read_b64_tr_b16 v[132:133], v121 offset:1024
pw 32,200,240
ex 21
pw 32,204,244
ds_read_b64_tr_b16 v[134:135], v121 offset:1056
cv 150,20,21
pw 32,208,248
ex 22
pb 80,176,180
ds_read_b32 v255, v12 offset:1024
pb 80,180,184
ex 23
pb 112,188,184
cv 151,22,23
pb 112,184,180
ex 24
pa 88,192,180
pa 88,196,184
ex 25
pa 120,204,184
s_waitcnt lgkmcnt(1)
buffer_store_dwordx4 v[132:135], v122, s[16:19], s39 offen offset:2048 sc0 sc1
cv 158,24,25
pa 120,200,180
s_waitcnt lgkmcnt(0)
v_cmp_gt_u32 vcc, 17, v255
v_accvgpr_read_b32 v132, a16
pa 152,208,180
ex 26
pa 152,212,184
s_cbranch_vccnz LsY17
LrY17:
lk 196,0,49152
v_mov_b32 v255, 18
pa 156,212,192
lk 200,1,49152
v_accvgpr_read_b32 v133, a20
pa 156,208,188
lk 204,2,49152
v_accvgpr_read_b32 v134, a24
pa 124,200,188
lk 208,3,49152
v_accvgpr_read_b32 v135, a28
pa 124,204,192
ex 27
pa 92,196,192
lv 180,4,32768
cv 159,26,27
pa 92,192,188
ex 28
pb 116,184,188
ex 29
pb 116,188,192
ex 30
pb 84,180,192
ex 31
pb 84,176,188
lv 182,4,36864
cv 166,28,29
v_smfmac_f32_16x16x64_bf16 a[168:171], a[172:175], v[208:215], v14
s_waitcnt lgkmcnt(2)
lv 184,4,40960
qb 16,196,212,36
lv 186,4,45056
cv 167,30,31
qb 16,200,216,16
ex 32
qb 16,204,220,16
ex 33
qb 16,208,224,16
ex 34
qb 20,208,240,40
ex 35
qb 20,204,236,20
lv 192,5,40960
cv 174,32,33
qb 20,200,232,20
lv 194,5,45056
cv 175,34,35
qb 20,196,228,20
lv 188,5,32768
v_fma_f32 v132, v132, v124, v128
qb 24,196,244,44
global_load_lds_dwordx4 v12, s[96:97] offset:0 nt
lv 190,5,36864
qb 24,200,248,24
ex 16
qb 24,204,252,24
ex 17
pw 24,208,216
ex 18
qa 28,208,232,48
cv 176,16,17
v_fma_f32 v133, v133, v124, v128
pw 28,204,228
ex 19
pw 28,200,224
cv 177,18,19
v_fma_f32 v134, v134, v124, v128
pw 28,196,220
ex 20
qa 32,196,236,52
lk 196,0,53248
v_fma_f32 v135, v135, v124, v128
pw 32,200,240
lk 200,1,53248
cv 132,132,133
pw 32,204,244
lk 204,2,53248
cv 133,134,135
pw 32,208,248
s_waitcnt lgkmcnt(3)
lk 208,3,53248
v_accvgpr_read_b32 v134, a25
pb 56,136,180
ex 21
pb 56,140,184
ex 22
pb 88,148,184
ex 23
pb 88,144,180
global_load_lds_dwordx4 v13, s[96:97] offset:1024 nt
cv 184,20,21
pa 64,152,180
ds_write_b64 v120, v[132:133] offset:0
pa 64,156,184
cv 185,22,23
v_accvgpr_read_b32 v132, a17
pa 96,164,184
ex 24
pa 96,160,180
ex 25
pa 128,168,180
ex 26
pa 128,172,184
ex 27
pa 132,172,192
lv 180,6,32768
cv 192,24,25
pa 132,168,188
lv 182,6,36864
cv 193,26,27
pa 100,160,188
ex 28
pa 100,164,192
ex 29
pa 68,156,192
lv 184,6,40960
cv 200,28,29
pa 68,152,188
ex 30
pb 92,144,188
lv 186,6,45056
v_accvgpr_read_b32 v133, a21
pb 92,148,192
ex 31
pb 60,140,192
global_load_lds_dwordx4 v12, s[96:97] offset:2048 nt
cv 201,30,31
pb 60,136,188
ex 32
v_smfmac_f32_16x16x64_bf16 a[160:163], a[172:175], v[136:143], v14
s_waitcnt lgkmcnt(2)
lv 192,7,40960
qb 16,196,212,36
ex 33
qb 16,200,216,16
lv 194,7,45056
cv 208,32,33
qb 16,204,220,16
ex 34
qb 16,208,224,16
lv 188,7,32768
v_accvgpr_read_b32 v135, a29
qb 20,208,240,40
ex 35
qb 20,204,236,20
lv 190,7,36864
cv 209,34,35
qb 20,200,232,20
v_fma_f32 v132, v132, v125, v129
v_fma_f32 v133, v133, v125, v129
qb 20,196,228,20
ex 16
qb 24,196,244,44
v_fma_f32 v134, v134, v125, v129
v_fma_f32 v135, v135, v125, v129
qb 24,200,248,24
ex 17
qb 24,204,252,24
cv 178,16,17
cv 132,132,133
pw 24,208,216
ex 18
qa 28,208,232,48
global_load_lds_dwordx4 v13, s[96:97] offset:3072 nt
s_add_u32 m0, s21, 98304
pw 28,204,228
s_add_u32 s96, s96, 16384
s_addc_u32 s97, s97, 0
cv 133,134,135
pw 28,200,224
ex 19
pw 28,196,220
ds_write_b64 v120, v[132:133] offset:128
qa 32,196,236,52
lk 196,0,57344
cv 179,18,19
pw 32,200,240
lk 200,1,57344
v_accvgpr_read_b32 v132, a18
pw 32,204,244
lk 204,2,57344
v_accvgpr_read_b32 v133, a22
pw 32,208,248
lk 208,3,57344
v_accvgpr_read_b32 v134, a26
pb 64,136,180
s_waitcnt lgkmcnt(5)
ex 20
pb 64,140,184
ex 21
pb 96,148,184
ex 22
pb 96,144,180
ex 23
pa 72,152,180
cv 186,20,21
cv 187,22,23
pa 72,156,184
ex 24
pa 104,164,184
ex 25
pa 104,160,180
global_load_lds_dwordx4 v12, s[98:99] offset:0 nt
cv 194,24,25
pa 136,168,180
ex 26
pa 136,172,184
ex 27
pa 140,172,192
lv 180,8,32768
cv 195,26,27
pa 140,168,188
ex 28
pa 108,160,188
lv 182,8,36864
v_accvgpr_read_b32 v135, a30
pa 108,164,192
ex 29
pa 76,156,192
lv 184,8,40960
cv 202,28,29
pa 76,152,188
ex 30
pb 100,144,188
lv 186,8,45056
v_fma_f32 v132, v132, v126, v130
pb 100,148,192
ex 31
pb 68,140,192
lv 192,9,40960
cv 203,30,31
pb 68,136,188
ex 32
v_smfmac_f32_16x16x64_bf16 a[160:163], a[176:179], v[144:151], v14
s_waitcnt lgkmcnt(3)
lv 194,9,45056
qb 16,196,212,36
ex 33
qb 16,200,216,16
global_load_lds_dwordx4 v13, s[98:99] offset:1024 nt
cv 210,32,33
qb 16,204,220,16
ex 34
qb 16,208,224,16
lv 188,9,32768
v_fma_f32 v133, v133, v126, v130
qb 20,208,240,40
ex 35
qb 20,204,236,20
lv 190,9,36864
cv 211,34,35
qb 20,200,232,20
v_fma_f32 v134, v134, v126, v130
v_fma_f32 v135, v135, v126, v130
qb 20,196,228,20
ex 16
qb 24,196,244,44
cv 132,132,133
cv 133,134,135
qb 24,200,248,24
ex 17
qb 24,204,252,24
ds_write_b64 v120, v[132:133] offset:256
pw 24,208,216
ex 18
qa 28,208,232,48
cv 180,16,17
v_accvgpr_read_b32 v132, a19
pw 28,204,228
ex 19
pw 28,200,224
cv 181,18,19
v_accvgpr_read_b32 v133, a23
pw 28,196,220
ex 20
qa 32,196,236,52
global_load_lds_dwordx4 v12, s[98:99] offset:2048 nt
lk 196,0,61440
pw 32,200,240
lk 200,1,61440
v_accvgpr_read_b32 v134, a27
pw 32,204,244
lk 204,2,61440
v_accvgpr_read_b32 v135, a31
pw 32,208,248
lk 208,3,61440
v_fma_f32 v132, v132, v127, v131
pb 72,136,180
s_waitcnt lgkmcnt(4)
ex 21
pb 72,140,184
ex 22
pb 104,148,184
ex 23
pb 104,144,180
cv 188,20,21
cv 189,22,23
pa 80,152,180
ex 24
pa 80,156,184
ex 25
pa 112,164,184
cv 196,24,25
v_fma_f32 v133, v133, v127, v131
pa 112,160,180
ex 26
pa 144,168,180
lv 180,10,32768
v_fma_f32 v134, v134, v127, v131
pa 144,172,184
ex 27
pa 148,172,192
lv 182,10,36864
cv 197,26,27
pa 148,168,188
global_load_lds_dwordx4 v13, s[98:99] offset:3072 nt
lv 184,10,40960
pa 116,160,188
s_add_u32 m0, s21, 65536
lv 186,10,45056
v_fma_f32 v135, v135, v127, v131
pa 116,164,192
s_add_u32 s98, s98, 16384
s_addc_u32 s99, s99, 0
cv 132,132,133
pa 84,156,192
ex 28
pa 84,152,188
ex 29
pb 108,144,188
ex 30
pb 108,148,192
ex 31
pb 76,140,192
lv 192,11,40960
cv 204,28,29
pb 76,136,188
lv 194,11,45056
cv 205,30,31
v_smfmac_f32_16x16x64_bf16 a[164:167], a[172:175], v[152:159], v14
lv 188,11,32768
v_smfmac_f32_16x16x64_bf16 a[164:167], a[176:179], v[160:167], v14
s_waitcnt lgkmcnt(3)
lv 190,11,36864
qb 16,196,212,36
s_waitcnt vmcnt(10)
ds_write_b32 v254, v255 offset:0
qb 16,200,216,16
ex 32
qb 16,204,220,16
ex 33
qb 16,208,224,16
ex 34
qb 20,208,240,40
ex 35
qb 20,204,236,20
ds_read_b128 v[124:127], v123 offset:128
cv 212,32,33
qb 20,200,232,20
ds_read_b128 v[128:131], v123 offset:192
cv 213,34,35
qb 20,196,228,20
ex 16
qb 24,196,244,44
cv 133,134,135
qb 24,200,248,24
ex 17
qb 24,204,252,24
ds_write_b64 v120, v[132:133] offset:384
pw 24,208,216
ex 18
qa 28,208,232,48
ds_read_b64_tr_b16 v[132:133], v121 offset:0
cv 182,16,17
pw 28,204,228
ex 19
pw 28,200,224
ds_read_b64_tr_b16 v[134:135], v121 offset:32
cv 183,18,19
pw 28,196,220
ex 20
qa 32,196,236,52
pw 32,200,240
ex 21
pw 32,204,244
cv 190,20,21
pw 32,208,248
ex 22
pb 80,136,180
ds_read_b32 v255, v12 offset:1024
pb 80,140,184
ex 23
pb 112,148,184
s_waitcnt lgkmcnt(1)
buffer_store_dwordx4 v[132:135], v122, s[16:19], s36 offen offset:0 sc0 sc1
cv 191,22,23
pb 112,144,180
ex 24
pa 88,152,180
ds_read_b64_tr_b16 v[132:133], v121 offset:1024
pa 88,156,184
ex 25
pa 120,164,184
s_waitcnt lgkmcnt(1)
ds_read_b64_tr_b16 v[134:135], v121 offset:1056
v_cmp_gt_u32 vcc, 18, v255
pa 120,160,180
ex 26
pa 152,168,180
cv 198,24,25
pa 152,172,184
s_cbranch_vccnz LsY18
LrY18:
lk 196,0,0
v_mov_b32 v255, 19
pa 156,172,192
lk 200,1,0
pa 156,168,188
lk 204,2,0
pa 124,160,188
lk 208,3,0
pa 124,164,192
global_load_lds_dwordx4 v12, s[96:97] offset:0 nt
lv 180,4,49152
pa 92,156,192
ex 27
pa 92,152,188
lv 182,4,53248
cv 199,26,27
pb 116,144,188
ex 28
pb 116,148,192
ex 29
pb 84,140,192
ex 30
pb 84,136,188
ex 31
v_smfmac_f32_16x16x64_bf16 a[168:171], a[172:175], v[168:175], v14
s_waitcnt lgkmcnt(2)
lv 184,4,57344
qb 16,196,212,36
lv 186,4,61440
cv 206,28,29
qb 16,200,216,16
lv 192,5,57344
cv 207,30,31
qb 16,204,220,16
ex 32
qb 16,208,224,16
ex 33
qb 20,208,240,40
ex 34
qb 20,204,236,20
ex 35
qb 20,200,232,20
lv 194,5,61440
cv 214,32,33
qb 20,196,228,20
global_load_lds_dwordx4 v13, s[96:97] offset:1024 nt
cv 215,34,35
qb 24,196,244,44
lv 188,5,49152
qb 24,200,248,24
lv 190,5,53248
qb 24,204,252,24
ex 16
pw 24,208,216
ex 17
qa 28,208,232,48
ex 18
pw 28,204,228
ex 19
pw 28,200,224
buffer_store_dwordx4 v[132:135], v122, s[16:19], s36 offen offset:2048 sc0 sc1
cv 136,16,17
cv 137,18,19
v_accvgpr_read_b32 v132, a32
v_accvgpr_read_b32 v133, a36
pw 28,196,220
ex 20
qa 32,196,236,52
lk 196,0,4096
v_accvgpr_read_b32 v134, a40
pw 32,200,240
lk 200,1,4096
v_accvgpr_read_b32 v135, a44
pw 32,204,244
lk 204,2,4096
v_fma_f32 v132, v132, v124, v128
pw 32,208,248
s_waitcnt lgkmcnt(3)
lk 208,3,4096
v_fma_f32 v133, v133, v124, v128
pb 56,176,180
ex 21
pb 56,180,184
ex 22
pb 88,188,184
global_load_lds_dwordx4 v12, s[96:97] offset:2048 nt
cv 144,20,21
pb 88,184,180
ex 23
pa 64,192,180
cv 145,22,23
v_fma_f32 v134, v134, v124, v128
pa 64,196,184
ex 24
pa 96,204,184
ex 25
pa 96,200,180
ex 26
pa 128,208,180
lv 180,6,49152
cv 152,24,25
pa 128,212,184
ex 27
pa 132,212,192
lv 182,6,53248
cv 153,26,27
pa 132,208,188
ex 28
pa 100,200,188
lv 184,6,57344
v_fma_f32 v135, v135, v124, v128
pa 100,204,192
ex 29
pa 68,196,192
lv 186,6,61440
cv 160,28,29
pa 68,192,188
ex 30
pb 92,184,188
cv 132,132,133
cv 133,134,135
pb 92,188,192

LwY0_13:
s_cbranch_vccnz LwrY0
global_load_lds_dwordx4 v13, s[96:97] offset:3072 nt
s_add_u32 m0, s21, 114688
pb 60,180,192
s_add_u32 s96, s96, 16384
s_addc_u32 s97, s97, 0
lv 192,7,57344
pb 60,176,188
ex 31
v_smfmac_f32_16x16x64_bf16 a[160:163], a[172:175], v[176:183], v14
s_waitcnt lgkmcnt(2)
lv 194,7,61440
qb 16,196,212,36
lv 188,7,49152
cv 161,30,31
qb 16,200,216,16
ex 32
qb 16,204,220,16
ex 33
qb 16,208,224,16
ex 34
qb 20,208,240,40
ex 35
qb 20,204,236,20
lv 190,7,53248
cv 168,32,33
qb 20,200,232,20
ds_write_b64 v120, v[132:133] offset:0
qb 20,196,228,20
cv 169,34,35
v_accvgpr_read_b32 v132, a33
qb 24,196,244,44
ex 16
qb 24,200,248,24
ex 17
qb 24,204,252,24
cv 138,16,17
v_accvgpr_read_b32 v133, a37
pw 24,208,216
global_load_lds_dwordx4 v12, s[98:99] offset:0 nt
v_accvgpr_read_b32 v134, a41
qa 28,208,232,48
ex 18
pw 28,204,228
ex 19
pw 28,200,224
cv 139,18,19
v_accvgpr_read_b32 v135, a45
pw 28,196,220
ex 20
qa 32,196,236,52
lk 196,0,8192
v_fma_f32 v132, v132, v125, v129
pw 32,200,240
lk 200,1,8192
v_fma_f32 v133, v133, v125, v129
pw 32,204,244
lk 204,2,8192
v_fma_f32 v134, v134, v125, v129
pw 32,208,248
lk 208,3,8192
v_fma_f32 v135, v135, v125, v129
pb 64,176,180
s_waitcnt lgkmcnt(4)
ex 21
pb 64,180,184
ex 22
pb 96,188,184
ex 23
pb 96,184,180
cv 146,20,21
cv 147,22,23
pa 72,192,180
ex 24
pa 72,196,184
ex 25
pa 104,204,184
global_load_lds_dwordx4 v13, s[98:99] offset:1024 nt
cv 154,24,25
pa 104,200,180
ex 26
pa 136,208,180
lv 180,8,49152
cv 132,132,133
pa 136,212,184
ex 27
pa 140,212,192
lv 182,8,53248
cv 155,26,27
pa 140,208,188
ex 28
pa 108,200,188
lv 184,8,57344
cv 133,134,135
pa 108,204,192
ex 29
pa 76,196,192
lv 186,8,61440
cv 162,28,29
pa 76,192,188
ex 30
pb 100,184,188
ds_write_b64 v120, v[132:133] offset:128
pb 100,188,192
ex 31
pb 68,180,192
lv 192,9,57344
cv 163,30,31
pb 68,176,188
ex 32
v_smfmac_f32_16x16x64_bf16 a[160:163], a[176:179], v[184:191], v14
s_waitcnt lgkmcnt(3)
lv 194,9,61440
qb 16,196,212,36
global_load_lds_dwordx4 v12, s[98:99] offset:2048 nt
lv 188,9,49152
qb 16,200,216,16
ex 33
qb 16,204,220,16
ex 34
qb 16,208,224,16
lv 190,9,53248
cv 170,32,33
qb 20,208,240,40
ex 35
qb 20,204,236,20
cv 171,34,35
v_accvgpr_read_b32 v132, a34
qb 20,200,232,20
v_accvgpr_read_b32 v133, a38
v_accvgpr_read_b32 v134, a42
qb 20,196,228,20
ex 16
qb 24,196,244,44
v_accvgpr_read_b32 v135, a46
v_fma_f32 v132, v132, v126, v130
qb 24,200,248,24
ex 17
qb 24,204,252,24
cv 140,16,17
v_fma_f32 v133, v133, v126, v130
pw 24,208,216
ex 18
qa 28,208,232,48
s_mov_b64 vcc, -1
s_cmp_eq_u32 s21, 0
s_cbranch_scc1 LwY1_0
s_cmp_eq_u32 s21, 4096
s_cbranch_scc1 LwY1_1
s_cmp_eq_u32 s21, 8192
s_cbranch_scc1 LwY1_2
s_branch LwY1_3
LwrY1:
s_mov_b64 vcc, 0
v_fma_f32 v134, v134, v126, v130
v_fma_f32 v135, v135, v126, v130
pw 28,204,228
ex 19
pw 28,200,224
cv 141,18,19
cv 132,132,133
pw 28,196,220
global_load_lds_dwordx4 v13, s[98:99] offset:3072 nt
s_add_u32 m0, s21, 81920
qa 32,196,236,52
s_add_u32 s98, s98, 16384
s_addc_u32 s99, s99, 0
lk 196,0,12288
pw 32,200,240
lk 200,1,12288
cv 133,134,135
pw 32,204,244
lk 204,2,12288
v_accvgpr_read_b32 v134, a43
pw 32,208,248
lk 208,3,12288
v_accvgpr_read_b32 v135, a47
pb 72,176,180
s_waitcnt lgkmcnt(4)
ex 20
pb 72,180,184
ex 21
pb 104,188,184
ex 22
pb 104,184,180
ex 23
pa 80,192,180
ds_write_b64 v120, v[132:133] offset:256
pa 80,196,184
cv 148,20,21
cv 149,22,23
pa 112,204,184
ex 24
pa 112,200,180
ex 25
pa 144,208,180
ex 26
pa 144,212,184
ex 27
pa 148,212,192
lv 180,10,49152
cv 156,24,25
pa 148,208,188
lv 182,10,53248
cv 157,26,27
pa 116,200,188
lv 184,10,57344
v_accvgpr_read_b32 v132, a35
pa 116,204,192
lv 186,10,61440
v_accvgpr_read_b32 v133, a39
pa 84,196,192
ex 28
pa 84,192,188
ex 29
pb 108,184,188
ex 30
pb 108,188,192
ex 31
pb 76,180,192
lv 192,11,57344
cv 164,28,29
pb 76,176,188
lv 194,11,61440
cv 165,30,31
v_smfmac_f32_16x16x64_bf16 a[164:167], a[172:175], v[192:199], v14
lv 188,11,49152
v_smfmac_f32_16x16x64_bf16 a[164:167], a[176:179], v[200:207], v14
s_waitcnt lgkmcnt(3)
lv 190,11,53248
qb 16,196,212,36
s_waitcnt vmcnt(10)
ds_write_b32 v254, v255 offset:0
qb 16,200,216,16
ex 32
qb 16,204,220,16
ex 33
qb 16,208,224,16
ex 34
qb 20,208,240,40
ex 35
qb 20,204,236,20
cv 172,32,33
cv 173,34,35
qb 20,200,232,20
v_fma_f32 v132, v132, v127, v131
v_fma_f32 v133, v133, v127, v131
qb 20,196,228,20
ex 16
qb 24,196,244,44
v_fma_f32 v134, v134, v127, v131
v_fma_f32 v135, v135, v127, v131
qb 24,200,248,24
ex 17
qb 24,204,252,24
cv 142,16,17
cv 132,132,133
pw 24,208,216
ex 18
qa 28,208,232,48
cv 133,134,135
pw 28,204,228
ex 19
pw 28,200,224
ds_write_b64 v120, v[132:133] offset:384
pw 28,196,220
ds_read_b64_tr_b16 v[132:133], v121 offset:0
cv 143,18,19
qa 32,196,236,52
ex 20
pw 32,200,240
ex 21
pw 32,204,244
ds_read_b64_tr_b16 v[134:135], v121 offset:32
cv 150,20,21
pw 32,208,248
ex 22
pb 80,176,180
ds_read_b32 v255, v12 offset:1024
global_load_lds_dwordx4 v12, s[96:97] offset:0 nt
pb 80,180,184
ex 23
pb 112,188,184
cv 151,22,23
pb 112,184,180
ex 24
pa 88,192,180
pa 88,196,184
ex 25
pa 120,204,184
s_waitcnt lgkmcnt(1)
buffer_store_dwordx4 v[132:135], v122, s[16:19], s37 offen offset:0 sc0 sc1
cv 158,24,25
pa 120,200,180
s_waitcnt lgkmcnt(0)
ds_read_b64_tr_b16 v[132:133], v121 offset:1024
v_cmp_gt_u32 vcc, 19, v255
pa 152,208,180
ex 26
pa 152,212,184
s_cbranch_vccnz LsY19
LrY19:
lk 196,0,16384
v_mov_b32 v255, 20
pa 156,212,192
lk 200,1,16384
pa 156,208,188
lk 204,2,16384
pa 124,200,188
lk 208,3,16384
pa 124,204,192
ex 27
pa 92,196,192
lv 180,4,0
cv 159,26,27
pa 92,192,188
global_load_lds_dwordx4 v13, s[96:97] offset:1024 nt
lv 182,4,4096
pb 116,184,188
ex 28
pb 116,188,192
ex 29
pb 84,180,192
ex 30
pb 84,176,188
ex 31
v_smfmac_f32_16x16x64_bf16 a[168:171], a[172:175], v[208:215], v14
s_waitcnt lgkmcnt(2)
lv 184,4,8192
qb 16,196,212,36
lv 186,4,12288
cv 166,28,29
qb 16,200,216,16
lv 192,5,8192
cv 167,30,31
qb 16,204,220,16
ex 32
qb 16,208,224,16
ex 33
qb 20,208,240,40
ex 34
qb 20,204,236,20
ex 35
qb 20,200,232,20
lv 194,5,12288
cv 174,32,33
qb 20,196,228,20
lv 188,5,0
cv 175,34,35
qb 24,196,244,44
lv 190,5,4096
qb 24,200,248,24
global_load_lds_dwordx4 v12, s[96:97] offset:2048 nt
ds_read_b64_tr_b16 v[134:135], v121 offset:1056
qb 24,204,252,24
ex 16
pw 24,208,216
ex 17
qa 28,208,232,48
ex 18
pw 28,204,228
ex 19
pw 28,200,224
cv 176,16,17
cv 177,18,19
pw 28,196,220
ex 20
qa 32,196,236,52
lk 196,0,20480
pw 32,200,240
lk 200,1,20480
pw 32,204,244
lk 204,2,20480
pw 32,208,248
s_waitcnt lgkmcnt(3)
lk 208,3,20480
pb 56,136,180
ex 21
pb 56,140,184
ex 22
pb 88,148,184
ex 23
pb 88,144,180
buffer_store_dwordx4 v[132:135], v122, s[16:19], s37 offen offset:2048 sc0 sc1
cv 184,20,21
cv 185,22,23
ex 24
pa 64,152,180
s_mov_b32 s37, s27
v_accvgpr_read_b32 v132, a48
v_accvgpr_read_b32 v133, a52
pa 64,156,184
ex 25
pa 96,164,184
cv 192,24,25
v_accvgpr_read_b32 v134, a56
pa 96,160,180
global_load_lds_dwordx4 v13, s[96:97] offset:3072 nt
s_add_u32 m0, s21, 131072
pa 128,168,180
s_add_u32 s96, s96, 16384
s_addc_u32 s97, s97, 0
lv 180,6,0
pa 128,172,184
ex 26
pa 132,172,192
ex 27
pa 132,168,188
lv 182,6,4096
cv 193,26,27
pa 100,160,188
ex 28
pa 100,164,192
ex 29
pa 68,156,192
lv 184,6,8192
cv 200,28,29
pa 68,152,188
ex 30
pb 92,144,188
lv 186,6,12288
v_accvgpr_read_b32 v135, a60
pb 92,148,192
ex 31
pb 60,140,192
lv 192,7,8192
cv 201,30,31
pb 60,136,188
global_load_lds_dwordx4 v12, s[98:99] offset:0 nt
lv 194,7,12288
v_smfmac_f32_16x16x64_bf16 a[160:163], a[172:175], v[136:143], v14
s_waitcnt lgkmcnt(4)
lv 188,7,0
qb 16,196,212,36
ex 32
qb 16,200,216,16
ex 33
qb 16,204,220,16
ex 34
qb 16,208,224,16
lv 190,7,4096
cv 208,32,33
qb 20,208,240,40
ex 35
qb 20,204,236,20
cv 209,34,35
v_fma_f32 v132, v132, v124, v128
qb 20,200,232,20
v_fma_f32 v133, v133, v124, v128
v_fma_f32 v134, v134, v124, v128
qb 20,196,228,20
ex 16
qb 24,196,244,44
v_fma_f32 v135, v135, v124, v128
cv 132,132,133
qb 24,200,248,24
ex 17
qb 24,204,252,24
cv 178,16,17
cv 133,134,135
pw 24,208,216
ex 18
qa 28,208,232,48
ds_write_b64 v120, v[132:133] offset:0
pw 28,204,228
global_load_lds_dwordx4 v13, s[98:99] offset:1024 nt
v_accvgpr_read_b32 v132, a49
pw 28,200,224
ex 19
pw 28,196,220
cv 179,18,19
v_accvgpr_read_b32 v133, a53
qa 32,196,236,52
lk 196,0,24576
v_accvgpr_read_b32 v134, a57
pw 32,200,240
lk 200,1,24576
v_accvgpr_read_b32 v135, a61
pw 32,204,244
lk 204,2,24576
v_fma_f32 v132, v132, v125, v129
pw 32,208,248
lk 208,3,24576
v_fma_f32 v133, v133, v125, v129
pb 64,136,180
s_waitcnt lgkmcnt(4)
ex 20
pb 64,140,184
ex 21
pb 96,148,184
ex 22
pb 96,144,180
ex 23
pa 72,152,180
cv 186,20,21
cv 187,22,23
pa 72,156,184
ex 24
pa 104,164,184
ex 25
pa 104,160,180
ex 26
pa 136,168,180
global_load_lds_dwordx4 v12, s[98:99] offset:2048 nt
cv 194,24,25
pa 136,172,184
ex 27
pa 140,172,192
lv 180,8,0
cv 195,26,27
pa 140,168,188
ex 28
pa 108,160,188
lv 182,8,4096
v_fma_f32 v134, v134, v125, v129
pa 108,164,192
ex 29
pa 76,156,192
lv 184,8,8192
cv 202,28,29
pa 76,152,188
ex 30
pb 100,144,188
lv 186,8,12288
v_fma_f32 v135, v135, v125, v129
pb 100,148,192
ex 31
pb 68,140,192
lv 192,9,8192
cv 203,30,31
pb 68,136,188
ex 32
v_smfmac_f32_16x16x64_bf16 a[160:163], a[176:179], v[144:151], v14
s_waitcnt lgkmcnt(3)
lv 194,9,12288
qb 16,196,212,36
ex 33
qb 16,200,216,16
lv 188,9,0
cv 210,32,33
qb 16,204,220,16
global_load_lds_dwordx4 v13, s[98:99] offset:3072 nt
lv 190,9,4096
qb 16,208,224,16
s_add_u32 m0, s21, 32768
ex 34
qb 20,208,240,40
s_add_u32 s98, s98, 16384
s_addc_u32 s99, s99, 0
cv 132,132,133
qb 20,204,236,20
ex 35
qb 20,200,232,20
cv 211,34,35
cv 133,134,135
qb 20,196,228,20
ex 16
qb 24,196,244,44
ds_write_b64 v120, v[132:133] offset:128
qb 24,200,248,24
ex 17
qb 24,204,252,24
cv 180,16,17
v_accvgpr_read_b32 v132, a50
pw 24,208,216
ex 18
qa 28,208,232,48
v_accvgpr_read_b32 v133, a54
v_accvgpr_read_b32 v134, a58
pw 28,204,228
ex 19
pw 28,200,224
cv 181,18,19
v_accvgpr_read_b32 v135, a62
pw 28,196,220
ex 20
qa 32,196,236,52
lk 196,0,28672
v_fma_f32 v132, v132, v126, v130
pw 32,200,240
lk 200,1,28672
v_fma_f32 v133, v133, v126, v130
pw 32,204,244

LwY1_0:
s_cbranch_vccnz LwY1_4
lk 204,2,28672
v_fma_f32 v134, v134, v126, v130
pw 32,208,248
lk 208,3,28672
v_fma_f32 v135, v135, v126, v130
pb 72,136,180
s_waitcnt lgkmcnt(4)
ex 21
pb 72,140,184
ex 22
pb 104,148,184
ex 23
pb 104,144,180
cv 188,20,21
cv 189,22,23
pa 80,152,180
ex 24
pa 80,156,184
ex 25
pa 112,164,184
cv 196,24,25
cv 132,132,133
pa 112,160,180
ex 26
pa 144,168,180
lv 180,10,0
cv 133,134,135
pa 144,172,184
ex 27
pa 148,172,192
lv 182,10,4096
cv 197,26,27
pa 148,168,188
lv 184,10,8192
v_accvgpr_read_b32 v134, a59
pa 116,160,188
lv 186,10,12288
v_accvgpr_read_b32 v135, a63
pa 116,164,192
ex 28
pa 84,156,192
ex 29
pa 84,152,188
ex 30
pb 108,144,188
ds_write_b64 v120, v[132:133] offset:256
pb 108,148,192
ex 31
pb 76,140,192
lv 192,11,8192
cv 204,28,29
pb 76,136,188
lv 194,11,12288
cv 205,30,31
v_smfmac_f32_16x16x64_bf16 a[164:167], a[172:175], v[152:159], v14
lv 188,11,0
v_smfmac_f32_16x16x64_bf16 a[164:167], a[176:179], v[160:167], v14
s_waitcnt lgkmcnt(4)
lv 190,11,4096
qb 16,196,212,36
s_waitcnt vmcnt(10)
ds_write_b32 v254, v255 offset:0
qb 16,200,216,16
ex 32
qb 16,204,220,16
ex 33
qb 16,208,224,16
ex 34
qb 20,208,240,40
ex 35
qb 20,204,236,20
cv 212,32,33
cv 213,34,35
qb 20,200,232,20
v_accvgpr_read_b32 v132, a51
v_accvgpr_read_b32 v133, a55
qb 20,196,228,20
global_load_lds_dwordx4 v12, s[96:97] offset:0 nt
v_fma_f32 v132, v132, v127, v131
qb 24,196,244,44
ex 16
qb 24,200,248,24
ex 17
qb 24,204,252,24
cv 182,16,17
v_fma_f32 v133, v133, v127, v131
pw 24,208,216
ex 18
qa 28,208,232,48
v_fma_f32 v134, v134, v127, v131
v_fma_f32 v135, v135, v127, v131
pw 28,204,228
ex 19
pw 28,200,224
cv 183,18,19
cv 132,132,133
pw 28,196,220
ex 20
qa 32,196,236,52
cv 133,134,135
pw 32,200,240
ex 21
pw 32,204,244
ds_write_b64 v120, v[132:133] offset:384
pw 32,208,248
ex 22
pb 80,136,180
ds_read_b32 v255, v12 offset:1024
cv 190,20,21
pb 80,140,184
ex 23
pb 112,148,184
global_load_lds_dwordx4 v13, s[96:97] offset:1024 nt
cv 191,22,23
pb 112,144,180
ex 24
pa 88,152,180
ds_read_b64_tr_b16 v[132:133], v121 offset:0
pa 88,156,184
ex 25
pa 120,164,184
ds_read_b64_tr_b16 v[134:135], v121 offset:32
cv 198,24,25
pa 120,160,180
s_waitcnt lgkmcnt(2)
v_cmp_gt_u32 vcc, 20, v255
pa 152,168,180
ex 26
pa 152,172,184
s_cbranch_vccnz LsY20
LrY20:
lk 196,0,32768
v_mov_b32 v255, 21
pa 156,172,192
lk 200,1,32768
pa 156,168,188
lk 204,2,32768
pa 124,160,188
lk 208,3,32768
pa 124,164,192
ex 27
pa 92,156,192
lv 180,4,16384
cv 199,26,27
pa 92,152,188
ex 28
pb 116,144,188
ex 29
pb 116,148,192
global_load_lds_dwordx4 v12, s[96:97] offset:2048 nt
cv 206,28,29
pb 84,140,192
ex 30
pb 84,136,188
ex 31
v_smfmac_f32_16x16x64_bf16 a[168:171], a[172:175], v[168:175], v14
s_waitcnt lgkmcnt(1)
lv 182,4,20480
qb 16,196,212,36
lv 184,4,24576
cv 207,30,31
qb 16,200,216,16
lv 186,4,28672
qb 16,204,220,16
ex 32
qb 16,208,224,16
ex 33
qb 20,208,240,40
ex 34
qb 20,204,236,20
ex 35
qb 20,200,232,20
lv 192,5,24576
cv 214,32,33
qb 20,196,228,20
lv 194,5,28672
cv 215,34,35
qb 24,196,244,44
lv 188,5,16384
qb 24,200,248,24
lv 190,5,20480
qb 24,204,252,24
ex 16
pw 24,208,216
global_load_lds_dwordx4 v13, s[96:97] offset:3072 nt
s_add_u32 m0, s21, 147456
qa 28,208,232,48
s_add_u32 s96, s96, 16384
s_addc_u32 s97, s97, 0
pw 28,204,228
ex 17
pw 28,200,224
ex 18
pw 28,196,220
ex 19
qa 32,196,236,52
lk 196,0,36864
cv 136,16,17
pw 32,200,240
lk 200,1,36864
cv 137,18,19
pw 32,204,244
lk 204,2,36864
pw 32,208,248
s_waitcnt lgkmcnt(3)
lk 208,3,36864
pb 56,176,180
ex 20
pb 56,180,184
ex 21
pb 88,188,184
ex 22
pb 88,184,180
ex 23
pa 64,192,180
buffer_store_dwordx4 v[132:135], v122, s[16:19], s38 offen offset:0 sc0 sc1
cv 144,20,21
cv 145,22,23
ex 24
pa 64,196,184
ex 25
pa 96,204,184
ds_read_b64_tr_b16 v[132:133], v121 offset:1024
cv 152,24,25
pa 96,200,180
ex 26
pa 128,208,180
global_load_lds_dwordx4 v12, s[98:99] offset:0 nt
lv 180,6,16384
pa 128,212,184
ex 27
pa 132,212,192
lv 182,6,20480
cv 153,26,27
pa 132,208,188
ex 28
pa 100,200,188
lv 184,6,24576
pa 100,204,192
ex 29
pa 68,196,192
lv 186,6,28672
cv 160,28,29
pa 68,192,188
ex 30
pb 92,184,188
ds_read_b64_tr_b16 v[134:135], v121 offset:1056
pb 92,188,192
ex 31
pb 60,180,192
lv 192,7,24576
cv 161,30,31
pb 60,176,188
ex 32
v_smfmac_f32_16x16x64_bf16 a[160:163], a[172:175], v[176:183], v14
s_waitcnt lgkmcnt(3)
lv 194,7,28672
qb 16,196,212,36
global_load_lds_dwordx4 v13, s[98:99] offset:1024 nt
lv 188,7,16384
qb 16,200,216,16
ex 33
qb 16,204,220,16
ex 34
qb 16,208,224,16
lv 190,7,20480
cv 168,32,33
qb 20,208,240,40
ex 35
qb 20,204,236,20
s_waitcnt lgkmcnt(3)
buffer_store_dwordx4 v[132:135], v122, s[16:19], s38 offen offset:2048 sc0 sc1
cv 169,34,35
s_add_u32 s38, s26, 12288
qb 20,200,232,20
qb 20,196,228,20
ex 16
qb 24,196,244,44
qb 24,200,248,24
ex 17
qb 24,204,252,24
cv 138,16,17
pw 24,208,216
ex 18
qa 28,208,232,48
pw 28,204,228
ex 19
pw 28,200,224
cv 139,18,19
pw 28,196,220
global_load_lds_dwordx4 v12, s[98:99] offset:2048 nt
qa 32,196,236,52
lk 196,0,40960
pw 32,200,240
lk 200,1,40960
pw 32,204,244
lk 204,2,40960
pw 32,208,248
lk 208,3,40960
pb 64,176,180
ex 20
pb 64,180,184
ex 21
pb 96,188,184
ex 22
pb 96,184,180
ex 23
pa 72,192,180
cv 146,20,21
cv 147,22,23
pa 72,196,184
ex 24
pa 104,204,184
ex 25
pa 104,200,180
ex 26
pa 136,208,180
lv 180,8,16384
cv 154,24,25
pa 136,212,184
s_waitcnt lgkmcnt(1)
ex 27
pa 140,212,192
global_load_lds_dwordx4 v13, s[98:99] offset:3072 nt
cv 155,26,27
pa 140,208,188
s_add_u32 m0, s21, 49152
ex 28
pa 108,200,188
s_add_u32 s98, s98, 16384
s_addc_u32 s99, s99, 0
lv 182,8,20480
pa 108,204,192
ex 29
pa 76,196,192
lv 184,8,24576
cv 162,28,29
pa 76,192,188
ex 30
pb 100,184,188
lv 186,8,28672
pb 100,188,192
ex 31
pb 68,180,192
lv 192,9,24576
cv 163,30,31
pb 68,176,188
ex 32
v_smfmac_f32_16x16x64_bf16 a[160:163], a[176:179], v[184:191], v14
lv 194,9,28672
qb 16,196,212,36
ex 33
qb 16,200,216,16
lv 188,9,16384
cv 170,32,33
qb 16,204,220,16
ex 34
qb 16,208,224,16
lv 190,9,20480
qb 20,208,240,40
ex 35
qb 20,204,236,20
cv 171,34,35
s_nop 0
qb 20,200,232,20
qb 20,196,228,20
ex 16
qb 24,196,244,44
qb 24,200,248,24
ex 17
qb 24,204,252,24
cv 140,16,17
pw 24,208,216
ex 18
qa 28,208,232,48
pw 28,204,228
ex 19
pw 28,200,224
cv 141,18,19
pw 28,196,220
ex 20
qa 32,196,236,52
lk 196,0,45056
pw 32,200,240
lk 200,1,45056
pw 32,204,244
lk 204,2,45056
pw 32,208,248
s_waitcnt lgkmcnt(3)
lk 208,3,45056
pb 72,176,180
ex 21
pb 72,180,184
ex 22
pb 104,188,184
ex 23
pb 104,184,180
cv 148,20,21
cv 149,22,23
pa 80,192,180
ex 24
pa 80,196,184
ex 25
pa 112,204,184
cv 156,24,25
pa 112,200,180
ex 26
pa 144,208,180
lv 180,10,16384
pa 144,212,184
ex 27
pa 148,212,192
lv 182,10,20480
cv 157,26,27
pa 148,208,188
lv 184,10,24576
pa 116,200,188
lv 186,10,28672
pa 116,204,192
ex 28
pa 84,196,192
ex 29
pa 84,192,188
global_load_lds_dwordx4 v12, s[96:97] offset:0 nt
cv 164,28,29
pb 108,184,188
ex 30
pb 108,188,192
ex 31
pb 76,180,192
lv 192,11,24576
cv 165,30,31
pb 76,176,188
lv 194,11,28672
v_smfmac_f32_16x16x64_bf16 a[164:167], a[172:175], v[192:199], v14
lv 188,11,16384
v_smfmac_f32_16x16x64_bf16 a[164:167], a[176:179], v[200:207], v14
s_waitcnt lgkmcnt(3)
lv 190,11,20480
qb 16,196,212,36
s_waitcnt vmcnt(11)
ds_write_b32 v254, v255 offset:0
qb 16,200,216,16
ex 32
qb 16,204,220,16
ex 33
qb 16,208,224,16
ex 34
qb 20,208,240,40
ex 35
qb 20,204,236,20
cv 172,32,33
cv 173,34,35
qb 20,200,232,20
qb 20,196,228,20
ex 16
qb 24,196,244,44
global_load_lds_dwordx4 v13, s[96:97] offset:1024 nt
qb 24,200,248,24
ex 17
qb 24,204,252,24
cv 142,16,17
pw 24,208,216
ex 18
qa 28,208,232,48
pw 28,204,228
ex 19
pw 28,200,224
cv 143,18,19
pw 28,196,220
ex 20
qa 32,196,236,52
pw 32,200,240
ex 21
pw 32,204,244
cv 150,20,21
pw 32,208,248
ex 22
pb 80,176,180
ds_read_b32 v255, v12 offset:1024
pb 80,180,184
ex 23
pb 112,188,184
cv 151,22,23
pb 112,184,180
global_load_lds_dwordx4 v12, s[96:97] offset:2048 nt
pa 88,192,180
ex 24
pa 88,196,184
ex 25
pa 120,204,184
cv 158,24,25
pa 120,200,180
s_waitcnt lgkmcnt(0)
v_cmp_gt_u32 vcc, 21, v255
pa 152,208,180
ex 26
pa 152,212,184
s_cbranch_vccnz LsY21
LrY21:
lk 196,0,49152
v_mov_b32 v255, 22
pa 156,212,192
lk 200,1,49152
pa 156,208,188
lk 204,2,49152
pa 124,200,188
lk 208,3,49152
pa 124,204,192
ex 27
pa 92,196,192
lv 180,4,32768
cv 159,26,27
pa 92,192,188
ex 28
pb 116,184,188
ex 29
pb 116,188,192
ex 30
pb 84,180,192
s_waitcnt lgkmcnt(3)
global_load_lds_dwordx4 v13, s[96:97] offset:3072 nt
cv 166,28,29
pb 84,176,188
s_add_u32 m0, s21, 98304
ex 31
v_smfmac_f32_16x16x64_bf16 a[168:171], a[172:175], v[208:215], v14
s_add_u32 s96, s96, 16384
s_addc_u32 s97, s97, 0
qb 16,196,212,36
lv 182,4,36864
cv 167,30,31
qb 16,200,216,16
s_waitcnt lgkmcnt(1)
lv 184,4,40960
qb 16,204,220,16
lv 186,4,45056
qb 16,208,224,16
ex 32
qb 20,208,240,40
ex 33
qb 20,204,236,20
ex 34
qb 20,200,232,20
ex 35
qb 20,196,228,20
lv 192,5,40960
cv 174,32,33
qb 24,196,244,44
lv 194,5,45056
cv 175,34,35
qb 24,200,248,24
lv 188,5,32768
qb 24,204,252,24
lv 190,5,36864
pw 24,208,216
ex 16
qa 28,208,232,48
global_load_lds_dwordx4 v12, s[98:99] offset:0 nt
pw 28,204,228
ex 17
pw 28,200,224
ex 18
pw 28,196,220
ex 19
qa 32,196,236,52
lk 196,0,53248
cv 176,16,17
pw 32,200,240
lk 200,1,53248
cv 177,18,19
pw 32,204,244
lk 204,2,53248
pw 32,208,248
s_waitcnt lgkmcnt(3)
lk 208,3,53248
pb 56,136,180
ex 20
pb 56,140,184
ex 21
pb 88,148,184
ex 22
pb 88,144,180
ex 23
pa 64,152,180
cv 184,20,21
cv 185,22,23
pa 64,156,184

LwY1_1:
s_cbranch_vccnz LwY1_5
ex 24
pa 96,164,184
ex 25
pa 96,160,180
global_load_lds_dwordx4 v13, s[98:99] offset:1024 nt
cv 192,24,25
pa 128,168,180
ex 26
pa 128,172,184
ex 27
pa 132,172,192
lv 180,6,32768
cv 193,26,27
pa 132,168,188
ex 28
pa 100,160,188
lv 182,6,36864
pa 100,164,192
ex 29
pa 68,156,192
lv 184,6,40960
cv 200,28,29
pa 68,152,188
ex 30
pb 92,144,188
lv 186,6,45056
pb 92,148,192
ex 31
pb 60,140,192
lv 192,7,40960
cv 201,30,31
pb 60,136,188
ex 32
v_smfmac_f32_16x16x64_bf16 a[160:163], a[172:175], v[136:143], v14
s_waitcnt lgkmcnt(3)
lv 194,7,45056
qb 16,196,212,36
ex 33
qb 16,200,216,16
global_load_lds_dwordx4 v12, s[98:99] offset:2048 nt
cv 208,32,33
qb 16,204,220,16
ex 34
qb 16,208,224,16
lv 188,7,32768
qb 20,208,240,40
ex 35
qb 20,204,236,20
lv 190,7,36864
cv 209,34,35
qb 20,200,232,20
qb 20,196,228,20
ex 16
qb 24,196,244,44
qb 24,200,248,24
ex 17
qb 24,204,252,24
cv 178,16,17
pw 24,208,216
ex 18
qa 28,208,232,48
pw 28,204,228
ex 19
pw 28,200,224
cv 179,18,19
pw 28,196,220
ex 20
qa 32,196,236,52
global_load_lds_dwordx4 v13, s[98:99] offset:3072 nt
lk 196,0,57344
pw 32,200,240
s_add_u32 m0, s21, 65536
lk 200,1,57344
pw 32,204,244
s_add_u32 s98, s98, 16384
s_addc_u32 s99, s99, 0
lk 204,2,57344
pw 32,208,248
lk 208,3,57344
pb 64,136,180
s_waitcnt lgkmcnt(4)
ex 21
pb 64,140,184
ex 22
pb 96,148,184
ex 23
pb 96,144,180
cv 186,20,21
cv 187,22,23
pa 72,152,180
ex 24
pa 72,156,184
ex 25
pa 104,164,184
cv 194,24,25
pa 104,160,180
ex 26
pa 136,168,180
lv 180,8,32768
pa 136,172,184
ex 27
pa 140,172,192
lv 182,8,36864
cv 195,26,27
pa 140,168,188
ex 28
pa 108,160,188
lv 184,8,40960
pa 108,164,192
ex 29
pa 76,156,192
lv 186,8,45056
cv 202,28,29
pa 76,152,188
ex 30
pb 100,144,188
pb 100,148,192
ex 31
pb 68,140,192
lv 192,9,40960
cv 203,30,31
pb 68,136,188
ex 32
v_smfmac_f32_16x16x64_bf16 a[160:163], a[176:179], v[144:151], v14
s_waitcnt lgkmcnt(2)
lv 194,9,45056
qb 16,196,212,36
ex 33
qb 16,200,216,16
lv 188,9,32768
cv 210,32,33
qb 16,204,220,16
ex 34
qb 16,208,224,16
lv 190,9,36864
qb 20,208,240,40
ex 35
qb 20,204,236,20
cv 211,34,35
s_nop 0
qb 20,200,232,20
qb 20,196,228,20
ex 16
qb 24,196,244,44
qb 24,200,248,24
ex 17
qb 24,204,252,24
cv 180,16,17
pw 24,208,216
ex 18
qa 28,208,232,48
pw 28,204,228
ex 19
pw 28,200,224
cv 181,18,19
pw 28,196,220
ex 20
qa 32,196,236,52
lk 196,0,61440
pw 32,200,240
lk 200,1,61440
pw 32,204,244
lk 204,2,61440
pw 32,208,248
lk 208,3,61440
pb 72,136,180
s_waitcnt lgkmcnt(4)
ex 21
pb 72,140,184
ex 22
pb 104,148,184
ex 23
pb 104,144,180
global_load_lds_dwordx4 v12, s[96:97] offset:0 nt
cv 188,20,21
pa 80,152,180
cv 189,22,23
pa 80,156,184
ex 24
pa 112,164,184
ex 25
pa 112,160,180
ex 26
pa 144,168,180
lv 180,10,32768
cv 196,24,25
pa 144,172,184
ex 27
pa 148,172,192
lv 182,10,36864
cv 197,26,27
pa 148,168,188
lv 184,10,40960
pa 116,160,188
lv 186,10,45056
pa 116,164,192
ex 28
pa 84,156,192
ex 29
pa 84,152,188
ex 30
pb 108,144,188
cv 204,28,29
pb 108,148,192
ex 31
pb 76,140,192
global_load_lds_dwordx4 v13, s[96:97] offset:1024 nt
lv 192,11,40960
pb 76,136,188
lv 194,11,45056
cv 205,30,31
v_smfmac_f32_16x16x64_bf16 a[164:167], a[172:175], v[152:159], v14
lv 188,11,32768
v_smfmac_f32_16x16x64_bf16 a[164:167], a[176:179], v[160:167], v14
s_waitcnt lgkmcnt(3)
lv 190,11,36864
qb 16,196,212,36
s_waitcnt vmcnt(10)
ds_write_b32 v254, v255 offset:0
qb 16,200,216,16
ex 32
qb 16,204,220,16
ex 33
qb 16,208,224,16
ex 34
qb 20,208,240,40
ex 35
qb 20,204,236,20
cv 212,32,33
cv 213,34,35
qb 20,200,232,20
qb 20,196,228,20
ex 16
qb 24,196,244,44
qb 24,200,248,24
ex 17
qb 24,204,252,24
cv 182,16,17
pw 24,208,216
global_load_lds_dwordx4 v12, s[96:97] offset:2048 nt
qa 28,208,232,48
ex 18
pw 28,204,228
ex 19
pw 28,200,224
cv 183,18,19
pw 28,196,220
ex 20
qa 32,196,236,52
pw 32,200,240
ex 21
pw 32,204,244
cv 190,20,21
pw 32,208,248
ex 22
pb 80,136,180
ds_read_b32 v255, v12 offset:1024
pb 80,140,184
ex 23
pb 112,148,184
cv 191,22,23
pb 112,144,180
ex 24
pa 88,152,180
pa 88,156,184
ex 25
pa 120,164,184
global_load_lds_dwordx4 v13, s[96:97] offset:3072 nt
cv 198,24,25
pa 120,160,180
s_add_u32 m0, s21, 114688
s_waitcnt lgkmcnt(0)
v_cmp_gt_u32 vcc, 22, v255
pa 152,168,180
s_add_u32 s96, s96, 16384
s_addc_u32 s97, s97, 0
pa 152,172,184
s_cbranch_vccnz LsY22
LrY22:
lk 196,0,0
v_mov_b32 v255, 23
pa 156,172,192
lk 200,1,0
pa 156,168,188
lk 204,2,0
pa 124,160,188
lk 208,3,0
pa 124,164,192
ex 26
pa 92,156,192
ex 27
pa 92,152,188
lv 180,4,49152
cv 199,26,27
pb 116,144,188
ex 28
pb 116,148,192
ex 29
pb 84,140,192
ex 30
pb 84,136,188
ex 31
v_smfmac_f32_16x16x64_bf16 a[168:171], a[172:175], v[168:175], v14
s_waitcnt lgkmcnt(1)
lv 182,4,53248
qb 16,196,212,36
global_load_lds_dwordx4 v12, s[98:99] offset:0 nt
cv 206,28,29
qb 16,200,216,16
lv 184,4,57344
cv 207,30,31
qb 16,204,220,16
lv 186,4,61440
qb 16,208,224,16
ex 32
qb 20,208,240,40
ex 33
qb 20,204,236,20
ex 34
qb 20,200,232,20
ex 35
qb 20,196,228,20
lv 192,5,57344
cv 214,32,33
qb 24,196,244,44
lv 194,5,61440
cv 215,34,35
qb 24,200,248,24
lv 188,5,49152
qb 24,204,252,24
lv 190,5,53248
pw 24,208,216
ex 16
qa 28,208,232,48
ex 17
pw 28,204,228
ex 18
pw 28,200,224
ex 19
pw 28,196,220
global_load_lds_dwordx4 v13, s[98:99] offset:1024 nt
cv 136,16,17
qa 32,196,236,52
lk 196,0,4096
cv 137,18,19
pw 32,200,240
lk 200,1,4096
pw 32,204,244
lk 204,2,4096
pw 32,208,248
s_waitcnt lgkmcnt(3)
lk 208,3,4096
pb 56,176,180
ex 20
pb 56,180,184
ex 21
pb 88,188,184
ex 22
pb 88,184,180
ex 23
pa 64,192,180
cv 144,20,21
cv 145,22,23
pa 64,196,184
ex 24
pa 96,204,184
ex 25
pa 96,200,180
ex 26
pa 128,208,180
lv 180,6,49152
cv 152,24,25
pa 128,212,184
ex 27
pa 132,212,192
global_load_lds_dwordx4 v12, s[98:99] offset:2048 nt
cv 153,26,27
pa 132,208,188
ex 28
pa 100,200,188
lv 182,6,53248
pa 100,204,192
ex 29
pa 68,196,192
lv 184,6,57344
cv 160,28,29
pa 68,192,188
ex 30
pb 92,184,188
lv 186,6,61440
pb 92,188,192
ex 31
pb 60,180,192
lv 192,7,57344
cv 161,30,31
pb 60,176,188
ex 32
v_smfmac_f32_16x16x64_bf16 a[160:163], a[172:175], v[176:183], v14
s_waitcnt lgkmcnt(3)
lv 194,7,61440
qb 16,196,212,36
ex 33
qb 16,200,216,16
lv 188,7,49152
cv 168,32,33
qb 16,204,220,16
ex 34
qb 16,208,224,16
lv 190,7,53248
qb 20,208,240,40
global_load_lds_dwordx4 v13, s[98:99] offset:3072 nt
s_add_u32 m0, s21, 81920
qb 20,204,236,20
s_add_u32 s98, s98, 16384
s_addc_u32 s99, s99, 0
s_nop 0
qb 20,200,232,20
ex 35
qb 20,196,228,20
cv 169,34,35
qb 24,196,244,44
ex 16
qb 24,200,248,24
ex 17
qb 24,204,252,24
cv 138,16,17
pw 24,208,216
ex 18
qa 28,208,232,48
pw 28,204,228
ex 19
pw 28,200,224
cv 139,18,19
pw 28,196,220
ex 20
qa 32,196,236,52
lk 196,0,8192
pw 32,200,240
lk 200,1,8192
pw 32,204,244
lk 204,2,8192
pw 32,208,248
lk 208,3,8192
pb 64,176,180
s_waitcnt lgkmcnt(4)
ex 21
pb 64,180,184
ex 22
pb 96,188,184
ex 23
pb 96,184,180
cv 146,20,21
cv 147,22,23
pa 72,192,180
ex 24
pa 72,196,184
ex 25
pa 104,204,184
cv 154,24,25
pa 104,200,180
ex 26
pa 136,208,180
lv 180,8,49152
pa 136,212,184
ex 27
pa 140,212,192
lv 182,8,53248
cv 155,26,27
pa 140,208,188
ex 28
pa 108,200,188
lv 184,8,57344
pa 108,204,192
ex 29
pa 76,196,192
lv 186,8,61440
cv 162,28,29
pa 76,192,188
ex 30
pb 100,184,188
pb 100,188,192
ex 31
pb 68,180,192
lv 192,9,57344
cv 163,30,31
pb 68,176,188
ex 32
v_smfmac_f32_16x16x64_bf16 a[160:163], a[176:179], v[184:191], v14
s_waitcnt lgkmcnt(2)
lv 194,9,61440
qb 16,196,212,36
ex 33
qb 16,200,216,16
lv 188,9,49152
cv 170,32,33
qb 16,204,220,16
ex 34
qb 16,208,224,16
lv 190,9,53248
qb 20,208,240,40
ex 35
qb 20,204,236,20
cv 171,34,35
s_nop 0
qb 20,200,232,20
qb 20,196,228,20
ex 16
qb 24,196,244,44
qb 24,200,248,24
ex 17
qb 24,204,252,24
cv 140,16,17
pw 24,208,216
global_load_lds_dwordx4 v12, s[96:97] offset:0 nt
qa 28,208,232,48
ex 18
pw 28,204,228
ex 19
pw 28,200,224
cv 141,18,19
pw 28,196,220
ex 20
qa 32,196,236,52
lk 196,0,12288
pw 32,200,240
lk 200,1,12288
pw 32,204,244
lk 204,2,12288
pw 32,208,248
lk 208,3,12288
pb 72,176,180
s_waitcnt lgkmcnt(4)
ex 21
pb 72,180,184
ex 22
pb 104,188,184
ex 23
pb 104,184,180
cv 148,20,21
cv 149,22,23
pa 80,192,180
ex 24
pa 80,196,184
ex 25
pa 112,204,184
global_load_lds_dwordx4 v13, s[96:97] offset:1024 nt
cv 156,24,25
pa 112,200,180
ex 26
pa 144,208,180
lv 180,10,49152
pa 144,212,184
ex 27
pa 148,212,192
lv 182,10,53248
cv 157,26,27
pa 148,208,188
lv 184,10,57344
pa 116,200,188
lv 186,10,61440
pa 116,204,192
ex 28
pa 84,196,192
ex 29
pa 84,192,188
ex 30
pb 108,184,188
cv 164,28,29
pb 108,188,192
ex 31
pb 76,180,192
lv 192,11,57344
cv 165,30,31
pb 76,176,188
lv 194,11,61440
v_smfmac_f32_16x16x64_bf16 a[164:167], a[172:175], v[192:199], v14
lv 188,11,49152
v_smfmac_f32_16x16x64_bf16 a[164:167], a[176:179], v[200:207], v14
s_waitcnt lgkmcnt(3)
global_load_lds_dwordx4 v12, s[96:97] offset:2048 nt
qb 16,196,212,36
s_waitcnt vmcnt(11)
lv 190,11,53248
qb 16,200,216,16
ds_write_b32 v254, v255 offset:0
qb 16,204,220,16
ex 32
qb 16,208,224,16

LwY1_2:
s_cbranch_vccnz LwY1_6
ex 33
qb 20,208,240,40
ex 34
qb 20,204,236,20
ex 35
qb 20,200,232,20
cv 172,32,33
cv 173,34,35
qb 20,196,228,20
ex 16
qb 24,196,244,44
qb 24,200,248,24
ex 17
qb 24,204,252,24
cv 142,16,17
pw 24,208,216
ex 18
qa 28,208,232,48
pw 28,204,228
ex 19
pw 28,200,224
global_load_lds_dwordx4 v13, s[96:97] offset:3072 nt
s_add_u32 m0, s21, 131072
pw 28,196,220
s_add_u32 s96, s96, 16384
s_addc_u32 s97, s97, 0
cv 143,18,19
qa 32,196,236,52
ex 20
pw 32,200,240
ex 21
pw 32,204,244
cv 150,20,21
pw 32,208,248
ex 22
pb 80,176,180
ds_read_b32 v255, v12 offset:1024
pb 80,180,184
ex 23
pb 112,188,184
cv 151,22,23
pb 112,184,180
ex 24
pa 88,192,180
pa 88,196,184
ex 25
pa 120,204,184
cv 158,24,25
pa 120,200,180
s_waitcnt lgkmcnt(0)
v_cmp_gt_u32 vcc, 23, v255
pa 152,208,180
ex 26
pa 152,212,184
s_cbranch_vccnz LsY23
LrY23:
lk 196,0,16384
global_load_lds_dwordx4 v12, s[98:99] offset:0 nt
pa 156,212,192
lk 200,1,16384
v_mov_b32 v255, 24
pa 156,208,188
lk 204,2,16384
pa 124,200,188
lk 208,3,16384
pa 124,204,192
ex 27
pa 92,196,192
lv 180,4,0
cv 159,26,27
pa 92,192,188
ex 28
pb 116,184,188
ex 29
pb 116,188,192
ex 30
pb 84,180,192
ex 31
pb 84,176,188
lv 182,4,4096
cv 166,28,29
v_smfmac_f32_16x16x64_bf16 a[168:171], a[172:175], v[208:215], v14
s_waitcnt lgkmcnt(2)
lv 184,4,8192
qb 16,196,212,36
lv 186,4,12288
cv 167,30,31
qb 16,200,216,16
ex 32
qb 16,204,220,16
ex 33
qb 16,208,224,16
global_load_lds_dwordx4 v13, s[98:99] offset:1024 nt
cv 174,32,33
qb 20,208,240,40
ex 34
qb 20,204,236,20
ex 35
qb 20,200,232,20
lv 192,5,8192
cv 175,34,35
qb 20,196,228,20
lv 194,5,12288
qb 24,196,244,44
lv 188,5,0
qb 24,200,248,24
lv 190,5,4096
qb 24,204,252,24
ex 16
pw 24,208,216
ex 17
qa 28,208,232,48
ex 18
pw 28,204,228
ex 19
pw 28,200,224
cv 176,16,17
cv 177,18,19
pw 28,196,220
ex 20
qa 32,196,236,52
lk 196,0,20480
pw 32,200,240
lk 200,1,20480
pw 32,204,244
global_load_lds_dwordx4 v12, s[98:99] offset:2048 nt
lk 204,2,20480
pw 32,208,248
s_waitcnt lgkmcnt(3)
lk 208,3,20480
pb 56,136,180
ex 21
pb 56,140,184
ex 22
pb 88,148,184
ex 23
pb 88,144,180
cv 184,20,21
cv 185,22,23
pa 64,152,180
ex 24
pa 64,156,184
ex 25
pa 96,164,184
cv 192,24,25
pa 96,160,180
ex 26
pa 128,168,180
lv 180,6,0
pa 128,172,184
ex 27
pa 132,172,192
lv 182,6,4096
cv 193,26,27
pa 132,168,188
ex 28
pa 100,160,188
lv 184,6,8192
pa 100,164,192
global_load_lds_dwordx4 v13, s[98:99] offset:3072 nt
lv 186,6,12288
pa 68,156,192
s_add_u32 m0, s21, 32768
ex 29
pa 68,152,188
s_add_u32 s98, s98, 16384
s_addc_u32 s99, s99, 0
cv 200,28,29
pb 92,144,188
ex 30
pb 92,148,192
ex 31
pb 60,140,192
lv 192,7,8192
cv 201,30,31
pb 60,136,188
ex 32
v_smfmac_f32_16x16x64_bf16 a[160:163], a[172:175], v[136:143], v14
s_waitcnt lgkmcnt(2)
lv 194,7,12288
qb 16,196,212,36
ex 33
qb 16,200,216,16
lv 188,7,0
cv 208,32,33
qb 16,204,220,16
ex 34
qb 16,208,224,16
lv 190,7,4096
qb 20,208,240,40
ex 35
qb 20,204,236,20
cv 209,34,35
s_nop 0
qb 20,200,232,20
qb 20,196,228,20
ex 16
qb 24,196,244,44
qb 24,200,248,24
ex 17
qb 24,204,252,24
cv 178,16,17
pw 24,208,216
ex 18
qa 28,208,232,48
pw 28,204,228
ex 19
pw 28,200,224
cv 179,18,19
pw 28,196,220
ex 20
qa 32,196,236,52
lk 196,0,24576
pw 32,200,240
lk 200,1,24576
pw 32,204,244
lk 204,2,24576
pw 32,208,248
lk 208,3,24576
pb 64,136,180
s_waitcnt lgkmcnt(4)
ex 21
pb 64,140,184
ex 22
pb 96,148,184
ex 23
pb 96,144,180
cv 186,20,21
cv 187,22,23
pa 72,152,180
ex 24
pa 72,156,184
ex 25
pa 104,164,184
cv 194,24,25
pa 104,160,180
ex 26
pa 136,168,180
lv 180,8,0
pa 136,172,184
ex 27
pa 140,172,192
lv 182,8,4096
cv 195,26,27
pa 140,168,188
ex 28
pa 108,160,188
lv 184,8,8192
pa 108,164,192
ex 29
pa 76,156,192
lv 186,8,12288
cv 202,28,29
pa 76,152,188
ex 30
pb 100,144,188
pb 100,148,192
ex 31
pb 68,140,192
global_load_lds_dwordx4 v12, s[96:97] offset:0 nt
cv 203,30,31
pb 68,136,188
ex 32
v_smfmac_f32_16x16x64_bf16 a[160:163], a[176:179], v[144:151], v14
s_waitcnt lgkmcnt(1)
lv 192,9,8192
qb 16,196,212,36
ex 33
qb 16,200,216,16
lv 194,9,12288
cv 210,32,33
qb 16,204,220,16
ex 34
qb 16,208,224,16
lv 188,9,0
qb 20,208,240,40
ex 35
qb 20,204,236,20
lv 190,9,4096
cv 211,34,35
qb 20,200,232,20
qb 20,196,228,20
ex 16
qb 24,196,244,44
qb 24,200,248,24
ex 17
qb 24,204,252,24
cv 180,16,17
pw 24,208,216
ex 18
qa 28,208,232,48
global_load_lds_dwordx4 v13, s[96:97] offset:1024 nt
pw 28,204,228
ex 19
pw 28,200,224
cv 181,18,19
pw 28,196,220
ex 20
qa 32,196,236,52
lk 196,0,28672
pw 32,200,240
lk 200,1,28672
pw 32,204,244
lk 204,2,28672
pw 32,208,248
lk 208,3,28672
pb 72,136,180
s_waitcnt lgkmcnt(4)
ex 21
pb 72,140,184
ex 22
pb 104,148,184
ex 23
pb 104,144,180
cv 188,20,21
cv 189,22,23
pa 80,152,180
ex 24
pa 80,156,184
ex 25
pa 112,164,184
cv 196,24,25
pa 112,160,180
global_load_lds_dwordx4 v12, s[96:97] offset:2048 nt
pa 144,168,180
ex 26
pa 144,172,184
ex 27
pa 148,172,192
lv 180,10,0
cv 197,26,27
pa 148,168,188
lv 182,10,4096
pa 116,160,188
lv 184,10,8192
pa 116,164,192
lv 186,10,12288
pa 84,156,192
ex 28
pa 84,152,188
ex 29
pb 108,144,188
ex 30
pb 108,148,192
ex 31
pb 76,140,192
lv 192,11,8192
cv 204,28,29
pb 76,136,188
lv 194,11,12288
cv 205,30,31
v_smfmac_f32_16x16x64_bf16 a[164:167], a[172:175], v[152:159], v14
lv 188,11,0
v_smfmac_f32_16x16x64_bf16 a[164:167], a[176:179], v[160:167], v14
s_waitcnt lgkmcnt(3)
lv 190,11,4096
qb 16,196,212,36
s_waitcnt vmcnt(11)
global_load_lds_dwordx4 v13, s[96:97] offset:3072 nt
s_add_u32 m0, s21, 147456
qb 16,200,216,16
s_add_u32 s96, s96, 16384
s_addc_u32 s97, s97, 0
qb 16,204,220,16
ds_write_b32 v254, v255 offset:0
qb 16,208,224,16
ex 32
qb 20,208,240,40
ex 33
qb 20,204,236,20
ex 34
qb 20,200,232,20
ex 35
qb 20,196,228,20
cv 212,32,33
cv 213,34,35
qb 24,196,244,44
ex 16
qb 24,200,248,24
ex 17
qb 24,204,252,24
cv 182,16,17
pw 24,208,216
ex 18
qa 28,208,232,48
pw 28,204,228
ex 19
pw 28,200,224
cv 183,18,19
pw 28,196,220
global_load_lds_dwordx4 v12, s[98:99] offset:0 nt
qa 32,196,236,52
ex 20
pw 32,200,240
ex 21
pw 32,204,244
cv 190,20,21
pw 32,208,248
ex 22
pb 80,136,180
ds_read_b32 v255, v12 offset:1024
pb 80,140,184
ex 23
pb 112,148,184
cv 191,22,23
pb 112,144,180
ex 24
pa 88,152,180
pa 88,156,184
ex 25
pa 120,164,184
cv 198,24,25
pa 120,160,180
s_waitcnt lgkmcnt(0)
v_cmp_gt_u32 vcc, 24, v255
pa 152,168,180
ex 26
pa 152,172,184
s_cbranch_vccnz LsY24
LrY24:
lk 196,0,32768
v_mov_b32 v255, 25
pa 156,172,192
lk 200,1,32768
global_load_lds_dwordx4 v13, s[98:99] offset:1024 nt
pa 156,168,188
lk 204,2,32768
pa 124,160,188
lk 208,3,32768
pa 124,164,192
ex 27
pa 92,156,192
lv 180,4,16384
cv 199,26,27
pa 92,152,188
ex 28
pb 116,144,188
ex 29
pb 116,148,192
ex 30
pb 84,140,192
ex 31
pb 84,136,188
lv 182,4,20480
cv 206,28,29
v_smfmac_f32_16x16x64_bf16 a[168:171], a[172:175], v[168:175], v14
s_waitcnt lgkmcnt(2)
lv 184,4,24576
qb 16,196,212,36
lv 186,4,28672
cv 207,30,31
qb 16,200,216,16
ex 32
qb 16,204,220,16
ex 33
qb 16,208,224,16
ex 34
qb 20,208,240,40
global_load_lds_dwordx4 v12, s[98:99] offset:2048 nt
cv 214,32,33
qb 20,204,236,20
ex 35
qb 20,200,232,20
lv 192,5,24576
cv 215,34,35
qb 20,196,228,20
lv 194,5,28672
qb 24,196,244,44
lv 188,5,16384
qb 24,200,248,24
lv 190,5,20480
qb 24,204,252,24
ex 16
pw 24,208,216
ex 17
qa 28,208,232,48
ex 18
pw 28,204,228
ex 19
pw 28,200,224
cv 136,16,17
cv 137,18,19
pw 28,196,220
ex 20
qa 32,196,236,52
lk 196,0,36864
pw 32,200,240
lk 200,1,36864
pw 32,204,244
lk 204,2,36864
pw 32,208,248
s_waitcnt lgkmcnt(3)
global_load_lds_dwordx4 v13, s[98:99] offset:3072 nt
lk 208,3,36864
pb 56,176,180
s_add_u32 m0, s21, 49152
ex 21
pb 56,180,184
s_add_u32 s98, s98, 16384
s_addc_u32 s99, s99, 0
cv 144,20,21
pb 88,188,184
ex 22
pb 88,184,180
ex 23
pa 64,192,180
cv 145,22,23
pa 64,196,184
ex 24
pa 96,204,184
ex 25
pa 96,200,180
ex 26
pa 128,208,180
lv 180,6,16384
cv 152,24,25
pa 128,212,184
ex 27
pa 132,212,192
lv 182,6,20480
cv 153,26,27
pa 132,208,188
ex 28
pa 100,200,188
lv 184,6,24576
pa 100,204,192
ex 29
pa 68,196,192
lv 186,6,28672
cv 160,28,29
pa 68,192,188
ex 30
pb 92,184,188
pb 92,188,192
ex 31
pb 60,180,192
lv 192,7,24576
cv 161,30,31
pb 60,176,188
ex 32
v_smfmac_f32_16x16x64_bf16 a[160:163], a[172:175], v[176:183], v14
s_waitcnt lgkmcnt(2)
lv 194,7,28672
qb 16,196,212,36
ex 33
qb 16,200,216,16
lv 188,7,16384
cv 168,32,33
qb 16,204,220,16
ex 34
qb 16,208,224,16
lv 190,7,20480
qb 20,208,240,40
ex 35
qb 20,204,236,20
cv 169,34,35
s_nop 0
qb 20,200,232,20
qb 20,196,228,20
ex 16
qb 24,196,244,44
qb 24,200,248,24
ex 17
qb 24,204,252,24
cv 138,16,17
pw 24,208,216
ex 18
qa 28,208,232,48
pw 28,204,228
ex 19
pw 28,200,224
cv 139,18,19
pw 28,196,220
ex 20
qa 32,196,236,52
lk 196,0,40960
pw 32,200,240
lk 200,1,40960
pw 32,204,244
lk 204,2,40960
pw 32,208,248
lk 208,3,40960
pb 64,176,180
s_waitcnt lgkmcnt(4)
ex 21
pb 64,180,184
ex 22
pb 96,188,184
ex 23
pb 96,184,180
cv 146,20,21
cv 147,22,23
pa 72,192,180

LwY1_3:
s_cbranch_vccnz LwY1_7
global_load_lds_dwordx4 v12, s[96:97] offset:0 nt
pa 72,196,184
ex 24
pa 104,204,184
ex 25
pa 104,200,180
ex 26
pa 136,208,180
lv 180,8,16384
cv 154,24,25
pa 136,212,184
ex 27
pa 140,212,192
lv 182,8,20480
cv 155,26,27
pa 140,208,188
ex 28
pa 108,200,188
lv 184,8,24576
pa 108,204,192
ex 29
pa 76,196,192
lv 186,8,28672
cv 162,28,29
pa 76,192,188
ex 30
pb 100,184,188
pb 100,188,192
ex 31
pb 68,180,192
lv 192,9,24576
cv 163,30,31
pb 68,176,188
global_load_lds_dwordx4 v13, s[96:97] offset:1024 nt
lv 194,9,28672
v_smfmac_f32_16x16x64_bf16 a[160:163], a[176:179], v[184:191], v14
s_waitcnt lgkmcnt(3)
lv 188,9,16384
qb 16,196,212,36
ex 32
qb 16,200,216,16
ex 33
qb 16,204,220,16
ex 34
qb 16,208,224,16
lv 190,9,20480
cv 170,32,33
qb 20,208,240,40
ex 35
qb 20,204,236,20
cv 171,34,35
s_nop 0
qb 20,200,232,20
qb 20,196,228,20
ex 16
qb 24,196,244,44
qb 24,200,248,24
ex 17
qb 24,204,252,24
cv 140,16,17
pw 24,208,216
ex 18
qa 28,208,232,48
pw 28,204,228
global_load_lds_dwordx4 v12, s[96:97] offset:2048 nt
pw 28,200,224
ex 19
pw 28,196,220
cv 141,18,19
qa 32,196,236,52
lk 196,0,45056
pw 32,200,240
lk 200,1,45056
pw 32,204,244
lk 204,2,45056
pw 32,208,248
lk 208,3,45056
pb 72,176,180
s_waitcnt lgkmcnt(4)
ex 20
pb 72,180,184
ex 21
pb 104,188,184
ex 22
pb 104,184,180
ex 23
pa 80,192,180
cv 148,20,21
cv 149,22,23
pa 80,196,184
ex 24
pa 112,204,184
ex 25
pa 112,200,180
ex 26
pa 144,208,180
global_load_lds_dwordx4 v13, s[96:97] offset:3072 nt
cv 156,24,25
pa 144,212,184
s_add_u32 m0, s21, 98304
ex 27
pa 148,212,192
s_add_u32 s96, s96, 16384
s_addc_u32 s97, s97, 0
lv 180,10,16384
pa 148,208,188
lv 182,10,20480
cv 157,26,27
pa 116,200,188
lv 184,10,24576
pa 116,204,192
lv 186,10,28672
pa 84,196,192
ex 28
pa 84,192,188
ex 29
pb 108,184,188
ex 30
pb 108,188,192
ex 31
pb 76,180,192
lv 192,11,24576
cv 164,28,29
pb 76,176,188
lv 194,11,28672
cv 165,30,31
v_smfmac_f32_16x16x64_bf16 a[164:167], a[172:175], v[192:199], v14
lv 188,11,16384
v_smfmac_f32_16x16x64_bf16 a[164:167], a[176:179], v[200:207], v14
s_waitcnt lgkmcnt(3)
lv 190,11,20480
qb 16,196,212,36
s_waitcnt vmcnt(12)
ds_write_b32 v254, v255 offset:0
qb 16,200,216,16
global_load_lds_dwordx4 v12, s[98:99] offset:0 nt
qb 16,204,220,16
ex 32
qb 16,208,224,16
ex 33
qb 20,208,240,40
ex 34
qb 20,204,236,20
ex 35
qb 20,200,232,20
cv 172,32,33
cv 173,34,35
qb 20,196,228,20
ex 16
qb 24,196,244,44
qb 24,200,248,24
ex 17
qb 24,204,252,24
cv 142,16,17
pw 24,208,216
ex 18
qa 28,208,232,48
pw 28,204,228
ex 19
pw 28,200,224
cv 143,18,19
pw 28,196,220
ex 20
qa 32,196,236,52
global_load_lds_dwordx4 v13, s[98:99] offset:1024 nt
pw 32,200,240
ex 21
pw 32,204,244
cv 150,20,21
pw 32,208,248
ex 22
pb 80,176,180
ds_read_b32 v255, v12 offset:1024
pb 80,180,184
ex 23
pb 112,188,184
cv 151,22,23
pb 112,184,180
ex 24
pa 88,192,180
pa 88,196,184
ex 25
pa 120,204,184
cv 158,24,25
pa 120,200,180
s_waitcnt lgkmcnt(0)
v_cmp_gt_u32 vcc, 25, v255
pa 152,208,180
ex 26
pa 152,212,184
s_cbranch_vccnz LsY25
LrY25:
lk 196,0,49152
v_mov_b32 v255, 26
pa 156,212,192
lk 200,1,49152
pa 156,208,188
lk 204,2,49152
global_load_lds_dwordx4 v12, s[98:99] offset:2048 nt
pa 124,200,188
lk 208,3,49152
pa 124,204,192
ex 27
pa 92,196,192
lv 180,4,32768
cv 159,26,27
pa 92,192,188
ex 28
pb 116,184,188
ex 29
pb 116,188,192
ex 30
pb 84,180,192
ex 31
pb 84,176,188
lv 182,4,36864
cv 166,28,29
v_smfmac_f32_16x16x64_bf16 a[168:171], a[172:175], v[208:215], v14
s_waitcnt lgkmcnt(2)
lv 184,4,40960
qb 16,196,212,36
lv 186,4,45056
cv 167,30,31
qb 16,200,216,16
ex 32
qb 16,204,220,16
ex 33
qb 16,208,224,16
ex 34
qb 20,208,240,40
ex 35
qb 20,204,236,20
global_load_lds_dwordx4 v13, s[98:99] offset:3072 nt
cv 174,32,33
qb 20,200,232,20
s_add_u32 m0, s21, 65536
lv 192,5,40960
cv 175,34,35
qb 20,196,228,20
s_add_u32 s98, s98, 16384
s_addc_u32 s99, s99, 0
lv 194,5,45056
qb 24,196,244,44
lv 188,5,32768
qb 24,200,248,24
lv 190,5,36864
qb 24,204,252,24
ex 16
pw 24,208,216
ex 17
qa 28,208,232,48
ex 18
pw 28,204,228
ex 19
pw 28,200,224
cv 176,16,17
cv 177,18,19
pw 28,196,220
ex 20
qa 32,196,236,52
lk 196,0,53248
pw 32,200,240
lk 200,1,53248
pw 32,204,244
lk 204,2,53248
pw 32,208,248
s_waitcnt lgkmcnt(3)
lk 208,3,53248
pb 56,136,180
ex 21
pb 56,140,184
ex 22
pb 88,148,184
ex 23
pb 88,144,180
cv 184,20,21
cv 185,22,23
pa 64,152,180
ex 24
pa 64,156,184
ex 25
pa 96,164,184
cv 192,24,25
pa 96,160,180
ex 26
pa 128,168,180
lv 180,6,32768
pa 128,172,184
ex 27
pa 132,172,192
lv 182,6,36864
cv 193,26,27
pa 132,168,188
ex 28
pa 100,160,188
lv 184,6,40960
pa 100,164,192
ex 29
pa 68,156,192
lv 186,6,45056
cv 200,28,29
pa 68,152,188
ex 30
pb 92,144,188
pb 92,148,192
ex 31
pb 60,140,192
lv 192,7,40960
cv 201,30,31
pb 60,136,188
ex 32
v_smfmac_f32_16x16x64_bf16 a[160:163], a[172:175], v[136:143], v14
s_waitcnt lgkmcnt(2)
lv 194,7,45056
qb 16,196,212,36
ex 33
qb 16,200,216,16
lv 188,7,32768
cv 208,32,33
qb 16,204,220,16
ex 34
qb 16,208,224,16
lv 190,7,36864
qb 20,208,240,40
ex 35
qb 20,204,236,20
cv 209,34,35
s_nop 0
qb 20,200,232,20
qb 20,196,228,20
ex 16
qb 24,196,244,44
qb 24,200,248,24
ex 17
qb 24,204,252,24
cv 178,16,17
pw 24,208,216
global_load_lds_dwordx4 v12, s[96:97] offset:0 nt
qa 28,208,232,48
ex 18
pw 28,204,228
ex 19
pw 28,200,224
cv 179,18,19
pw 28,196,220
ex 20
qa 32,196,236,52
lk 196,0,57344
pw 32,200,240
lk 200,1,57344
pw 32,204,244
lk 204,2,57344
pw 32,208,248
lk 208,3,57344
pb 64,136,180
s_waitcnt lgkmcnt(4)
ex 21
pb 64,140,184
ex 22
pb 96,148,184
ex 23
pb 96,144,180
cv 186,20,21
cv 187,22,23
pa 72,152,180
ex 24
pa 72,156,184
ex 25
pa 104,164,184
global_load_lds_dwordx4 v13, s[96:97] offset:1024 nt
cv 194,24,25
pa 104,160,180
ex 26
pa 136,168,180
lv 180,8,32768
pa 136,172,184
ex 27
pa 140,172,192
lv 182,8,36864
cv 195,26,27
pa 140,168,188
ex 28
pa 108,160,188
lv 184,8,40960
pa 108,164,192
ex 29
pa 76,156,192
lv 186,8,45056
cv 202,28,29
pa 76,152,188
ex 30
pb 100,144,188
pb 100,148,192
ex 31
pb 68,140,192
lv 192,9,40960
cv 203,30,31
pb 68,136,188
ex 32
v_smfmac_f32_16x16x64_bf16 a[160:163], a[176:179], v[144:151], v14
s_waitcnt lgkmcnt(2)
lv 194,9,45056
qb 16,196,212,36
global_load_lds_dwordx4 v12, s[96:97] offset:2048 nt
lv 188,9,32768
qb 16,200,216,16
ex 33
qb 16,204,220,16
ex 34
qb 16,208,224,16
lv 190,9,36864
cv 210,32,33
qb 20,208,240,40
ex 35
qb 20,204,236,20
cv 211,34,35
s_nop 0
qb 20,200,232,20
qb 20,196,228,20
ex 16
qb 24,196,244,44
qb 24,200,248,24
ex 17
qb 24,204,252,24
cv 180,16,17
pw 24,208,216
ex 18
qa 28,208,232,48
pw 28,204,228
ex 19
pw 28,200,224
cv 181,18,19
pw 28,196,220
global_load_lds_dwordx4 v13, s[96:97] offset:3072 nt
s_add_u32 m0, s21, 114688
qa 32,196,236,52
s_add_u32 s96, s96, 16384
s_addc_u32 s97, s97, 0
lk 196,0,61440
pw 32,200,240
lk 200,1,61440
pw 32,204,244
lk 204,2,61440
pw 32,208,248
lk 208,3,61440
pb 72,136,180
s_waitcnt lgkmcnt(4)
ex 20
pb 72,140,184
ex 21
pb 104,148,184
ex 22
pb 104,144,180
ex 23
pa 80,152,180
cv 188,20,21
cv 189,22,23
pa 80,156,184
ex 24
pa 112,164,184
ex 25
pa 112,160,180
ex 26
pa 144,168,180
lv 180,10,32768
cv 196,24,25
pa 144,172,184
ex 27
pa 148,172,192
global_load_lds_dwordx4 v12, s[98:99] offset:0 nt
cv 197,26,27
pa 148,168,188
lv 182,10,36864
pa 116,160,188
lv 184,10,40960
pa 116,164,192
lv 186,10,45056
pa 84,156,192
ex 28
pa 84,152,188
ex 29
pb 108,144,188
ex 30
pb 108,148,192
ex 31
pb 76,140,192
lv 192,11,40960
cv 204,28,29
pb 76,136,188
lv 194,11,45056
cv 205,30,31
v_smfmac_f32_16x16x64_bf16 a[164:167], a[172:175], v[152:159], v14
lv 188,11,32768
v_smfmac_f32_16x16x64_bf16 a[164:167], a[176:179], v[160:167], v14
s_waitcnt lgkmcnt(3)
lv 190,11,36864
qb 16,196,212,36
s_waitcnt vmcnt(13)
ds_write_b32 v254, v255 offset:0
qb 16,200,216,16
ex 32
qb 16,204,220,16
ex 33
qb 16,208,224,16
global_load_lds_dwordx4 v13, s[98:99] offset:1024 nt
cv 212,32,33
qb 20,208,240,40
ex 34
qb 20,204,236,20
ex 35
qb 20,200,232,20
cv 213,34,35
qb 20,196,228,20
ex 16
qb 24,196,244,44
qb 24,200,248,24
ex 17
qb 24,204,252,24
cv 182,16,17
pw 24,208,216
ex 18
qa 28,208,232,48
pw 28,204,228
ex 19
pw 28,200,224
cv 183,18,19
pw 28,196,220
ex 20
qa 32,196,236,52
pw 32,200,240
ex 21
pw 32,204,244
global_load_lds_dwordx4 v12, s[98:99] offset:2048 nt
cv 190,20,21
pw 32,208,248
ex 22
pb 80,136,180
ds_read_b32 v255, v12 offset:1024
pb 80,140,184
ex 23
pb 112,148,184
cv 191,22,23
pb 112,144,180
ex 24
pa 88,152,180
pa 88,156,184
ex 25
pa 120,164,184
cv 198,24,25
pa 120,160,180
s_waitcnt lgkmcnt(0)
v_cmp_gt_u32 vcc, 26, v255
pa 152,168,180
ex 26
pa 152,172,184
s_cbranch_vccnz LsY26
LrY26:
lk 196,0,0
v_mov_b32 v255, 27
pa 156,172,192
lk 200,1,0
pa 156,168,188
lk 204,2,0
pa 124,160,188
lk 208,3,0
pa 124,164,192
global_load_lds_dwordx4 v13, s[98:99] offset:3072 nt
lv 180,4,49152
pa 92,156,192
s_add_u32 m0, s21, 81920
ex 27
pa 92,152,188
s_add_u32 s98, s98, 16384
s_addc_u32 s99, s99, 0
lv 182,4,53248
pb 116,144,188
lv 184,4,57344
cv 199,26,27
pb 116,148,192
ex 28
pb 84,140,192
ex 29
pb 84,136,188
ex 30
v_smfmac_f32_16x16x64_bf16 a[168:171], a[172:175], v[168:175], v14
s_waitcnt lgkmcnt(3)
cv 206,28,29
qb 16,196,212,36
ex 31
qb 16,200,216,16
lv 186,4,61440
cv 207,30,31
qb 16,204,220,16

LwY1_4:
s_cbranch_vccnz LwrY1
ex 32
qb 16,208,224,16
ex 33
qb 20,208,240,40
ex 34
qb 20,204,236,20
ex 35
qb 20,200,232,20
lv 192,5,57344
cv 214,32,33
qb 20,196,228,20
lv 194,5,61440
cv 215,34,35
qb 24,196,244,44
lv 188,5,49152
qb 24,200,248,24
lv 190,5,53248
qb 24,204,252,24
ex 16
pw 24,208,216
ex 17
qa 28,208,232,48
ex 18
pw 28,204,228
ex 19
pw 28,200,224
cv 136,16,17
cv 137,18,19
pw 28,196,220
ex 20
qa 32,196,236,52
lk 196,0,4096
pw 32,200,240
lk 200,1,4096
pw 32,204,244
lk 204,2,4096
pw 32,208,248
s_waitcnt lgkmcnt(3)
lk 208,3,4096
pb 56,176,180
ex 21
pb 56,180,184
ex 22
pb 88,188,184
ex 23
pb 88,184,180
cv 144,20,21
cv 145,22,23
pa 64,192,180
ex 24
pa 64,196,184
ex 25
pa 96,204,184
cv 152,24,25
pa 96,200,180
ex 26
pa 128,208,180
lv 180,6,49152
pa 128,212,184
ex 27
pa 132,212,192
lv 182,6,53248
cv 153,26,27
pa 132,208,188
ex 28
pa 100,200,188
lv 184,6,57344
pa 100,204,192
ex 29
pa 68,196,192
lv 186,6,61440
cv 160,28,29
pa 68,192,188
ex 30
pb 92,184,188
pb 92,188,192
ex 31
pb 60,180,192
global_load_lds_dwordx4 v12, s[96:97] offset:0 nt
cv 161,30,31
pb 60,176,188
ex 32
v_smfmac_f32_16x16x64_bf16 a[160:163], a[172:175], v[176:183], v14
s_waitcnt lgkmcnt(1)
lv 192,7,57344
qb 16,196,212,36
ex 33
qb 16,200,216,16
lv 194,7,61440
cv 168,32,33
qb 16,204,220,16
ex 34
qb 16,208,224,16
lv 188,7,49152
qb 20,208,240,40
ex 35
qb 20,204,236,20
lv 190,7,53248
cv 169,34,35
qb 20,200,232,20
qb 20,196,228,20
ex 16
qb 24,196,244,44
qb 24,200,248,24
ex 17
qb 24,204,252,24
cv 138,16,17
pw 24,208,216
ex 18
qa 28,208,232,48
global_load_lds_dwordx4 v13, s[96:97] offset:1024 nt
pw 28,204,228
ex 19
pw 28,200,224
cv 139,18,19
pw 28,196,220
ex 20
qa 32,196,236,52
lk 196,0,8192
pw 32,200,240
lk 200,1,8192
pw 32,204,244
lk 204,2,8192
pw 32,208,248
lk 208,3,8192
pb 64,176,180
s_waitcnt lgkmcnt(4)
ex 21
pb 64,180,184
ex 22
pb 96,188,184
ex 23
pb 96,184,180
cv 146,20,21
cv 147,22,23
pa 72,192,180
ex 24
pa 72,196,184
ex 25
pa 104,204,184
cv 154,24,25
pa 104,200,180
global_load_lds_dwordx4 v12, s[96:97] offset:2048 nt
pa 136,208,180
ex 26
pa 136,212,184
ex 27
pa 140,212,192
lv 180,8,49152
cv 155,26,27
pa 140,208,188
ex 28
pa 108,200,188
lv 182,8,53248
pa 108,204,192
ex 29
pa 76,196,192
lv 184,8,57344
cv 162,28,29
pa 76,192,188
ex 30
pb 100,184,188
lv 186,8,61440
pb 100,188,192
ex 31
pb 68,180,192
lv 192,9,57344
cv 163,30,31
pb 68,176,188
ex 32
v_smfmac_f32_16x16x64_bf16 a[160:163], a[176:179], v[184:191], v14
s_waitcnt lgkmcnt(3)
lv 194,9,61440
qb 16,196,212,36
ex 33
qb 16,200,216,16
global_load_lds_dwordx4 v13, s[96:97] offset:3072 nt
cv 170,32,33
qb 16,204,220,16
s_add_u32 m0, s21, 131072
ex 34
qb 16,208,224,16
lv 188,9,49152
qb 20,208,240,40
ex 35
qb 20,204,236,20
lv 190,9,53248
cv 171,34,35
qb 20,200,232,20
qb 20,196,228,20
ex 16
qb 24,196,244,44
qb 24,200,248,24
ex 17
qb 24,204,252,24
cv 140,16,17
pw 24,208,216
ex 18
qa 28,208,232,48
pw 28,204,228
ex 19
pw 28,200,224
cv 141,18,19
pw 28,196,220
ex 20
qa 32,196,236,52
global_load_lds_dwordx4 v12, s[98:99] offset:0 nt
lk 196,0,12288
pw 32,200,240
lk 200,1,12288
pw 32,204,244
lk 204,2,12288
pw 32,208,248
lk 208,3,12288
pb 72,176,180
s_waitcnt lgkmcnt(4)
ex 21
pb 72,180,184
ex 22
pb 104,188,184
ex 23
pb 104,184,180
cv 148,20,21
cv 149,22,23
pa 80,192,180
ex 24
pa 80,196,184
ex 25
pa 112,204,184
cv 156,24,25
pa 112,200,180
ex 26
pa 144,208,180
lv 180,10,49152
pa 144,212,184
ex 27
pa 148,212,192
lv 182,10,53248
cv 157,26,27
pa 148,208,188
global_load_lds_dwordx4 v13, s[98:99] offset:1024 nt
lv 184,10,57344
pa 116,200,188
lv 186,10,61440
pa 116,204,192
ex 28
pa 84,196,192
ex 29
pa 84,192,188
ex 30
pb 108,184,188
cv 164,28,29
pb 108,188,192
ex 31
pb 76,180,192
lv 192,11,57344
cv 165,30,31
pb 76,176,188
lv 194,11,61440
v_smfmac_f32_16x16x64_bf16 a[164:167], a[172:175], v[192:199], v14
lv 188,11,49152
v_smfmac_f32_16x16x64_bf16 a[164:167], a[176:179], v[200:207], v14
s_waitcnt lgkmcnt(3)
lv 190,11,53248
qb 16,196,212,36
s_waitcnt vmcnt(14)
ds_write_b32 v254, v255 offset:0
qb 16,200,216,16
ex 32
qb 16,204,220,16
ex 33
qb 16,208,224,16
ex 34
qb 20,208,240,40
global_load_lds_dwordx4 v12, s[98:99] offset:2048 nt
cv 172,32,33
qb 20,204,236,20
ex 35
qb 20,200,232,20
cv 173,34,35
qb 20,196,228,20
ex 16
qb 24,196,244,44
qb 24,200,248,24
ex 17
qb 24,204,252,24
cv 142,16,17
pw 24,208,216
ex 18
qa 28,208,232,48
pw 28,204,228
ex 19
pw 28,200,224
cv 143,18,19
pw 28,196,220
ex 20
qa 32,196,236,52
pw 32,200,240
ex 21
pw 32,204,244
cv 150,20,21
pw 32,208,248
global_load_lds_dwordx4 v13, s[98:99] offset:3072 nt
s_add_u32 m0, s21, 147456
pb 80,176,180
s_add_u32 s98, s98, 16384
s_addc_u32 s99, s99, 0
ds_read_b32 v255, v12 offset:1024
pb 80,180,184
ex 22
pb 112,188,184
ex 23
pb 112,184,180
cv 151,22,23
pa 88,192,180
ex 24
pa 88,196,184
ex 25
pa 120,204,184
cv 158,24,25
pa 120,200,180
ex 26
pa 152,208,180
s_waitcnt lgkmcnt(0)
v_cmp_gt_u32 vcc, 27, v255
pa 152,212,184
s_cbranch_vccnz LsY27
LrY27:
lk 196,0,16384
v_mov_b32 v255, 28
pa 156,212,192
lk 200,1,16384
pa 156,208,188
lk 204,2,16384
pa 124,200,188
lk 208,3,16384
pa 124,204,192
ex 27
pa 92,196,192
lv 180,4,0
cv 159,26,27
pa 92,192,188
ex 28
pb 116,184,188
ex 29
pb 116,188,192
ex 30
pb 84,180,192
ex 31
pb 84,176,188
lv 182,4,4096
cv 166,28,29
v_smfmac_f32_16x16x64_bf16 a[168:171], a[172:175], v[208:215], v14
s_waitcnt lgkmcnt(2)
lv 184,4,8192
qb 16,196,212,36
s_add_u32 s39, s21, 98304
lv 186,4,12288
cv 167,30,31
qb 16,200,216,16
s_add_u32 s36, s21, 32768
ex 32
qb 16,204,220,16
ex 33
qb 16,208,224,16
ex 34
qb 20,208,240,40
ex 35
qb 20,204,236,20
lv 192,5,8192
cv 174,32,33
qb 20,200,232,20
lv 194,5,12288
cv 175,34,35
qb 20,196,228,20
lv 188,5,0
v_mbcnt_lo_u32_b32 v126, -1, 0
qb 24,196,244,44
lv 190,5,4096
v_mbcnt_hi_u32_b32 v126, -1, v126
qb 24,200,248,24
ex 16
qb 24,204,252,24
ex 17
pw 24,208,216
ex 18
qa 28,208,232,48
cv 176,16,17
v_and_b32 v127, 15, v126
pw 28,204,228
ex 19
pw 28,200,224
cv 177,18,19
v_lshl_add_u32 v123, v127, 2, s36
pw 28,196,220
ex 20
qa 32,196,236,52
lk 196,0,20480
v_lshl_add_u32 v120, v127, 3, s39
pw 32,200,240
lk 200,1,20480
v_lshrrev_b32 v127, 4, v126
pw 32,204,244
lk 204,2,20480
v_lshl_add_u32 v120, v127, 9, v120
pw 32,208,248
s_waitcnt lgkmcnt(3)
lk 208,3,20480
v_lshl_add_u32 v124, v127, 4, s36
pb 56,136,180
s_add_u32 s36, s26, 12288
ex 21
pb 56,140,184
ex 22
pb 88,148,184
ex 23
pb 88,144,180
cv 184,20,21
cv 185,22,23
pa 64,152,180
ex 24
pa 64,156,184
global_load_lds_dwordx4 v12, s[98:99] offset:0 nt
v_lshl_add_u32 v121, v127, 8, s39
pa 96,164,184
s_mov_b32 s39, s27
ex 25
pa 96,160,180
ex 26
pa 128,168,180
lv 180,6,0
cv 192,24,25
pa 128,172,184
ex 27
pa 132,172,192
lv 182,6,4096
cv 193,26,27
pa 132,168,188
ex 28
pa 100,160,188
lv 184,6,8192
v_and_b32 v127, 3, v126
pa 100,164,192
ex 29
pa 68,156,192
lv 186,6,12288
cv 200,28,29
pa 68,152,188
ex 30
pb 92,144,188
v_lshl_add_u32 v121, v127, 6, v121
v_and_b32 v127, 12, v126
pb 92,148,192
ex 31
pb 60,140,192
lv 192,7,8192
cv 201,30,31
pb 60,136,188
ex 32
v_smfmac_f32_16x16x64_bf16 a[160:163], a[172:175], v[136:143], v14
s_waitcnt lgkmcnt(2)
global_load_lds_dwordx4 v13, s[98:99] offset:1024 nt
qb 16,196,212,36
ex 33
qb 16,200,216,16
lv 194,7,12288
cv 208,32,33
qb 16,204,220,16
ex 34
qb 16,208,224,16
lv 188,7,0
v_lshl_add_u32 v121, v127, 1, v121
qb 20,208,240,40
ex 35
qb 20,204,236,20
lv 190,7,4096
cv 209,34,35
qb 20,200,232,20
v_and_b32 v127, 7, v126
v_lshlrev_b32 v127, 4, v127
qb 20,196,228,20
ex 16
qb 24,196,244,44
v_lshrrev_b32 v126, 3, v126
v_lshl_add_u32 v122, v126, 8, v127
qb 24,200,248,24
ex 17
qb 24,204,252,24
cv 178,16,17
pw 24,208,216
ex 18
qa 28,208,232,48
pw 28,204,228
ex 19
pw 28,200,224
global_load_lds_dwordx4 v12, s[98:99] offset:2048 nt
cv 179,18,19
pw 28,196,220
ex 20
qa 32,196,236,52
lk 196,0,24576
pw 32,200,240
lk 200,1,24576
pw 32,204,244
lk 204,2,24576
pw 32,208,248
lk 208,3,24576
pb 64,136,180
s_waitcnt lgkmcnt(4)
ex 21
pb 64,140,184
ex 22
pb 96,148,184
ex 23
pb 96,144,180
cv 186,20,21
cv 187,22,23
pa 72,152,180
ex 24
pa 72,156,184
ex 25
pa 104,164,184
cv 194,24,25
pa 104,160,180
ex 26
pa 136,168,180
lv 180,8,0
pa 136,172,184
global_load_lds_dwordx4 v13, s[98:99] offset:3072 nt
lv 182,8,4096
pa 140,172,192
ex 27
pa 140,168,188
lv 184,8,8192
cv 195,26,27
pa 108,160,188
ex 28
pa 108,164,192
ex 29
pa 76,156,192
lv 186,8,12288
cv 202,28,29
pa 76,152,188
ex 30
pb 100,144,188
pb 100,148,192
ex 31
pb 68,140,192
lv 192,9,8192
cv 203,30,31
pb 68,136,188
ex 32
v_smfmac_f32_16x16x64_bf16 a[160:163], a[176:179], v[144:151], v14
s_waitcnt lgkmcnt(2)
lv 194,9,12288
qb 16,196,212,36
ex 33
qb 16,200,216,16
lv 188,9,0
cv 210,32,33
qb 16,204,220,16
ex 34
qb 16,208,224,16
lv 190,9,4096
qb 20,208,240,40
ex 35
qb 20,204,236,20
cv 211,34,35
s_nop 0
qb 20,200,232,20
qb 20,196,228,20
ex 16
qb 24,196,244,44
qb 24,200,248,24
ex 17
qb 24,204,252,24
cv 180,16,17
pw 24,208,216
ex 18
qa 28,208,232,48
pw 28,204,228
ex 19
pw 28,200,224
cv 181,18,19
pw 28,196,220
ex 20
qa 32,196,236,52
lk 196,0,28672
pw 32,200,240

LwY1_5:
s_cbranch_vccnz LwrY1
lk 200,1,28672
pw 32,204,244
lk 204,2,28672
pw 32,208,248
lk 208,3,28672
pb 72,136,180
s_waitcnt lgkmcnt(4)
ex 21
pb 72,140,184
ex 22
pb 104,148,184
ex 23
pb 104,144,180
cv 188,20,21
cv 189,22,23
pa 80,152,180
ex 24
pa 80,156,184
ex 25
pa 112,164,184
cv 196,24,25
pa 112,160,180
ex 26
pa 144,168,180
lv 180,10,0
pa 144,172,184
ex 27
pa 148,172,192
lv 182,10,4096
cv 197,26,27
pa 148,168,188
lv 184,10,8192
pa 116,160,188
lv 186,10,12288
pa 116,164,192
ex 28
pa 84,156,192
ex 29
pa 84,152,188
ex 30
pb 108,144,188
cv 204,28,29
pb 108,148,192
ex 31
pb 76,140,192
lv 192,11,8192
cv 205,30,31
pb 76,136,188
lv 194,11,12288
v_smfmac_f32_16x16x64_bf16 a[164:167], a[172:175], v[152:159], v14
lv 188,11,0
v_smfmac_f32_16x16x64_bf16 a[164:167], a[176:179], v[160:167], v14
s_waitcnt lgkmcnt(3)
lv 190,11,4096
qb 16,196,212,36
s_waitcnt vmcnt(12)
ds_write_b32 v254, v255 offset:0
qb 16,200,216,16
ex 32
qb 16,204,220,16
ex 33
qb 16,208,224,16
ex 34
qb 20,208,240,40
ex 35
qb 20,204,236,20
cv 212,32,33
cv 213,34,35
qb 20,200,232,20
qb 20,196,228,20
ex 16
qb 24,196,244,44
qb 24,200,248,24
ex 17
qb 24,204,252,24
cv 182,16,17
pw 24,208,216
ex 18
qa 28,208,232,48
pw 28,204,228
ex 19
pw 28,200,224
cv 183,18,19
pw 28,196,220
ex 20
qa 32,196,236,52
pw 32,200,240
ex 21
pw 32,204,244
cv 190,20,21
pw 32,208,248
ex 22
pb 80,136,180
ds_read_b32 v255, v12 offset:1024
pb 80,140,184
ex 23
pb 112,148,184
cv 191,22,23
pb 112,144,180
ex 24
pa 88,152,180
pa 88,156,184
ex 25
pa 120,164,184
cv 198,24,25
pa 120,160,180
s_waitcnt lgkmcnt(0)
v_cmp_gt_u32 vcc, 28, v255
pa 152,168,180
ex 26
pa 152,172,184
s_cbranch_vccnz LsY28
LrY28:
lk 196,0,32768
v_mov_b32 v255, 29
pa 156,172,192
lk 200,1,32768
pa 156,168,188
lk 204,2,32768
pa 124,160,188
lk 208,3,32768
pa 124,164,192
ex 27
pa 92,156,192
lv 180,4,16384
cv 199,26,27
pa 92,152,188
ex 28
pb 116,144,188
ex 29
pb 116,148,192
ex 30
pb 84,140,192
ex 31
pb 84,136,188
lv 182,4,20480
cv 206,28,29
v_smfmac_f32_16x16x64_bf16 a[168:171], a[172:175], v[168:175], v14
s_waitcnt lgkmcnt(2)
lv 184,4,24576
qb 16,196,212,36
lv 186,4,28672
cv 207,30,31
qb 16,200,216,16
ex 32
qb 16,204,220,16
ex 33
qb 16,208,224,16
ex 34
qb 20,208,240,40
ex 35
qb 20,204,236,20
lv 192,5,24576
cv 214,32,33
qb 20,200,232,20
lv 194,5,28672
cv 215,34,35
qb 20,196,228,20
lv 188,5,16384
qb 24,196,244,44
lv 190,5,20480
qb 24,200,248,24
ex 16
qb 24,204,252,24
ex 17
pw 24,208,216
ex 18
qa 28,208,232,48
cv 136,16,17
pw 28,204,228
ex 19
pw 28,200,224
cv 137,18,19
pw 28,196,220
ex 20
qa 32,196,236,52
lk 196,0,36864
pw 32,200,240
lk 200,1,36864
pw 32,204,244
lk 204,2,36864
pw 32,208,248
s_waitcnt lgkmcnt(3)
lk 208,3,36864
pb 56,176,180
ex 21
pb 56,180,184
ex 22
pb 88,188,184
ex 23
pb 88,184,180
cv 144,20,21
cv 145,22,23
pa 64,192,180
ex 24
pa 64,196,184
ex 25
pa 96,204,184
cv 152,24,25
pa 96,200,180
ex 26
pa 128,208,180
lv 180,6,16384
pa 128,212,184
ex 27
pa 132,212,192
lv 182,6,20480
cv 153,26,27
pa 132,208,188
ex 28
pa 100,200,188
lv 184,6,24576
pa 100,204,192
ex 29
pa 68,196,192
lv 186,6,28672
cv 160,28,29
pa 68,192,188
ex 30
pb 92,184,188
pb 92,188,192
ex 31
pb 60,180,192
lv 192,7,24576
cv 161,30,31
pb 60,176,188
ex 32
v_smfmac_f32_16x16x64_bf16 a[160:163], a[172:175], v[176:183], v14
s_waitcnt lgkmcnt(2)
lv 194,7,28672
qb 16,196,212,36
ex 33
qb 16,200,216,16
lv 188,7,16384
cv 168,32,33
qb 16,204,220,16
ex 34
qb 16,208,224,16
lv 190,7,20480
qb 20,208,240,40
ex 35
qb 20,204,236,20
cv 169,34,35
s_nop 0
qb 20,200,232,20
qb 20,196,228,20
ex 16
qb 24,196,244,44
qb 24,200,248,24
ex 17
qb 24,204,252,24
cv 138,16,17
pw 24,208,216
ex 18
qa 28,208,232,48
pw 28,204,228
ex 19
pw 28,200,224
cv 139,18,19
pw 28,196,220
ex 20
qa 32,196,236,52
lk 196,0,40960
pw 32,200,240
lk 200,1,40960
pw 32,204,244
lk 204,2,40960
pw 32,208,248
lk 208,3,40960
pb 64,176,180
s_waitcnt lgkmcnt(4)
ex 21
pb 64,180,184
ex 22
pb 96,188,184
ex 23
pb 96,184,180
cv 146,20,21
cv 147,22,23
pa 72,192,180
ex 24
pa 72,196,184
ex 25
pa 104,204,184
cv 154,24,25
pa 104,200,180
ex 26
pa 136,208,180
lv 180,8,16384
pa 136,212,184
ex 27
pa 140,212,192
lv 182,8,20480
cv 155,26,27
pa 140,208,188
ex 28
pa 108,200,188
lv 184,8,24576
pa 108,204,192
ex 29
pa 76,196,192
lv 186,8,28672
cv 162,28,29
pa 76,192,188
ex 30
pb 100,184,188
pb 100,188,192
ex 31
pb 68,180,192
lv 192,9,24576
cv 163,30,31
pb 68,176,188
ex 32
v_smfmac_f32_16x16x64_bf16 a[160:163], a[176:179], v[184:191], v14
s_waitcnt lgkmcnt(2)
lv 194,9,28672
qb 16,196,212,36
ex 33
qb 16,200,216,16
lv 188,9,16384
cv 170,32,33
qb 16,204,220,16
ex 34
qb 16,208,224,16
lv 190,9,20480
qb 20,208,240,40
ex 35
qb 20,204,236,20
cv 171,34,35
s_nop 0
qb 20,200,232,20
qb 20,196,228,20
ex 16
qb 24,196,244,44
qb 24,200,248,24
ex 17
qb 24,204,252,24
cv 140,16,17
pw 24,208,216
ex 18
qa 28,208,232,48
pw 28,204,228
ex 19
pw 28,200,224
cv 141,18,19
pw 28,196,220
ex 20
qa 32,196,236,52
lk 196,0,45056
pw 32,200,240
lk 200,1,45056
pw 32,204,244
lk 204,2,45056
pw 32,208,248
lk 208,3,45056
pb 72,176,180
s_waitcnt lgkmcnt(4)
ex 21
pb 72,180,184
ex 22
pb 104,188,184
ex 23
pb 104,184,180
cv 148,20,21
cv 149,22,23
pa 80,192,180
ex 24
pa 80,196,184
ex 25
pa 112,204,184
cv 156,24,25
pa 112,200,180
ex 26
pa 144,208,180
lv 180,10,16384
pa 144,212,184
ex 27
pa 148,212,192
lv 182,10,20480
cv 157,26,27
pa 148,208,188
lv 184,10,24576
pa 116,200,188
lv 186,10,28672
pa 116,204,192
ex 28
pa 84,196,192
ex 29
pa 84,192,188
ex 30
pb 108,184,188
cv 164,28,29
pb 108,188,192
ex 31
pb 76,180,192
lv 192,11,24576
cv 165,30,31
pb 76,176,188
lv 194,11,28672
v_smfmac_f32_16x16x64_bf16 a[164:167], a[172:175], v[192:199], v14
lv 188,11,16384
v_smfmac_f32_16x16x64_bf16 a[164:167], a[176:179], v[200:207], v14
s_waitcnt lgkmcnt(3)
lv 190,11,20480
qb 16,196,212,36
s_waitcnt vmcnt(0)
ds_write_b32 v254, v255 offset:0
qb 16,200,216,16
ex 32
qb 16,204,220,16
ex 33
qb 16,208,224,16
ex 34
qb 20,208,240,40
ex 35
qb 20,204,236,20
cv 172,32,33
cv 173,34,35
qb 20,200,232,20
qb 20,196,228,20
ex 16
qb 24,196,244,44
qb 24,200,248,24
ex 17
qb 24,204,252,24
cv 142,16,17
pw 24,208,216
ex 18
qa 28,208,232,48
pw 28,204,228
ex 19
pw 28,200,224
cv 143,18,19
pw 28,196,220
ex 20
qa 32,196,236,52
pw 32,200,240
ex 21
pw 32,204,244
cv 150,20,21
pw 32,208,248
ex 22
pb 80,176,180
ds_read_b32 v255, v12 offset:1024
pb 80,180,184
ex 23
pb 112,188,184
cv 151,22,23
pb 112,184,180
ex 24
pa 88,192,180
pa 88,196,184
ex 25
pa 120,204,184
cv 158,24,25
pa 120,200,180
s_waitcnt lgkmcnt(0)
v_cmp_gt_u32 vcc, 29, v255
pa 152,208,180
ex 26
pa 152,212,184
s_cbranch_vccnz LsY29
LrY29:
lk 196,0,49152
pa 156,212,192
lk 200,1,49152
pa 156,208,188
lk 204,2,49152
pa 124,200,188
lk 208,3,49152
pa 124,204,192
lv 180,4,32768
pa 92,196,192
lv 182,4,36864
pa 92,192,188
lv 184,4,40960
pb 116,184,188
lv 186,4,45056
pb 116,188,192
ex 27
pb 84,180,192
lv 192,5,40960
cv 159,26,27
pb 84,176,188
lv 194,5,45056
v_smfmac_f32_16x16x64_bf16 a[168:171], a[172:175], v[208:215], v14
s_waitcnt lgkmcnt(6)
lv 188,5,32768
qa 20,196,236,52
lv 190,5,36864
pw 20,200,240
ex 28
pw 20,204,244
ex 29
pw 20,208,248
s_waitcnt lgkmcnt(4)
ex 30
pb 56,136,180
ex 31
pb 56,140,184
ds_read_b128 v[176:179], v0 offset:53248
cv 166,28,29
pb 88,148,184
ds_read_b128 v[180:183], v1 offset:53248
cv 167,30,31
pb 88,144,180
ex 32
pa 64,152,180
ex 33
pa 64,156,184
ex 34
pa 96,164,184
ex 35
pa 96,160,180
ds_read_b128 v[184:187], v2 offset:53248
cv 174,32,33
pa 128,168,180
ds_read_b128 v[188:191], v3 offset:53248
cv 175,34,35
ds_read_b128 v[192:195], v0 offset:57344
ds_read_b128 v[196:199], v1 offset:57344
pa 128,172,184
s_waitcnt lgkmcnt(4)
ds_read_b128 v[200:203], v2 offset:57344
pa 132,172,192
ds_read_b128 v[204:207], v3 offset:57344
pa 132,168,188
lk 48,0,61440
pa 100,160,188
lk 52,1,61440
pa 100,164,192
lk 56,2,61440
pa 68,156,192
lk 60,3,61440
pa 68,152,188
lv 180,6,32768
pb 92,144,188
lv 182,6,36864
pb 92,148,192
lv 184,6,40960
pb 60,140,192
lv 186,6,45056
pb 60,136,188
lv 192,7,40960
v_mfma_f32_16x16x32_bf16 v[24:27], v[176:179], v[236:239], v[52:55]
s_waitcnt lgkmcnt(7)
lv 194,7,45056
v_mfma_f32_16x16x32_bf16 v[24:27], v[180:183], v[240:243], v[24:27]
lv 188,7,32768
v_mfma_f32_16x16x32_bf16 v[24:27], v[184:187], v[244:247], v[24:27]
lv 190,7,36864
v_mfma_f32_16x16x32_bf16 v[24:27], v[188:191], v[248:251], v[24:27]
lv 0,4,49152
v_mfma_f32_16x16x32_bf16 v[28:31], v[192:195], v[236:239], v[52:55]
lv 2,4,53248
v_mfma_f32_16x16x32_bf16 v[28:31], v[196:199], v[240:243], v[28:31]
ex 20
v_mfma_f32_16x16x32_bf16 v[28:31], v[200:203], v[244:247], v[28:31]
ex 21
v_mfma_f32_16x16x32_bf16 v[28:31], v[204:207], v[248:251], v[28:31]
ex 22
qa 32,48,236,52
ex 23
pw 32,52,240
s_waitcnt lgkmcnt(3)
lv 4,4,57344
cv 208,20,21
pw 32,56,244
lv 6,4,61440
cv 209,22,23
pw 32,60,248
ex 24
pb 64,136,180
ex 25
pb 64,140,184
ex 26
pb 96,148,184
ex 27
pb 96,144,180
ex 28
pa 72,152,180
ex 29
pa 72,156,184
ex 30
pa 104,164,184
ex 31
pa 104,160,180
ex 32
pa 136,168,180

LwY1_6:
s_cbranch_vccnz LwrY1
ex 33
pa 136,172,184
ex 34
pa 140,172,192
s_waitcnt lgkmcnt(0)
ex 35
pa 140,168,188
lv 12,5,57344
cv 210,24,25
pa 108,160,188
lv 14,5,61440
cv 211,26,27
pa 108,164,192
lv 8,5,49152
cv 212,28,29
pa 76,156,192
lv 10,5,53248
cv 213,30,31
pa 76,152,188
lv 16,6,49152
cv 214,32,33
pb 100,144,188
lv 18,6,53248
cv 215,34,35
pb 100,148,192
lv 20,6,57344
pb 68,140,192
lv 22,6,61440
pb 68,136,188
lv 28,7,57344
v_smfmac_f32_16x16x64_bf16 a[168:171], a[172:175], v[168:175], v14
lv 30,7,61440
v_smfmac_f32_16x16x64_bf16 a[168:171], a[172:175], v[208:215], v14
lv 24,7,49152
qa 16,208,232,48
lv 26,7,53248
s_nop 0
pw 16,204,228
lv 180,8,32768
s_nop 0
pw 16,200,224
lv 182,8,36864
v_accvgpr_read_b32 v126, a168
pw 16,196,220
lv 184,8,40960
v_accvgpr_read_b32 v127, a169
v_add_f32 v126, v126, v127
pa 128,208,0
s_waitcnt lgkmcnt(7)
lv 186,8,45056
v_cmp_nge_f32 s[42:43], s29, v126
v_rcp_f32 v126, v126
pa 128,212,4
s_or_b64 s[32:33], s[32:33], s[42:43]
lv 192,9,40960
v_mul_f32_e64 v127, -s41, v126
pa 132,212,12
ds_write2_b32 v123, v126, v127 offset0:128 offset1:144
pa 132,208,8
ds_read_b128 v[128:131], v124 offset:512
v_mfma_f32_16x16x32_bf16 v[20:23], v[188:191], v[232:235], v[48:51]
ds_read_b128 v[132:135], v124 offset:576
v_accvgpr_read_b32 v244, a128
v_mfma_f32_16x16x32_bf16 v[20:23], v[184:187], v[228:231], v[20:23]
lv 194,9,45056
v_accvgpr_read_b32 v245, a129
v_mfma_f32_16x16x32_bf16 v[20:23], v[180:183], v[224:227], v[20:23]
lv 188,9,32768
v_accvgpr_read_b32 v246, a132
v_mfma_f32_16x16x32_bf16 v[20:23], v[176:179], v[220:223], v[20:23]
lv 190,9,36864
v_accvgpr_read_b32 v247, a133
pa 136,208,16
ex 16
pa 136,212,20
s_waitcnt lgkmcnt(6)
ex 17
pa 140,212,28
ex 18
pa 140,208,24
s_waitcnt lgkmcnt(3)
lv 32,8,49152
v_fma_f32 v244, v244, v128, v132
v_fma_f32 v245, v245, v129, v133
v_fma_f32 v246, v246, v128, v132
v_fma_f32 v247, v247, v129, v133
v_accvgpr_read_b32 v248, a136
v_accvgpr_read_b32 v249, a137
cv 244,244,246
v_accvgpr_read_b32 v250, a140
v_accvgpr_read_b32 v251, a141
v_mfma_f32_16x16x32_bf16 v[24:27], v[204:207], v[232:235], v[48:51]
lv 34,8,53248
cv 246,245,247
v_fma_f32 v248, v248, v128, v132
v_fma_f32 v249, v249, v129, v133
v_fma_f32 v250, v250, v128, v132
v_fma_f32 v251, v251, v129, v133
cv 245,248,250
cv 247,249,251
v_mfma_f32_16x16x32_bf16 v[24:27], v[200:203], v[228:231], v[24:27]
ds_write_b64 v120, v[244:245] offset:0
v_mfma_f32_16x16x32_bf16 v[24:27], v[196:199], v[224:227], v[24:27]
ds_write_b64 v120, v[246:247] offset:128
v_accvgpr_read_b32 v244, a130
v_accvgpr_read_b32 v245, a131
v_accvgpr_read_b32 v246, a134
v_accvgpr_read_b32 v247, a135
v_mfma_f32_16x16x32_bf16 v[24:27], v[192:195], v[220:223], v[24:27]
lv 36,8,57344
v_accvgpr_read_b32 v248, a138
v_accvgpr_read_b32 v249, a139
v_accvgpr_read_b32 v250, a142
v_accvgpr_read_b32 v251, a143
v_pk_fma_f32 v[244:245], v[244:245], v[130:131], v[134:135]
v_pk_fma_f32 v[246:247], v[246:247], v[130:131], v[134:135]
cv 244,244,246
v_pk_fma_f32 v[248:249], v[248:249], v[130:131], v[134:135]
v_pk_fma_f32 v[250:251], v[250:251], v[130:131], v[134:135]
cv 246,245,247
cv 245,248,250
qa 28,60,232,48
ds_write_b64 v120, v[244:245] offset:256
cv 247,249,251
pw 28,56,228
ds_write_b64 v120, v[246:247] offset:384
pw 28,52,224
ds_read_b64_tr_b16 v[52:53], v121 offset:0
cv 236,16,17
pw 28,48,220
ds_read_b64_tr_b16 v[54:55], v121 offset:32
pb 72,136,180
ds_read_b64_tr_b16 v[244:245], v121 offset:1024
pb 72,140,184
ds_read_b64_tr_b16 v[246:247], v121 offset:1056
pb 104,148,184
ex 19
pb 104,144,180
ex 20
pa 80,152,180
ex 21
pa 80,156,184
ex 22
pa 112,164,184
s_waitcnt lgkmcnt(2)
buffer_store_dwordx4 v[52:55], v122, s[16:19], s37 offen offset:0 sc0 sc1
ex 23
ex 24
pa 112,160,180
ex 25
pa 144,168,180
ex 26
pa 144,172,184
ex 27
pa 148,172,192
s_waitcnt lgkmcnt(0)
buffer_store_dwordx4 v[244:247], v122, s[16:19], s37 offen offset:2048 sc0 sc1
ex 28
ex 29
pa 148,168,188
s_add_u32 s37, s26, 8192
ex 30
pa 116,160,188
ex 31
pa 116,164,192
lv 180,10,32768
cv 237,18,19
pa 84,156,192
lv 182,10,36864
cv 238,20,21
pa 84,152,188
lv 184,10,40960
cv 239,22,23
pb 108,144,188
lv 186,10,45056
cv 240,24,25
pb 108,148,192
lv 38,8,61440
cv 241,26,27
pb 76,140,192
lv 192,11,40960
cv 242,28,29
pb 76,136,188
lv 194,11,45056
cv 243,30,31
v_smfmac_f32_16x16x64_bf16 a[164:167], a[176:179], v[160:167], v14
lv 188,11,32768
v_smfmac_f32_16x16x64_bf16 a[164:167], a[176:179], v[236:243], v14
lv 190,11,36864
pa 96,236,0
lv 44,9,57344
s_nop 0
pa 96,240,4
lv 46,9,61440
s_nop 0
pa 100,240,12
lv 40,9,49152
v_accvgpr_read_b32 v126, a166
v_accvgpr_read_b32 v127, a167
v_add_f32 v126, v126, v127
v_cmp_nge_f32 s[42:43], s29, v126
v_rcp_f32 v126, v126
pa 100,236,8
s_or_b64 s[32:33], s[32:33], s[42:43]
lv 42,9,53248
v_mul_f32_e64 v127, -s41, v126
pa 104,236,16
ds_write2_b32 v123, v126, v127 offset0:96 offset1:112
pa 104,240,20
ds_read_b128 v[128:131], v124 offset:384
v_accvgpr_read_b32 v244, a96
pa 108,240,28
s_waitcnt lgkmcnt(5)
ds_read_b128 v[132:135], v124 offset:448
v_accvgpr_read_b32 v245, a97
v_accvgpr_read_b32 v246, a100
v_accvgpr_read_b32 v247, a101
pa 108,236,24
v_accvgpr_read_b32 v248, a104
v_accvgpr_read_b32 v249, a105
pb 80,136,180
s_nop 2
pb 80,140,184
pb 112,148,184
v_accvgpr_read_b32 v250, a108
v_accvgpr_read_b32 v251, a109
pb 112,144,180
pa 88,152,180
pa 88,156,184
s_waitcnt lgkmcnt(0)
v_fma_f32 v244, v244, v128, v132
v_fma_f32 v245, v245, v129, v133
v_fma_f32 v246, v246, v128, v132
v_fma_f32 v247, v247, v129, v133
cv 244,244,246
v_pk_fma_f32 v[248:249], v[248:249], v[128:129], v[132:133]
v_pk_fma_f32 v[250:251], v[250:251], v[128:129], v[132:133]
cv 246,245,247
cv 245,248,250
cv 247,249,251
pa 120,164,184
ds_write_b64 v120, v[244:245] offset:2048
pa 120,160,180
ds_write_b64 v120, v[246:247] offset:2176
v_accvgpr_read_b32 v244, a98
v_accvgpr_read_b32 v245, a99
v_accvgpr_read_b32 v246, a102
v_accvgpr_read_b32 v247, a103
v_pk_fma_f32 v[244:245], v[244:245], v[130:131], v[134:135]
v_pk_fma_f32 v[246:247], v[246:247], v[130:131], v[134:135]
v_accvgpr_read_b32 v248, a106
v_accvgpr_read_b32 v249, a107
v_accvgpr_read_b32 v250, a110
v_accvgpr_read_b32 v251, a111
cv 244,244,246
v_pk_fma_f32 v[248:249], v[248:249], v[130:131], v[134:135]
v_pk_fma_f32 v[250:251], v[250:251], v[130:131], v[134:135]
cv 246,245,247
cv 245,248,250
cv 247,249,251
pa 152,168,180
ds_write_b64 v120, v[244:245] offset:2304
pa 152,172,184
ds_write_b64 v120, v[246:247] offset:2432
pa 156,172,192
ds_read_b64_tr_b16 v[228:229], v121 offset:2048
pa 156,168,188
ds_read_b64_tr_b16 v[230:231], v121 offset:2080
pa 124,160,188
ds_read_b64_tr_b16 v[232:233], v121 offset:3072
pa 124,164,192
ds_read_b64_tr_b16 v[234:235], v121 offset:3104
pa 92,156,192
lv 180,10,49152
pa 92,152,188
lv 182,10,53248
pb 116,144,188
lv 184,10,57344
pb 116,148,192
lv 186,10,61440
pb 84,140,192
s_waitcnt lgkmcnt(6)
buffer_store_dwordx4 v[228:231], v122, s[16:19], s38 offen offset:0 sc0 sc1
lv 192,11,57344
lv 194,11,61440
pb 84,136,188
lv 188,11,49152
v_smfmac_f32_16x16x64_bf16 a[160:163], a[172:175], v[136:143], v14
lv 190,11,53248
v_smfmac_f32_16x16x64_bf16 a[160:163], a[176:179], v[144:151], v14
s_waitcnt lgkmcnt(7)
buffer_store_dwordx4 v[232:235], v122, s[16:19], s38 offen offset:2048 sc0 sc1
ds_read_b128 v[128:131], v124 offset:512
ds_read_b128 v[132:135], v124 offset:576
s_add_u32 s38, s26, 8192
v_smfmac_f32_16x16x64_bf16 a[164:167], a[172:175], v[152:159], v14
ds_read_b128 v[152:155], v124 offset:384
pa 144,208,32
ds_read_b128 v[156:159], v124 offset:448
pa 144,212,36
s_nop 2
pa 148,212,44
s_nop 2
pa 148,208,40
v_accvgpr_read_b32 v136, a144
v_accvgpr_read_b32 v137, a145
qb 32,196,244,44
v_accvgpr_read_b32 v144, a146
v_accvgpr_read_b32 v145, a147
qb 32,200,248,32
s_waitcnt lgkmcnt(2)
v_fma_f32 v136, v136, v128, v132
v_fma_f32 v137, v137, v129, v133
qb 32,204,252,32
v_accvgpr_read_b32 v138, a148
v_accvgpr_read_b32 v139, a149
pw 32,208,216
v_accvgpr_read_b32 v146, a150
v_accvgpr_read_b32 v147, a151
pa 112,236,32
v_fma_f32 v138, v138, v128, v132
v_fma_f32 v139, v139, v129, v133
pa 112,240,36
v_fma_f32 v144, v144, v130, v134
v_fma_f32 v145, v145, v131, v135
pa 116,240,44
v_fma_f32 v146, v146, v130, v134
v_fma_f32 v147, v147, v131, v135
pa 116,236,40
cv 136,136,138
cv 144,144,146
v_mfma_f32_16x16x32_bf16 v[16:19], v[176:179], a[244:247], v[44:47]
cv 138,137,139
cv 146,145,147
pb 16,180,248
ex 32
pb 16,184,252
ex 33
v_mfma_f32_16x16x32_bf16 v[16:19], v[188:191], v[216:219], v[16:19]
ex 34
pa 152,208,180
ex 35
pa 152,212,184
cv 220,32,33
cv 221,34,35
pa 156,212,192
s_nop 2
pa 156,208,188
ex 16
v_mfma_f32_16x16x32_bf16 v[20:23], v[192:195], a[244:247], v[44:47]
v_accvgpr_read_b32 v140, a152
v_accvgpr_read_b32 v141, a153
pb 20,196,248
v_accvgpr_read_b32 v148, a154
v_accvgpr_read_b32 v149, a155
pb 20,200,252
v_accvgpr_read_b32 v142, a156
v_accvgpr_read_b32 v143, a157
v_mfma_f32_16x16x32_bf16 v[20:23], v[204:207], v[216:219], v[20:23]
v_accvgpr_read_b32 v150, a158
v_accvgpr_read_b32 v151, a159
pa 120,236,180
ex 17
ex 18
ex 19
v_pk_fma_f32 v[140:141], v[140:141], v[128:129], v[132:133]
v_pk_fma_f32 v[142:143], v[142:143], v[128:129], v[132:133]
v_pk_fma_f32 v[148:149], v[148:149], v[130:131], v[134:135]
v_pk_fma_f32 v[150:151], v[150:151], v[130:131], v[134:135]
cv 137,140,142
cv 139,141,143
cv 145,148,150
cv 147,149,151
pa 120,240,184
ds_write_b64 v120, v[136:137] offset:16384
pa 124,240,192
ds_write_b64 v120, v[138:139] offset:16512
pa 124,236,188
ds_write_b64 v120, v[144:145] offset:16640
qb 24,48,244,44
ds_write_b64 v120, v[146:147] offset:16768
qb 24,52,248,24
ds_read_b64_tr_b16 v[160:161], v121 offset:16384
v_accvgpr_read_b32 v136, a112
qb 24,56,252,24
ds_read_b64_tr_b16 v[162:163], v121 offset:16416
v_accvgpr_read_b32 v137, a113
pw 24,60,216
ds_read_b64_tr_b16 v[164:165], v121 offset:17408
v_accvgpr_read_b32 v138, a116
qb 28,208,240,40
s_waitcnt lgkmcnt(6)
ds_read_b64_tr_b16 v[166:167], v121 offset:17440
v_accvgpr_read_b32 v139, a117
v_accvgpr_read_b32 v144, a114
v_accvgpr_read_b32 v145, a115
v_accvgpr_read_b32 v146, a118
v_accvgpr_read_b32 v147, a119
v_pk_fma_f32 v[136:137], v[136:137], v[152:153], v[156:157]
v_pk_fma_f32 v[138:139], v[138:139], v[152:153], v[156:157]
v_pk_fma_f32 v[144:145], v[144:145], v[154:155], v[158:159]
v_pk_fma_f32 v[146:147], v[146:147], v[154:155], v[158:159]
v_accvgpr_read_b32 v140, a120
v_accvgpr_read_b32 v141, a121
v_accvgpr_read_b32 v142, a124
v_accvgpr_read_b32 v143, a125
cv 136,136,138
v_accvgpr_read_b32 v148, a122
v_accvgpr_read_b32 v149, a123
v_accvgpr_read_b32 v150, a126
v_accvgpr_read_b32 v151, a127
cv 144,144,146
v_pk_fma_f32 v[140:141], v[140:141], v[152:153], v[156:157]
v_pk_fma_f32 v[142:143], v[142:143], v[152:153], v[156:157]
cv 138,137,139
v_pk_fma_f32 v[148:149], v[148:149], v[154:155], v[158:159]
v_pk_fma_f32 v[150:151], v[150:151], v[154:155], v[158:159]
cv 146,145,147
cv 137,140,142
cv 139,141,143
cv 145,148,150
cv 147,149,151
qb 28,204,236,28
ds_write_b64 v120, v[136:137] offset:18432
qb 28,200,232,28
ds_write_b64 v120, v[138:139] offset:18560
qb 28,196,228,28
s_waitcnt lgkmcnt(2)
ds_write_b64 v120, v[144:145] offset:18688
ds_write_b64 v120, v[146:147] offset:18816
buffer_store_dwordx4 v[160:163], v122, s[16:19], s39 offen offset:128 sc0 sc1
ex 20
ex 21
ex 22
ex 23
ex 24
ex 25
ex 26
ex 27
buffer_store_dwordx4 v[164:167], v122, s[16:19], s39 offen offset:2176 sc0 sc1
ds_read_b64_tr_b16 v[168:169], v121 offset:18432
ds_read_b64_tr_b16 v[170:171], v121 offset:18464
cv 222,16,17
cv 223,18,19
cv 224,20,21
cv 225,22,23
ds_read_b64_tr_b16 v[172:173], v121 offset:19456
ds_read_b64_tr_b16 v[174:175], v121 offset:19488
cv 226,24,25
cv 227,26,27
ex 28
ex 29
v_smfmac_f32_16x16x64_bf16 a[164:167], a[172:175], v[220:227], v14
s_add_u32 s39, s26, 4096
cv 208,28,29
pa 64,220,0
ex 30
pa 64,224,4
ex 31
pa 68,224,12
s_waitcnt lgkmcnt(2)
buffer_store_dwordx4 v[168:171], v122, s[16:19], s36 offen offset:128 sc0 sc1
v_accvgpr_read_b32 v126, a164
v_accvgpr_read_b32 v127, a165
v_add_f32 v126, v126, v127
v_cmp_nge_f32 s[42:43], s29, v126
pa 68,220,8
s_or_b64 s[32:33], s[32:33], s[42:43]
v_rcp_f32 v126, v126
v_mfma_f32_16x16x32_bf16 v[32:35], v[188:191], a[240:243], v[40:43]
v_mul_f32_e64 v127, -s41, v126
v_accvgpr_read_b32 v136, a64
pb 32,184,236
ds_write2_b32 v123, v126, v127 offset0:64 offset1:80
pb 32,180,232
s_waitcnt lgkmcnt(1)
buffer_store_dwordx4 v[172:175], v122, s[16:19], s36 offen offset:2176 sc0 sc1
ds_read_b128 v[128:131], v124 offset:256
ds_read_b128 v[132:135], v124 offset:320
v_accvgpr_read_b32 v137, a65
pb 32,176,228
s_add_u32 s36, s26, 4096
v_accvgpr_read_b32 v138, a68
v_accvgpr_read_b32 v139, a69
pa 72,220,16
v_accvgpr_read_b32 v144, a66
v_accvgpr_read_b32 v145, a67
pa 72,224,20
v_accvgpr_read_b32 v146, a70
v_accvgpr_read_b32 v147, a71
pa 76,224,28
ex 32
pa 76,220,24
ex 33
v_mfma_f32_16x16x32_bf16 v[16:19], v[204:207], a[240:243], v[40:43]
ex 34
pb 16,200,236
s_waitcnt lgkmcnt(0)
v_fma_f32 v136, v136, v128, v132
v_fma_f32 v137, v137, v129, v133
pb 16,196,232
v_fma_f32 v138, v138, v128, v132
v_fma_f32 v139, v139, v129, v133
pb 16,192,228
v_accvgpr_read_b32 v140, a72
v_accvgpr_read_b32 v141, a73
v_accvgpr_read_b32 v142, a76
v_accvgpr_read_b32 v143, a77
cv 136,136,138
v_pk_fma_f32 v[144:145], v[144:145], v[130:131], v[134:135]
v_pk_fma_f32 v[146:147], v[146:147], v[130:131], v[134:135]
v_accvgpr_read_b32 v148, a74
v_accvgpr_read_b32 v149, a75
v_accvgpr_read_b32 v150, a78
v_accvgpr_read_b32 v151, a79
cv 144,144,146
pa 80,220,32
cv 138,137,139
cv 146,145,147
v_fma_f32 v140, v140, v128, v132
v_fma_f32 v141, v141, v129, v133
v_fma_f32 v142, v142, v128, v132
v_fma_f32 v143, v143, v129, v133
v_pk_fma_f32 v[148:149], v[148:149], v[130:131], v[134:135]
v_pk_fma_f32 v[150:151], v[150:151], v[130:131], v[134:135]
cv 137,140,142
cv 139,141,143
cv 145,148,150
cv 147,149,151
pa 80,224,36
ds_write_b64 v120, v[136:137] offset:0
pa 84,224,44
ds_write_b64 v120, v[138:139] offset:128
pa 84,220,40
ds_write_b64 v120, v[144:145] offset:256
qb 20,60,240,40
ds_write_b64 v120, v[146:147] offset:384
qb 20,56,236,20
ds_read_b64_tr_b16 v[160:161], v121 offset:0
v_accvgpr_read_b32 v136, a80
qb 20,52,232,20
ds_read_b64_tr_b16 v[162:163], v121 offset:32
v_accvgpr_read_b32 v137, a81
qb 20,48,228,20
ds_read_b64_tr_b16 v[164:165], v121 offset:1024
v_accvgpr_read_b32 v138, a84
pa 88,220,180
ds_read_b64_tr_b16 v[166:167], v121 offset:1056
v_accvgpr_read_b32 v139, a85
pa 88,224,184

LwY1_7:
s_cbranch_vccnz LwrY1
ex 35
pa 92,224,192
ex 16
pa 92,220,188
ex 17
qb 24,196,212,36
ex 18
qb 24,200,216,24
s_waitcnt lgkmcnt(2)
buffer_store_dwordx4 v[160:163], v122, s[16:19], s37 offen offset:0 sc0 sc1
ex 19
ex 20
qb 24,204,220,24
ex 21
ex 22
ex 23
v_accvgpr_read_b32 v144, a82
v_accvgpr_read_b32 v145, a83
v_accvgpr_read_b32 v146, a86
qb 24,208,224,24
s_waitcnt lgkmcnt(0)
buffer_store_dwordx4 v[164:167], v122, s[16:19], s37 offen offset:2048 sc0 sc1
v_accvgpr_read_b32 v147, a87
cv 209,30,31
cv 210,32,33
cv 211,34,35
cv 212,16,17
cv 213,18,19
cv 214,20,21
cv 215,22,23
v_pk_fma_f32 v[136:137], v[136:137], v[128:129], v[132:133]
v_pk_fma_f32 v[138:139], v[138:139], v[128:129], v[132:133]
v_pk_fma_f32 v[144:145], v[144:145], v[130:131], v[134:135]
v_pk_fma_f32 v[146:147], v[146:147], v[130:131], v[134:135]
v_accvgpr_read_b32 v140, a88
v_accvgpr_read_b32 v141, a89
v_accvgpr_read_b32 v142, a92
v_accvgpr_read_b32 v143, a93
cv 136,136,138
v_accvgpr_read_b32 v148, a90
v_accvgpr_read_b32 v149, a91
v_accvgpr_read_b32 v150, a94
v_accvgpr_read_b32 v151, a95
cv 144,144,146
v_smfmac_f32_16x16x64_bf16 a[160:163], a[176:179], v[208:215], v14
s_add_u32 s37, s26, 0
cv 138,137,139
cv 146,145,147
v_fma_f32 v140, v140, v128, v132
v_fma_f32 v141, v141, v129, v133
v_pk_fma_f32 v[142:143], v[142:143], v[128:129], v[132:133]
v_pk_fma_f32 v[148:149], v[148:149], v[130:131], v[134:135]
v_pk_fma_f32 v[150:151], v[150:151], v[130:131], v[134:135]
cv 137,140,142
cv 139,141,143
cv 145,148,150
cv 147,149,151
pb 88,208,0
ds_write_b64 v120, v[136:137] offset:2048
pb 88,212,4
ds_write_b64 v120, v[138:139] offset:2176
pb 92,212,12
ds_write_b64 v120, v[144:145] offset:2304
pb 92,208,8
ds_write_b64 v120, v[146:147] offset:2432
v_mfma_f32_16x16x32_bf16 v[28:31], v[176:179], a[212:215], v[36:39]
ds_read_b64_tr_b16 v[168:169], v121 offset:2048
v_accvgpr_read_b32 v126, a162
pb 28,180,216
ds_read_b64_tr_b16 v[170:171], v121 offset:2080
v_accvgpr_read_b32 v127, a163
pb 28,184,220
ds_read_b64_tr_b16 v[172:173], v121 offset:3072
v_add_f32 v126, v126, v127
pb 28,188,224
ds_read_b64_tr_b16 v[174:175], v121 offset:3104
v_cmp_nge_f32 s[42:43], s29, v126
v_rcp_f32 v126, v126
pb 96,208,16
s_or_b64 s[32:33], s[32:33], s[42:43]
v_mul_f32_e64 v127, -s41, v126
pb 96,212,20
ds_write2_b32 v123, v126, v127 offset0:32 offset1:48
pb 100,212,28
ds_read_b128 v[152:155], v124 offset:128
pb 100,208,24
ds_read_b128 v[156:159], v124 offset:192
v_mfma_f32_16x16x32_bf16 v[32:35], v[192:195], a[212:215], v[36:39]
s_waitcnt lgkmcnt(5)
buffer_store_dwordx4 v[168:171], v122, s[16:19], s38 offen offset:128 sc0 sc1
ex 24
ex 25
pb 32,196,216
ex 26
pb 32,200,220
ex 27
pb 32,204,224
ex 28
pb 104,208,32
s_waitcnt lgkmcnt(0)
buffer_store_dwordx4 v[172:175], v122, s[16:19], s38 offen offset:2176 sc0 sc1
ex 29
ex 30
v_pk_fma_f32 v[88:89], v[88:89], v[152:153], v[156:157]
v_pk_fma_f32 v[92:93], v[92:93], v[152:153], v[156:157]
v_pk_fma_f32 v[96:97], v[96:97], v[152:153], v[156:157]
v_pk_fma_f32 v[100:101], v[100:101], v[152:153], v[156:157]
v_pk_fma_f32 v[90:91], v[90:91], v[154:155], v[158:159]
v_pk_fma_f32 v[94:95], v[94:95], v[154:155], v[158:159]
v_pk_fma_f32 v[98:99], v[98:99], v[154:155], v[158:159]
v_pk_fma_f32 v[102:103], v[102:103], v[154:155], v[158:159]
cv 136,88,92
cv 138,89,93
cv 137,96,100
cv 139,97,101
cv 144,90,94
cv 146,91,95
cv 145,98,102
cv 147,99,103
pb 104,212,36
s_add_u32 s38, s26, 0
ds_write_b64 v120, v[136:137] offset:16384
pb 108,212,44
ds_write_b64 v120, v[138:139] offset:16512
pb 108,208,40
ds_write_b64 v120, v[144:145] offset:16640
qb 16,48,212,36
ds_write_b64 v120, v[146:147] offset:16768
qb 16,52,216,16
ds_read_b64_tr_b16 v[160:161], v121 offset:16384
cv 236,24,25
qb 16,56,220,16
ds_read_b64_tr_b16 v[162:163], v121 offset:16416
cv 237,26,27
qb 16,60,224,16
ds_read_b64_tr_b16 v[164:165], v121 offset:17408
cv 238,28,29
pb 112,208,180
ds_read_b64_tr_b16 v[166:167], v121 offset:17440
v_fma_f32 v104, v104, v152, v156
pb 112,212,184
v_fma_f32 v105, v105, v153, v157
v_fma_f32 v108, v108, v152, v156
v_fma_f32 v109, v109, v153, v157
cv 136,104,108
cv 138,105,109
v_pk_fma_f32 v[106:107], v[106:107], v[154:155], v[158:159]
v_pk_fma_f32 v[110:111], v[110:111], v[154:155], v[158:159]
cv 144,106,110
v_pk_fma_f32 v[112:113], v[112:113], v[152:153], v[156:157]
v_pk_fma_f32 v[114:115], v[114:115], v[154:155], v[158:159]
cv 146,107,111
ex 31
pb 116,212,192
ex 32
pb 116,208,188
s_waitcnt lgkmcnt(0)
buffer_store_dwordx4 v[160:163], v122, s[16:19], s39 offen offset:0 sc0 sc1
ex 33
ex 34
ex 35
ex 16
ex 17
ex 18
ex 19
v_pk_fma_f32 v[116:117], v[116:117], v[152:153], v[156:157]
v_pk_fma_f32 v[118:119], v[118:119], v[154:155], v[158:159]
cv 137,112,116
cv 139,113,117
cv 145,114,118
cv 147,115,119
ds_write_b64 v120, v[136:137] offset:18432
ds_write_b64 v120, v[138:139] offset:18560
ds_write_b64 v120, v[144:145] offset:18688
ds_write_b64 v120, v[146:147] offset:18816
buffer_store_dwordx4 v[164:167], v122, s[16:19], s39 offen offset:2048 sc0 sc1
cv 239,30,31
cv 240,32,33
cv 241,34,35
cv 242,16,17
cv 243,18,19
ds_read_b64_tr_b16 v[168:169], v121 offset:18432
ds_read_b64_tr_b16 v[170:171], v121 offset:18464
v_smfmac_f32_16x16x64_bf16 a[160:163], a[172:175], v[236:243], v14
ds_read_b64_tr_b16 v[172:173], v121 offset:19456
pb 56,236,0
ds_read_b64_tr_b16 v[174:175], v121 offset:19488
s_nop 0
pb 56,240,4
s_nop 1
pb 60,240,12
v_accvgpr_read_b32 v126, a160
v_accvgpr_read_b32 v127, a161
v_add_f32 v126, v126, v127
v_cmp_nge_f32 s[42:43], s29, v126
v_rcp_f32 v126, v126
pb 60,236,8
s_or_b64 s[32:33], s[32:33], s[42:43]
v_mul_f32_e64 v127, -s41, v126
pb 64,236,16
ds_write2_b32 v123, v126, v127 offset0:0 offset1:16
pb 64,240,20
ds_read_b128 v[128:131], v124 offset:0
pb 68,240,28
ds_read_b128 v[132:135], v124 offset:64
pb 68,236,24
s_waitcnt lgkmcnt(3)
buffer_store_dwordx4 v[168:171], v122, s[16:19], s36 offen offset:128 sc0 sc1
pb 72,236,32
buffer_store_dwordx4 v[172:175], v122, s[16:19], s36 offen offset:2176 sc0 sc1
pb 72,240,36
pb 76,240,44
pb 76,236,40
pb 80,236,180
s_waitcnt lgkmcnt(0)
v_fma_f32 v56, v56, v128, v132
v_fma_f32 v57, v57, v129, v133
v_fma_f32 v60, v60, v128, v132
v_fma_f32 v61, v61, v129, v133
cv 136,56,60
v_pk_fma_f32 v[64:65], v[64:65], v[128:129], v[132:133]
v_pk_fma_f32 v[68:69], v[68:69], v[128:129], v[132:133]
v_pk_fma_f32 v[58:59], v[58:59], v[130:131], v[134:135]
v_pk_fma_f32 v[62:63], v[62:63], v[130:131], v[134:135]
v_pk_fma_f32 v[66:67], v[66:67], v[130:131], v[134:135]
v_pk_fma_f32 v[70:71], v[70:71], v[130:131], v[134:135]
cv 138,57,61
cv 137,64,68
cv 139,65,69
cv 144,58,62
cv 146,59,63
cv 145,66,70
cv 147,67,71
pb 80,240,184
ds_write_b64 v120, v[136:137] offset:0
pb 84,240,192
ds_write_b64 v120, v[138:139] offset:128
pb 84,236,188
s_waitcnt lgkmcnt(1)
ds_write_b64 v120, v[144:145] offset:256
ds_write_b64 v120, v[146:147] offset:384
v_pk_fma_f32 v[72:73], v[72:73], v[128:129], v[132:133]
v_pk_fma_f32 v[76:77], v[76:77], v[128:129], v[132:133]
v_pk_fma_f32 v[80:81], v[80:81], v[128:129], v[132:133]
v_pk_fma_f32 v[74:75], v[74:75], v[130:131], v[134:135]
v_pk_fma_f32 v[78:79], v[78:79], v[130:131], v[134:135]
v_pk_fma_f32 v[82:83], v[82:83], v[130:131], v[134:135]
v_pk_fma_f32 v[84:85], v[84:85], v[128:129], v[132:133]
v_pk_fma_f32 v[86:87], v[86:87], v[130:131], v[134:135]
cv 136,72,76
cv 138,73,77
cv 137,80,84
cv 139,81,85
cv 144,74,78
cv 146,75,79
cv 145,82,86
cv 147,83,87
ds_write_b64 v120, v[136:137] offset:2048
ds_write_b64 v120, v[138:139] offset:2176
ds_write_b64 v120, v[144:145] offset:2304
ds_write_b64 v120, v[146:147] offset:2432
ds_read_b64_tr_b16 v[160:161], v121 offset:0
ds_read_b64_tr_b16 v[162:163], v121 offset:32
ds_read_b64_tr_b16 v[164:165], v121 offset:1024
ds_read_b64_tr_b16 v[166:167], v121 offset:1056
ds_read_b64_tr_b16 v[168:169], v121 offset:2048
ds_read_b64_tr_b16 v[170:171], v121 offset:2080
ds_read_b64_tr_b16 v[172:173], v121 offset:3072
ds_read_b64_tr_b16 v[174:175], v121 offset:3104
s_waitcnt lgkmcnt(6)
buffer_store_dwordx4 v[160:163], v122, s[16:19], s37 offen offset:0 sc0 sc1
s_waitcnt lgkmcnt(4)
buffer_store_dwordx4 v[164:167], v122, s[16:19], s37 offen offset:2048 sc0 sc1
s_waitcnt lgkmcnt(2)
buffer_store_dwordx4 v[168:171], v122, s[16:19], s38 offen offset:128 sc0 sc1
s_waitcnt lgkmcnt(0)
buffer_store_dwordx4 v[172:175], v122, s[16:19], s38 offen offset:2176 sc0 sc1
Lfin1:
s_or_b64 s[36:37], s[30:31], s[32:33]
s_cbranch_scc1 Lslow
s_endpgm
LsY1:
ds_read_b32 v255, v12 offset:1024
s_waitcnt lgkmcnt(0)
v_cmp_gt_u32 vcc, 1, v255
s_nop 0
s_cbranch_vccnz LsY1
s_branch LrY1
LsY2:
ds_read_b32 v255, v12 offset:1024
s_waitcnt lgkmcnt(0)
v_cmp_gt_u32 vcc, 2, v255
s_nop 0
s_cbranch_vccnz LsY2
s_branch LrY2
LsY3:
ds_read_b32 v255, v12 offset:1024
s_waitcnt lgkmcnt(0)
v_cmp_gt_u32 vcc, 3, v255
s_nop 0
s_cbranch_vccnz LsY3
s_branch LrY3
LsY4:
ds_read_b32 v255, v12 offset:1024
s_waitcnt lgkmcnt(0)
v_cmp_gt_u32 vcc, 4, v255
s_nop 0
s_cbranch_vccnz LsY4
s_branch LrY4
LsY5:
ds_read_b32 v255, v12 offset:1024
s_waitcnt lgkmcnt(0)
v_cmp_gt_u32 vcc, 5, v255
s_nop 0
s_cbranch_vccnz LsY5
s_branch LrY5
LsY6:
ds_read_b32 v255, v12 offset:1024
s_waitcnt lgkmcnt(0)
v_cmp_gt_u32 vcc, 6, v255
s_nop 0
s_cbranch_vccnz LsY6
s_branch LrY6
LsY7:
ds_read_b32 v255, v12 offset:1024
s_waitcnt lgkmcnt(0)
v_cmp_gt_u32 vcc, 7, v255
s_nop 0
s_cbranch_vccnz LsY7
s_branch LrY7
LsY8:
ds_read_b32 v255, v12 offset:1024
s_waitcnt lgkmcnt(0)
v_cmp_gt_u32 vcc, 8, v255
s_nop 0
s_cbranch_vccnz LsY8
s_branch LrY8
LsY9:
ds_read_b32 v255, v12 offset:1024
s_waitcnt lgkmcnt(0)
v_cmp_gt_u32 vcc, 9, v255
s_nop 0
s_cbranch_vccnz LsY9
s_branch LrY9
LsY10:
ds_read_b32 v255, v12 offset:1024
s_waitcnt lgkmcnt(0)
v_cmp_gt_u32 vcc, 10, v255
s_nop 0
s_cbranch_vccnz LsY10
s_branch LrY10
LsY11:
ds_read_b32 v255, v12 offset:1024
s_waitcnt lgkmcnt(0)
v_cmp_gt_u32 vcc, 11, v255
s_nop 0
s_cbranch_vccnz LsY11
s_branch LrY11
LsY12:
ds_read_b32 v255, v12 offset:1024
s_waitcnt lgkmcnt(0)
v_cmp_gt_u32 vcc, 12, v255
s_nop 0
s_cbranch_vccnz LsY12
s_branch LrY12
LsY13:
ds_read_b32 v255, v12 offset:1024
s_waitcnt lgkmcnt(0)
v_cmp_gt_u32 vcc, 13, v255
s_nop 0
s_cbranch_vccnz LsY13
s_branch LrY13
LsY14:
ds_read_b32 v255, v12 offset:1024
s_waitcnt lgkmcnt(0)
v_cmp_gt_u32 vcc, 14, v255
s_nop 0
s_cbranch_vccnz LsY14
s_branch LrY14
LsY15:
ds_read_b32 v255, v12 offset:1024
s_waitcnt lgkmcnt(0)
v_cmp_gt_u32 vcc, 15, v255
s_nop 0
s_cbranch_vccnz LsY15
s_branch LrY15
LsY16:
ds_read_b32 v255, v12 offset:1024
s_waitcnt lgkmcnt(0)
v_cmp_gt_u32 vcc, 16, v255
s_nop 0
s_cbranch_vccnz LsY16
s_branch LrY16
LsY17:
ds_read_b32 v255, v12 offset:1024
s_waitcnt lgkmcnt(0)
v_cmp_gt_u32 vcc, 17, v255
s_nop 0
s_cbranch_vccnz LsY17
s_branch LrY17
LsY18:
ds_read_b32 v255, v12 offset:1024
s_waitcnt lgkmcnt(0)
v_cmp_gt_u32 vcc, 18, v255
s_nop 0
s_cbranch_vccnz LsY18
s_branch LrY18
LsY19:
ds_read_b32 v255, v12 offset:1024
s_waitcnt lgkmcnt(0)
v_cmp_gt_u32 vcc, 19, v255
s_nop 0
s_cbranch_vccnz LsY19
s_branch LrY19
LsY20:
ds_read_b32 v255, v12 offset:1024
s_waitcnt lgkmcnt(0)
v_cmp_gt_u32 vcc, 20, v255
s_nop 0
s_cbranch_vccnz LsY20
s_branch LrY20
LsY21:
ds_read_b32 v255, v12 offset:1024
s_waitcnt lgkmcnt(0)
v_cmp_gt_u32 vcc, 21, v255
s_nop 0
s_cbranch_vccnz LsY21
s_branch LrY21
LsY22:
ds_read_b32 v255, v12 offset:1024
s_waitcnt lgkmcnt(0)
v_cmp_gt_u32 vcc, 22, v255
s_nop 0
s_cbranch_vccnz LsY22
s_branch LrY22
LsY23:
ds_read_b32 v255, v12 offset:1024
s_waitcnt lgkmcnt(0)
v_cmp_gt_u32 vcc, 23, v255
s_nop 0
s_cbranch_vccnz LsY23
s_branch LrY23
LsY24:
ds_read_b32 v255, v12 offset:1024
s_waitcnt lgkmcnt(0)
v_cmp_gt_u32 vcc, 24, v255
s_nop 0
s_cbranch_vccnz LsY24
s_branch LrY24
LsY25:
ds_read_b32 v255, v12 offset:1024
s_waitcnt lgkmcnt(0)
v_cmp_gt_u32 vcc, 25, v255
s_nop 0
s_cbranch_vccnz LsY25
s_branch LrY25
LsY26:
ds_read_b32 v255, v12 offset:1024
s_waitcnt lgkmcnt(0)
v_cmp_gt_u32 vcc, 26, v255
s_nop 0
s_cbranch_vccnz LsY26
s_branch LrY26
LsY27:
ds_read_b32 v255, v12 offset:1024
s_waitcnt lgkmcnt(0)
v_cmp_gt_u32 vcc, 27, v255
s_nop 0
s_cbranch_vccnz LsY27
s_branch LrY27
LsY28:
ds_read_b32 v255, v12 offset:1024
s_waitcnt lgkmcnt(0)
v_cmp_gt_u32 vcc, 28, v255
s_nop 0
s_cbranch_vccnz LsY28
s_branch LrY28
LsY29:
ds_read_b32 v255, v12 offset:1024
s_waitcnt lgkmcnt(0)
v_cmp_gt_u32 vcc, 29, v255
s_nop 0
s_cbranch_vccnz LsY29
s_branch LrY29
Lcodeend:
s_endpgm
.section .rodata,"a"
.p2align 6
.amdhsa_kernel standalone__mha_softmax__near_ridge_kernel
  .amdhsa_next_free_vgpr 512
  .amdhsa_next_free_sgpr 102
  .amdhsa_accum_offset 256
  .amdhsa_group_segment_fixed_size 0
  .amdhsa_kernarg_size 48
  .amdhsa_user_sgpr_count 2
  .amdhsa_user_sgpr_kernarg_segment_ptr 1
  .amdhsa_system_sgpr_workgroup_id_x 1
  .amdhsa_float_denorm_mode_32 3
.end_amdhsa_kernel
```
